```python
import torch

def _softmax(x, axis=-1):
    return torch.softmax(x, dim=axis)

def _gelu(x):
    return torch.nn.functional.gelu(x, approximate='tanh')

def _silu(x):
    return torch.nn.functional.silu(x)

def _sigmoid(x):
    return torch.sigmoid(x)

def _layernorm(x, axis=-1, eps=1e-05):
    m = x.mean(dim=axis, keepdim=True)
    v = x.var(dim=axis, keepdim=True, unbiased=False)
    return (x - m) / torch.sqrt(v + eps)

def _scatter_add(tgt, idx, src, axis=0):
    return tgt.clone().index_add_(axis, idx, src)

def _segment_sum(src, seg, n):
    out = torch.zeros((n,) + src.shape[1:], dtype=src.dtype)
    return out.index_add_(0, seg, src)

def _pad(x, pw):
    flat = tuple((v for pair in reversed(pw) for v in pair))
    return torch.nn.functional.pad(x, flat)
kernel_name = 'gated_mix__memory_aug_recurrent_mem_tr__mixer_channel_mlp__prompt'

def setup_inputs():

    _w = lambda a: (lambda t: t.to(torch.bfloat16) if t.is_floating_point() else t)(torch.as_tensor(a))

    def _A_setup():
        B, S, Dm = (1, 2048, 1024)
        H, Dh = (32, 128)
        M, seg = (8, 32)
        seg = min(seg, S)
        S = S // seg * seg
        return {'x': _w((lambda *s: torch.randn(*s, dtype=torch.bfloat16) * 0.05)(B, S, Dm)), 'mem0': _w((lambda *s: torch.randn(*s, dtype=torch.bfloat16) * 0.8)(B, M, Dm)), 'Wq': _w((lambda *s: torch.randn(*s, dtype=torch.bfloat16) * 3.2)(Dm, H, Dh) * Dm ** (-0.5)), 'Wk': _w((lambda *s: torch.randn(*s, dtype=torch.bfloat16) * 3.2)(Dm, H, Dh) * Dm ** (-0.5)), 'Wv': _w((lambda *s: torch.randn(*s, dtype=torch.bfloat16) * 0.8)(Dm, H, Dh) * Dm ** (-0.5)), 'Wo': _w((lambda *s: torch.randn(*s, dtype=torch.bfloat16) * 0.8)(H, Dh, Dm) * (H * Dh) ** (-0.5)), 'seg_len': seg}
    _A_in = _A_setup()

    def _B_setup():
        B, S, D, F = (1, 2048, 1024, 3584)
        return {'x': _w((lambda *s: torch.randn(*s, dtype=torch.bfloat16) * 0.05)(B, S, D)), 'w1': _w((lambda *s: torch.randn(*s, dtype=torch.bfloat16) * 1.6)(D, F) * D ** (-0.5)), 'b1': _w((lambda *s: torch.randn(*s, dtype=torch.bfloat16) * 0.8)(F)), 'w2': _w((lambda *s: torch.randn(*s, dtype=torch.bfloat16) * 0.05)(F, D) * F ** (-0.5)), 'b2': _w((lambda *s: torch.randn(*s, dtype=torch.bfloat16) * 0.05)(D))}
    _B_in = _B_setup()
    return {'A_x': _A_in['x'], 'A_mem0': _A_in['mem0'], 'A_Wq': _A_in['Wq'], 'A_Wk': _A_in['Wk'], 'A_Wv': _A_in['Wv'], 'A_Wo': _A_in['Wo'], 'A_seg_len': _A_in['seg_len'], 'B_x': _B_in['x'], 'B_w1': _B_in['w1'], 'B_b1': _B_in['b1'], 'B_w2': _B_in['w2'], 'B_b2': _B_in['b2'], 'gate_w': _w((lambda *s: torch.randn(*s, dtype=torch.bfloat16) * 0.05)(1024) * 16.0)}

def reference(A_x, A_mem0, A_Wq, A_Wk, A_Wv, A_Wo, A_seg_len, B_x, B_w1, B_b1, B_w2, B_b2, gate_w):

    def _A_ref(x, mem0, Wq, Wk, Wv, Wo, seg_len):
        B, S, Dm = x.shape
        H, Dh = (Wq.shape[1], Wq.shape[2])
        M = mem0.shape[1]
        scale = Dh ** (-0.5)
        n_seg = S // seg_len
        L = M + seg_len
        idx = torch.arange(L)
        mask = (idx[:, None] < M) | (idx[:, None] >= idx[None, :])
        mem = mem0
        outs = []
        for s in range(n_seg):
            xs = x[:, s * seg_len:(s + 1) * seg_len, :].clone()
            h = torch.concatenate([mem, xs], axis=1)
            q = torch.einsum('btd,dhe->bhte', h, Wq)
            k = torch.einsum('btd,dhe->bhte', h, Wk)
            v = torch.einsum('btd,dhe->bhte', h, Wv)
            scores = torch.einsum('bhqe,bhke->bhqk', q, k) * scale
            scores = torch.where(mask[None, None], scores, -1000000000.0)
            p = _softmax(scores, axis=-1)
            o = torch.einsum('bhqk,bhke->bhqe', p, v)
            o = torch.einsum('bhte,hed->btd', o, Wo)
            mem = o[:, :M, :].clone()
            outs.append(o[:, M:, :])
        return torch.concatenate(outs, axis=1)

    def _B_ref(x, w1, b1, w2, b2):
        y = _layernorm(x, axis=-1)
        h = _gelu(torch.einsum('bsd,df->bsf', y, w1) + b1)
        return torch.einsum('bsf,fd->bsd', h, w2) + b2
    x = A_x
    g = _sigmoid((x * gate_w).sum(-1, keepdims=True))
    a = _A_ref(x, A_mem0, A_Wq, A_Wk, A_Wv, A_Wo, A_seg_len)
    b = _B_ref(x, B_w1, B_b1, B_w2, B_b2)
    return g * a + (1 - g) * b
```

```asm
; @launch grid=(256,1,1) block=(256,1,1) lds=163840
.amdgcn_target "amdgcn-amd-amdhsa--gfx950"
.text
.globl gated_mix__memory_aug_recurrent_mem_tr__mixer_channel_mlp__prompt_kernel
.p2align 8
.type gated_mix__memory_aug_recurrent_mem_tr__mixer_channel_mlp__prompt_kernel,@function
gated_mix__memory_aug_recurrent_mem_tr__mixer_channel_mlp__prompt_kernel:
  s_load_dwordx16 s[64:79], s[0:1], 0
  s_load_dwordx16 s[80:95], s[0:1], 64
  v_and_b32 v1, 63, v0
  v_lshrrev_b32 v2, 6, v0
  s_mov_b32 s50, 0x40000
  v_readfirstlane_b32 s23, v2
  s_waitcnt lgkmcnt(0)
  s_add_u32 s94, s94, 0x1fffff
  s_addc_u32 s95, s95, 0
  s_and_b32 s94, s94, 0xffe00000
  s_add_u32 s4, s94, 0
  s_addc_u32 s5, s95, 0
  s_mov_b32 s6, 266338304
  s_mov_b32 s7, 0x20000
  s_add_u32 s8, s92, 0
  s_addc_u32 s9, s93, 0
  s_mov_b32 s10, 256
  s_mov_b32 s11, 0x20000
  s_getreg_b32 s44, hwreg(HW_REG_XCC_ID)
  s_and_b32 s44, s44, 7
  s_lshl_b32 s26, s44, 3
  s_mov_b64 s[28:29], 1
  s_lshl_b64 s[28:29], s[28:29], s26
  s_cmp_lg_u32 s23, 0
  s_cbranch_scc1 .cen0
  v_mov_b32 v2, s28
  v_mov_b32 v3, s29
  s_mov_b64 exec, 1
  buffer_atomic_add_x2 v[2:3], off, s[8:11], 0 sc0 sc1
  v_mov_b32 v4, 0
  s_waitcnt vmcnt(0)
  ds_write_b64 v4, v[2:3]
  s_mov_b64 exec, -1
  s_waitcnt lgkmcnt(0)
.cen0:
  s_min_u32 s57, s2, 319
  s_lshl_b32 s57, s57, 7
  s_add_u32 s57, s57, 119537664
  s_cmp_lg_u32 s23, 2
  s_cbranch_scc1 .cen3
  v_mov_b32 v2, 0
  v_mov_b32 v3, 0
  buffer_store_dwordx2 v[2:3], off, s[4:7], s57 sc0 sc1
  s_waitcnt vmcnt(0)
.cen3:
  s_lshl_b32 s27, s44, 2
  s_or_b32 s27, s27, s23
  s_cmp_lg_u32 s27, 1
  s_cbranch_scc1 .cen1
  v_mov_b32 v2, -1
  s_mov_b32 s34, -1
  s_mov_b32 s35, -1
  s_and_b32 s36, s2, 0xf8
  s_lshl_b32 s36, s36, 5
  s_add_u32 s27, s36, 105512960
  s_memtime s[38:39]
  s_waitcnt lgkmcnt(0)
  buffer_store_dword v2, off, s[4:7], s27 sc1
  s_waitcnt vmcnt(0)
  s_memtime s[30:31]
  s_waitcnt lgkmcnt(0)
  s_sub_u32 s30, s30, s38
  s_min_u32 s34, s34, s30
  s_add_u32 s27, s36, 105521152
  s_memtime s[38:39]
  s_waitcnt lgkmcnt(0)
  buffer_store_dword v2, off, s[4:7], s27 sc1
  s_waitcnt vmcnt(0)
  s_memtime s[30:31]
  s_waitcnt lgkmcnt(0)
  s_sub_u32 s30, s30, s38
  s_min_u32 s35, s35, s30
  s_add_u32 s27, s36, 105512960
  s_memtime s[38:39]
  s_waitcnt lgkmcnt(0)
  buffer_store_dword v2, off, s[4:7], s27 sc1
  s_waitcnt vmcnt(0)
  s_memtime s[30:31]
  s_waitcnt lgkmcnt(0)
  s_sub_u32 s30, s30, s38
  s_min_u32 s34, s34, s30
  s_add_u32 s27, s36, 105521152
  s_memtime s[38:39]
  s_waitcnt lgkmcnt(0)
  buffer_store_dword v2, off, s[4:7], s27 sc1
  s_waitcnt vmcnt(0)
  s_memtime s[30:31]
  s_waitcnt lgkmcnt(0)
  s_sub_u32 s30, s30, s38
  s_min_u32 s35, s35, s30
  s_add_u32 s27, s36, 105512960
  s_memtime s[38:39]
  s_waitcnt lgkmcnt(0)
  buffer_store_dword v2, off, s[4:7], s27 sc1
  s_waitcnt vmcnt(0)
  s_memtime s[30:31]
  s_waitcnt lgkmcnt(0)
  s_sub_u32 s30, s30, s38
  s_min_u32 s34, s34, s30
  s_add_u32 s27, s36, 105521152
  s_memtime s[38:39]
  s_waitcnt lgkmcnt(0)
  buffer_store_dword v2, off, s[4:7], s27 sc1
  s_waitcnt vmcnt(0)
  s_memtime s[30:31]
  s_waitcnt lgkmcnt(0)
  s_sub_u32 s30, s30, s38
  s_min_u32 s35, s35, s30
  s_sub_u32 s35, s34, s35
.cen1:
  s_barrier
  v_mov_b32 v4, 0
  ds_read_b64 v[2:3], v4
  s_waitcnt lgkmcnt(0)
  v_sad_u8 v4, v2, 0, 0
  v_sad_u8 v4, v3, 0, v4
  v_readfirstlane_b32 s30, v2
  v_readfirstlane_b32 s31, v3
  v_readfirstlane_b32 s60, v4
  s_barrier
  s_cmp_ge_u32 s60, 256
  s_cbranch_scc1 .rec_end
  s_lshr_b64 s[32:33], s[30:31], s26
  s_and_b32 s45, s32, 255
  s_mov_b32 s61, 1
  s_cmp_lg_u32 s60, 255
  s_cbranch_scc1 .cen2
  s_add_u32 s30, s30, s28
  s_addc_u32 s31, s31, s29
  s_mov_b32 s32, 2
  s_cmp_eq_u32 s30, 0x20202020
  s_cselect_b32 s33, 1, 2
  s_cmp_eq_u32 s31, 0x20202020
  s_cselect_b32 s33, s33, 2
  s_lshl_b32 s33, s33, 16
  s_add_u32 s61, s61, s33
.cen2:
  s_or_b32 s26, s44, s45
  s_lshl2_add_u32 s26, s26, s23
  s_cmp_lg_u32 s26, 1
  s_cbranch_scc1 .pb1
  s_cmp_gt_i32 s35, 0
  s_cselect_b32 s33, 0x100000, 0
  s_add_u32 s61, s61, s33
.pb1:
  s_mov_b32 s62, 0
  s_mov_b32 s53, 0
  v_mov_b32 v96, 0
  s_cmp_ge_u32 s45, 32
  s_cbranch_scc1 .rec_pl
  s_cmp_ge_u32 s44, 4
  s_cbranch_scc1 .rec_pl
  s_cmp_lg_u32 s23, 1
  s_cbranch_scc1 .ar0
  v_mov_b32 v2, s61
  s_mov_b64 exec, 1
  buffer_atomic_add v2, off, s[8:11], 0 offset:128 sc0 sc1
  s_mov_b64 exec, -1
  s_waitcnt vmcnt(0)
  v_readfirstlane_b32 s27, v2
  s_add_u32 s27, s27, s61
  s_and_b32 s26, s27, 0xffff
  s_cmp_lg_u32 s26, 256
  s_cbranch_scc1 .ar0
  s_lshr_b32 s27, s27, 16
  v_mov_b32 v2, s27
  v_lshlrev_b32 v3, 7, v1
  s_mov_b32 s26, 119537664
  buffer_store_dword v2, v3, s[4:7], s26 offen sc0 sc1
  s_mov_b32 s26, 119545856
  buffer_store_dword v2, v3, s[4:7], s26 offen sc0 sc1
  s_mov_b32 s26, 119554048
  buffer_store_dword v2, v3, s[4:7], s26 offen sc0 sc1
  s_mov_b32 s26, 119562240
  buffer_store_dword v2, v3, s[4:7], s26 offen sc0 sc1
  s_mov_b32 s26, 119570432
  buffer_store_dword v2, v3, s[4:7], s26 offen sc0 sc1
.ar0:
.rec_ld:
  s_lshr_b32 s58, s45, 2
  s_lshl3_add_u32 s58, s44, s58
  s_lshl_b32 s26, s44, 5
  s_add_u32 s26, s26, s45
  s_lshl_b32 s26, s26, 6
  s_lshl_b32 s27, s23, 21
  s_add_u32 s26, s26, s27
  s_sub_u32 s27, 0x800000, s26
  s_add_u32 s12, s68, s26
  s_addc_u32 s13, s69, 0
  s_mov_b32 s14, s27
  s_mov_b32 s15, 0x20000
  s_add_u32 s16, s70, s26
  s_addc_u32 s17, s71, 0
  s_mov_b32 s18, s27
  s_mov_b32 s19, 0x20000
  s_add_u32 s36, s72, s26
  s_addc_u32 s37, s73, 0
  s_mov_b32 s38, s27
  s_mov_b32 s39, 0x20000
  s_lshl2_add_u32 s26, s44, s23
  s_lshl_b32 s26, s26, 19
  s_lshl_b32 s27, s45, 6
  s_add_u32 s26, s26, s27
  s_sub_u32 s27, 0x800000, s26
  s_add_u32 s40, s74, s26
  s_addc_u32 s41, s75, 0
  s_mov_b32 s42, s27
  s_mov_b32 s43, 0x20000
  v_lshrrev_b32 v2, 2, v1
  v_and_b32 v3, 3, v1
  v_lshlrev_b32 v4, 4, v3
  v_lshl_add_u32 v5, v2, 11, v4
  v_lshl_add_u32 v4, v2, 13, v4
  v_lshrrev_b32 v6, 5, v1
  v_lshlrev_b32 v6, 4, v6
  v_bfe_u32 v7, v1, 4, 1
  v_lshl_add_u32 v6, v7, 2, v6
  v_bfe_u32 v7, v1, 3, 1
  v_lshl_add_u32 v6, v7, 3, v6
  v_bfe_u32 v7, v1, 2, 1
  v_add_u32 v6, v6, v7
  v_lshlrev_b32 v6, 6, v6
  v_lshl_add_u32 v6, v3, 3, v6
  s_lshl_b32 s24, s23, 15
  v_add_u32 v6, s24, v6
  s_add_u32 m0, s24, 0
  s_mov_b32 s26, 0
  buffer_load_dwordx4 v4, s[12:15], s26 offen lds
  s_add_u32 m0, s24, 1024
  s_mov_b32 s26, 131072
  buffer_load_dwordx4 v4, s[12:15], s26 offen lds
  s_add_u32 m0, s24, 2048
  s_mov_b32 s26, 262144
  buffer_load_dwordx4 v4, s[12:15], s26 offen lds
  s_add_u32 m0, s24, 3072
  s_mov_b32 s26, 393216
  buffer_load_dwordx4 v4, s[12:15], s26 offen lds
  s_add_u32 m0, s24, 4096
  s_mov_b32 s26, 524288
  buffer_load_dwordx4 v4, s[12:15], s26 offen lds
  s_add_u32 m0, s24, 5120
  s_mov_b32 s26, 655360
  buffer_load_dwordx4 v4, s[12:15], s26 offen lds
  s_add_u32 m0, s24, 6144
  s_mov_b32 s26, 786432
  buffer_load_dwordx4 v4, s[12:15], s26 offen lds
  s_add_u32 m0, s24, 7168
  s_mov_b32 s26, 917504
  buffer_load_dwordx4 v4, s[12:15], s26 offen lds
  s_add_u32 m0, s24, 8192
  s_mov_b32 s26, 1048576
  buffer_load_dwordx4 v4, s[12:15], s26 offen lds
  s_add_u32 m0, s24, 9216
  s_mov_b32 s26, 1179648
  buffer_load_dwordx4 v4, s[12:15], s26 offen lds
  s_add_u32 m0, s24, 10240
  s_mov_b32 s26, 1310720
  buffer_load_dwordx4 v4, s[12:15], s26 offen lds
  s_add_u32 m0, s24, 11264
  s_mov_b32 s26, 1441792
  buffer_load_dwordx4 v4, s[12:15], s26 offen lds
  s_add_u32 m0, s24, 12288
  s_mov_b32 s26, 1572864
  buffer_load_dwordx4 v4, s[12:15], s26 offen lds
  s_add_u32 m0, s24, 13312
  s_mov_b32 s26, 1703936
  buffer_load_dwordx4 v4, s[12:15], s26 offen lds
  s_add_u32 m0, s24, 14336
  s_mov_b32 s26, 1835008
  buffer_load_dwordx4 v4, s[12:15], s26 offen lds
  s_add_u32 m0, s24, 15360
  s_mov_b32 s26, 1966080
  buffer_load_dwordx4 v4, s[12:15], s26 offen lds
  s_add_u32 m0, s24, 16384
  s_mov_b32 s26, 0
  buffer_load_dwordx4 v4, s[16:19], s26 offen lds
  s_add_u32 m0, s24, 17408
  s_mov_b32 s26, 131072
  buffer_load_dwordx4 v4, s[16:19], s26 offen lds
  s_add_u32 m0, s24, 18432
  s_mov_b32 s26, 262144
  buffer_load_dwordx4 v4, s[16:19], s26 offen lds
  s_add_u32 m0, s24, 19456
  s_mov_b32 s26, 393216
  buffer_load_dwordx4 v4, s[16:19], s26 offen lds
  s_add_u32 m0, s24, 20480
  s_mov_b32 s26, 524288
  buffer_load_dwordx4 v4, s[16:19], s26 offen lds
  s_add_u32 m0, s24, 21504
  s_mov_b32 s26, 655360
  buffer_load_dwordx4 v4, s[16:19], s26 offen lds
  s_add_u32 m0, s24, 22528
  s_mov_b32 s26, 786432
  buffer_load_dwordx4 v4, s[16:19], s26 offen lds
  s_add_u32 m0, s24, 23552
  s_mov_b32 s26, 917504
  buffer_load_dwordx4 v4, s[16:19], s26 offen lds
  s_add_u32 m0, s24, 24576
  s_mov_b32 s26, 1048576
  buffer_load_dwordx4 v4, s[16:19], s26 offen lds
  s_add_u32 m0, s24, 25600
  s_mov_b32 s26, 1179648
  buffer_load_dwordx4 v4, s[16:19], s26 offen lds
  s_add_u32 m0, s24, 26624
  s_mov_b32 s26, 1310720
  buffer_load_dwordx4 v4, s[16:19], s26 offen lds
  s_add_u32 m0, s24, 27648
  s_mov_b32 s26, 1441792
  buffer_load_dwordx4 v4, s[16:19], s26 offen lds
  s_add_u32 m0, s24, 28672
  s_mov_b32 s26, 1572864
  buffer_load_dwordx4 v4, s[16:19], s26 offen lds
  s_add_u32 m0, s24, 29696
  s_mov_b32 s26, 1703936
  buffer_load_dwordx4 v4, s[16:19], s26 offen lds
  s_add_u32 m0, s24, 30720
  s_mov_b32 s26, 1835008
  buffer_load_dwordx4 v4, s[16:19], s26 offen lds
  s_add_u32 m0, s24, 31744
  s_mov_b32 s26, 1966080
  buffer_load_dwordx4 v4, s[16:19], s26 offen lds
  s_waitcnt vmcnt(16)
  ds_read_b64_tr_b16 a[0:1], v6 offset:0
  ds_read_b64_tr_b16 a[2:3], v6 offset:128
  ds_read_b64_tr_b16 a[4:5], v6 offset:2048
  ds_read_b64_tr_b16 a[6:7], v6 offset:2176
  ds_read_b64_tr_b16 a[8:9], v6 offset:32
  ds_read_b64_tr_b16 a[10:11], v6 offset:160
  ds_read_b64_tr_b16 a[12:13], v6 offset:2080
  ds_read_b64_tr_b16 a[14:15], v6 offset:2208
  ds_read_b64_tr_b16 a[48:49], v6 offset:4096
  ds_read_b64_tr_b16 a[50:51], v6 offset:4224
  ds_read_b64_tr_b16 a[52:53], v6 offset:6144
  ds_read_b64_tr_b16 a[54:55], v6 offset:6272
  ds_read_b64_tr_b16 a[56:57], v6 offset:4128
  ds_read_b64_tr_b16 a[58:59], v6 offset:4256
  ds_read_b64_tr_b16 a[60:61], v6 offset:6176
  ds_read_b64_tr_b16 a[62:63], v6 offset:6304
  ds_read_b64_tr_b16 a[96:97], v6 offset:8192
  ds_read_b64_tr_b16 a[98:99], v6 offset:8320
  ds_read_b64_tr_b16 a[100:101], v6 offset:10240
  ds_read_b64_tr_b16 a[102:103], v6 offset:10368
  ds_read_b64_tr_b16 a[104:105], v6 offset:8224
  ds_read_b64_tr_b16 a[106:107], v6 offset:8352
  ds_read_b64_tr_b16 a[108:109], v6 offset:10272
  ds_read_b64_tr_b16 a[110:111], v6 offset:10400
  ds_read_b64_tr_b16 a[144:145], v6 offset:12288
  ds_read_b64_tr_b16 a[146:147], v6 offset:12416
  ds_read_b64_tr_b16 a[148:149], v6 offset:14336
  ds_read_b64_tr_b16 a[150:151], v6 offset:14464
  ds_read_b64_tr_b16 a[152:153], v6 offset:12320
  ds_read_b64_tr_b16 a[154:155], v6 offset:12448
  ds_read_b64_tr_b16 a[156:157], v6 offset:14368
  ds_read_b64_tr_b16 a[158:159], v6 offset:14496
  s_waitcnt lgkmcnt(0)
  s_add_u32 m0, s24, 0
  s_mov_b32 s26, 0
  buffer_load_dwordx4 v4, s[36:39], s26 offen lds
  s_add_u32 m0, s24, 1024
  s_mov_b32 s26, 131072
  buffer_load_dwordx4 v4, s[36:39], s26 offen lds
  s_add_u32 m0, s24, 2048
  s_mov_b32 s26, 262144
  buffer_load_dwordx4 v4, s[36:39], s26 offen lds
  s_add_u32 m0, s24, 3072
  s_mov_b32 s26, 393216
  buffer_load_dwordx4 v4, s[36:39], s26 offen lds
  s_add_u32 m0, s24, 4096
  s_mov_b32 s26, 524288
  buffer_load_dwordx4 v4, s[36:39], s26 offen lds
  s_add_u32 m0, s24, 5120
  s_mov_b32 s26, 655360
  buffer_load_dwordx4 v4, s[36:39], s26 offen lds
  s_add_u32 m0, s24, 6144
  s_mov_b32 s26, 786432
  buffer_load_dwordx4 v4, s[36:39], s26 offen lds
  s_add_u32 m0, s24, 7168
  s_mov_b32 s26, 917504
  buffer_load_dwordx4 v4, s[36:39], s26 offen lds
  s_add_u32 m0, s24, 8192
  s_mov_b32 s26, 1048576
  buffer_load_dwordx4 v4, s[36:39], s26 offen lds
  s_add_u32 m0, s24, 9216
  s_mov_b32 s26, 1179648
  buffer_load_dwordx4 v4, s[36:39], s26 offen lds
  s_add_u32 m0, s24, 10240
  s_mov_b32 s26, 1310720
  buffer_load_dwordx4 v4, s[36:39], s26 offen lds
  s_add_u32 m0, s24, 11264
  s_mov_b32 s26, 1441792
  buffer_load_dwordx4 v4, s[36:39], s26 offen lds
  s_add_u32 m0, s24, 12288
  s_mov_b32 s26, 1572864
  buffer_load_dwordx4 v4, s[36:39], s26 offen lds
  s_add_u32 m0, s24, 13312
  s_mov_b32 s26, 1703936
  buffer_load_dwordx4 v4, s[36:39], s26 offen lds
  s_add_u32 m0, s24, 14336
  s_mov_b32 s26, 1835008
  buffer_load_dwordx4 v4, s[36:39], s26 offen lds
  s_add_u32 m0, s24, 15360
  s_mov_b32 s26, 1966080
  buffer_load_dwordx4 v4, s[36:39], s26 offen lds
  s_waitcnt vmcnt(16)
  ds_read_b64_tr_b16 a[16:17], v6 offset:16384
  ds_read_b64_tr_b16 a[18:19], v6 offset:16512
  ds_read_b64_tr_b16 a[20:21], v6 offset:18432
  ds_read_b64_tr_b16 a[22:23], v6 offset:18560
  ds_read_b64_tr_b16 a[24:25], v6 offset:16416
  ds_read_b64_tr_b16 a[26:27], v6 offset:16544
  ds_read_b64_tr_b16 a[28:29], v6 offset:18464
  ds_read_b64_tr_b16 a[30:31], v6 offset:18592
  ds_read_b64_tr_b16 a[64:65], v6 offset:20480
  ds_read_b64_tr_b16 a[66:67], v6 offset:20608
  ds_read_b64_tr_b16 a[68:69], v6 offset:22528
  ds_read_b64_tr_b16 a[70:71], v6 offset:22656
  ds_read_b64_tr_b16 a[72:73], v6 offset:20512
  ds_read_b64_tr_b16 a[74:75], v6 offset:20640
  ds_read_b64_tr_b16 a[76:77], v6 offset:22560
  ds_read_b64_tr_b16 a[78:79], v6 offset:22688
  ds_read_b64_tr_b16 a[112:113], v6 offset:24576
  ds_read_b64_tr_b16 a[114:115], v6 offset:24704
  ds_read_b64_tr_b16 a[116:117], v6 offset:26624
  ds_read_b64_tr_b16 a[118:119], v6 offset:26752
  ds_read_b64_tr_b16 a[120:121], v6 offset:24608
  ds_read_b64_tr_b16 a[122:123], v6 offset:24736
  ds_read_b64_tr_b16 a[124:125], v6 offset:26656
  ds_read_b64_tr_b16 a[126:127], v6 offset:26784
  ds_read_b64_tr_b16 a[160:161], v6 offset:28672
  ds_read_b64_tr_b16 a[162:163], v6 offset:28800
  ds_read_b64_tr_b16 a[164:165], v6 offset:30720
  ds_read_b64_tr_b16 a[166:167], v6 offset:30848
  ds_read_b64_tr_b16 a[168:169], v6 offset:28704
  ds_read_b64_tr_b16 a[170:171], v6 offset:28832
  ds_read_b64_tr_b16 a[172:173], v6 offset:30752
  ds_read_b64_tr_b16 a[174:175], v6 offset:30880
  s_waitcnt lgkmcnt(0)
  s_add_u32 m0, s24, 16384
  s_mov_b32 s26, 0
  buffer_load_dwordx4 v5, s[40:43], s26 offen lds
  s_add_u32 m0, s24, 17408
  s_mov_b32 s26, 32768
  buffer_load_dwordx4 v5, s[40:43], s26 offen lds
  s_add_u32 m0, s24, 18432
  s_mov_b32 s26, 65536
  buffer_load_dwordx4 v5, s[40:43], s26 offen lds
  s_add_u32 m0, s24, 19456
  s_mov_b32 s26, 98304
  buffer_load_dwordx4 v5, s[40:43], s26 offen lds
  s_add_u32 m0, s24, 20480
  s_mov_b32 s26, 131072
  buffer_load_dwordx4 v5, s[40:43], s26 offen lds
  s_add_u32 m0, s24, 21504
  s_mov_b32 s26, 163840
  buffer_load_dwordx4 v5, s[40:43], s26 offen lds
  s_add_u32 m0, s24, 22528
  s_mov_b32 s26, 196608
  buffer_load_dwordx4 v5, s[40:43], s26 offen lds
  s_add_u32 m0, s24, 23552
  s_mov_b32 s26, 229376
  buffer_load_dwordx4 v5, s[40:43], s26 offen lds
  s_add_u32 m0, s24, 24576
  s_mov_b32 s26, 262144
  buffer_load_dwordx4 v5, s[40:43], s26 offen lds
  s_add_u32 m0, s24, 25600
  s_mov_b32 s26, 294912
  buffer_load_dwordx4 v5, s[40:43], s26 offen lds
  s_add_u32 m0, s24, 26624
  s_mov_b32 s26, 327680
  buffer_load_dwordx4 v5, s[40:43], s26 offen lds
  s_add_u32 m0, s24, 27648
  s_mov_b32 s26, 360448
  buffer_load_dwordx4 v5, s[40:43], s26 offen lds
  s_add_u32 m0, s24, 28672
  s_mov_b32 s26, 393216
  buffer_load_dwordx4 v5, s[40:43], s26 offen lds
  s_add_u32 m0, s24, 29696
  s_mov_b32 s26, 425984
  buffer_load_dwordx4 v5, s[40:43], s26 offen lds
  s_add_u32 m0, s24, 30720
  s_mov_b32 s26, 458752
  buffer_load_dwordx4 v5, s[40:43], s26 offen lds
  s_add_u32 m0, s24, 31744
  s_mov_b32 s26, 491520
  buffer_load_dwordx4 v5, s[40:43], s26 offen lds
  s_waitcnt vmcnt(16)
  ds_read_b64_tr_b16 a[32:33], v6 offset:0
  ds_read_b64_tr_b16 a[34:35], v6 offset:128
  ds_read_b64_tr_b16 a[36:37], v6 offset:2048
  ds_read_b64_tr_b16 a[38:39], v6 offset:2176
  ds_read_b64_tr_b16 a[40:41], v6 offset:32
  ds_read_b64_tr_b16 a[42:43], v6 offset:160
  ds_read_b64_tr_b16 a[44:45], v6 offset:2080
  ds_read_b64_tr_b16 a[46:47], v6 offset:2208
  ds_read_b64_tr_b16 a[80:81], v6 offset:4096
  ds_read_b64_tr_b16 a[82:83], v6 offset:4224
  ds_read_b64_tr_b16 a[84:85], v6 offset:6144
  ds_read_b64_tr_b16 a[86:87], v6 offset:6272
  ds_read_b64_tr_b16 a[88:89], v6 offset:4128
  ds_read_b64_tr_b16 a[90:91], v6 offset:4256
  ds_read_b64_tr_b16 a[92:93], v6 offset:6176
  ds_read_b64_tr_b16 a[94:95], v6 offset:6304
  ds_read_b64_tr_b16 a[128:129], v6 offset:8192
  ds_read_b64_tr_b16 a[130:131], v6 offset:8320
  ds_read_b64_tr_b16 a[132:133], v6 offset:10240
  ds_read_b64_tr_b16 a[134:135], v6 offset:10368
  ds_read_b64_tr_b16 a[136:137], v6 offset:8224
  ds_read_b64_tr_b16 a[138:139], v6 offset:8352
  ds_read_b64_tr_b16 a[140:141], v6 offset:10272
  ds_read_b64_tr_b16 a[142:143], v6 offset:10400
  ds_read_b64_tr_b16 a[176:177], v6 offset:12288
  ds_read_b64_tr_b16 a[178:179], v6 offset:12416
  ds_read_b64_tr_b16 a[180:181], v6 offset:14336
  ds_read_b64_tr_b16 a[182:183], v6 offset:14464
  ds_read_b64_tr_b16 a[184:185], v6 offset:12320
  ds_read_b64_tr_b16 a[186:187], v6 offset:12448
  ds_read_b64_tr_b16 a[188:189], v6 offset:14368
  ds_read_b64_tr_b16 a[190:191], v6 offset:14496
  s_waitcnt lgkmcnt(0)
  s_waitcnt vmcnt(0)
  ds_read_b64_tr_b16 a[192:193], v6 offset:16384
  ds_read_b64_tr_b16 a[194:195], v6 offset:16512
  ds_read_b64_tr_b16 a[196:197], v6 offset:18432
  ds_read_b64_tr_b16 a[198:199], v6 offset:18560
  ds_read_b64_tr_b16 a[200:201], v6 offset:16416
  ds_read_b64_tr_b16 a[202:203], v6 offset:16544
  ds_read_b64_tr_b16 a[204:205], v6 offset:18464
  ds_read_b64_tr_b16 a[206:207], v6 offset:18592
  ds_read_b64_tr_b16 a[208:209], v6 offset:20480
  ds_read_b64_tr_b16 a[210:211], v6 offset:20608
  ds_read_b64_tr_b16 a[212:213], v6 offset:22528
  ds_read_b64_tr_b16 a[214:215], v6 offset:22656
  ds_read_b64_tr_b16 a[216:217], v6 offset:20512
  ds_read_b64_tr_b16 a[218:219], v6 offset:20640
  ds_read_b64_tr_b16 a[220:221], v6 offset:22560
  ds_read_b64_tr_b16 a[222:223], v6 offset:22688
  ds_read_b64_tr_b16 a[224:225], v6 offset:24576
  ds_read_b64_tr_b16 a[226:227], v6 offset:24704
  ds_read_b64_tr_b16 a[228:229], v6 offset:26624
  ds_read_b64_tr_b16 a[230:231], v6 offset:26752
  ds_read_b64_tr_b16 a[232:233], v6 offset:24608
  ds_read_b64_tr_b16 a[234:235], v6 offset:24736
  ds_read_b64_tr_b16 a[236:237], v6 offset:26656
  ds_read_b64_tr_b16 a[238:239], v6 offset:26784
  ds_read_b64_tr_b16 a[240:241], v6 offset:28672
  ds_read_b64_tr_b16 a[242:243], v6 offset:28800
  ds_read_b64_tr_b16 a[244:245], v6 offset:30720
  ds_read_b64_tr_b16 a[246:247], v6 offset:30848
  ds_read_b64_tr_b16 a[248:249], v6 offset:28704
  ds_read_b64_tr_b16 a[250:251], v6 offset:28832
  ds_read_b64_tr_b16 a[252:253], v6 offset:30752
  ds_read_b64_tr_b16 a[254:255], v6 offset:30880
  s_waitcnt lgkmcnt(0)
  s_cmp_lg_u32 s53, 0
  s_cbranch_scc1 .rec_run
  s_branch .rec_nold
.rec_pl:
  s_sub_u32 s2, s44, 4
  s_lshl_b32 s2, s2, 5
  s_add_u32 s2, s2, s45
  s_and_b32 s2, s2, 127
  v_and_b32 v96, 7, v0
  v_lshrrev_b32 v97, 3, v0
  s_lshl_b32 s3, s2, 15
  s_lshl_b32 s2, s2, 1
  v_lshlrev_b32 v98, 11, v96
  v_lshl_add_u32 v98, v97, 4, v98
  v_lshlrev_b32 v99, 4, v97
  s_movk_i32 s20, 16384
  s_add_u32 s36, s64, s3
  s_addc_u32 s37, s65, 0
  s_mov_b32 s38, 32768
  s_mov_b32 s39, 0x20000
  s_add_u32 s40, s88, 0
  s_addc_u32 s41, s89, 0
  s_mov_b32 s42, 2048
  s_mov_b32 s43, 0x20000
  s_add_u32 s16, s66, 0
  s_addc_u32 s17, s67, 0
  s_mov_b32 s18, 16384
  s_mov_b32 s19, 0x20000
  buffer_load_dwordx4 v[8:11], v98, s[36:39], 0 offen offset:0
  buffer_load_dwordx4 v[12:15], v98, s[36:39], 0 offen offset:512
  buffer_load_dwordx4 v[16:19], v98, s[36:39], 0 offen offset:1024
  buffer_load_dwordx4 v[20:23], v98, s[36:39], 0 offen offset:1536
  buffer_load_dwordx4 v[24:27], v99, s[40:43], 0 offen offset:0
  buffer_load_dwordx4 v[28:31], v99, s[40:43], 0 offen offset:512
  buffer_load_dwordx4 v[32:35], v99, s[40:43], 0 offen offset:1024
  buffer_load_dwordx4 v[36:39], v99, s[40:43], 0 offen offset:1536
  buffer_load_dwordx4 v[100:103], v98, s[36:39], s20 offen offset:0
  buffer_load_dwordx4 v[104:107], v98, s[36:39], s20 offen offset:512
  buffer_load_dwordx4 v[108:111], v98, s[36:39], s20 offen offset:1024
  buffer_load_dwordx4 v[112:115], v98, s[36:39], s20 offen offset:1536
  s_and_b32 s20, s2, 2
  s_lshl_b32 s20, s20, 9
  buffer_load_dwordx4 v[40:43], v98, s[16:19], s20 offen
  buffer_load_dwordx4 v[132:135], v98, s[16:19], s20 offen offset:512
  s_waitcnt vmcnt(2)
  s_lshr_b32 s20, s2, 2
  s_lshl_b32 s20, s20, 16
  s_and_b32 s21, s2, 3
  s_lshl_b32 s21, s21, 7
  s_add_u32 s20, s20, s21
  v_lshlrev_b32 v5, 9, v97
  v_lshl_add_u32 v5, v96, 4, v5
  v_add_u32 v5, s20, v5
  s_mov_b32 s21, 0
  buffer_store_dwordx4 v[8:11], v5, s[4:7], s21 offen sc1
  s_mov_b32 s21, 16384
  buffer_store_dwordx4 v[12:15], v5, s[4:7], s21 offen sc1
  s_mov_b32 s21, 32768
  buffer_store_dwordx4 v[16:19], v5, s[4:7], s21 offen sc1
  s_mov_b32 s21, 49152
  buffer_store_dwordx4 v[20:23], v5, s[4:7], s21 offen sc1
  s_add_u32 s2, s2, 1
  s_lshr_b32 s20, s2, 2
  s_lshl_b32 s20, s20, 16
  s_and_b32 s21, s2, 3
  s_lshl_b32 s21, s21, 7
  s_add_u32 s20, s20, s21
  v_lshlrev_b32 v6, 9, v97
  v_lshl_add_u32 v6, v96, 4, v6
  v_add_u32 v6, s20, v6
  s_mov_b32 s21, 0
  buffer_store_dwordx4 v[100:103], v6, s[4:7], s21 offen sc1
  s_mov_b32 s21, 16384
  buffer_store_dwordx4 v[104:107], v6, s[4:7], s21 offen sc1
  s_mov_b32 s21, 32768
  buffer_store_dwordx4 v[108:111], v6, s[4:7], s21 offen sc1
  s_mov_b32 s21, 49152
  buffer_store_dwordx4 v[112:115], v6, s[4:7], s21 offen sc1
  s_waitcnt vmcnt(0)
  s_barrier
  s_cmp_eq_u32 s53, 0
  s_cbranch_scc1 .fp_f
  s_cmp_lg_u32 s23, 0
  s_cbranch_scc1 .ar1
  v_mov_b32 v2, 1
  s_mov_b64 exec, 1
  buffer_atomic_add v2, off, s[8:11], 0 offset:136 sc1
  s_mov_b64 exec, -1
.fp_p:
  buffer_load_dword v2, off, s[8:11], 0 offset:136 sc0 sc1
  s_sub_u32 s50, s50, 1
  s_cbranch_scc1 .rec_end
  s_waitcnt vmcnt(0)
  v_readfirstlane_b32 s27, v2
  s_cmp_lg_u32 s27, 128
  s_cbranch_scc1 .fp_p
  s_branch .ar1
.fp_f:
  s_cmp_lg_u32 s23, 0
  s_cbranch_scc1 .ar1
  v_mov_b32 v2, s61
  s_mov_b64 exec, 1
  buffer_atomic_add v2, off, s[8:11], 0 offset:128 sc0 sc1
  s_mov_b64 exec, -1
  s_waitcnt vmcnt(0)
  v_readfirstlane_b32 s27, v2
  s_add_u32 s27, s27, s61
  s_and_b32 s26, s27, 0xffff
  s_cmp_lg_u32 s26, 256
  s_cbranch_scc1 .ar1
  s_lshr_b32 s27, s27, 16
  v_mov_b32 v2, s27
  v_lshlrev_b32 v3, 7, v1
  s_mov_b32 s26, 119537664
  buffer_store_dword v2, v3, s[4:7], s26 offen sc0 sc1
  s_mov_b32 s26, 119545856
  buffer_store_dword v2, v3, s[4:7], s26 offen sc0 sc1
  s_mov_b32 s26, 119554048
  buffer_store_dword v2, v3, s[4:7], s26 offen sc0 sc1
  s_mov_b32 s26, 119562240
  buffer_store_dword v2, v3, s[4:7], s26 offen sc0 sc1
  s_mov_b32 s26, 119570432
  buffer_store_dword v2, v3, s[4:7], s26 offen sc0 sc1
.ar1:
  v_mov_b32 v80, 0
  v_mov_b32 v81, 0
  v_lshlrev_b32 v48, 16, v8
  v_and_b32 v49, 0xffff0000, v8
  v_lshlrev_b32 v82, 16, v24
  v_and_b32 v83, 0xffff0000, v24
  v_fmac_f32 v80, v82, v48
  v_fmac_f32 v80, v83, v49
  v_add_f32 v81, v81, v48
  v_add_f32 v81, v81, v49
  v_lshlrev_b32 v50, 16, v9
  v_and_b32 v51, 0xffff0000, v9
  v_lshlrev_b32 v82, 16, v25
  v_and_b32 v83, 0xffff0000, v25
  v_fmac_f32 v80, v82, v50
  v_fmac_f32 v80, v83, v51
  v_add_f32 v81, v81, v50
  v_add_f32 v81, v81, v51
  v_lshlrev_b32 v52, 16, v10
  v_and_b32 v53, 0xffff0000, v10
  v_lshlrev_b32 v82, 16, v26
  v_and_b32 v83, 0xffff0000, v26
  v_fmac_f32 v80, v82, v52
  v_fmac_f32 v80, v83, v53
  v_add_f32 v81, v81, v52
  v_add_f32 v81, v81, v53
  v_lshlrev_b32 v54, 16, v11
  v_and_b32 v55, 0xffff0000, v11
  v_lshlrev_b32 v82, 16, v27
  v_and_b32 v83, 0xffff0000, v27
  v_fmac_f32 v80, v82, v54
  v_fmac_f32 v80, v83, v55
  v_add_f32 v81, v81, v54
  v_add_f32 v81, v81, v55
  v_lshlrev_b32 v56, 16, v12
  v_and_b32 v57, 0xffff0000, v12
  v_lshlrev_b32 v82, 16, v28
  v_and_b32 v83, 0xffff0000, v28
  v_fmac_f32 v80, v82, v56
  v_fmac_f32 v80, v83, v57
  v_add_f32 v81, v81, v56
  v_add_f32 v81, v81, v57
  v_lshlrev_b32 v58, 16, v13
  v_and_b32 v59, 0xffff0000, v13
  v_lshlrev_b32 v82, 16, v29
  v_and_b32 v83, 0xffff0000, v29
  v_fmac_f32 v80, v82, v58
  v_fmac_f32 v80, v83, v59
  v_add_f32 v81, v81, v58
  v_add_f32 v81, v81, v59
  v_lshlrev_b32 v60, 16, v14
  v_and_b32 v61, 0xffff0000, v14
  v_lshlrev_b32 v82, 16, v30
  v_and_b32 v83, 0xffff0000, v30
  v_fmac_f32 v80, v82, v60
  v_fmac_f32 v80, v83, v61
  v_add_f32 v81, v81, v60
  v_add_f32 v81, v81, v61
  v_lshlrev_b32 v62, 16, v15
  v_and_b32 v63, 0xffff0000, v15
  v_lshlrev_b32 v82, 16, v31
  v_and_b32 v83, 0xffff0000, v31
  v_fmac_f32 v80, v82, v62
  v_fmac_f32 v80, v83, v63
  v_add_f32 v81, v81, v62
  v_add_f32 v81, v81, v63
  v_lshlrev_b32 v64, 16, v16
  v_and_b32 v65, 0xffff0000, v16
  v_lshlrev_b32 v82, 16, v32
  v_and_b32 v83, 0xffff0000, v32
  v_fmac_f32 v80, v82, v64
  v_fmac_f32 v80, v83, v65
  v_add_f32 v81, v81, v64
  v_add_f32 v81, v81, v65
  v_lshlrev_b32 v66, 16, v17
  v_and_b32 v67, 0xffff0000, v17
  v_lshlrev_b32 v82, 16, v33
  v_and_b32 v83, 0xffff0000, v33
  v_fmac_f32 v80, v82, v66
  v_fmac_f32 v80, v83, v67
  v_add_f32 v81, v81, v66
  v_add_f32 v81, v81, v67
  v_lshlrev_b32 v68, 16, v18
  v_and_b32 v69, 0xffff0000, v18
  v_lshlrev_b32 v82, 16, v34
  v_and_b32 v83, 0xffff0000, v34
  v_fmac_f32 v80, v82, v68
  v_fmac_f32 v80, v83, v69
  v_add_f32 v81, v81, v68
  v_add_f32 v81, v81, v69
  v_lshlrev_b32 v70, 16, v19
  v_and_b32 v71, 0xffff0000, v19
  v_lshlrev_b32 v82, 16, v35
  v_and_b32 v83, 0xffff0000, v35
  v_fmac_f32 v80, v82, v70
  v_fmac_f32 v80, v83, v71
  v_add_f32 v81, v81, v70
  v_add_f32 v81, v81, v71
  v_lshlrev_b32 v72, 16, v20
  v_and_b32 v73, 0xffff0000, v20
  v_lshlrev_b32 v82, 16, v36
  v_and_b32 v83, 0xffff0000, v36
  v_fmac_f32 v80, v82, v72
  v_fmac_f32 v80, v83, v73
  v_add_f32 v81, v81, v72
  v_add_f32 v81, v81, v73
  v_lshlrev_b32 v74, 16, v21
  v_and_b32 v75, 0xffff0000, v21
  v_lshlrev_b32 v82, 16, v37
  v_and_b32 v83, 0xffff0000, v37
  v_fmac_f32 v80, v82, v74
  v_fmac_f32 v80, v83, v75
  v_add_f32 v81, v81, v74
  v_add_f32 v81, v81, v75
  v_lshlrev_b32 v76, 16, v22
  v_and_b32 v77, 0xffff0000, v22
  v_lshlrev_b32 v82, 16, v38
  v_and_b32 v83, 0xffff0000, v38
  v_fmac_f32 v80, v82, v76
  v_fmac_f32 v80, v83, v77
  v_add_f32 v81, v81, v76
  v_add_f32 v81, v81, v77
  v_lshlrev_b32 v78, 16, v23
  v_and_b32 v79, 0xffff0000, v23
  v_lshlrev_b32 v82, 16, v39
  v_and_b32 v83, 0xffff0000, v39
  v_fmac_f32 v80, v82, v78
  v_fmac_f32 v80, v83, v79
  v_add_f32 v81, v81, v78
  v_add_f32 v81, v81, v79
  s_nop 1
  v_add_f32_dpp v80, v80, v80 row_ror:8 row_mask:0xf bank_mask:0xf
  v_mov_b32 v82, v80
  s_nop 1
  v_permlane16_swap_b32 v82, v80
  s_nop 1
  v_add_f32 v80, v82, v80
  v_mov_b32 v82, v80
  s_nop 1
  v_permlane32_swap_b32 v82, v80
  s_nop 1
  v_add_f32 v80, v82, v80
  s_nop 1
  v_add_f32_dpp v81, v81, v81 row_ror:8 row_mask:0xf bank_mask:0xf
  v_mov_b32 v82, v81
  s_nop 1
  v_permlane16_swap_b32 v82, v81
  s_nop 1
  v_add_f32 v81, v82, v81
  v_mov_b32 v82, v81
  s_nop 1
  v_permlane32_swap_b32 v82, v81
  s_nop 1
  v_add_f32 v81, v82, v81
  v_lshrrev_b32 v84, 6, v0
  v_lshlrev_b32 v85, 5, v96
  v_lshl_add_u32 v84, v84, 3, v85
  ds_write_b64 v84, v[80:81] offset:0
  s_waitcnt lgkmcnt(0)
  s_barrier
  ds_read_b128 v[88:91], v85 offset:0
  ds_read_b128 v[92:95], v85 offset:16
  s_waitcnt lgkmcnt(0)
  v_add_f32 v80, v88, v90
  v_add_f32 v81, v89, v91
  v_add_f32 v82, v92, v94
  v_add_f32 v83, v93, v95
  v_add_f32 v80, v80, v82
  v_add_f32 v81, v81, v83
  v_mul_f32 v81, 0x3a800000, v81
  v_mov_b32 v86, 0
  v_sub_f32 v48, v48, v81
  v_fmac_f32 v86, v48, v48
  v_sub_f32 v49, v49, v81
  v_fmac_f32 v86, v49, v49
  v_sub_f32 v50, v50, v81
  v_fmac_f32 v86, v50, v50
  v_sub_f32 v51, v51, v81
  v_fmac_f32 v86, v51, v51
  v_sub_f32 v52, v52, v81
  v_fmac_f32 v86, v52, v52
  v_sub_f32 v53, v53, v81
  v_fmac_f32 v86, v53, v53
  v_sub_f32 v54, v54, v81
  v_fmac_f32 v86, v54, v54
  v_sub_f32 v55, v55, v81
  v_fmac_f32 v86, v55, v55
  v_sub_f32 v56, v56, v81
  v_fmac_f32 v86, v56, v56
  v_sub_f32 v57, v57, v81
  v_fmac_f32 v86, v57, v57
  v_sub_f32 v58, v58, v81
  v_fmac_f32 v86, v58, v58
  v_sub_f32 v59, v59, v81
  v_fmac_f32 v86, v59, v59
  v_sub_f32 v60, v60, v81
  v_fmac_f32 v86, v60, v60
  v_sub_f32 v61, v61, v81
  v_fmac_f32 v86, v61, v61
  v_sub_f32 v62, v62, v81
  v_fmac_f32 v86, v62, v62
  v_sub_f32 v63, v63, v81
  v_fmac_f32 v86, v63, v63
  v_sub_f32 v64, v64, v81
  v_fmac_f32 v86, v64, v64
  v_sub_f32 v65, v65, v81
  v_fmac_f32 v86, v65, v65
  v_sub_f32 v66, v66, v81
  v_fmac_f32 v86, v66, v66
  v_sub_f32 v67, v67, v81
  v_fmac_f32 v86, v67, v67
  v_sub_f32 v68, v68, v81
  v_fmac_f32 v86, v68, v68
  v_sub_f32 v69, v69, v81
  v_fmac_f32 v86, v69, v69
  v_sub_f32 v70, v70, v81
  v_fmac_f32 v86, v70, v70
  v_sub_f32 v71, v71, v81
  v_fmac_f32 v86, v71, v71
  v_sub_f32 v72, v72, v81
  v_fmac_f32 v86, v72, v72
  v_sub_f32 v73, v73, v81
  v_fmac_f32 v86, v73, v73
  v_sub_f32 v74, v74, v81
  v_fmac_f32 v86, v74, v74
  v_sub_f32 v75, v75, v81
  v_fmac_f32 v86, v75, v75
  v_sub_f32 v76, v76, v81
  v_fmac_f32 v86, v76, v76
  v_sub_f32 v77, v77, v81
  v_fmac_f32 v86, v77, v77
  v_sub_f32 v78, v78, v81
  v_fmac_f32 v86, v78, v78
  v_sub_f32 v79, v79, v81
  v_fmac_f32 v86, v79, v79
  s_nop 1
  v_add_f32_dpp v86, v86, v86 row_ror:8 row_mask:0xf bank_mask:0xf
  v_mov_b32 v82, v86
  s_nop 1
  v_permlane16_swap_b32 v82, v86
  s_nop 1
  v_add_f32 v86, v82, v86
  v_mov_b32 v82, v86
  s_nop 1
  v_permlane32_swap_b32 v82, v86
  s_nop 1
  v_add_f32 v86, v82, v86
  ds_write_b32 v84, v86 offset:256
  s_waitcnt lgkmcnt(0)
  s_barrier
  ds_read_b128 v[88:91], v85 offset:256
  ds_read_b128 v[92:95], v85 offset:272
  v_mul_f32 v80, 0xbfb8aa3b, v80
  v_exp_f32 v80, v80
  s_waitcnt lgkmcnt(0)
  v_add_f32 v86, v88, v90
  v_add_f32 v82, v92, v94
  v_add_f32 v86, v86, v82
  v_add_f32 v80, 1.0, v80
  v_mov_b32 v82, 0x3727c5ac
  v_fmac_f32 v82, 0x3a800000, v86
  v_rcp_f32 v152, v80
  v_rsq_f32 v82, v82
  s_nop 1
  v_mul_f32 v48, v48, v82
  v_mul_f32 v49, v49, v82
  v_cvt_pk_bf16_f32 v116, v48, v49
  v_mul_f32 v50, v50, v82
  v_mul_f32 v51, v51, v82
  v_cvt_pk_bf16_f32 v117, v50, v51
  v_mul_f32 v52, v52, v82
  v_mul_f32 v53, v53, v82
  v_cvt_pk_bf16_f32 v118, v52, v53
  v_mul_f32 v54, v54, v82
  v_mul_f32 v55, v55, v82
  v_cvt_pk_bf16_f32 v119, v54, v55
  v_mul_f32 v56, v56, v82
  v_mul_f32 v57, v57, v82
  v_cvt_pk_bf16_f32 v120, v56, v57
  v_mul_f32 v58, v58, v82
  v_mul_f32 v59, v59, v82
  v_cvt_pk_bf16_f32 v121, v58, v59
  v_mul_f32 v60, v60, v82
  v_mul_f32 v61, v61, v82
  v_cvt_pk_bf16_f32 v122, v60, v61
  v_mul_f32 v62, v62, v82
  v_mul_f32 v63, v63, v82
  v_cvt_pk_bf16_f32 v123, v62, v63
  v_mul_f32 v64, v64, v82
  v_mul_f32 v65, v65, v82
  v_cvt_pk_bf16_f32 v124, v64, v65
  v_mul_f32 v66, v66, v82
  v_mul_f32 v67, v67, v82
  v_cvt_pk_bf16_f32 v125, v66, v67
  v_mul_f32 v68, v68, v82
  v_mul_f32 v69, v69, v82
  v_cvt_pk_bf16_f32 v126, v68, v69
  v_mul_f32 v70, v70, v82
  v_mul_f32 v71, v71, v82
  v_cvt_pk_bf16_f32 v127, v70, v71
  v_mul_f32 v72, v72, v82
  v_mul_f32 v73, v73, v82
  v_cvt_pk_bf16_f32 v128, v72, v73
  v_mul_f32 v74, v74, v82
  v_mul_f32 v75, v75, v82
  v_cvt_pk_bf16_f32 v129, v74, v75
  v_mul_f32 v76, v76, v82
  v_mul_f32 v77, v77, v82
  v_cvt_pk_bf16_f32 v130, v76, v77
  v_mul_f32 v78, v78, v82
  v_mul_f32 v79, v79, v82
  v_cvt_pk_bf16_f32 v131, v78, v79
  v_mov_b32 v80, 0
  v_mov_b32 v81, 0
  v_lshlrev_b32 v48, 16, v100
  v_and_b32 v49, 0xffff0000, v100
  v_lshlrev_b32 v82, 16, v24
  v_and_b32 v83, 0xffff0000, v24
  v_fmac_f32 v80, v82, v48
  v_fmac_f32 v80, v83, v49
  v_add_f32 v81, v81, v48
  v_add_f32 v81, v81, v49
  v_lshlrev_b32 v50, 16, v101
  v_and_b32 v51, 0xffff0000, v101
  v_lshlrev_b32 v82, 16, v25
  v_and_b32 v83, 0xffff0000, v25
  v_fmac_f32 v80, v82, v50
  v_fmac_f32 v80, v83, v51
  v_add_f32 v81, v81, v50
  v_add_f32 v81, v81, v51
  v_lshlrev_b32 v52, 16, v102
  v_and_b32 v53, 0xffff0000, v102
  v_lshlrev_b32 v82, 16, v26
  v_and_b32 v83, 0xffff0000, v26
  v_fmac_f32 v80, v82, v52
  v_fmac_f32 v80, v83, v53
  v_add_f32 v81, v81, v52
  v_add_f32 v81, v81, v53
  v_lshlrev_b32 v54, 16, v103
  v_and_b32 v55, 0xffff0000, v103
  v_lshlrev_b32 v82, 16, v27
  v_and_b32 v83, 0xffff0000, v27
  v_fmac_f32 v80, v82, v54
  v_fmac_f32 v80, v83, v55
  v_add_f32 v81, v81, v54
  v_add_f32 v81, v81, v55
  v_lshlrev_b32 v56, 16, v104
  v_and_b32 v57, 0xffff0000, v104
  v_lshlrev_b32 v82, 16, v28
  v_and_b32 v83, 0xffff0000, v28
  v_fmac_f32 v80, v82, v56
  v_fmac_f32 v80, v83, v57
  v_add_f32 v81, v81, v56
  v_add_f32 v81, v81, v57
  v_lshlrev_b32 v58, 16, v105
  v_and_b32 v59, 0xffff0000, v105
  v_lshlrev_b32 v82, 16, v29
  v_and_b32 v83, 0xffff0000, v29
  v_fmac_f32 v80, v82, v58
  v_fmac_f32 v80, v83, v59
  v_add_f32 v81, v81, v58
  v_add_f32 v81, v81, v59
  v_lshlrev_b32 v60, 16, v106
  v_and_b32 v61, 0xffff0000, v106
  v_lshlrev_b32 v82, 16, v30
  v_and_b32 v83, 0xffff0000, v30
  v_fmac_f32 v80, v82, v60
  v_fmac_f32 v80, v83, v61
  v_add_f32 v81, v81, v60
  v_add_f32 v81, v81, v61
  v_lshlrev_b32 v62, 16, v107
  v_and_b32 v63, 0xffff0000, v107
  v_lshlrev_b32 v82, 16, v31
  v_and_b32 v83, 0xffff0000, v31
  v_fmac_f32 v80, v82, v62
  v_fmac_f32 v80, v83, v63
  v_add_f32 v81, v81, v62
  v_add_f32 v81, v81, v63
  v_lshlrev_b32 v64, 16, v108
  v_and_b32 v65, 0xffff0000, v108
  v_lshlrev_b32 v82, 16, v32
  v_and_b32 v83, 0xffff0000, v32
  v_fmac_f32 v80, v82, v64
  v_fmac_f32 v80, v83, v65
  v_add_f32 v81, v81, v64
  v_add_f32 v81, v81, v65
  v_lshlrev_b32 v66, 16, v109
  v_and_b32 v67, 0xffff0000, v109
  v_lshlrev_b32 v82, 16, v33
  v_and_b32 v83, 0xffff0000, v33
  v_fmac_f32 v80, v82, v66
  v_fmac_f32 v80, v83, v67
  v_add_f32 v81, v81, v66
  v_add_f32 v81, v81, v67
  v_lshlrev_b32 v68, 16, v110
  v_and_b32 v69, 0xffff0000, v110
  v_lshlrev_b32 v82, 16, v34
  v_and_b32 v83, 0xffff0000, v34
  v_fmac_f32 v80, v82, v68
  v_fmac_f32 v80, v83, v69
  v_add_f32 v81, v81, v68
  v_add_f32 v81, v81, v69
  v_lshlrev_b32 v70, 16, v111
  v_and_b32 v71, 0xffff0000, v111
  v_lshlrev_b32 v82, 16, v35
  v_and_b32 v83, 0xffff0000, v35
  v_fmac_f32 v80, v82, v70
  v_fmac_f32 v80, v83, v71
  v_add_f32 v81, v81, v70
  v_add_f32 v81, v81, v71
  v_lshlrev_b32 v72, 16, v112
  v_and_b32 v73, 0xffff0000, v112
  v_lshlrev_b32 v82, 16, v36
  v_and_b32 v83, 0xffff0000, v36
  v_fmac_f32 v80, v82, v72
  v_fmac_f32 v80, v83, v73
  v_add_f32 v81, v81, v72
  v_add_f32 v81, v81, v73
  v_lshlrev_b32 v74, 16, v113
  v_and_b32 v75, 0xffff0000, v113
  v_lshlrev_b32 v82, 16, v37
  v_and_b32 v83, 0xffff0000, v37
  v_fmac_f32 v80, v82, v74
  v_fmac_f32 v80, v83, v75
  v_add_f32 v81, v81, v74
  v_add_f32 v81, v81, v75
  v_lshlrev_b32 v76, 16, v114
  v_and_b32 v77, 0xffff0000, v114
  v_lshlrev_b32 v82, 16, v38
  v_and_b32 v83, 0xffff0000, v38
  v_fmac_f32 v80, v82, v76
  v_fmac_f32 v80, v83, v77
  v_add_f32 v81, v81, v76
  v_add_f32 v81, v81, v77
  v_lshlrev_b32 v78, 16, v115
  v_and_b32 v79, 0xffff0000, v115
  v_lshlrev_b32 v82, 16, v39
  v_and_b32 v83, 0xffff0000, v39
  v_fmac_f32 v80, v82, v78
  v_fmac_f32 v80, v83, v79
  v_add_f32 v81, v81, v78
  v_add_f32 v81, v81, v79
  s_nop 1
  v_add_f32_dpp v80, v80, v80 row_ror:8 row_mask:0xf bank_mask:0xf
  v_mov_b32 v82, v80
  s_nop 1
  v_permlane16_swap_b32 v82, v80
  s_nop 1
  v_add_f32 v80, v82, v80
  v_mov_b32 v82, v80
  s_nop 1
  v_permlane32_swap_b32 v82, v80
  s_nop 1
  v_add_f32 v80, v82, v80
  s_nop 1
  v_add_f32_dpp v81, v81, v81 row_ror:8 row_mask:0xf bank_mask:0xf
  v_mov_b32 v82, v81
  s_nop 1
  v_permlane16_swap_b32 v82, v81
  s_nop 1
  v_add_f32 v81, v82, v81
  v_mov_b32 v82, v81
  s_nop 1
  v_permlane32_swap_b32 v82, v81
  s_nop 1
  v_add_f32 v81, v82, v81
  v_lshrrev_b32 v84, 6, v0
  v_lshlrev_b32 v85, 5, v96
  v_lshl_add_u32 v84, v84, 3, v85
  ds_write_b64 v84, v[80:81] offset:512
  s_waitcnt lgkmcnt(0)
  s_barrier
  ds_read_b128 v[88:91], v85 offset:512
  ds_read_b128 v[92:95], v85 offset:528
  s_waitcnt lgkmcnt(0)
  v_add_f32 v80, v88, v90
  v_add_f32 v81, v89, v91
  v_add_f32 v82, v92, v94
  v_add_f32 v83, v93, v95
  v_add_f32 v80, v80, v82
  v_add_f32 v81, v81, v83
  v_mul_f32 v81, 0x3a800000, v81
  v_mov_b32 v86, 0
  v_sub_f32 v48, v48, v81
  v_fmac_f32 v86, v48, v48
  v_sub_f32 v49, v49, v81
  v_fmac_f32 v86, v49, v49
  v_sub_f32 v50, v50, v81
  v_fmac_f32 v86, v50, v50
  v_sub_f32 v51, v51, v81
  v_fmac_f32 v86, v51, v51
  v_sub_f32 v52, v52, v81
  v_fmac_f32 v86, v52, v52
  v_sub_f32 v53, v53, v81
  v_fmac_f32 v86, v53, v53
  v_sub_f32 v54, v54, v81
  v_fmac_f32 v86, v54, v54
  v_sub_f32 v55, v55, v81
  v_fmac_f32 v86, v55, v55
  v_sub_f32 v56, v56, v81
  v_fmac_f32 v86, v56, v56
  v_sub_f32 v57, v57, v81
  v_fmac_f32 v86, v57, v57
  v_sub_f32 v58, v58, v81
  v_fmac_f32 v86, v58, v58
  v_sub_f32 v59, v59, v81
  v_fmac_f32 v86, v59, v59
  v_sub_f32 v60, v60, v81
  v_fmac_f32 v86, v60, v60
  v_sub_f32 v61, v61, v81
  v_fmac_f32 v86, v61, v61
  v_sub_f32 v62, v62, v81
  v_fmac_f32 v86, v62, v62
  v_sub_f32 v63, v63, v81
  v_fmac_f32 v86, v63, v63
  v_sub_f32 v64, v64, v81
  v_fmac_f32 v86, v64, v64
  v_sub_f32 v65, v65, v81
  v_fmac_f32 v86, v65, v65
  v_sub_f32 v66, v66, v81
  v_fmac_f32 v86, v66, v66
  v_sub_f32 v67, v67, v81
  v_fmac_f32 v86, v67, v67
  v_sub_f32 v68, v68, v81
  v_fmac_f32 v86, v68, v68
  v_sub_f32 v69, v69, v81
  v_fmac_f32 v86, v69, v69
  v_sub_f32 v70, v70, v81
  v_fmac_f32 v86, v70, v70
  v_sub_f32 v71, v71, v81
  v_fmac_f32 v86, v71, v71
  v_sub_f32 v72, v72, v81
  v_fmac_f32 v86, v72, v72
  v_sub_f32 v73, v73, v81
  v_fmac_f32 v86, v73, v73
  v_sub_f32 v74, v74, v81
  v_fmac_f32 v86, v74, v74
  v_sub_f32 v75, v75, v81
  v_fmac_f32 v86, v75, v75
  v_sub_f32 v76, v76, v81
  v_fmac_f32 v86, v76, v76
  v_sub_f32 v77, v77, v81
  v_fmac_f32 v86, v77, v77
  v_sub_f32 v78, v78, v81
  v_fmac_f32 v86, v78, v78
  v_sub_f32 v79, v79, v81
  v_fmac_f32 v86, v79, v79
  s_nop 1
  v_add_f32_dpp v86, v86, v86 row_ror:8 row_mask:0xf bank_mask:0xf
  v_mov_b32 v82, v86
  s_nop 1
  v_permlane16_swap_b32 v82, v86
  s_nop 1
  v_add_f32 v86, v82, v86
  v_mov_b32 v82, v86
  s_nop 1
  v_permlane32_swap_b32 v82, v86
  s_nop 1
  v_add_f32 v86, v82, v86
  ds_write_b32 v84, v86 offset:768
  s_waitcnt lgkmcnt(0)
  s_barrier
  ds_read_b128 v[88:91], v85 offset:768
  ds_read_b128 v[92:95], v85 offset:784
  v_mul_f32 v80, 0xbfb8aa3b, v80
  v_exp_f32 v80, v80
  s_waitcnt lgkmcnt(0)
  v_add_f32 v86, v88, v90
  v_add_f32 v82, v92, v94
  v_add_f32 v86, v86, v82
  v_add_f32 v80, 1.0, v80
  v_mov_b32 v82, 0x3727c5ac
  v_fmac_f32 v82, 0x3a800000, v86
  v_rcp_f32 v153, v80
  v_rsq_f32 v82, v82
  s_nop 1
  v_mul_f32 v48, v48, v82
  v_mul_f32 v49, v49, v82
  v_cvt_pk_bf16_f32 v136, v48, v49
  v_mul_f32 v50, v50, v82
  v_mul_f32 v51, v51, v82
  v_cvt_pk_bf16_f32 v137, v50, v51
  v_mul_f32 v52, v52, v82
  v_mul_f32 v53, v53, v82
  v_cvt_pk_bf16_f32 v138, v52, v53
  v_mul_f32 v54, v54, v82
  v_mul_f32 v55, v55, v82
  v_cvt_pk_bf16_f32 v139, v54, v55
  v_mul_f32 v56, v56, v82
  v_mul_f32 v57, v57, v82
  v_cvt_pk_bf16_f32 v140, v56, v57
  v_mul_f32 v58, v58, v82
  v_mul_f32 v59, v59, v82
  v_cvt_pk_bf16_f32 v141, v58, v59
  v_mul_f32 v60, v60, v82
  v_mul_f32 v61, v61, v82
  v_cvt_pk_bf16_f32 v142, v60, v61
  v_mul_f32 v62, v62, v82
  v_mul_f32 v63, v63, v82
  v_cvt_pk_bf16_f32 v143, v62, v63
  v_mul_f32 v64, v64, v82
  v_mul_f32 v65, v65, v82
  v_cvt_pk_bf16_f32 v144, v64, v65
  v_mul_f32 v66, v66, v82
  v_mul_f32 v67, v67, v82
  v_cvt_pk_bf16_f32 v145, v66, v67
  v_mul_f32 v68, v68, v82
  v_mul_f32 v69, v69, v82
  v_cvt_pk_bf16_f32 v146, v68, v69
  v_mul_f32 v70, v70, v82
  v_mul_f32 v71, v71, v82
  v_cvt_pk_bf16_f32 v147, v70, v71
  v_mul_f32 v72, v72, v82
  v_mul_f32 v73, v73, v82
  v_cvt_pk_bf16_f32 v148, v72, v73
  v_mul_f32 v74, v74, v82
  v_mul_f32 v75, v75, v82
  v_cvt_pk_bf16_f32 v149, v74, v75
  v_mul_f32 v76, v76, v82
  v_mul_f32 v77, v77, v82
  v_cvt_pk_bf16_f32 v150, v76, v77
  v_mul_f32 v78, v78, v82
  v_mul_f32 v79, v79, v82
  v_cvt_pk_bf16_f32 v151, v78, v79
  s_barrier
  s_cmp_lg_u32 s53, 0
  s_cbranch_scc1 .rec_g
.rec_nold:
.wm2:
  buffer_load_dword v2, off, s[4:7], s57 sc0 sc1
  s_sub_u32 s50, s50, 1
  s_cbranch_scc1 .rec_end
  s_waitcnt vmcnt(0)
  v_readfirstlane_b32 s53, v2
  s_cmp_eq_u32 s53, 0
  s_cbranch_scc1 .wm2
  s_lshr_b32 s62, s53, 4
  s_lshl_b32 s62, s62, 13
  s_and_b32 s62, s62, 8192
  s_and_b32 s53, s53, 3
  s_sub_u32 s53, s53, 1
  s_mov_b32 s59, s53
  s_cmp_eq_u32 s53, 0
  s_cbranch_scc1 .rec_fast
  s_lshr_b32 s44, s60, 5
  s_and_b32 s45, s60, 31
  s_barrier
  s_cmp_ge_u32 s44, 4
  s_cbranch_scc0 .rec_ld
  s_branch .rec_pl
.rec_fast:
  s_cmp_ge_u32 s44, 4
  s_cbranch_scc1 .rec_g
.rec_run:
  s_mov_b32 s97, s57
  s_mov_b32 s54, 0x00ff00ff
  s_mov_b32 s55, 0x00ff00ff
  s_mov_b32 s56, 0
  s_mov_b32 s57, 0x00ff00ff
  v_and_b32 v2, 15, v1
  v_lshrrev_b32 v3, 4, v1
  v_mov_b32 v15, 0x4444
  v_mov_b32 v14, 0xeeee
  v_cmp_lt_u32 vcc, 7, v2
  s_lshl_b32 s26, s44, 14
  s_lshl_b32 s27, s23, 12
  v_cndmask_b32 v15, v15, v14, vcc
  s_add_u32 s27, s27, s26
  s_add_u32 s27, s27, 106954752
  v_lshl_add_u32 v4, v1, 4, s27
  v_add_u32 v5, 262144, v4
  s_mul_i32 s27, s23, 2304
  v_mul_u32_u24 v6, 576, v3
  v_lshl_add_u32 v6, v2, 2, v6
  v_add_u32 v6, s27, v6
  v_lshrrev_b32 v7, 1, v3
  v_lshl_add_u32 v7, v7, 4, v2
  v_and_b32 v14, 1, v3
  s_mul_i32 s27, s23, 1152
  s_add_u32 s27, s27, 13312
  v_mul_u32_u24 v109, 576, v14
  v_lshl_add_u32 v109, v7, 2, v109
  v_add_u32 v109, s27, v109
  v_lshlrev_b32 v7, 5, v7
  v_lshl_add_u32 v7, v14, 4, v7
  s_lshl_b32 s27, s23, 10
  v_add_u32 v7, s27, v7
  v_mov_b32 v100, -1
  v_mov_b32 v101, -1
  v_mov_b32 v102, -1
  v_mov_b32 v103, -1
  v_lshlrev_b32 v9, 4, v1
  s_lshl_b32 s28, s44, 5
  s_add_u32 s28, s28, s45
  s_lshl_b32 s29, s45, 9
  s_add_u32 s29, s29, s26
  s_and_b32 s30, s45, 3
  v_mul_u32_u24 v10, 144, v2
  v_lshl_add_u32 v10, v3, 5, v10
  v_and_b32 v14, 7, v2
  v_mov_b32 v104, v4
  v_mov_b32 v105, v4
  v_mov_b32 v106, v4
  v_mov_b32 v107, v4
  v_mov_b32 v108, v4
  s_mov_b32 s46, 0
  s_cmp_eq_u32 s23, 1
  s_cbranch_scc1 .rc3
  s_cmp_eq_u32 s23, 2
  s_cbranch_scc1 .rc4
  s_cmp_eq_u32 s23, 3
  s_cbranch_scc1 .rc5
  s_lshl_b32 s27, s28, 11
  s_add_u32 s27, s27, 105906176
  v_lshl_add_u32 v11, v3, 3, v14
  v_lshl_add_u32 v11, v11, 4, s27
  v_bfe_u32 v12, v1, 1, 3
  v_mul_u32_u24 v12, 144, v12
  v_lshl_add_u32 v12, v3, 5, v12
  v_and_b32 v13, 1, v1
  v_lshl_add_u32 v12, v13, 4, v12
  s_add_u32 s27, s29, 106954752
  v_lshl_add_u32 v13, v1, 3, s27
  s_xor_b32 s27, s28, 0
  s_lshr_b32 s31, s27, 3
  s_lshl_b32 s31, s31, 14
  s_and_b32 s27, s27, 7
  s_lshl_b32 s27, s27, 10
  s_add_u32 s27, s27, s31
  s_add_u32 s27, s27, 104857600
  s_add_u32 s27, s27, s62
  v_add_u32 v104, s27, v9
  s_xor_b32 s27, s28, 32
  s_lshr_b32 s31, s27, 3
  s_lshl_b32 s31, s31, 14
  s_and_b32 s27, s27, 7
  s_lshl_b32 s27, s27, 10
  s_add_u32 s27, s27, s31
  s_add_u32 s27, s27, 104857600
  s_add_u32 s27, s27, s62
  v_add_u32 v105, s27, v9
  s_xor_b32 s27, s28, 64
  s_lshr_b32 s31, s27, 3
  s_lshl_b32 s31, s31, 14
  s_and_b32 s27, s27, 7
  s_lshl_b32 s27, s27, 10
  s_add_u32 s27, s27, s31
  s_add_u32 s27, s27, 104857600
  s_add_u32 s27, s27, s62
  v_add_u32 v106, s27, v9
  s_xor_b32 s27, s28, 96
  s_lshr_b32 s31, s27, 3
  s_lshl_b32 s31, s31, 14
  s_and_b32 s27, s27, 7
  s_lshl_b32 s27, s27, 10
  s_add_u32 s27, s27, s31
  s_add_u32 s27, s27, 104857600
  s_add_u32 s27, s27, s62
  v_add_u32 v107, s27, v9
  s_branch .rc6
.rc3:
  s_and_b32 s27, s28, 0xfc
  s_lshl_b32 s27, s27, 11
  s_add_u32 s27, s27, 105906176
  v_lshrrev_b32 v13, 3, v2
  v_lshl_add_u32 v11, v13, 2, v3
  v_lshl_add_u32 v11, v11, 3, v14
  v_lshl_add_u32 v11, v11, 4, s27
  v_add_u32 v12, 4096, v11
  v_lshrrev_b32 v104, 1, v3
  v_lshl_add_u32 v104, v104, 3, v14
  v_lshlrev_b32 v104, 2, v104
  v_and_b32 v105, 1, v3
  v_lshl_add_u32 v104, v105, 1, v104
  v_add_u32 v104, v104, v13
  v_lshl_add_u32 v104, v104, 2, s27
  v_add_u32 v105, 4096, v104
  s_add_u32 s27, s29, 107216896
  v_lshl_add_u32 v13, v3, 3, v14
  v_lshl_add_u32 v13, v13, 4, s27
  v_lshrrev_b32 v106, 2, v2
  v_lshlrev_b32 v106, 3, v106
  v_and_b32 v107, 3, v2
  v_add_u32 v106, v106, v107
  v_lshlrev_b32 v106, 5, v106
  v_lshl_add_u32 v106, v3, 3, v106
  s_lshl_b32 s27, s28, 11
  s_add_u32 s27, s27, 105906176
  v_add_u32 v108, s27, v9
  v_mov_b32 v110, 0x3f803f80
  v_mov_b32 v111, 0x3f803f80
  v_mov_b32 v112, 0x3f803f80
  v_mov_b32 v113, 0x3f803f80
  v_mov_b32 v88, 0
  v_mov_b32 v89, 0
  v_mov_b32 v90, 0
  v_mov_b32 v91, 0
  v_mov_b32 v92, 0
  v_mov_b32 v93, 0
  v_mov_b32 v94, 0
  v_mov_b32 v95, 0
  v_mov_b32 v96, 0
  v_mov_b32 v97, 0
  v_mov_b32 v98, 0
  v_mov_b32 v99, 0
  s_branch .rc6
.rc4:
  s_lshl_b32 s27, s58, 11
  s_lshl_b32 s31, s30, 9
  s_add_u32 s27, s27, s31
  s_add_u32 s27, s27, 94371840
  v_lshl_add_u32 v11, v3, 3, v14
  v_lshl_add_u32 v11, v11, 4, s27
  v_lshrrev_b32 v12, 3, v2
  v_lshlrev_b32 v12, 4, v12
  v_add_u32 v12, v12, v14
  v_and_b32 v13, 1, v3
  v_lshl_add_u32 v12, v13, 5, v12
  v_lshrrev_b32 v13, 1, v3
  v_lshl_add_u32 v12, v13, 6, v12
  s_lshl_b32 s27, s28, 11
  v_lshl_add_u32 v12, v12, 4, s27
  s_barrier
  s_mov_b32 s26, 0
.rc_k0:
  buffer_load_dword v110, off, s[4:7], s97 offset:4 sc0 sc1
  s_sub_u32 s50, s50, 1
  s_cbranch_scc1 .rec_end
  s_waitcnt vmcnt(0)
  v_readfirstlane_b32 s27, v110
  s_cmp_lg_u32 s27, 128
  s_cbranch_scc1 .rc_k0
  v_readfirstlane_b32 s27, v110
  s_cmp_lg_u32 s27, 128
  s_cbranch_scc1 .kf7
.kf7k:
  s_add_u32 s61, s26, 4
  s_and_b32 s25, s26, 4
  s_lshl_b32 s25, s25, 12
  s_lshl_b32 s26, s26, 18
  s_add_u32 m0, s25, 18432
  s_add_u32 s27, s26, 25165824
  buffer_load_dwordx4 v12, s[4:7], s27 offen offset:0 lds
  s_add_u32 s27, s26, 25164928
  buffer_load_dwordx4 v12, s[4:7], s27 offen offset:1024 lds
  s_add_u32 s27, s26, 41940992
  buffer_load_dwordx4 v12, s[4:7], s27 offen offset:2048 lds
  s_add_u32 s27, s26, 41940096
  buffer_load_dwordx4 v12, s[4:7], s27 offen offset:3072 lds
  s_add_u32 m0, s25, 22528
  s_add_u32 s27, s26, 25427968
  buffer_load_dwordx4 v12, s[4:7], s27 offen offset:0 lds
  s_add_u32 s27, s26, 25427072
  buffer_load_dwordx4 v12, s[4:7], s27 offen offset:1024 lds
  s_add_u32 s27, s26, 42203136
  buffer_load_dwordx4 v12, s[4:7], s27 offen offset:2048 lds
  s_add_u32 s27, s26, 42202240
  buffer_load_dwordx4 v12, s[4:7], s27 offen offset:3072 lds
  s_add_u32 m0, s25, 26624
  s_add_u32 s27, s26, 25690112
  buffer_load_dwordx4 v12, s[4:7], s27 offen offset:0 lds
  s_add_u32 s27, s26, 25689216
  buffer_load_dwordx4 v12, s[4:7], s27 offen offset:1024 lds
  s_add_u32 s27, s26, 42465280
  buffer_load_dwordx4 v12, s[4:7], s27 offen offset:2048 lds
  s_add_u32 s27, s26, 42464384
  buffer_load_dwordx4 v12, s[4:7], s27 offen offset:3072 lds
  s_add_u32 m0, s25, 30720
  s_add_u32 s27, s26, 25952256
  buffer_load_dwordx4 v12, s[4:7], s27 offen offset:0 lds
  s_add_u32 s27, s26, 25951360
  buffer_load_dwordx4 v12, s[4:7], s27 offen offset:1024 lds
  s_add_u32 s27, s26, 42727424
  buffer_load_dwordx4 v12, s[4:7], s27 offen offset:2048 lds
  s_add_u32 s27, s26, 42726528
  buffer_load_dwordx4 v12, s[4:7], s27 offen offset:3072 lds
  s_and_b32 s27, s61, 7
  s_cbranch_scc1 .kf7n
  s_lshr_b32 s61, s61, 1
  buffer_load_dword v110, off, s[8:11], s61 offset:16 sc0 sc1
.kf7n:
  s_waitcnt vmcnt(0)
  s_branch .rc_go
.rc5:
  s_lshl_b32 s27, s58, 11
  s_lshl_b32 s31, s30, 9
  s_add_u32 s27, s27, s31
  s_add_u32 s27, s27, 98566144
  v_lshl_add_u32 v11, v1, 3, s27
  v_and_b32 v12, 0x13, v1
  v_bfe_u32 v13, v1, 2, 1
  v_lshl_add_u32 v12, v13, 3, v12
  v_bfe_u32 v13, v1, 3, 1
  v_lshl_add_u32 v12, v13, 2, v12
  v_lshlrev_b32 v12, 5, v12
  v_lshrrev_b32 v13, 5, v1
  v_lshl_add_u32 v12, v13, 4, v12
  s_add_u32 s27, s29, 106954752
  v_lshl_add_u32 v13, v1, 3, s27
.rc6:
  s_barrier
.rc_go:
  s_barrier
  s_lshl_b32 s63, s44, 6
  s_add_u32 s63, s63, s45
  s_lshl_b32 s63, s63, 8
  s_add_u32 s63, s63, s62
  s_add_u32 s63, s63, 105381888
.rc_pre:
  s_and_b32 s26, s46, 3
  s_lshl_b32 s47, s26, 16
  s_lshl_b32 s48, s26, 18
  s_and_b32 s27, s46, 7
  s_lshl_b32 s27, s27, 12
  s_and_b32 s26, s23, 1
  s_lshl_b32 s26, s26, 11
  s_add_u32 s27, s27, s26
  v_add_u32 v8, s27, v9
  s_waitcnt vmcnt(0) lgkmcnt(0)
.rc_step:
  s_barrier
  buffer_load_dwordx4 v[16:19], v4, s[4:7], s47 offen offset:0 sc1
  v_mov_b32 v32, 0
  v_mov_b32 v33, 0
  v_mov_b32 v34, 0
  v_mov_b32 v35, 0
  v_mov_b32 v36, 0
  v_mov_b32 v37, 0
  v_mov_b32 v38, 0
  v_mov_b32 v39, 0
  buffer_load_dwordx4 v[20:23], v4, s[4:7], s47 offen offset:1024 sc1
  v_mov_b32 v40, 0
  v_mov_b32 v41, 0
  v_mov_b32 v42, 0
  v_mov_b32 v43, 0
  v_mov_b32 v44, 0
  v_mov_b32 v45, 0
  v_mov_b32 v46, 0
  v_mov_b32 v47, 0
  buffer_load_dwordx4 v[24:27], v4, s[4:7], s47 offen offset:2048 sc1
  v_mov_b32 v48, 0
  v_mov_b32 v49, 0
  v_mov_b32 v50, 0
  v_mov_b32 v51, 0
  v_mov_b32 v52, 0
  v_mov_b32 v53, 0
  v_mov_b32 v54, 0
  v_mov_b32 v55, 0
  buffer_load_dwordx4 v[28:31], v4, s[4:7], s47 offen offset:3072 sc1
  ds_read_b128 v[120:123], v8 offset:18432
  ds_read_b128 v[124:127], v8 offset:19456
  s_waitcnt vmcnt(3)
  v_max3_u32 v14, v16, v17, v18
  v_max_u32 v14, v14, v19
  v_cmp_eq_u32 vcc, -1, v14
  s_cbranch_vccnz .g8n0_0
  v_smfmac_f32_16x16x64_bf16 v[32:35], v[16:19], a[0:7], v15
  v_smfmac_f32_16x16x64_bf16 v[40:43], v[16:19], a[16:23], v15
  v_smfmac_f32_16x16x64_bf16 v[36:39], v[16:19], a[8:15], v15
  v_smfmac_f32_16x16x64_bf16 v[44:47], v[16:19], a[24:31], v15
  s_waitcnt vmcnt(2)
  v_max3_u32 v14, v20, v21, v22
  v_max_u32 v14, v14, v23
  v_cmp_eq_u32 vcc, -1, v14
  s_cbranch_vccnz .g8n1_0
  v_smfmac_f32_16x16x64_bf16 v[32:35], v[20:23], a[48:55], v15
  v_smfmac_f32_16x16x64_bf16 v[40:43], v[20:23], a[64:71], v15
  v_smfmac_f32_16x16x64_bf16 v[36:39], v[20:23], a[56:63], v15
  v_smfmac_f32_16x16x64_bf16 v[44:47], v[20:23], a[72:79], v15
  s_waitcnt vmcnt(1)
  v_max3_u32 v14, v24, v25, v26
  v_max_u32 v14, v14, v27
  v_cmp_eq_u32 vcc, -1, v14
  s_cbranch_vccnz .g8n2_0
  v_smfmac_f32_16x16x64_bf16 v[32:35], v[24:27], a[96:103], v15
  v_smfmac_f32_16x16x64_bf16 v[40:43], v[24:27], a[112:119], v15
  v_smfmac_f32_16x16x64_bf16 v[36:39], v[24:27], a[104:111], v15
  v_smfmac_f32_16x16x64_bf16 v[44:47], v[24:27], a[120:127], v15
  s_waitcnt vmcnt(0)
  v_max3_u32 v14, v28, v29, v30
  v_max_u32 v14, v14, v31
  v_cmp_eq_u32 vcc, -1, v14
  s_cbranch_vccnz .g8n3_0
  v_smfmac_f32_16x16x64_bf16 v[32:35], v[28:31], a[144:151], v15
  v_smfmac_f32_16x16x64_bf16 v[40:43], v[28:31], a[160:167], v15
  v_smfmac_f32_16x16x64_bf16 v[36:39], v[28:31], a[152:159], v15
  v_smfmac_f32_16x16x64_bf16 v[44:47], v[28:31], a[168:175], v15
.g8l0:
  s_nop 5
  v_permlane32_swap_b32 v32, v40
  v_permlane32_swap_b32 v33, v41
  v_permlane32_swap_b32 v34, v42
  v_permlane32_swap_b32 v35, v43
  v_permlane32_swap_b32 v36, v44
  v_permlane32_swap_b32 v37, v45
  v_permlane32_swap_b32 v38, v46
  v_permlane32_swap_b32 v39, v47
  v_pk_add_f32 v[32:33], v[32:33], v[40:41]
  v_pk_add_f32 v[36:37], v[36:37], v[44:45]
  ds_write2_b32 v6, v32, v36 offset0:0 offset1:16
  ds_write2_b32 v6, v33, v37 offset0:36 offset1:52
  v_pk_add_f32 v[34:35], v[34:35], v[42:43]
  v_pk_add_f32 v[38:39], v[38:39], v[46:47]
  ds_write2_b32 v6, v34, v38 offset0:72 offset1:88
  ds_write2_b32 v6, v35, v39 offset0:108 offset1:124
  s_waitcnt lgkmcnt(0)
  s_barrier
  s_cmp_lg_u32 s23, 0
  s_cbranch_scc1 .rx9
  ds_read_b128 v[56:59], v10 offset:0
  ds_read_b128 v[60:63], v10 offset:16
  ds_read_b128 v[64:67], v10 offset:2304
  ds_read_b128 v[68:71], v10 offset:2320
  ds_read_b128 v[72:75], v10 offset:4608
  ds_read_b128 v[76:79], v10 offset:4624
  ds_read_b128 v[80:83], v10 offset:6912
  ds_read_b128 v[84:87], v10 offset:6928
  v_smfmac_f32_16x16x64_bf16 v[48:51], v[16:19], a[32:39], v15
  v_smfmac_f32_16x16x64_bf16 v[52:55], v[16:19], a[40:47], v15
  v_smfmac_f32_16x16x64_bf16 v[48:51], v[20:23], a[80:87], v15
  v_smfmac_f32_16x16x64_bf16 v[52:55], v[20:23], a[88:95], v15
  s_waitcnt lgkmcnt(4)
  v_pk_add_f32 v[56:57], v[56:57], v[64:65]
  v_pk_add_f32 v[58:59], v[58:59], v[66:67]
  v_pk_add_f32 v[60:61], v[60:61], v[68:69]
  v_pk_add_f32 v[62:63], v[62:63], v[70:71]
  s_waitcnt lgkmcnt(2)
  v_pk_add_f32 v[56:57], v[56:57], v[72:73]
  v_pk_add_f32 v[58:59], v[58:59], v[74:75]
  v_pk_add_f32 v[60:61], v[60:61], v[76:77]
  v_pk_add_f32 v[62:63], v[62:63], v[78:79]
  s_waitcnt lgkmcnt(0)
  v_pk_add_f32 v[56:57], v[56:57], v[80:81]
  v_pk_add_f32 v[58:59], v[58:59], v[82:83]
  v_pk_add_f32 v[60:61], v[60:61], v[84:85]
  v_pk_add_f32 v[62:63], v[62:63], v[86:87]
  v_cvt_pk_bf16_f32 v88, v56, v57
  v_cvt_pk_bf16_f32 v89, v58, v59
  v_cvt_pk_bf16_f32 v90, v60, v61
  v_cvt_pk_bf16_f32 v91, v62, v63
  s_nop 1
  v_mfma_f32_16x16x32_bf16 v[56:59], v[120:123], v[88:91], 0
  v_mfma_f32_16x16x32_bf16 v[60:63], v[124:127], v[88:91], 0
  v_mfma_f32_16x16x32_bf16 v[64:67], v[88:91], v[88:91], 0
  s_nop 2
  s_cmp_lg_u32 s53, 0
  s_cbranch_scc1 .st13
  s_mov_b64 exec, s[54:55]
  buffer_store_dwordx4 v[56:59], v11, s[4:7], s48 offen
  buffer_store_dwordx4 v[60:63], v11, s[4:7], s48 offen offset:512
  s_mov_b64 exec, s[56:57]
  buffer_store_dwordx4 v[64:67], v11, s[4:7], s48 offen offset:768
  s_mov_b64 exec, -1
.st14:
  v_smfmac_f32_16x16x64_bf16 v[48:51], v[24:27], a[128:135], v15
  v_smfmac_f32_16x16x64_bf16 v[52:55], v[24:27], a[136:143], v15
  v_smfmac_f32_16x16x64_bf16 v[48:51], v[28:31], a[176:183], v15
  v_smfmac_f32_16x16x64_bf16 v[52:55], v[28:31], a[184:191], v15
  s_nop 6
  s_nop 0
  v_permlane32_swap_b32 v48, v52
  v_permlane32_swap_b32 v49, v53
  v_permlane32_swap_b32 v50, v54
  v_permlane32_swap_b32 v51, v55
  v_pk_add_f32 v[48:49], v[48:49], v[52:53]
  v_pk_add_f32 v[50:51], v[50:51], v[54:55]
  ds_write_b128 v7, v[48:51] offset:9216
  s_waitcnt lgkmcnt(0)
  s_barrier
  s_and_b32 s34, s46, 1
  s_lshl_b32 s34, s34, 18
  s_bfe_u32 s35, s46, 0x10001
  s_branch .rx12
.rx9:
  v_smfmac_f32_16x16x64_bf16 v[48:51], v[16:19], a[32:39], v15
  v_smfmac_f32_16x16x64_bf16 v[52:55], v[16:19], a[40:47], v15
  v_smfmac_f32_16x16x64_bf16 v[48:51], v[20:23], a[80:87], v15
  v_smfmac_f32_16x16x64_bf16 v[52:55], v[20:23], a[88:95], v15
  v_smfmac_f32_16x16x64_bf16 v[48:51], v[24:27], a[128:135], v15
  v_smfmac_f32_16x16x64_bf16 v[52:55], v[24:27], a[136:143], v15
  v_smfmac_f32_16x16x64_bf16 v[48:51], v[28:31], a[176:183], v15
  v_smfmac_f32_16x16x64_bf16 v[52:55], v[28:31], a[184:191], v15
  s_nop 6
  s_nop 0
  v_permlane32_swap_b32 v48, v52
  v_permlane32_swap_b32 v49, v53
  v_permlane32_swap_b32 v50, v54
  v_permlane32_swap_b32 v51, v55
  v_pk_add_f32 v[48:49], v[48:49], v[52:53]
  v_pk_add_f32 v[50:51], v[50:51], v[54:55]
  ds_write_b128 v7, v[48:51] offset:9216
  s_waitcnt lgkmcnt(0)
  s_cmp_eq_u32 s23, 2
  s_cbranch_scc1 .rx10
  s_cmp_eq_u32 s23, 3
  s_cbranch_scc1 .rx11
  s_mov_b32 s27, 1040356334
  s_cmp_eq_u32 s46, 63
  s_cbranch_scc1 .l6315
  buffer_load_dwordx4 v[56:59], v11, s[4:7], s48 offen offset:0 sc1
  buffer_load_dwordx4 v[60:63], v11, s[4:7], s48 offen offset:2048 sc1
  buffer_load_dwordx4 v[64:67], v12, s[4:7], s48 offen offset:0 sc1
  buffer_load_dwordx4 v[68:71], v12, s[4:7], s48 offen offset:2048 sc1
  buffer_load_dword v72, v104, s[4:7], s48 offen offset:1024 sc1
  buffer_load_dword v73, v104, s[4:7], s48 offen offset:3072 sc1
  buffer_load_dword v74, v105, s[4:7], s48 offen offset:1024 sc1
  buffer_load_dword v75, v105, s[4:7], s48 offen offset:3072 sc1
  buffer_load_dwordx4 v[56:59], v11, s[4:7], s48 offen offset:0 sc1
  buffer_load_dwordx4 v[60:63], v11, s[4:7], s48 offen offset:2048 sc1
  buffer_load_dwordx4 v[64:67], v12, s[4:7], s48 offen offset:0 sc1
  buffer_load_dwordx4 v[68:71], v12, s[4:7], s48 offen offset:2048 sc1
  buffer_load_dword v72, v104, s[4:7], s48 offen offset:1024 sc1
  buffer_load_dword v73, v104, s[4:7], s48 offen offset:3072 sc1
  buffer_load_dword v74, v105, s[4:7], s48 offen offset:1024 sc1
  buffer_load_dword v75, v105, s[4:7], s48 offen offset:3072 sc1
.sp16c:
  s_waitcnt vmcnt(8)
  v_pk_add_f32 v[80:81], v[56:57], v[60:61]
  v_pk_add_f32 v[82:83], v[58:59], v[62:63]
  v_pk_add_f32 v[84:85], v[72:73], v[74:75]
  v_pk_add_f32 v[80:81], v[80:81], v[64:65]
  v_pk_add_f32 v[82:83], v[82:83], v[66:67]
  v_add_f32 v84, v84, v85
  v_pk_add_f32 v[80:81], v[80:81], v[68:69]
  v_pk_add_f32 v[82:83], v[82:83], v[70:71]
  v_pk_add_f32 v[86:87], v[80:81], v[82:83]
  v_max3_f32 v14, v80, v81, v84
  v_add_f32 v86, v86, v87
  v_max3_f32 v14, v14, v82, v83
  v_cmp_u_f32 vcc, v86, v84
  s_cbranch_vccnz .sp16
.sp16k:
  s_barrier
  ds_read_b64 v[32:33], v106 offset:9216
  ds_read_b64 v[34:35], v106 offset:10240
  ds_read_b64 v[36:37], v106 offset:11264
  ds_read_b64 v[38:39], v106 offset:12288
  ds_read_b64 v[40:41], v106 offset:9344
  ds_read_b64 v[42:43], v106 offset:10368
  ds_read_b64 v[44:45], v106 offset:11392
  ds_read_b64 v[46:47], v106 offset:12416
  v_max_f32_dpp v14, v14, v14 row_ror:8 row_mask:0xf bank_mask:0xf
  v_mov_b32 v85, v14
  s_nop 1
  v_permlane16_swap_b32 v85, v14
  v_max_f32 v14, v85, v14
  v_mov_b32 v85, v14
  s_nop 1
  v_permlane32_swap_b32 v85, v14
  v_max_f32 v14, v85, v14
  v_mul_f32 v14, s27, v14
  v_fma_f32 v84, v84, s27, -v14
  v_fma_f32 v80, v80, s27, -v14
  v_fma_f32 v81, v81, s27, -v14
  v_fma_f32 v82, v82, s27, -v14
  v_fma_f32 v83, v83, s27, -v14
  s_waitcnt lgkmcnt(0)
  v_exp_f32 v84, v84
  v_exp_f32 v80, v80
  v_exp_f32 v81, v81
  v_exp_f32 v82, v82
  v_exp_f32 v83, v83
  v_pk_add_f32 v[32:33], v[32:33], v[34:35]
  v_pk_add_f32 v[36:37], v[36:37], v[38:39]
  v_pk_add_f32 v[32:33], v[32:33], v[36:37]
  v_cvt_pk_bf16_f32 v88, v32, v33
  v_pk_add_f32 v[40:41], v[40:41], v[42:43]
  v_pk_add_f32 v[44:45], v[44:45], v[46:47]
  v_pk_add_f32 v[40:41], v[40:41], v[44:45]
  v_cvt_pk_bf16_f32 v92, v40, v41
  v_mov_b32_dpp v85, v84 row_ror:8 row_mask:0xf bank_mask:0xf
  v_cvt_pk_bf16_f32 v76, v80, v81
  v_cvt_pk_bf16_f32 v77, v82, v83
  v_cvt_pk_bf16_f32 v96, v84, v85
  v_mov_b32_dpp v78, v76 row_ror:8 row_mask:0xf bank_mask:0xf
  v_mov_b32_dpp v79, v77 row_ror:8 row_mask:0xf bank_mask:0xf
  v_mfma_f32_16x16x32_bf16 v[40:43], v[110:113], v[96:99], 0
  v_mfma_f32_16x16x32_bf16 v[32:35], v[88:91], v[96:99], 0
  v_mfma_f32_16x16x32_bf16 v[40:43], v[110:113], v[76:79], v[40:43]
  v_mfma_f32_16x16x32_bf16 v[32:35], v[120:123], v[76:79], v[32:35]
  v_mfma_f32_16x16x32_bf16 v[36:39], v[92:95], v[96:99], 0
  v_mfma_f32_16x16x32_bf16 v[36:39], v[124:127], v[76:79], v[36:39]
  s_nop 4
  v_rcp_f32 v40, v40
  s_nop 0
  v_pk_mul_f32 v[32:33], v[32:33], v[40:41] op_sel_hi:[1,0]
  v_pk_mul_f32 v[34:35], v[34:35], v[40:41] op_sel_hi:[1,0]
  v_pk_mul_f32 v[36:37], v[36:37], v[40:41] op_sel_hi:[1,0]
  v_pk_mul_f32 v[38:39], v[38:39], v[40:41] op_sel_hi:[1,0]
  v_cvt_pk_bf16_f32 v44, v32, v33
  v_cvt_pk_bf16_f32 v45, v34, v35
  v_cvt_pk_bf16_f32 v46, v36, v37
  v_cvt_pk_bf16_f32 v47, v38, v39
  v_min_u32 v44, -2, v44
  v_min_u32 v45, -2, v45
  v_min_u32 v46, -2, v46
  v_min_u32 v47, -2, v47
  s_cmp_lg_u32 s53, 0
  s_cbranch_scc1 .st17
  s_mov_b64 exec, s[54:55]
  buffer_store_dwordx4 v[44:47], v13, s[4:7], s47 offen
  s_mov_b64 exec, -1
.st18:
  s_branch .rx12
.rx10:
  s_barrier
  ds_read_b128 v[56:59], v10 offset:0
  ds_read_b128 v[60:63], v10 offset:16
  ds_read_b128 v[64:67], v10 offset:2304
  ds_read_b128 v[68:71], v10 offset:2320
  ds_read_b128 v[72:75], v10 offset:4608
  ds_read_b128 v[76:79], v10 offset:4624
  ds_read_b128 v[80:83], v10 offset:6912
  ds_read_b128 v[84:87], v10 offset:6928
  s_waitcnt lgkmcnt(4)
  v_pk_add_f32 v[56:57], v[56:57], v[64:65]
  v_pk_add_f32 v[58:59], v[58:59], v[66:67]
  v_pk_add_f32 v[60:61], v[60:61], v[68:69]
  v_pk_add_f32 v[62:63], v[62:63], v[70:71]
  s_waitcnt lgkmcnt(2)
  v_pk_add_f32 v[56:57], v[56:57], v[72:73]
  v_pk_add_f32 v[58:59], v[58:59], v[74:75]
  v_pk_add_f32 v[60:61], v[60:61], v[76:77]
  v_pk_add_f32 v[62:63], v[62:63], v[78:79]
  s_waitcnt lgkmcnt(0)
  v_pk_add_f32 v[56:57], v[56:57], v[80:81]
  v_pk_add_f32 v[58:59], v[58:59], v[82:83]
  v_pk_add_f32 v[60:61], v[60:61], v[84:85]
  v_pk_add_f32 v[62:63], v[62:63], v[86:87]
  v_cvt_pk_bf16_f32 v88, v56, v57
  v_cvt_pk_bf16_f32 v89, v58, v59
  v_cvt_pk_bf16_f32 v90, v60, v61
  v_cvt_pk_bf16_f32 v91, v62, v63
  s_branch .rx12
.rx11:
  s_barrier
  ds_read_b128 v[56:59], v12 offset:9216
  ds_read_b128 v[60:63], v12 offset:10240
  ds_read_b128 v[64:67], v12 offset:11264
  ds_read_b128 v[68:71], v12 offset:12288
  s_waitcnt lgkmcnt(2)
  v_pk_add_f32 v[56:57], v[56:57], v[60:61]
  v_pk_add_f32 v[58:59], v[58:59], v[62:63]
  s_waitcnt lgkmcnt(1)
  v_pk_add_f32 v[56:57], v[56:57], v[64:65]
  v_pk_add_f32 v[58:59], v[58:59], v[66:67]
  s_waitcnt lgkmcnt(0)
  v_pk_add_f32 v[56:57], v[56:57], v[68:69]
  v_pk_add_f32 v[58:59], v[58:59], v[70:71]
  v_cvt_pk_bf16_f32 v88, v56, v57
  v_cvt_pk_bf16_f32 v89, v58, v59
.rx12:
  s_cmp_eq_u32 s46, 63
  s_cbranch_scc1 .rc_last
  s_barrier
  buffer_load_dwordx4 v[16:19], v5, s[4:7], s47 offen offset:0 sc1
  v_mov_b32 v128, 0
  v_mov_b32 v129, 0
  v_mov_b32 v130, 0
  buffer_load_dwordx4 v[20:23], v5, s[4:7], s47 offen offset:1024 sc1
  v_mov_b32 v131, 0
  v_mov_b32 v132, 0
  v_mov_b32 v133, 0
  buffer_load_dwordx4 v[24:27], v5, s[4:7], s47 offen offset:2048 sc1
  v_mov_b32 v134, 0
  v_mov_b32 v135, 0
  buffer_load_dwordx4 v[28:31], v5, s[4:7], s47 offen offset:3072 sc1
  s_waitcnt vmcnt(3)
  v_max3_u32 v14, v16, v17, v18
  v_max_u32 v14, v14, v19
  v_cmp_eq_u32 vcc, -1, v14
  s_cbranch_vccnz .g19n0_0
  v_smfmac_f32_16x16x64_bf16 v[128:131], v[16:19], a[192:199], v15
  v_smfmac_f32_16x16x64_bf16 v[132:135], v[16:19], a[200:207], v15
  s_waitcnt vmcnt(2)
  v_max3_u32 v14, v20, v21, v22
  v_max_u32 v14, v14, v23
  v_cmp_eq_u32 vcc, -1, v14
  s_cbranch_vccnz .g19n1_0
  v_smfmac_f32_16x16x64_bf16 v[128:131], v[20:23], a[208:215], v15
  v_smfmac_f32_16x16x64_bf16 v[132:135], v[20:23], a[216:223], v15
  s_waitcnt vmcnt(1)
  v_max3_u32 v14, v24, v25, v26
  v_max_u32 v14, v14, v27
  v_cmp_eq_u32 vcc, -1, v14
  s_cbranch_vccnz .g19n2_0
  v_smfmac_f32_16x16x64_bf16 v[128:131], v[24:27], a[224:231], v15
  v_smfmac_f32_16x16x64_bf16 v[132:135], v[24:27], a[232:239], v15
  s_waitcnt vmcnt(0)
  v_max3_u32 v14, v28, v29, v30
  v_max_u32 v14, v14, v31
  v_cmp_eq_u32 vcc, -1, v14
  s_cbranch_vccnz .g19n3_0
  v_smfmac_f32_16x16x64_bf16 v[128:131], v[28:31], a[240:247], v15
  v_smfmac_f32_16x16x64_bf16 v[132:135], v[28:31], a[248:255], v15
.g19l0:
  s_nop 7
  v_permlane32_swap_b32 v128, v132
  v_permlane32_swap_b32 v129, v133
  v_permlane32_swap_b32 v130, v134
  v_permlane32_swap_b32 v131, v135
  v_pk_add_f32 v[128:129], v[128:129], v[132:133]
  ds_write2_b32 v109, v128, v129 offset0:0 offset1:36
  v_pk_add_f32 v[130:131], v[130:131], v[134:135]
  ds_write2_b32 v109, v130, v131 offset0:72 offset1:108
  s_cmp_eq_u32 s23, 0
  s_waitcnt lgkmcnt(0)
  s_barrier
  s_cbranch_scc1 .rc_e
.rc_last:
  s_lshl_b32 s59, s46, 16
  s_xor_b32 s51, s47, 0x20000
  s_xor_b32 s52, s48, 0x80000
  s_add_u32 s46, s46, 1
  s_cmp_eq_u32 s23, 2
  s_cbranch_scc1 .rc_t2
  s_cmp_eq_u32 s23, 3
  s_cbranch_scc1 .rc_t3
  s_cmp_eq_u32 s46, 64
  s_cbranch_scc1 .rc_done
  s_cmp_lg_u32 s53, 0
  s_cbranch_scc1 .st20
  buffer_store_dwordx4 v[100:103], v108, s[4:7], s52 offen
  buffer_store_dwordx4 v[100:103], v108, s[4:7], s52 offen offset:1024
  buffer_store_dwordx4 v[100:103], v13, s[4:7], s51 offen
.st21:
  s_branch .rc_pre
.rc_t3:
  s_cmp_gt_u32 s46, 60
  s_cbranch_scc1 .rc_p31
  s_and_b32 s26, s46, 3
  s_cbranch_scc0 .rc_p34
  v_mov_b32 v148, v144
  v_mov_b32 v149, v145
  v_mov_b32 v144, v140
  v_mov_b32 v145, v141
  v_mov_b32 v140, v88
  v_mov_b32 v141, v89
  s_branch .rc_p30
.rc_p34:
  s_sub_u32 s26, s59, 65536
  buffer_store_dwordx2 v[140:141], v11, s[4:7], s26 offen sc1
  s_sub_u32 s26, s59, 131072
  buffer_store_dwordx2 v[144:145], v11, s[4:7], s26 offen sc1
  s_sub_u32 s26, s59, 196608
  buffer_store_dwordx2 v[148:149], v11, s[4:7], s26 offen sc1
.rc_p31:
  buffer_store_dwordx2 v[88:89], v11, s[4:7], s59 offen sc1
.rc_p30:
  s_and_b32 s26, s46, 3
  s_cmp_gt_u32 s46, 60
  s_cselect_b32 s26, 1, s26
  s_cmp_lg_u32 s26, 1
  s_cbranch_scc1 .rc_t3b
  v_mov_b32 v110, s46
  s_mov_b64 exec, 1
  buffer_store_dword v110, off, s[4:7], s63 sc1
  s_mov_b64 exec, -1
.rc_t3b:
  s_cmp_eq_u32 s46, 64
  s_cbranch_scc1 .rc_done
  s_cmp_lg_u32 s53, 0
  s_cbranch_scc1 .st22
  buffer_store_dwordx2 v[100:101], v13, s[4:7], s51 offen
.st23:
  s_branch .rc_pre
.rc_t2:
  s_not_b64 exec, s[54:55]
  s_cmp_gt_u32 s46, 60
  s_cbranch_scc1 .rc_p21
  s_and_b32 s26, s46, 3
  s_cbranch_scc0 .rc_p24
  v_mov_b32 v148, v144
  v_mov_b32 v149, v145
  v_mov_b32 v150, v146
  v_mov_b32 v151, v147
  v_mov_b32 v144, v140
  v_mov_b32 v145, v141
  v_mov_b32 v146, v142
  v_mov_b32 v147, v143
  v_mov_b32 v140, v88
  v_mov_b32 v141, v89
  v_mov_b32 v142, v90
  v_mov_b32 v143, v91
  s_branch .rc_p20
.rc_p24:
  s_sub_u32 s26, s59, 65536
  buffer_store_dwordx4 v[140:143], v11, s[4:7], s26 offen sc1
  s_sub_u32 s26, s59, 131072
  buffer_store_dwordx4 v[144:147], v11, s[4:7], s26 offen sc1
  s_sub_u32 s26, s59, 196608
  buffer_store_dwordx4 v[148:151], v11, s[4:7], s26 offen sc1
.rc_p21:
  buffer_store_dwordx4 v[88:91], v11, s[4:7], s59 offen sc1
.rc_p20:
  s_mov_b64 exec, -1
  s_cmp_eq_u32 s46, 64
  s_cbranch_scc1 .rc_done
  s_and_b32 s26, s46, 3
  s_cbranch_scc1 .rc_pre
  s_mov_b32 s26, s46
  v_readfirstlane_b32 s27, v110
  s_cmp_lg_u32 s27, 128
  s_cbranch_scc1 .kf24
.kf24k:
  s_add_u32 s61, s26, 4
  s_and_b32 s25, s26, 4
  s_lshl_b32 s25, s25, 12
  s_lshl_b32 s26, s26, 18
  s_add_u32 m0, s25, 18432
  s_add_u32 s27, s26, 25165824
  buffer_load_dwordx4 v12, s[4:7], s27 offen offset:0 lds
  s_add_u32 s27, s26, 25164928
  buffer_load_dwordx4 v12, s[4:7], s27 offen offset:1024 lds
  s_add_u32 s27, s26, 41940992
  buffer_load_dwordx4 v12, s[4:7], s27 offen offset:2048 lds
  s_add_u32 s27, s26, 41940096
  buffer_load_dwordx4 v12, s[4:7], s27 offen offset:3072 lds
  s_add_u32 m0, s25, 22528
  s_add_u32 s27, s26, 25427968
  buffer_load_dwordx4 v12, s[4:7], s27 offen offset:0 lds
  s_add_u32 s27, s26, 25427072
  buffer_load_dwordx4 v12, s[4:7], s27 offen offset:1024 lds
  s_add_u32 s27, s26, 42203136
  buffer_load_dwordx4 v12, s[4:7], s27 offen offset:2048 lds
  s_add_u32 s27, s26, 42202240
  buffer_load_dwordx4 v12, s[4:7], s27 offen offset:3072 lds
  s_add_u32 m0, s25, 26624
  s_add_u32 s27, s26, 25690112
  buffer_load_dwordx4 v12, s[4:7], s27 offen offset:0 lds
  s_add_u32 s27, s26, 25689216
  buffer_load_dwordx4 v12, s[4:7], s27 offen offset:1024 lds
  s_add_u32 s27, s26, 42465280
  buffer_load_dwordx4 v12, s[4:7], s27 offen offset:2048 lds
  s_add_u32 s27, s26, 42464384
  buffer_load_dwordx4 v12, s[4:7], s27 offen offset:3072 lds
  s_add_u32 m0, s25, 30720
  s_add_u32 s27, s26, 25952256
  buffer_load_dwordx4 v12, s[4:7], s27 offen offset:0 lds
  s_add_u32 s27, s26, 25951360
  buffer_load_dwordx4 v12, s[4:7], s27 offen offset:1024 lds
  s_add_u32 s27, s26, 42727424
  buffer_load_dwordx4 v12, s[4:7], s27 offen offset:2048 lds
  s_add_u32 s27, s26, 42726528
  buffer_load_dwordx4 v12, s[4:7], s27 offen offset:3072 lds
  s_and_b32 s27, s61, 7
  s_cbranch_scc1 .kf24n
  s_lshr_b32 s61, s61, 1
  buffer_load_dword v110, off, s[8:11], s61 offset:16 sc0 sc1
.kf24n:
  s_branch .rc_pre
.rc_e:
  ds_read_b128 v[56:59], v12 offset:13312
  ds_read_b128 v[60:63], v12 offset:14464
  ds_read_b128 v[64:67], v12 offset:15616
  ds_read_b128 v[68:71], v12 offset:16768
  s_waitcnt lgkmcnt(2)
  v_pk_add_f32 v[56:57], v[56:57], v[60:61]
  v_pk_add_f32 v[58:59], v[58:59], v[62:63]
  s_waitcnt lgkmcnt(1)
  v_pk_add_f32 v[56:57], v[56:57], v[64:65]
  v_pk_add_f32 v[58:59], v[58:59], v[66:67]
  s_waitcnt lgkmcnt(0)
  v_pk_add_f32 v[56:57], v[56:57], v[68:69]
  v_pk_add_f32 v[58:59], v[58:59], v[70:71]
  v_bfi_b32 v56, 1, s35, v56
  v_bfi_b32 v58, 1, s35, v58
  buffer_store_dwordx4 v[56:59], v104, s[4:7], s34 offen sc1
  s_add_u32 s46, s46, 1
  s_and_b32 s26, s46, 3
  s_lshl_b32 s47, s26, 16
  s_lshl_b32 s48, s26, 18
  s_and_b32 s27, s46, 7
  s_lshl_b32 s27, s27, 12
  s_and_b32 s26, s23, 1
  s_lshl_b32 s26, s26, 11
  s_add_u32 s27, s27, s26
  v_add_u32 v8, s27, v9
  s_waitcnt vmcnt(0)
.ep25:
  buffer_load_dwordx4 v[60:63], v105, s[4:7], s34 offen sc1
  buffer_load_dwordx4 v[64:67], v106, s[4:7], s34 offen sc1
  buffer_load_dwordx4 v[68:71], v107, s[4:7], s34 offen sc1
  s_sub_u32 s50, s50, 1
  s_cbranch_scc1 .rec_end
  s_waitcnt vmcnt(0)
  v_bitop3_b32 v14, v60, v62, s35 bitop3:0x7e
  v_bitop3_b32 v80, v64, v66, s35 bitop3:0x7e
  v_bitop3_b32 v81, v68, v70, s35 bitop3:0x7e
  v_or3_b32 v14, v14, v80, v81
  v_and_b32 v14, 1, v14
  v_cmp_ne_u32 vcc, 0, v14
  s_cbranch_vccnz .ep25
  v_pk_add_f32 v[72:73], v[56:57], v[60:61]
  v_pk_add_f32 v[74:75], v[58:59], v[62:63]
  v_pk_add_f32 v[76:77], v[64:65], v[68:69]
  v_pk_add_f32 v[78:79], v[66:67], v[70:71]
  v_pk_add_f32 v[72:73], v[72:73], v[76:77]
  v_pk_add_f32 v[74:75], v[74:75], v[78:79]
  v_cvt_pk_bf16_f32 v72, v72, v73
  v_cvt_pk_bf16_f32 v73, v74, v75
  v_min_u32 v72, -2, v72
  v_min_u32 v73, -2, v73
  s_cmp_lg_u32 s53, 0
  s_cbranch_scc1 .st26
  buffer_store_dwordx2 v[72:73], v13, s[4:7], s47 offen
.st27:
  s_branch .rc_step
.kf7:
  s_lshr_b32 s61, s26, 3
  s_lshl_b32 s61, s61, 2
.kf7p:
  buffer_load_dword v110, off, s[8:11], s61 offset:16 sc0 sc1
  s_sub_u32 s50, s50, 1
  s_cbranch_scc1 .rec_end
  s_waitcnt vmcnt(0)
  v_readfirstlane_b32 s27, v110
  s_cmp_lg_u32 s27, 128
  s_cbranch_scc1 .kf7p
  s_branch .kf7k
.g8n3_0:
  s_mov_b64 exec, vcc
  buffer_load_dwordx4 v[28:31], v4, s[4:7], s47 offen offset:3072 sc1
  s_mov_b64 exec, -1
  s_branch .g8l8
.g8n2_0:
  s_mov_b64 exec, vcc
  buffer_load_dwordx4 v[24:27], v4, s[4:7], s47 offen offset:2048 sc1
  s_mov_b64 exec, -1
  s_waitcnt vmcnt(1)
  v_max3_u32 v14, v28, v29, v30
  v_max_u32 v14, v14, v31
  v_cmp_eq_u32 vcc, -1, v14
  s_cbranch_vccnz .g8n3_4
  v_smfmac_f32_16x16x64_bf16 v[32:35], v[28:31], a[144:151], v15
  v_smfmac_f32_16x16x64_bf16 v[40:43], v[28:31], a[160:167], v15
  v_smfmac_f32_16x16x64_bf16 v[36:39], v[28:31], a[152:159], v15
  v_smfmac_f32_16x16x64_bf16 v[44:47], v[28:31], a[168:175], v15
  s_branch .g8l4
.g8n3_4:
  s_mov_b64 exec, vcc
  buffer_load_dwordx4 v[28:31], v4, s[4:7], s47 offen offset:3072 sc1
  s_mov_b64 exec, -1
  s_branch .g8l12
.g8n1_0:
  s_mov_b64 exec, vcc
  buffer_load_dwordx4 v[20:23], v4, s[4:7], s47 offen offset:1024 sc1
  s_mov_b64 exec, -1
  s_waitcnt vmcnt(2)
  v_max3_u32 v14, v24, v25, v26
  v_max_u32 v14, v14, v27
  v_cmp_eq_u32 vcc, -1, v14
  s_cbranch_vccnz .g8n2_2
  v_smfmac_f32_16x16x64_bf16 v[32:35], v[24:27], a[96:103], v15
  v_smfmac_f32_16x16x64_bf16 v[40:43], v[24:27], a[112:119], v15
  v_smfmac_f32_16x16x64_bf16 v[36:39], v[24:27], a[104:111], v15
  v_smfmac_f32_16x16x64_bf16 v[44:47], v[24:27], a[120:127], v15
  s_waitcnt vmcnt(1)
  v_max3_u32 v14, v28, v29, v30
  v_max_u32 v14, v14, v31
  v_cmp_eq_u32 vcc, -1, v14
  s_cbranch_vccnz .g8n3_2
  v_smfmac_f32_16x16x64_bf16 v[32:35], v[28:31], a[144:151], v15
  v_smfmac_f32_16x16x64_bf16 v[40:43], v[28:31], a[160:167], v15
  v_smfmac_f32_16x16x64_bf16 v[36:39], v[28:31], a[152:159], v15
  v_smfmac_f32_16x16x64_bf16 v[44:47], v[28:31], a[168:175], v15
  s_branch .g8l2
.g8n3_2:
  s_mov_b64 exec, vcc
  buffer_load_dwordx4 v[28:31], v4, s[4:7], s47 offen offset:3072 sc1
  s_mov_b64 exec, -1
  s_branch .g8l10
.g8n2_2:
  s_mov_b64 exec, vcc
  buffer_load_dwordx4 v[24:27], v4, s[4:7], s47 offen offset:2048 sc1
  s_mov_b64 exec, -1
  s_waitcnt vmcnt(2)
  v_max3_u32 v14, v28, v29, v30
  v_max_u32 v14, v14, v31
  v_cmp_eq_u32 vcc, -1, v14
  s_cbranch_vccnz .g8n3_6
  v_smfmac_f32_16x16x64_bf16 v[32:35], v[28:31], a[144:151], v15
  v_smfmac_f32_16x16x64_bf16 v[40:43], v[28:31], a[160:167], v15
  v_smfmac_f32_16x16x64_bf16 v[36:39], v[28:31], a[152:159], v15
  v_smfmac_f32_16x16x64_bf16 v[44:47], v[28:31], a[168:175], v15
  s_branch .g8l6
.g8n3_6:
  s_mov_b64 exec, vcc
  buffer_load_dwordx4 v[28:31], v4, s[4:7], s47 offen offset:3072 sc1
  s_mov_b64 exec, -1
  s_branch .g8l14
.g8n0_0:
  s_mov_b64 exec, vcc
  buffer_load_dwordx4 v[16:19], v4, s[4:7], s47 offen offset:0 sc1
  s_mov_b64 exec, -1
  s_waitcnt vmcnt(3)
  v_max3_u32 v14, v20, v21, v22
  v_max_u32 v14, v14, v23
  v_cmp_eq_u32 vcc, -1, v14
  s_cbranch_vccnz .g8n1_1
  v_smfmac_f32_16x16x64_bf16 v[32:35], v[20:23], a[48:55], v15
  v_smfmac_f32_16x16x64_bf16 v[40:43], v[20:23], a[64:71], v15
  v_smfmac_f32_16x16x64_bf16 v[36:39], v[20:23], a[56:63], v15
  v_smfmac_f32_16x16x64_bf16 v[44:47], v[20:23], a[72:79], v15
  s_waitcnt vmcnt(2)
  v_max3_u32 v14, v24, v25, v26
  v_max_u32 v14, v14, v27
  v_cmp_eq_u32 vcc, -1, v14
  s_cbranch_vccnz .g8n2_1
  v_smfmac_f32_16x16x64_bf16 v[32:35], v[24:27], a[96:103], v15
  v_smfmac_f32_16x16x64_bf16 v[40:43], v[24:27], a[112:119], v15
  v_smfmac_f32_16x16x64_bf16 v[36:39], v[24:27], a[104:111], v15
  v_smfmac_f32_16x16x64_bf16 v[44:47], v[24:27], a[120:127], v15
  s_waitcnt vmcnt(1)
  v_max3_u32 v14, v28, v29, v30
  v_max_u32 v14, v14, v31
  v_cmp_eq_u32 vcc, -1, v14
  s_cbranch_vccnz .g8n3_1
  v_smfmac_f32_16x16x64_bf16 v[32:35], v[28:31], a[144:151], v15
  v_smfmac_f32_16x16x64_bf16 v[40:43], v[28:31], a[160:167], v15
  v_smfmac_f32_16x16x64_bf16 v[36:39], v[28:31], a[152:159], v15
  v_smfmac_f32_16x16x64_bf16 v[44:47], v[28:31], a[168:175], v15
  s_branch .g8l1
.g8n3_1:
  s_mov_b64 exec, vcc
  buffer_load_dwordx4 v[28:31], v4, s[4:7], s47 offen offset:3072 sc1
  s_mov_b64 exec, -1
  s_branch .g8l9
.g8n2_1:
  s_mov_b64 exec, vcc
  buffer_load_dwordx4 v[24:27], v4, s[4:7], s47 offen offset:2048 sc1
  s_mov_b64 exec, -1
  s_waitcnt vmcnt(2)
  v_max3_u32 v14, v28, v29, v30
  v_max_u32 v14, v14, v31
  v_cmp_eq_u32 vcc, -1, v14
  s_cbranch_vccnz .g8n3_5
  v_smfmac_f32_16x16x64_bf16 v[32:35], v[28:31], a[144:151], v15
  v_smfmac_f32_16x16x64_bf16 v[40:43], v[28:31], a[160:167], v15
  v_smfmac_f32_16x16x64_bf16 v[36:39], v[28:31], a[152:159], v15
  v_smfmac_f32_16x16x64_bf16 v[44:47], v[28:31], a[168:175], v15
  s_branch .g8l5
.g8n3_5:
  s_mov_b64 exec, vcc
  buffer_load_dwordx4 v[28:31], v4, s[4:7], s47 offen offset:3072 sc1
  s_mov_b64 exec, -1
  s_branch .g8l13
.g8n1_1:
  s_mov_b64 exec, vcc
  buffer_load_dwordx4 v[20:23], v4, s[4:7], s47 offen offset:1024 sc1
  s_mov_b64 exec, -1
  s_waitcnt vmcnt(3)
  v_max3_u32 v14, v24, v25, v26
  v_max_u32 v14, v14, v27
  v_cmp_eq_u32 vcc, -1, v14
  s_cbranch_vccnz .g8n2_3
  v_smfmac_f32_16x16x64_bf16 v[32:35], v[24:27], a[96:103], v15
  v_smfmac_f32_16x16x64_bf16 v[40:43], v[24:27], a[112:119], v15
  v_smfmac_f32_16x16x64_bf16 v[36:39], v[24:27], a[104:111], v15
  v_smfmac_f32_16x16x64_bf16 v[44:47], v[24:27], a[120:127], v15
  s_waitcnt vmcnt(2)
  v_max3_u32 v14, v28, v29, v30
  v_max_u32 v14, v14, v31
  v_cmp_eq_u32 vcc, -1, v14
  s_cbranch_vccnz .g8n3_3
  v_smfmac_f32_16x16x64_bf16 v[32:35], v[28:31], a[144:151], v15
  v_smfmac_f32_16x16x64_bf16 v[40:43], v[28:31], a[160:167], v15
  v_smfmac_f32_16x16x64_bf16 v[36:39], v[28:31], a[152:159], v15
  v_smfmac_f32_16x16x64_bf16 v[44:47], v[28:31], a[168:175], v15
  s_branch .g8l3
.g8n3_3:
  s_mov_b64 exec, vcc
  buffer_load_dwordx4 v[28:31], v4, s[4:7], s47 offen offset:3072 sc1
  s_mov_b64 exec, -1
  s_branch .g8l11
.g8n2_3:
  s_mov_b64 exec, vcc
  buffer_load_dwordx4 v[24:27], v4, s[4:7], s47 offen offset:2048 sc1
  s_mov_b64 exec, -1
  s_waitcnt vmcnt(3)
  v_max3_u32 v14, v28, v29, v30
  v_max_u32 v14, v14, v31
  v_cmp_eq_u32 vcc, -1, v14
  s_cbranch_vccnz .g8n3_7
  v_smfmac_f32_16x16x64_bf16 v[32:35], v[28:31], a[144:151], v15
  v_smfmac_f32_16x16x64_bf16 v[40:43], v[28:31], a[160:167], v15
  v_smfmac_f32_16x16x64_bf16 v[36:39], v[28:31], a[152:159], v15
  v_smfmac_f32_16x16x64_bf16 v[44:47], v[28:31], a[168:175], v15
  s_branch .g8l7
.g8n3_7:
  s_mov_b64 exec, vcc
  buffer_load_dwordx4 v[28:31], v4, s[4:7], s47 offen offset:3072 sc1
  s_mov_b64 exec, -1
  s_branch .g8l15
.g8l1:
  s_waitcnt vmcnt(2)
  v_max3_u32 v14, v16, v17, v18
  v_max_u32 v14, v14, v19
  v_cmp_eq_u32 vcc, -1, v14
  s_cbranch_vccz .g8k0_1
  s_mov_b64 exec, vcc
  buffer_load_dwordx4 v[16:19], v4, s[4:7], s47 offen offset:0 sc1
  s_mov_b64 exec, -1
  s_sub_u32 s50, s50, 1
  s_cbranch_scc0 .g8l1
  s_branch .rec_end
.g8k0_1:
  v_smfmac_f32_16x16x64_bf16 v[32:35], v[16:19], a[0:7], v15
  v_smfmac_f32_16x16x64_bf16 v[40:43], v[16:19], a[16:23], v15
  v_smfmac_f32_16x16x64_bf16 v[36:39], v[16:19], a[8:15], v15
  v_smfmac_f32_16x16x64_bf16 v[44:47], v[16:19], a[24:31], v15
  s_branch .g8l0
.g8l2:
  s_waitcnt vmcnt(2)
  v_max3_u32 v14, v20, v21, v22
  v_max_u32 v14, v14, v23
  v_cmp_eq_u32 vcc, -1, v14
  s_cbranch_vccz .g8k1_2
  s_mov_b64 exec, vcc
  buffer_load_dwordx4 v[20:23], v4, s[4:7], s47 offen offset:1024 sc1
  s_mov_b64 exec, -1
  s_sub_u32 s50, s50, 1
  s_cbranch_scc0 .g8l2
  s_branch .rec_end
.g8k1_2:
  v_smfmac_f32_16x16x64_bf16 v[32:35], v[20:23], a[48:55], v15
  v_smfmac_f32_16x16x64_bf16 v[40:43], v[20:23], a[64:71], v15
  v_smfmac_f32_16x16x64_bf16 v[36:39], v[20:23], a[56:63], v15
  v_smfmac_f32_16x16x64_bf16 v[44:47], v[20:23], a[72:79], v15
  s_branch .g8l0
.g8l3:
  s_waitcnt vmcnt(2)
  v_max3_u32 v14, v16, v17, v18
  v_max_u32 v14, v14, v19
  v_cmp_eq_u32 vcc, -1, v14
  s_cbranch_vccz .g8k0_3
  s_mov_b64 exec, vcc
  buffer_load_dwordx4 v[16:19], v4, s[4:7], s47 offen offset:0 sc1
  s_mov_b64 exec, -1
  s_waitcnt vmcnt(2)
  v_max3_u32 v14, v20, v21, v22
  v_max_u32 v14, v14, v23
  v_cmp_eq_u32 vcc, -1, v14
  s_cbranch_vccz .g8k1_3
  s_mov_b64 exec, vcc
  buffer_load_dwordx4 v[20:23], v4, s[4:7], s47 offen offset:1024 sc1
  s_mov_b64 exec, -1
  s_sub_u32 s50, s50, 1
  s_cbranch_scc0 .g8l3
  s_branch .rec_end
.g8k0_3:
  v_smfmac_f32_16x16x64_bf16 v[32:35], v[16:19], a[0:7], v15
  v_smfmac_f32_16x16x64_bf16 v[40:43], v[16:19], a[16:23], v15
  v_smfmac_f32_16x16x64_bf16 v[36:39], v[16:19], a[8:15], v15
  v_smfmac_f32_16x16x64_bf16 v[44:47], v[16:19], a[24:31], v15
  s_branch .g8l2
.g8k1_3:
  v_smfmac_f32_16x16x64_bf16 v[32:35], v[20:23], a[48:55], v15
  v_smfmac_f32_16x16x64_bf16 v[40:43], v[20:23], a[64:71], v15
  v_smfmac_f32_16x16x64_bf16 v[36:39], v[20:23], a[56:63], v15
  v_smfmac_f32_16x16x64_bf16 v[44:47], v[20:23], a[72:79], v15
  s_branch .g8l1
.g8l4:
  s_waitcnt vmcnt(2)
  v_max3_u32 v14, v24, v25, v26
  v_max_u32 v14, v14, v27
  v_cmp_eq_u32 vcc, -1, v14
  s_cbranch_vccz .g8k2_4
  s_mov_b64 exec, vcc
  buffer_load_dwordx4 v[24:27], v4, s[4:7], s47 offen offset:2048 sc1
  s_mov_b64 exec, -1
  s_sub_u32 s50, s50, 1
  s_cbranch_scc0 .g8l4
  s_branch .rec_end
.g8k2_4:
  v_smfmac_f32_16x16x64_bf16 v[32:35], v[24:27], a[96:103], v15
  v_smfmac_f32_16x16x64_bf16 v[40:43], v[24:27], a[112:119], v15
  v_smfmac_f32_16x16x64_bf16 v[36:39], v[24:27], a[104:111], v15
  v_smfmac_f32_16x16x64_bf16 v[44:47], v[24:27], a[120:127], v15
  s_branch .g8l0
.g8l5:
  s_waitcnt vmcnt(2)
  v_max3_u32 v14, v16, v17, v18
  v_max_u32 v14, v14, v19
  v_cmp_eq_u32 vcc, -1, v14
  s_cbranch_vccz .g8k0_5
  s_mov_b64 exec, vcc
  buffer_load_dwordx4 v[16:19], v4, s[4:7], s47 offen offset:0 sc1
  s_mov_b64 exec, -1
  s_waitcnt vmcnt(2)
  v_max3_u32 v14, v24, v25, v26
  v_max_u32 v14, v14, v27
  v_cmp_eq_u32 vcc, -1, v14
  s_cbranch_vccz .g8k2_5
  s_mov_b64 exec, vcc
  buffer_load_dwordx4 v[24:27], v4, s[4:7], s47 offen offset:2048 sc1
  s_mov_b64 exec, -1
  s_sub_u32 s50, s50, 1
  s_cbranch_scc0 .g8l5
  s_branch .rec_end
.g8k0_5:
  v_smfmac_f32_16x16x64_bf16 v[32:35], v[16:19], a[0:7], v15
  v_smfmac_f32_16x16x64_bf16 v[40:43], v[16:19], a[16:23], v15
  v_smfmac_f32_16x16x64_bf16 v[36:39], v[16:19], a[8:15], v15
  v_smfmac_f32_16x16x64_bf16 v[44:47], v[16:19], a[24:31], v15
  s_branch .g8l4
.g8k2_5:
  v_smfmac_f32_16x16x64_bf16 v[32:35], v[24:27], a[96:103], v15
  v_smfmac_f32_16x16x64_bf16 v[40:43], v[24:27], a[112:119], v15
  v_smfmac_f32_16x16x64_bf16 v[36:39], v[24:27], a[104:111], v15
  v_smfmac_f32_16x16x64_bf16 v[44:47], v[24:27], a[120:127], v15
  s_branch .g8l1
.g8l6:
  s_waitcnt vmcnt(2)
  v_max3_u32 v14, v20, v21, v22
  v_max_u32 v14, v14, v23
  v_cmp_eq_u32 vcc, -1, v14
  s_cbranch_vccz .g8k1_6
  s_mov_b64 exec, vcc
  buffer_load_dwordx4 v[20:23], v4, s[4:7], s47 offen offset:1024 sc1
  s_mov_b64 exec, -1
  s_waitcnt vmcnt(2)
  v_max3_u32 v14, v24, v25, v26
  v_max_u32 v14, v14, v27
  v_cmp_eq_u32 vcc, -1, v14
  s_cbranch_vccz .g8k2_6
  s_mov_b64 exec, vcc
  buffer_load_dwordx4 v[24:27], v4, s[4:7], s47 offen offset:2048 sc1
  s_mov_b64 exec, -1
  s_sub_u32 s50, s50, 1
  s_cbranch_scc0 .g8l6
  s_branch .rec_end
.g8k1_6:
  v_smfmac_f32_16x16x64_bf16 v[32:35], v[20:23], a[48:55], v15
  v_smfmac_f32_16x16x64_bf16 v[40:43], v[20:23], a[64:71], v15
  v_smfmac_f32_16x16x64_bf16 v[36:39], v[20:23], a[56:63], v15
  v_smfmac_f32_16x16x64_bf16 v[44:47], v[20:23], a[72:79], v15
  s_branch .g8l4
.g8k2_6:
  v_smfmac_f32_16x16x64_bf16 v[32:35], v[24:27], a[96:103], v15
  v_smfmac_f32_16x16x64_bf16 v[40:43], v[24:27], a[112:119], v15
  v_smfmac_f32_16x16x64_bf16 v[36:39], v[24:27], a[104:111], v15
  v_smfmac_f32_16x16x64_bf16 v[44:47], v[24:27], a[120:127], v15
  s_branch .g8l2
.g8l7:
  s_waitcnt vmcnt(2)
  v_max3_u32 v14, v16, v17, v18
  v_max_u32 v14, v14, v19
  v_cmp_eq_u32 vcc, -1, v14
  s_cbranch_vccz .g8k0_7
  s_mov_b64 exec, vcc
  buffer_load_dwordx4 v[16:19], v4, s[4:7], s47 offen offset:0 sc1
  s_mov_b64 exec, -1
  s_waitcnt vmcnt(2)
  v_max3_u32 v14, v20, v21, v22
  v_max_u32 v14, v14, v23
  v_cmp_eq_u32 vcc, -1, v14
  s_cbranch_vccz .g8k1_7
  s_mov_b64 exec, vcc
  buffer_load_dwordx4 v[20:23], v4, s[4:7], s47 offen offset:1024 sc1
  s_mov_b64 exec, -1
  s_waitcnt vmcnt(2)
  v_max3_u32 v14, v24, v25, v26
  v_max_u32 v14, v14, v27
  v_cmp_eq_u32 vcc, -1, v14
  s_cbranch_vccz .g8k2_7
  s_mov_b64 exec, vcc
  buffer_load_dwordx4 v[24:27], v4, s[4:7], s47 offen offset:2048 sc1
  s_mov_b64 exec, -1
  s_sub_u32 s50, s50, 1
  s_cbranch_scc0 .g8l7
  s_branch .rec_end
.g8k0_7:
  v_smfmac_f32_16x16x64_bf16 v[32:35], v[16:19], a[0:7], v15
  v_smfmac_f32_16x16x64_bf16 v[40:43], v[16:19], a[16:23], v15
  v_smfmac_f32_16x16x64_bf16 v[36:39], v[16:19], a[8:15], v15
  v_smfmac_f32_16x16x64_bf16 v[44:47], v[16:19], a[24:31], v15
  s_branch .g8l6
.g8k1_7:
  v_smfmac_f32_16x16x64_bf16 v[32:35], v[20:23], a[48:55], v15
  v_smfmac_f32_16x16x64_bf16 v[40:43], v[20:23], a[64:71], v15
  v_smfmac_f32_16x16x64_bf16 v[36:39], v[20:23], a[56:63], v15
  v_smfmac_f32_16x16x64_bf16 v[44:47], v[20:23], a[72:79], v15
  s_branch .g8l5
.g8k2_7:
  v_smfmac_f32_16x16x64_bf16 v[32:35], v[24:27], a[96:103], v15
  v_smfmac_f32_16x16x64_bf16 v[40:43], v[24:27], a[112:119], v15
  v_smfmac_f32_16x16x64_bf16 v[36:39], v[24:27], a[104:111], v15
  v_smfmac_f32_16x16x64_bf16 v[44:47], v[24:27], a[120:127], v15
  s_branch .g8l3
.g8l8:
  s_waitcnt vmcnt(2)
  v_max3_u32 v14, v28, v29, v30
  v_max_u32 v14, v14, v31
  v_cmp_eq_u32 vcc, -1, v14
  s_cbranch_vccz .g8k3_8
  s_mov_b64 exec, vcc
  buffer_load_dwordx4 v[28:31], v4, s[4:7], s47 offen offset:3072 sc1
  s_mov_b64 exec, -1
  s_sub_u32 s50, s50, 1
  s_cbranch_scc0 .g8l8
  s_branch .rec_end
.g8k3_8:
  v_smfmac_f32_16x16x64_bf16 v[32:35], v[28:31], a[144:151], v15
  v_smfmac_f32_16x16x64_bf16 v[40:43], v[28:31], a[160:167], v15
  v_smfmac_f32_16x16x64_bf16 v[36:39], v[28:31], a[152:159], v15
  v_smfmac_f32_16x16x64_bf16 v[44:47], v[28:31], a[168:175], v15
  s_branch .g8l0
.g8l9:
  s_waitcnt vmcnt(2)
  v_max3_u32 v14, v16, v17, v18
  v_max_u32 v14, v14, v19
  v_cmp_eq_u32 vcc, -1, v14
  s_cbranch_vccz .g8k0_9
  s_mov_b64 exec, vcc
  buffer_load_dwordx4 v[16:19], v4, s[4:7], s47 offen offset:0 sc1
  s_mov_b64 exec, -1
  s_waitcnt vmcnt(2)
  v_max3_u32 v14, v28, v29, v30
  v_max_u32 v14, v14, v31
  v_cmp_eq_u32 vcc, -1, v14
  s_cbranch_vccz .g8k3_9
  s_mov_b64 exec, vcc
  buffer_load_dwordx4 v[28:31], v4, s[4:7], s47 offen offset:3072 sc1
  s_mov_b64 exec, -1
  s_sub_u32 s50, s50, 1
  s_cbranch_scc0 .g8l9
  s_branch .rec_end
.g8k0_9:
  v_smfmac_f32_16x16x64_bf16 v[32:35], v[16:19], a[0:7], v15
  v_smfmac_f32_16x16x64_bf16 v[40:43], v[16:19], a[16:23], v15
  v_smfmac_f32_16x16x64_bf16 v[36:39], v[16:19], a[8:15], v15
  v_smfmac_f32_16x16x64_bf16 v[44:47], v[16:19], a[24:31], v15
  s_branch .g8l8
.g8k3_9:
  v_smfmac_f32_16x16x64_bf16 v[32:35], v[28:31], a[144:151], v15
  v_smfmac_f32_16x16x64_bf16 v[40:43], v[28:31], a[160:167], v15
  v_smfmac_f32_16x16x64_bf16 v[36:39], v[28:31], a[152:159], v15
  v_smfmac_f32_16x16x64_bf16 v[44:47], v[28:31], a[168:175], v15
  s_branch .g8l1
.g8l10:
  s_waitcnt vmcnt(2)
  v_max3_u32 v14, v20, v21, v22
  v_max_u32 v14, v14, v23
  v_cmp_eq_u32 vcc, -1, v14
  s_cbranch_vccz .g8k1_10
  s_mov_b64 exec, vcc
  buffer_load_dwordx4 v[20:23], v4, s[4:7], s47 offen offset:1024 sc1
  s_mov_b64 exec, -1
  s_waitcnt vmcnt(2)
  v_max3_u32 v14, v28, v29, v30
  v_max_u32 v14, v14, v31
  v_cmp_eq_u32 vcc, -1, v14
  s_cbranch_vccz .g8k3_10
  s_mov_b64 exec, vcc
  buffer_load_dwordx4 v[28:31], v4, s[4:7], s47 offen offset:3072 sc1
  s_mov_b64 exec, -1
  s_sub_u32 s50, s50, 1
  s_cbranch_scc0 .g8l10
  s_branch .rec_end
.g8k1_10:
  v_smfmac_f32_16x16x64_bf16 v[32:35], v[20:23], a[48:55], v15
  v_smfmac_f32_16x16x64_bf16 v[40:43], v[20:23], a[64:71], v15
  v_smfmac_f32_16x16x64_bf16 v[36:39], v[20:23], a[56:63], v15
  v_smfmac_f32_16x16x64_bf16 v[44:47], v[20:23], a[72:79], v15
  s_branch .g8l8
.g8k3_10:
  v_smfmac_f32_16x16x64_bf16 v[32:35], v[28:31], a[144:151], v15
  v_smfmac_f32_16x16x64_bf16 v[40:43], v[28:31], a[160:167], v15
  v_smfmac_f32_16x16x64_bf16 v[36:39], v[28:31], a[152:159], v15
  v_smfmac_f32_16x16x64_bf16 v[44:47], v[28:31], a[168:175], v15
  s_branch .g8l2
.g8l11:
  s_waitcnt vmcnt(2)
  v_max3_u32 v14, v16, v17, v18
  v_max_u32 v14, v14, v19
  v_cmp_eq_u32 vcc, -1, v14
  s_cbranch_vccz .g8k0_11
  s_mov_b64 exec, vcc
  buffer_load_dwordx4 v[16:19], v4, s[4:7], s47 offen offset:0 sc1
  s_mov_b64 exec, -1
  s_waitcnt vmcnt(2)
  v_max3_u32 v14, v20, v21, v22
  v_max_u32 v14, v14, v23
  v_cmp_eq_u32 vcc, -1, v14
  s_cbranch_vccz .g8k1_11
  s_mov_b64 exec, vcc
  buffer_load_dwordx4 v[20:23], v4, s[4:7], s47 offen offset:1024 sc1
  s_mov_b64 exec, -1
  s_waitcnt vmcnt(2)
  v_max3_u32 v14, v28, v29, v30
  v_max_u32 v14, v14, v31
  v_cmp_eq_u32 vcc, -1, v14
  s_cbranch_vccz .g8k3_11
  s_mov_b64 exec, vcc
  buffer_load_dwordx4 v[28:31], v4, s[4:7], s47 offen offset:3072 sc1
  s_mov_b64 exec, -1
  s_sub_u32 s50, s50, 1
  s_cbranch_scc0 .g8l11
  s_branch .rec_end
.g8k0_11:
  v_smfmac_f32_16x16x64_bf16 v[32:35], v[16:19], a[0:7], v15
  v_smfmac_f32_16x16x64_bf16 v[40:43], v[16:19], a[16:23], v15
  v_smfmac_f32_16x16x64_bf16 v[36:39], v[16:19], a[8:15], v15
  v_smfmac_f32_16x16x64_bf16 v[44:47], v[16:19], a[24:31], v15
  s_branch .g8l10
.g8k1_11:
  v_smfmac_f32_16x16x64_bf16 v[32:35], v[20:23], a[48:55], v15
  v_smfmac_f32_16x16x64_bf16 v[40:43], v[20:23], a[64:71], v15
  v_smfmac_f32_16x16x64_bf16 v[36:39], v[20:23], a[56:63], v15
  v_smfmac_f32_16x16x64_bf16 v[44:47], v[20:23], a[72:79], v15
  s_branch .g8l9
.g8k3_11:
  v_smfmac_f32_16x16x64_bf16 v[32:35], v[28:31], a[144:151], v15
  v_smfmac_f32_16x16x64_bf16 v[40:43], v[28:31], a[160:167], v15
  v_smfmac_f32_16x16x64_bf16 v[36:39], v[28:31], a[152:159], v15
  v_smfmac_f32_16x16x64_bf16 v[44:47], v[28:31], a[168:175], v15
  s_branch .g8l3
.g8l12:
  s_waitcnt vmcnt(2)
  v_max3_u32 v14, v24, v25, v26
  v_max_u32 v14, v14, v27
  v_cmp_eq_u32 vcc, -1, v14
  s_cbranch_vccz .g8k2_12
  s_mov_b64 exec, vcc
  buffer_load_dwordx4 v[24:27], v4, s[4:7], s47 offen offset:2048 sc1
  s_mov_b64 exec, -1
  s_waitcnt vmcnt(2)
  v_max3_u32 v14, v28, v29, v30
  v_max_u32 v14, v14, v31
  v_cmp_eq_u32 vcc, -1, v14
  s_cbranch_vccz .g8k3_12
  s_mov_b64 exec, vcc
  buffer_load_dwordx4 v[28:31], v4, s[4:7], s47 offen offset:3072 sc1
  s_mov_b64 exec, -1
  s_sub_u32 s50, s50, 1
  s_cbranch_scc0 .g8l12
  s_branch .rec_end
.g8k2_12:
  v_smfmac_f32_16x16x64_bf16 v[32:35], v[24:27], a[96:103], v15
  v_smfmac_f32_16x16x64_bf16 v[40:43], v[24:27], a[112:119], v15
  v_smfmac_f32_16x16x64_bf16 v[36:39], v[24:27], a[104:111], v15
  v_smfmac_f32_16x16x64_bf16 v[44:47], v[24:27], a[120:127], v15
  s_branch .g8l8
.g8k3_12:
  v_smfmac_f32_16x16x64_bf16 v[32:35], v[28:31], a[144:151], v15
  v_smfmac_f32_16x16x64_bf16 v[40:43], v[28:31], a[160:167], v15
  v_smfmac_f32_16x16x64_bf16 v[36:39], v[28:31], a[152:159], v15
  v_smfmac_f32_16x16x64_bf16 v[44:47], v[28:31], a[168:175], v15
  s_branch .g8l4
.g8l13:
  s_waitcnt vmcnt(2)
  v_max3_u32 v14, v16, v17, v18
  v_max_u32 v14, v14, v19
  v_cmp_eq_u32 vcc, -1, v14
  s_cbranch_vccz .g8k0_13
  s_mov_b64 exec, vcc
  buffer_load_dwordx4 v[16:19], v4, s[4:7], s47 offen offset:0 sc1
  s_mov_b64 exec, -1
  s_waitcnt vmcnt(2)
  v_max3_u32 v14, v24, v25, v26
  v_max_u32 v14, v14, v27
  v_cmp_eq_u32 vcc, -1, v14
  s_cbranch_vccz .g8k2_13
  s_mov_b64 exec, vcc
  buffer_load_dwordx4 v[24:27], v4, s[4:7], s47 offen offset:2048 sc1
  s_mov_b64 exec, -1
  s_waitcnt vmcnt(2)
  v_max3_u32 v14, v28, v29, v30
  v_max_u32 v14, v14, v31
  v_cmp_eq_u32 vcc, -1, v14
  s_cbranch_vccz .g8k3_13
  s_mov_b64 exec, vcc
  buffer_load_dwordx4 v[28:31], v4, s[4:7], s47 offen offset:3072 sc1
  s_mov_b64 exec, -1
  s_sub_u32 s50, s50, 1
  s_cbranch_scc0 .g8l13
  s_branch .rec_end
.g8k0_13:
  v_smfmac_f32_16x16x64_bf16 v[32:35], v[16:19], a[0:7], v15
  v_smfmac_f32_16x16x64_bf16 v[40:43], v[16:19], a[16:23], v15
  v_smfmac_f32_16x16x64_bf16 v[36:39], v[16:19], a[8:15], v15
  v_smfmac_f32_16x16x64_bf16 v[44:47], v[16:19], a[24:31], v15
  s_branch .g8l12
.g8k2_13:
  v_smfmac_f32_16x16x64_bf16 v[32:35], v[24:27], a[96:103], v15
  v_smfmac_f32_16x16x64_bf16 v[40:43], v[24:27], a[112:119], v15
  v_smfmac_f32_16x16x64_bf16 v[36:39], v[24:27], a[104:111], v15
  v_smfmac_f32_16x16x64_bf16 v[44:47], v[24:27], a[120:127], v15
  s_branch .g8l9
.g8k3_13:
  v_smfmac_f32_16x16x64_bf16 v[32:35], v[28:31], a[144:151], v15
  v_smfmac_f32_16x16x64_bf16 v[40:43], v[28:31], a[160:167], v15
  v_smfmac_f32_16x16x64_bf16 v[36:39], v[28:31], a[152:159], v15
  v_smfmac_f32_16x16x64_bf16 v[44:47], v[28:31], a[168:175], v15
  s_branch .g8l5
.g8l14:
  s_waitcnt vmcnt(2)
  v_max3_u32 v14, v20, v21, v22
  v_max_u32 v14, v14, v23
  v_cmp_eq_u32 vcc, -1, v14
  s_cbranch_vccz .g8k1_14
  s_mov_b64 exec, vcc
  buffer_load_dwordx4 v[20:23], v4, s[4:7], s47 offen offset:1024 sc1
  s_mov_b64 exec, -1
  s_waitcnt vmcnt(2)
  v_max3_u32 v14, v24, v25, v26
  v_max_u32 v14, v14, v27
  v_cmp_eq_u32 vcc, -1, v14
  s_cbranch_vccz .g8k2_14
  s_mov_b64 exec, vcc
  buffer_load_dwordx4 v[24:27], v4, s[4:7], s47 offen offset:2048 sc1
  s_mov_b64 exec, -1
  s_waitcnt vmcnt(2)
  v_max3_u32 v14, v28, v29, v30
  v_max_u32 v14, v14, v31
  v_cmp_eq_u32 vcc, -1, v14
  s_cbranch_vccz .g8k3_14
  s_mov_b64 exec, vcc
  buffer_load_dwordx4 v[28:31], v4, s[4:7], s47 offen offset:3072 sc1
  s_mov_b64 exec, -1
  s_sub_u32 s50, s50, 1
  s_cbranch_scc0 .g8l14
  s_branch .rec_end
.g8k1_14:
  v_smfmac_f32_16x16x64_bf16 v[32:35], v[20:23], a[48:55], v15
  v_smfmac_f32_16x16x64_bf16 v[40:43], v[20:23], a[64:71], v15
  v_smfmac_f32_16x16x64_bf16 v[36:39], v[20:23], a[56:63], v15
  v_smfmac_f32_16x16x64_bf16 v[44:47], v[20:23], a[72:79], v15
  s_branch .g8l12
.g8k2_14:
  v_smfmac_f32_16x16x64_bf16 v[32:35], v[24:27], a[96:103], v15
  v_smfmac_f32_16x16x64_bf16 v[40:43], v[24:27], a[112:119], v15
  v_smfmac_f32_16x16x64_bf16 v[36:39], v[24:27], a[104:111], v15
  v_smfmac_f32_16x16x64_bf16 v[44:47], v[24:27], a[120:127], v15
  s_branch .g8l10
.g8k3_14:
  v_smfmac_f32_16x16x64_bf16 v[32:35], v[28:31], a[144:151], v15
  v_smfmac_f32_16x16x64_bf16 v[40:43], v[28:31], a[160:167], v15
  v_smfmac_f32_16x16x64_bf16 v[36:39], v[28:31], a[152:159], v15
  v_smfmac_f32_16x16x64_bf16 v[44:47], v[28:31], a[168:175], v15
  s_branch .g8l6
.g8l15:
  s_waitcnt vmcnt(2)
  v_max3_u32 v14, v16, v17, v18
  v_max_u32 v14, v14, v19
  v_cmp_eq_u32 vcc, -1, v14
  s_cbranch_vccz .g8k0_15
  s_mov_b64 exec, vcc
  buffer_load_dwordx4 v[16:19], v4, s[4:7], s47 offen offset:0 sc1
  s_mov_b64 exec, -1
  s_waitcnt vmcnt(2)
  v_max3_u32 v14, v20, v21, v22
  v_max_u32 v14, v14, v23
  v_cmp_eq_u32 vcc, -1, v14
  s_cbranch_vccz .g8k1_15
  s_mov_b64 exec, vcc
  buffer_load_dwordx4 v[20:23], v4, s[4:7], s47 offen offset:1024 sc1
  s_mov_b64 exec, -1
  s_waitcnt vmcnt(2)
  v_max3_u32 v14, v24, v25, v26
  v_max_u32 v14, v14, v27
  v_cmp_eq_u32 vcc, -1, v14
  s_cbranch_vccz .g8k2_15
  s_mov_b64 exec, vcc
  buffer_load_dwordx4 v[24:27], v4, s[4:7], s47 offen offset:2048 sc1
  s_mov_b64 exec, -1
  s_waitcnt vmcnt(2)
  v_max3_u32 v14, v28, v29, v30
  v_max_u32 v14, v14, v31
  v_cmp_eq_u32 vcc, -1, v14
  s_cbranch_vccz .g8k3_15
  s_mov_b64 exec, vcc
  buffer_load_dwordx4 v[28:31], v4, s[4:7], s47 offen offset:3072 sc1
  s_mov_b64 exec, -1
  s_sub_u32 s50, s50, 1
  s_cbranch_scc0 .g8l15
  s_branch .rec_end
.g8k0_15:
  v_smfmac_f32_16x16x64_bf16 v[32:35], v[16:19], a[0:7], v15
  v_smfmac_f32_16x16x64_bf16 v[40:43], v[16:19], a[16:23], v15
  v_smfmac_f32_16x16x64_bf16 v[36:39], v[16:19], a[8:15], v15
  v_smfmac_f32_16x16x64_bf16 v[44:47], v[16:19], a[24:31], v15
  s_branch .g8l14
.g8k1_15:
  v_smfmac_f32_16x16x64_bf16 v[32:35], v[20:23], a[48:55], v15
  v_smfmac_f32_16x16x64_bf16 v[40:43], v[20:23], a[64:71], v15
  v_smfmac_f32_16x16x64_bf16 v[36:39], v[20:23], a[56:63], v15
  v_smfmac_f32_16x16x64_bf16 v[44:47], v[20:23], a[72:79], v15
  s_branch .g8l13
.g8k2_15:
  v_smfmac_f32_16x16x64_bf16 v[32:35], v[24:27], a[96:103], v15
  v_smfmac_f32_16x16x64_bf16 v[40:43], v[24:27], a[112:119], v15
  v_smfmac_f32_16x16x64_bf16 v[36:39], v[24:27], a[104:111], v15
  v_smfmac_f32_16x16x64_bf16 v[44:47], v[24:27], a[120:127], v15
  s_branch .g8l11
.g8k3_15:
  v_smfmac_f32_16x16x64_bf16 v[32:35], v[28:31], a[144:151], v15
  v_smfmac_f32_16x16x64_bf16 v[40:43], v[28:31], a[160:167], v15
  v_smfmac_f32_16x16x64_bf16 v[36:39], v[28:31], a[152:159], v15
  v_smfmac_f32_16x16x64_bf16 v[44:47], v[28:31], a[168:175], v15
  s_branch .g8l7
.st13:
  s_mov_b64 exec, s[54:55]
  buffer_store_dwordx4 v[56:59], v11, s[4:7], s48 offen sc1
  buffer_store_dwordx4 v[60:63], v11, s[4:7], s48 offen offset:512 sc1
  s_mov_b64 exec, s[56:57]
  buffer_store_dwordx4 v[64:67], v11, s[4:7], s48 offen offset:768 sc1
  s_mov_b64 exec, -1
  s_branch .st14
.l6315:
  s_barrier
  s_branch .rx12
.sp16:
  buffer_load_dwordx4 v[56:59], v11, s[4:7], s48 offen offset:0 sc1
  buffer_load_dwordx4 v[60:63], v11, s[4:7], s48 offen offset:2048 sc1
  buffer_load_dwordx4 v[64:67], v12, s[4:7], s48 offen offset:0 sc1
  buffer_load_dwordx4 v[68:71], v12, s[4:7], s48 offen offset:2048 sc1
  buffer_load_dword v72, v104, s[4:7], s48 offen offset:1024 sc1
  buffer_load_dword v73, v104, s[4:7], s48 offen offset:3072 sc1
  buffer_load_dword v74, v105, s[4:7], s48 offen offset:1024 sc1
  buffer_load_dword v75, v105, s[4:7], s48 offen offset:3072 sc1
  s_sub_u32 s50, s50, 1
  s_cbranch_scc1 .rec_end
  s_and_b32 s61, s50, 63
  s_cbranch_scc1 .sp16c
  s_waitcnt vmcnt(0)
  v_max3_u32 v85, v56, v57, v58
  v_max3_u32 v85, v85, v59, v60
  v_max3_u32 v85, v85, v61, v62
  v_max3_u32 v85, v85, v63, v64
  v_max3_u32 v85, v85, v65, v66
  v_max3_u32 v85, v85, v67, v68
  v_max3_u32 v85, v85, v69, v70
  v_max3_u32 v85, v85, v71, v72
  v_max3_u32 v85, v85, v73, v74
  v_max_u32 v85, v85, v75
  v_cmp_eq_u32 vcc, -1, v85
  s_cbranch_vccnz .sp16c
  v_pk_add_f32 v[80:81], v[56:57], v[60:61]
  v_pk_add_f32 v[82:83], v[58:59], v[62:63]
  v_pk_add_f32 v[84:85], v[72:73], v[74:75]
  v_pk_add_f32 v[80:81], v[80:81], v[64:65]
  v_pk_add_f32 v[82:83], v[82:83], v[66:67]
  v_add_f32 v84, v84, v85
  v_pk_add_f32 v[80:81], v[80:81], v[68:69]
  v_pk_add_f32 v[82:83], v[82:83], v[70:71]
  v_max3_f32 v14, v80, v81, v84
  v_max3_f32 v14, v14, v82, v83
  s_nop 1
  s_branch .sp16k
.st17:
  s_mov_b64 exec, s[54:55]
  buffer_store_dwordx4 v[44:47], v13, s[4:7], s47 offen sc1
  s_mov_b64 exec, -1
  s_branch .st18
.g19n3_0:
  s_mov_b64 exec, vcc
  buffer_load_dwordx4 v[28:31], v5, s[4:7], s47 offen offset:3072 sc1
  s_mov_b64 exec, -1
  s_branch .g19l8
.g19n2_0:
  s_mov_b64 exec, vcc
  buffer_load_dwordx4 v[24:27], v5, s[4:7], s47 offen offset:2048 sc1
  s_mov_b64 exec, -1
  s_waitcnt vmcnt(1)
  v_max3_u32 v14, v28, v29, v30
  v_max_u32 v14, v14, v31
  v_cmp_eq_u32 vcc, -1, v14
  s_cbranch_vccnz .g19n3_4
  v_smfmac_f32_16x16x64_bf16 v[128:131], v[28:31], a[240:247], v15
  v_smfmac_f32_16x16x64_bf16 v[132:135], v[28:31], a[248:255], v15
  s_branch .g19l4
.g19n3_4:
  s_mov_b64 exec, vcc
  buffer_load_dwordx4 v[28:31], v5, s[4:7], s47 offen offset:3072 sc1
  s_mov_b64 exec, -1
  s_branch .g19l12
.g19n1_0:
  s_mov_b64 exec, vcc
  buffer_load_dwordx4 v[20:23], v5, s[4:7], s47 offen offset:1024 sc1
  s_mov_b64 exec, -1
  s_waitcnt vmcnt(2)
  v_max3_u32 v14, v24, v25, v26
  v_max_u32 v14, v14, v27
  v_cmp_eq_u32 vcc, -1, v14
  s_cbranch_vccnz .g19n2_2
  v_smfmac_f32_16x16x64_bf16 v[128:131], v[24:27], a[224:231], v15
  v_smfmac_f32_16x16x64_bf16 v[132:135], v[24:27], a[232:239], v15
  s_waitcnt vmcnt(1)
  v_max3_u32 v14, v28, v29, v30
  v_max_u32 v14, v14, v31
  v_cmp_eq_u32 vcc, -1, v14
  s_cbranch_vccnz .g19n3_2
  v_smfmac_f32_16x16x64_bf16 v[128:131], v[28:31], a[240:247], v15
  v_smfmac_f32_16x16x64_bf16 v[132:135], v[28:31], a[248:255], v15
  s_branch .g19l2
.g19n3_2:
  s_mov_b64 exec, vcc
  buffer_load_dwordx4 v[28:31], v5, s[4:7], s47 offen offset:3072 sc1
  s_mov_b64 exec, -1
  s_branch .g19l10
.g19n2_2:
  s_mov_b64 exec, vcc
  buffer_load_dwordx4 v[24:27], v5, s[4:7], s47 offen offset:2048 sc1
  s_mov_b64 exec, -1
  s_waitcnt vmcnt(2)
  v_max3_u32 v14, v28, v29, v30
  v_max_u32 v14, v14, v31
  v_cmp_eq_u32 vcc, -1, v14
  s_cbranch_vccnz .g19n3_6
  v_smfmac_f32_16x16x64_bf16 v[128:131], v[28:31], a[240:247], v15
  v_smfmac_f32_16x16x64_bf16 v[132:135], v[28:31], a[248:255], v15
  s_branch .g19l6
.g19n3_6:
  s_mov_b64 exec, vcc
  buffer_load_dwordx4 v[28:31], v5, s[4:7], s47 offen offset:3072 sc1
  s_mov_b64 exec, -1
  s_branch .g19l14
.g19n0_0:
  s_mov_b64 exec, vcc
  buffer_load_dwordx4 v[16:19], v5, s[4:7], s47 offen offset:0 sc1
  s_mov_b64 exec, -1
  s_waitcnt vmcnt(3)
  v_max3_u32 v14, v20, v21, v22
  v_max_u32 v14, v14, v23
  v_cmp_eq_u32 vcc, -1, v14
  s_cbranch_vccnz .g19n1_1
  v_smfmac_f32_16x16x64_bf16 v[128:131], v[20:23], a[208:215], v15
  v_smfmac_f32_16x16x64_bf16 v[132:135], v[20:23], a[216:223], v15
  s_waitcnt vmcnt(2)
  v_max3_u32 v14, v24, v25, v26
  v_max_u32 v14, v14, v27
  v_cmp_eq_u32 vcc, -1, v14
  s_cbranch_vccnz .g19n2_1
  v_smfmac_f32_16x16x64_bf16 v[128:131], v[24:27], a[224:231], v15
  v_smfmac_f32_16x16x64_bf16 v[132:135], v[24:27], a[232:239], v15
  s_waitcnt vmcnt(1)
  v_max3_u32 v14, v28, v29, v30
  v_max_u32 v14, v14, v31
  v_cmp_eq_u32 vcc, -1, v14
  s_cbranch_vccnz .g19n3_1
  v_smfmac_f32_16x16x64_bf16 v[128:131], v[28:31], a[240:247], v15
  v_smfmac_f32_16x16x64_bf16 v[132:135], v[28:31], a[248:255], v15
  s_branch .g19l1
.g19n3_1:
  s_mov_b64 exec, vcc
  buffer_load_dwordx4 v[28:31], v5, s[4:7], s47 offen offset:3072 sc1
  s_mov_b64 exec, -1
  s_branch .g19l9
.g19n2_1:
  s_mov_b64 exec, vcc
  buffer_load_dwordx4 v[24:27], v5, s[4:7], s47 offen offset:2048 sc1
  s_mov_b64 exec, -1
  s_waitcnt vmcnt(2)
  v_max3_u32 v14, v28, v29, v30
  v_max_u32 v14, v14, v31
  v_cmp_eq_u32 vcc, -1, v14
  s_cbranch_vccnz .g19n3_5
  v_smfmac_f32_16x16x64_bf16 v[128:131], v[28:31], a[240:247], v15
  v_smfmac_f32_16x16x64_bf16 v[132:135], v[28:31], a[248:255], v15
  s_branch .g19l5
.g19n3_5:
  s_mov_b64 exec, vcc
  buffer_load_dwordx4 v[28:31], v5, s[4:7], s47 offen offset:3072 sc1
  s_mov_b64 exec, -1
  s_branch .g19l13
.g19n1_1:
  s_mov_b64 exec, vcc
  buffer_load_dwordx4 v[20:23], v5, s[4:7], s47 offen offset:1024 sc1
  s_mov_b64 exec, -1
  s_waitcnt vmcnt(3)
  v_max3_u32 v14, v24, v25, v26
  v_max_u32 v14, v14, v27
  v_cmp_eq_u32 vcc, -1, v14
  s_cbranch_vccnz .g19n2_3
  v_smfmac_f32_16x16x64_bf16 v[128:131], v[24:27], a[224:231], v15
  v_smfmac_f32_16x16x64_bf16 v[132:135], v[24:27], a[232:239], v15
  s_waitcnt vmcnt(2)
  v_max3_u32 v14, v28, v29, v30
  v_max_u32 v14, v14, v31
  v_cmp_eq_u32 vcc, -1, v14
  s_cbranch_vccnz .g19n3_3
  v_smfmac_f32_16x16x64_bf16 v[128:131], v[28:31], a[240:247], v15
  v_smfmac_f32_16x16x64_bf16 v[132:135], v[28:31], a[248:255], v15
  s_branch .g19l3
.g19n3_3:
  s_mov_b64 exec, vcc
  buffer_load_dwordx4 v[28:31], v5, s[4:7], s47 offen offset:3072 sc1
  s_mov_b64 exec, -1
  s_branch .g19l11
.g19n2_3:
  s_mov_b64 exec, vcc
  buffer_load_dwordx4 v[24:27], v5, s[4:7], s47 offen offset:2048 sc1
  s_mov_b64 exec, -1
  s_waitcnt vmcnt(3)
  v_max3_u32 v14, v28, v29, v30
  v_max_u32 v14, v14, v31
  v_cmp_eq_u32 vcc, -1, v14
  s_cbranch_vccnz .g19n3_7
  v_smfmac_f32_16x16x64_bf16 v[128:131], v[28:31], a[240:247], v15
  v_smfmac_f32_16x16x64_bf16 v[132:135], v[28:31], a[248:255], v15
  s_branch .g19l7
.g19n3_7:
  s_mov_b64 exec, vcc
  buffer_load_dwordx4 v[28:31], v5, s[4:7], s47 offen offset:3072 sc1
  s_mov_b64 exec, -1
  s_branch .g19l15
.g19l1:
  s_waitcnt vmcnt(2)
  v_max3_u32 v14, v16, v17, v18
  v_max_u32 v14, v14, v19
  v_cmp_eq_u32 vcc, -1, v14
  s_cbranch_vccz .g19k0_1
  s_mov_b64 exec, vcc
  buffer_load_dwordx4 v[16:19], v5, s[4:7], s47 offen offset:0 sc1
  s_mov_b64 exec, -1
  s_sub_u32 s50, s50, 1
  s_cbranch_scc0 .g19l1
  s_branch .rec_end
.g19k0_1:
  v_smfmac_f32_16x16x64_bf16 v[128:131], v[16:19], a[192:199], v15
  v_smfmac_f32_16x16x64_bf16 v[132:135], v[16:19], a[200:207], v15
  s_branch .g19l0
.g19l2:
  s_waitcnt vmcnt(2)
  v_max3_u32 v14, v20, v21, v22
  v_max_u32 v14, v14, v23
  v_cmp_eq_u32 vcc, -1, v14
  s_cbranch_vccz .g19k1_2
  s_mov_b64 exec, vcc
  buffer_load_dwordx4 v[20:23], v5, s[4:7], s47 offen offset:1024 sc1
  s_mov_b64 exec, -1
  s_sub_u32 s50, s50, 1
  s_cbranch_scc0 .g19l2
  s_branch .rec_end
.g19k1_2:
  v_smfmac_f32_16x16x64_bf16 v[128:131], v[20:23], a[208:215], v15
  v_smfmac_f32_16x16x64_bf16 v[132:135], v[20:23], a[216:223], v15
  s_branch .g19l0
.g19l3:
  s_waitcnt vmcnt(2)
  v_max3_u32 v14, v16, v17, v18
  v_max_u32 v14, v14, v19
  v_cmp_eq_u32 vcc, -1, v14
  s_cbranch_vccz .g19k0_3
  s_mov_b64 exec, vcc
  buffer_load_dwordx4 v[16:19], v5, s[4:7], s47 offen offset:0 sc1
  s_mov_b64 exec, -1
  s_waitcnt vmcnt(2)
  v_max3_u32 v14, v20, v21, v22
  v_max_u32 v14, v14, v23
  v_cmp_eq_u32 vcc, -1, v14
  s_cbranch_vccz .g19k1_3
  s_mov_b64 exec, vcc
  buffer_load_dwordx4 v[20:23], v5, s[4:7], s47 offen offset:1024 sc1
  s_mov_b64 exec, -1
  s_sub_u32 s50, s50, 1
  s_cbranch_scc0 .g19l3
  s_branch .rec_end
.g19k0_3:
  v_smfmac_f32_16x16x64_bf16 v[128:131], v[16:19], a[192:199], v15
  v_smfmac_f32_16x16x64_bf16 v[132:135], v[16:19], a[200:207], v15
  s_branch .g19l2
.g19k1_3:
  v_smfmac_f32_16x16x64_bf16 v[128:131], v[20:23], a[208:215], v15
  v_smfmac_f32_16x16x64_bf16 v[132:135], v[20:23], a[216:223], v15
  s_branch .g19l1
.g19l4:
  s_waitcnt vmcnt(2)
  v_max3_u32 v14, v24, v25, v26
  v_max_u32 v14, v14, v27
  v_cmp_eq_u32 vcc, -1, v14
  s_cbranch_vccz .g19k2_4
  s_mov_b64 exec, vcc
  buffer_load_dwordx4 v[24:27], v5, s[4:7], s47 offen offset:2048 sc1
  s_mov_b64 exec, -1
  s_sub_u32 s50, s50, 1
  s_cbranch_scc0 .g19l4
  s_branch .rec_end
.g19k2_4:
  v_smfmac_f32_16x16x64_bf16 v[128:131], v[24:27], a[224:231], v15
  v_smfmac_f32_16x16x64_bf16 v[132:135], v[24:27], a[232:239], v15
  s_branch .g19l0
.g19l5:
  s_waitcnt vmcnt(2)
  v_max3_u32 v14, v16, v17, v18
  v_max_u32 v14, v14, v19
  v_cmp_eq_u32 vcc, -1, v14
  s_cbranch_vccz .g19k0_5
  s_mov_b64 exec, vcc
  buffer_load_dwordx4 v[16:19], v5, s[4:7], s47 offen offset:0 sc1
  s_mov_b64 exec, -1
  s_waitcnt vmcnt(2)
  v_max3_u32 v14, v24, v25, v26
  v_max_u32 v14, v14, v27
  v_cmp_eq_u32 vcc, -1, v14
  s_cbranch_vccz .g19k2_5
  s_mov_b64 exec, vcc
  buffer_load_dwordx4 v[24:27], v5, s[4:7], s47 offen offset:2048 sc1
  s_mov_b64 exec, -1
  s_sub_u32 s50, s50, 1
  s_cbranch_scc0 .g19l5
  s_branch .rec_end
.g19k0_5:
  v_smfmac_f32_16x16x64_bf16 v[128:131], v[16:19], a[192:199], v15
  v_smfmac_f32_16x16x64_bf16 v[132:135], v[16:19], a[200:207], v15
  s_branch .g19l4
.g19k2_5:
  v_smfmac_f32_16x16x64_bf16 v[128:131], v[24:27], a[224:231], v15
  v_smfmac_f32_16x16x64_bf16 v[132:135], v[24:27], a[232:239], v15
  s_branch .g19l1
.g19l6:
  s_waitcnt vmcnt(2)
  v_max3_u32 v14, v20, v21, v22
  v_max_u32 v14, v14, v23
  v_cmp_eq_u32 vcc, -1, v14
  s_cbranch_vccz .g19k1_6
  s_mov_b64 exec, vcc
  buffer_load_dwordx4 v[20:23], v5, s[4:7], s47 offen offset:1024 sc1
  s_mov_b64 exec, -1
  s_waitcnt vmcnt(2)
  v_max3_u32 v14, v24, v25, v26
  v_max_u32 v14, v14, v27
  v_cmp_eq_u32 vcc, -1, v14
  s_cbranch_vccz .g19k2_6
  s_mov_b64 exec, vcc
  buffer_load_dwordx4 v[24:27], v5, s[4:7], s47 offen offset:2048 sc1
  s_mov_b64 exec, -1
  s_sub_u32 s50, s50, 1
  s_cbranch_scc0 .g19l6
  s_branch .rec_end
.g19k1_6:
  v_smfmac_f32_16x16x64_bf16 v[128:131], v[20:23], a[208:215], v15
  v_smfmac_f32_16x16x64_bf16 v[132:135], v[20:23], a[216:223], v15
  s_branch .g19l4
.g19k2_6:
  v_smfmac_f32_16x16x64_bf16 v[128:131], v[24:27], a[224:231], v15
  v_smfmac_f32_16x16x64_bf16 v[132:135], v[24:27], a[232:239], v15
  s_branch .g19l2
.g19l7:
  s_waitcnt vmcnt(2)
  v_max3_u32 v14, v16, v17, v18
  v_max_u32 v14, v14, v19
  v_cmp_eq_u32 vcc, -1, v14
  s_cbranch_vccz .g19k0_7
  s_mov_b64 exec, vcc
  buffer_load_dwordx4 v[16:19], v5, s[4:7], s47 offen offset:0 sc1
  s_mov_b64 exec, -1
  s_waitcnt vmcnt(2)
  v_max3_u32 v14, v20, v21, v22
  v_max_u32 v14, v14, v23
  v_cmp_eq_u32 vcc, -1, v14
  s_cbranch_vccz .g19k1_7
  s_mov_b64 exec, vcc
  buffer_load_dwordx4 v[20:23], v5, s[4:7], s47 offen offset:1024 sc1
  s_mov_b64 exec, -1
  s_waitcnt vmcnt(2)
  v_max3_u32 v14, v24, v25, v26
  v_max_u32 v14, v14, v27
  v_cmp_eq_u32 vcc, -1, v14
  s_cbranch_vccz .g19k2_7
  s_mov_b64 exec, vcc
  buffer_load_dwordx4 v[24:27], v5, s[4:7], s47 offen offset:2048 sc1
  s_mov_b64 exec, -1
  s_sub_u32 s50, s50, 1
  s_cbranch_scc0 .g19l7
  s_branch .rec_end
.g19k0_7:
  v_smfmac_f32_16x16x64_bf16 v[128:131], v[16:19], a[192:199], v15
  v_smfmac_f32_16x16x64_bf16 v[132:135], v[16:19], a[200:207], v15
  s_branch .g19l6
.g19k1_7:
  v_smfmac_f32_16x16x64_bf16 v[128:131], v[20:23], a[208:215], v15
  v_smfmac_f32_16x16x64_bf16 v[132:135], v[20:23], a[216:223], v15
  s_branch .g19l5
.g19k2_7:
  v_smfmac_f32_16x16x64_bf16 v[128:131], v[24:27], a[224:231], v15
  v_smfmac_f32_16x16x64_bf16 v[132:135], v[24:27], a[232:239], v15
  s_branch .g19l3
.g19l8:
  s_waitcnt vmcnt(2)
  v_max3_u32 v14, v28, v29, v30
  v_max_u32 v14, v14, v31
  v_cmp_eq_u32 vcc, -1, v14
  s_cbranch_vccz .g19k3_8
  s_mov_b64 exec, vcc
  buffer_load_dwordx4 v[28:31], v5, s[4:7], s47 offen offset:3072 sc1
  s_mov_b64 exec, -1
  s_sub_u32 s50, s50, 1
  s_cbranch_scc0 .g19l8
  s_branch .rec_end
.g19k3_8:
  v_smfmac_f32_16x16x64_bf16 v[128:131], v[28:31], a[240:247], v15
  v_smfmac_f32_16x16x64_bf16 v[132:135], v[28:31], a[248:255], v15
  s_branch .g19l0
.g19l9:
  s_waitcnt vmcnt(2)
  v_max3_u32 v14, v16, v17, v18
  v_max_u32 v14, v14, v19
  v_cmp_eq_u32 vcc, -1, v14
  s_cbranch_vccz .g19k0_9
  s_mov_b64 exec, vcc
  buffer_load_dwordx4 v[16:19], v5, s[4:7], s47 offen offset:0 sc1
  s_mov_b64 exec, -1
  s_waitcnt vmcnt(2)
  v_max3_u32 v14, v28, v29, v30
  v_max_u32 v14, v14, v31
  v_cmp_eq_u32 vcc, -1, v14
  s_cbranch_vccz .g19k3_9
  s_mov_b64 exec, vcc
  buffer_load_dwordx4 v[28:31], v5, s[4:7], s47 offen offset:3072 sc1
  s_mov_b64 exec, -1
  s_sub_u32 s50, s50, 1
  s_cbranch_scc0 .g19l9
  s_branch .rec_end
.g19k0_9:
  v_smfmac_f32_16x16x64_bf16 v[128:131], v[16:19], a[192:199], v15
  v_smfmac_f32_16x16x64_bf16 v[132:135], v[16:19], a[200:207], v15
  s_branch .g19l8
.g19k3_9:
  v_smfmac_f32_16x16x64_bf16 v[128:131], v[28:31], a[240:247], v15
  v_smfmac_f32_16x16x64_bf16 v[132:135], v[28:31], a[248:255], v15
  s_branch .g19l1
.g19l10:
  s_waitcnt vmcnt(2)
  v_max3_u32 v14, v20, v21, v22
  v_max_u32 v14, v14, v23
  v_cmp_eq_u32 vcc, -1, v14
  s_cbranch_vccz .g19k1_10
  s_mov_b64 exec, vcc
  buffer_load_dwordx4 v[20:23], v5, s[4:7], s47 offen offset:1024 sc1
  s_mov_b64 exec, -1
  s_waitcnt vmcnt(2)
  v_max3_u32 v14, v28, v29, v30
  v_max_u32 v14, v14, v31
  v_cmp_eq_u32 vcc, -1, v14
  s_cbranch_vccz .g19k3_10
  s_mov_b64 exec, vcc
  buffer_load_dwordx4 v[28:31], v5, s[4:7], s47 offen offset:3072 sc1
  s_mov_b64 exec, -1
  s_sub_u32 s50, s50, 1
  s_cbranch_scc0 .g19l10
  s_branch .rec_end
.g19k1_10:
  v_smfmac_f32_16x16x64_bf16 v[128:131], v[20:23], a[208:215], v15
  v_smfmac_f32_16x16x64_bf16 v[132:135], v[20:23], a[216:223], v15
  s_branch .g19l8
.g19k3_10:
  v_smfmac_f32_16x16x64_bf16 v[128:131], v[28:31], a[240:247], v15
  v_smfmac_f32_16x16x64_bf16 v[132:135], v[28:31], a[248:255], v15
  s_branch .g19l2
.g19l11:
  s_waitcnt vmcnt(2)
  v_max3_u32 v14, v16, v17, v18
  v_max_u32 v14, v14, v19
  v_cmp_eq_u32 vcc, -1, v14
  s_cbranch_vccz .g19k0_11
  s_mov_b64 exec, vcc
  buffer_load_dwordx4 v[16:19], v5, s[4:7], s47 offen offset:0 sc1
  s_mov_b64 exec, -1
  s_waitcnt vmcnt(2)
  v_max3_u32 v14, v20, v21, v22
  v_max_u32 v14, v14, v23
  v_cmp_eq_u32 vcc, -1, v14
  s_cbranch_vccz .g19k1_11
  s_mov_b64 exec, vcc
  buffer_load_dwordx4 v[20:23], v5, s[4:7], s47 offen offset:1024 sc1
  s_mov_b64 exec, -1
  s_waitcnt vmcnt(2)
  v_max3_u32 v14, v28, v29, v30
  v_max_u32 v14, v14, v31
  v_cmp_eq_u32 vcc, -1, v14
  s_cbranch_vccz .g19k3_11
  s_mov_b64 exec, vcc
  buffer_load_dwordx4 v[28:31], v5, s[4:7], s47 offen offset:3072 sc1
  s_mov_b64 exec, -1
  s_sub_u32 s50, s50, 1
  s_cbranch_scc0 .g19l11
  s_branch .rec_end
.g19k0_11:
  v_smfmac_f32_16x16x64_bf16 v[128:131], v[16:19], a[192:199], v15
  v_smfmac_f32_16x16x64_bf16 v[132:135], v[16:19], a[200:207], v15
  s_branch .g19l10
.g19k1_11:
  v_smfmac_f32_16x16x64_bf16 v[128:131], v[20:23], a[208:215], v15
  v_smfmac_f32_16x16x64_bf16 v[132:135], v[20:23], a[216:223], v15
  s_branch .g19l9
.g19k3_11:
  v_smfmac_f32_16x16x64_bf16 v[128:131], v[28:31], a[240:247], v15
  v_smfmac_f32_16x16x64_bf16 v[132:135], v[28:31], a[248:255], v15
  s_branch .g19l3
.g19l12:
  s_waitcnt vmcnt(2)
  v_max3_u32 v14, v24, v25, v26
  v_max_u32 v14, v14, v27
  v_cmp_eq_u32 vcc, -1, v14
  s_cbranch_vccz .g19k2_12
  s_mov_b64 exec, vcc
  buffer_load_dwordx4 v[24:27], v5, s[4:7], s47 offen offset:2048 sc1
  s_mov_b64 exec, -1
  s_waitcnt vmcnt(2)
  v_max3_u32 v14, v28, v29, v30
  v_max_u32 v14, v14, v31
  v_cmp_eq_u32 vcc, -1, v14
  s_cbranch_vccz .g19k3_12
  s_mov_b64 exec, vcc
  buffer_load_dwordx4 v[28:31], v5, s[4:7], s47 offen offset:3072 sc1
  s_mov_b64 exec, -1
  s_sub_u32 s50, s50, 1
  s_cbranch_scc0 .g19l12
  s_branch .rec_end
.g19k2_12:
  v_smfmac_f32_16x16x64_bf16 v[128:131], v[24:27], a[224:231], v15
  v_smfmac_f32_16x16x64_bf16 v[132:135], v[24:27], a[232:239], v15
  s_branch .g19l8
.g19k3_12:
  v_smfmac_f32_16x16x64_bf16 v[128:131], v[28:31], a[240:247], v15
  v_smfmac_f32_16x16x64_bf16 v[132:135], v[28:31], a[248:255], v15
  s_branch .g19l4
.g19l13:
  s_waitcnt vmcnt(2)
  v_max3_u32 v14, v16, v17, v18
  v_max_u32 v14, v14, v19
  v_cmp_eq_u32 vcc, -1, v14
  s_cbranch_vccz .g19k0_13
  s_mov_b64 exec, vcc
  buffer_load_dwordx4 v[16:19], v5, s[4:7], s47 offen offset:0 sc1
  s_mov_b64 exec, -1
  s_waitcnt vmcnt(2)
  v_max3_u32 v14, v24, v25, v26
  v_max_u32 v14, v14, v27
  v_cmp_eq_u32 vcc, -1, v14
  s_cbranch_vccz .g19k2_13
  s_mov_b64 exec, vcc
  buffer_load_dwordx4 v[24:27], v5, s[4:7], s47 offen offset:2048 sc1
  s_mov_b64 exec, -1
  s_waitcnt vmcnt(2)
  v_max3_u32 v14, v28, v29, v30
  v_max_u32 v14, v14, v31
  v_cmp_eq_u32 vcc, -1, v14
  s_cbranch_vccz .g19k3_13
  s_mov_b64 exec, vcc
  buffer_load_dwordx4 v[28:31], v5, s[4:7], s47 offen offset:3072 sc1
  s_mov_b64 exec, -1
  s_sub_u32 s50, s50, 1
  s_cbranch_scc0 .g19l13
  s_branch .rec_end
.g19k0_13:
  v_smfmac_f32_16x16x64_bf16 v[128:131], v[16:19], a[192:199], v15
  v_smfmac_f32_16x16x64_bf16 v[132:135], v[16:19], a[200:207], v15
  s_branch .g19l12
.g19k2_13:
  v_smfmac_f32_16x16x64_bf16 v[128:131], v[24:27], a[224:231], v15
  v_smfmac_f32_16x16x64_bf16 v[132:135], v[24:27], a[232:239], v15
  s_branch .g19l9
.g19k3_13:
  v_smfmac_f32_16x16x64_bf16 v[128:131], v[28:31], a[240:247], v15
  v_smfmac_f32_16x16x64_bf16 v[132:135], v[28:31], a[248:255], v15
  s_branch .g19l5
.g19l14:
  s_waitcnt vmcnt(2)
  v_max3_u32 v14, v20, v21, v22
  v_max_u32 v14, v14, v23
  v_cmp_eq_u32 vcc, -1, v14
  s_cbranch_vccz .g19k1_14
  s_mov_b64 exec, vcc
  buffer_load_dwordx4 v[20:23], v5, s[4:7], s47 offen offset:1024 sc1
  s_mov_b64 exec, -1
  s_waitcnt vmcnt(2)
  v_max3_u32 v14, v24, v25, v26
  v_max_u32 v14, v14, v27
  v_cmp_eq_u32 vcc, -1, v14
  s_cbranch_vccz .g19k2_14
  s_mov_b64 exec, vcc
  buffer_load_dwordx4 v[24:27], v5, s[4:7], s47 offen offset:2048 sc1
  s_mov_b64 exec, -1
  s_waitcnt vmcnt(2)
  v_max3_u32 v14, v28, v29, v30
  v_max_u32 v14, v14, v31
  v_cmp_eq_u32 vcc, -1, v14
  s_cbranch_vccz .g19k3_14
  s_mov_b64 exec, vcc
  buffer_load_dwordx4 v[28:31], v5, s[4:7], s47 offen offset:3072 sc1
  s_mov_b64 exec, -1
  s_sub_u32 s50, s50, 1
  s_cbranch_scc0 .g19l14
  s_branch .rec_end
.g19k1_14:
  v_smfmac_f32_16x16x64_bf16 v[128:131], v[20:23], a[208:215], v15
  v_smfmac_f32_16x16x64_bf16 v[132:135], v[20:23], a[216:223], v15
  s_branch .g19l12
.g19k2_14:
  v_smfmac_f32_16x16x64_bf16 v[128:131], v[24:27], a[224:231], v15
  v_smfmac_f32_16x16x64_bf16 v[132:135], v[24:27], a[232:239], v15
  s_branch .g19l10
.g19k3_14:
  v_smfmac_f32_16x16x64_bf16 v[128:131], v[28:31], a[240:247], v15
  v_smfmac_f32_16x16x64_bf16 v[132:135], v[28:31], a[248:255], v15
  s_branch .g19l6
.g19l15:
  s_waitcnt vmcnt(2)
  v_max3_u32 v14, v16, v17, v18
  v_max_u32 v14, v14, v19
  v_cmp_eq_u32 vcc, -1, v14
  s_cbranch_vccz .g19k0_15
  s_mov_b64 exec, vcc
  buffer_load_dwordx4 v[16:19], v5, s[4:7], s47 offen offset:0 sc1
  s_mov_b64 exec, -1
  s_waitcnt vmcnt(2)
  v_max3_u32 v14, v20, v21, v22
  v_max_u32 v14, v14, v23
  v_cmp_eq_u32 vcc, -1, v14
  s_cbranch_vccz .g19k1_15
  s_mov_b64 exec, vcc
  buffer_load_dwordx4 v[20:23], v5, s[4:7], s47 offen offset:1024 sc1
  s_mov_b64 exec, -1
  s_waitcnt vmcnt(2)
  v_max3_u32 v14, v24, v25, v26
  v_max_u32 v14, v14, v27
  v_cmp_eq_u32 vcc, -1, v14
  s_cbranch_vccz .g19k2_15
  s_mov_b64 exec, vcc
  buffer_load_dwordx4 v[24:27], v5, s[4:7], s47 offen offset:2048 sc1
  s_mov_b64 exec, -1
  s_waitcnt vmcnt(2)
  v_max3_u32 v14, v28, v29, v30
  v_max_u32 v14, v14, v31
  v_cmp_eq_u32 vcc, -1, v14
  s_cbranch_vccz .g19k3_15
  s_mov_b64 exec, vcc
  buffer_load_dwordx4 v[28:31], v5, s[4:7], s47 offen offset:3072 sc1
  s_mov_b64 exec, -1
  s_sub_u32 s50, s50, 1
  s_cbranch_scc0 .g19l15
  s_branch .rec_end
.g19k0_15:
  v_smfmac_f32_16x16x64_bf16 v[128:131], v[16:19], a[192:199], v15
  v_smfmac_f32_16x16x64_bf16 v[132:135], v[16:19], a[200:207], v15
  s_branch .g19l14
.g19k1_15:
  v_smfmac_f32_16x16x64_bf16 v[128:131], v[20:23], a[208:215], v15
  v_smfmac_f32_16x16x64_bf16 v[132:135], v[20:23], a[216:223], v15
  s_branch .g19l13
.g19k2_15:
  v_smfmac_f32_16x16x64_bf16 v[128:131], v[24:27], a[224:231], v15
  v_smfmac_f32_16x16x64_bf16 v[132:135], v[24:27], a[232:239], v15
  s_branch .g19l11
.g19k3_15:
  v_smfmac_f32_16x16x64_bf16 v[128:131], v[28:31], a[240:247], v15
  v_smfmac_f32_16x16x64_bf16 v[132:135], v[28:31], a[248:255], v15
  s_branch .g19l7
.st20:
  buffer_store_dwordx4 v[100:103], v108, s[4:7], s52 offen sc1
  buffer_store_dwordx4 v[100:103], v108, s[4:7], s52 offen offset:1024 sc1
  buffer_store_dwordx4 v[100:103], v13, s[4:7], s51 offen sc1
  s_branch .st21
.st22:
  buffer_store_dwordx2 v[100:101], v13, s[4:7], s51 offen sc1
  s_branch .st23
.kf24:
  s_lshr_b32 s61, s26, 3
  s_lshl_b32 s61, s61, 2
.kf24p:
  buffer_load_dword v110, off, s[8:11], s61 offset:16 sc0 sc1
  s_sub_u32 s50, s50, 1
  s_cbranch_scc1 .rec_end
  s_waitcnt vmcnt(0)
  v_readfirstlane_b32 s27, v110
  s_cmp_lg_u32 s27, 128
  s_cbranch_scc1 .kf24p
  s_branch .kf24k
.st26:
  buffer_store_dwordx2 v[72:73], v13, s[4:7], s47 offen sc1
  s_branch .st27
.rc_done:
  s_waitcnt vmcnt(0)
  s_barrier
  s_cmp_lg_u32 s23, 3
  s_cbranch_scc1 .rc_dn2
  v_mov_b32 v110, 65
  s_mov_b64 exec, 1
  buffer_store_dword v110, off, s[4:7], s63 sc1
  s_mov_b64 exec, -1
.rc_dn2:
  s_and_b32 s47, s45, 15
  s_lshl2_add_u32 s46, s44, 24
  s_branch .g_eng
.rec_end:
  s_endpgm
.rec_g:
  s_add_u32 s96, s92, 0
  s_addc_u32 s97, s93, 0
  s_mov_b32 s98, 256
  s_mov_b32 s99, 0x20000
  v_mov_b32 v44, -1
  v_mov_b32 v45, -1
  v_mov_b32 v46, -1
  v_mov_b32 v47, -1
  s_mul_i32 s21, s2, 10240
  s_sub_u32 s21, s21, 10240
  v_lshl_add_u32 v154, v0, 4, s21
  s_mov_b32 s22, 104857600
  s_mov_b32 s26, 0x10000
  s_cmp_ge_u32 s2, 16
  s_cbranch_scc1 .fp_nm1
  s_lshl_b32 s21, s2, 12
  s_add_u32 s21, s21, 106954752
  v_lshlrev_b32 v4, 4, v0
  v_min_u32 v132, -2, v132
  v_min_u32 v133, -2, v133
  v_min_u32 v134, -2, v134
  v_min_u32 v135, -2, v135
  buffer_store_dwordx4 v[132:135], v4, s[4:7], s21 offen sc1
.fp_nm1:
  s_mov_b32 s21, 4194304
  buffer_store_dwordx4 v[136:139], v6, s[4:7], s21 offen sc1
  s_mov_b32 s21, 4210688
  buffer_store_dwordx4 v[140:143], v6, s[4:7], s21 offen sc1
  s_mov_b32 s21, 4227072
  buffer_store_dwordx4 v[144:147], v6, s[4:7], s21 offen sc1
  s_mov_b32 s21, 4243456
  buffer_store_dwordx4 v[148:151], v6, s[4:7], s21 offen sc1
  s_lshl_b32 s21, s2, 5
  s_add_u32 s21, s21, 102760448
  v_lshlrev_b32 v7, 2, v96
  s_mov_b64 exec, 0xff
  buffer_store_dword v153, v7, s[4:7], s21 offen sc1
  s_mov_b64 exec, -1
  s_sub_u32 s2, s2, 1
  s_cmp_ge_u32 s2, 16
  s_cbranch_scc1 .fp_nm0
  s_lshl_b32 s21, s2, 12
  s_add_u32 s21, s21, 106954752
  v_lshlrev_b32 v3, 4, v0
  v_min_u32 v40, -2, v40
  v_min_u32 v41, -2, v41
  v_min_u32 v42, -2, v42
  v_min_u32 v43, -2, v43
  buffer_store_dwordx4 v[40:43], v3, s[4:7], s21 offen sc1
.fp_nm0:
  s_mov_b32 s21, 4194304
  buffer_store_dwordx4 v[116:119], v5, s[4:7], s21 offen sc1
  s_mov_b32 s21, 4210688
  buffer_store_dwordx4 v[120:123], v5, s[4:7], s21 offen sc1
  s_mov_b32 s21, 4227072
  buffer_store_dwordx4 v[124:127], v5, s[4:7], s21 offen sc1
  s_mov_b32 s21, 4243456
  buffer_store_dwordx4 v[128:131], v5, s[4:7], s21 offen sc1
  s_lshl_b32 s21, s2, 5
  s_add_u32 s21, s21, 102760448
  v_lshlrev_b32 v7, 2, v96
  s_mov_b64 exec, 0xff
  buffer_store_dword v152, v7, s[4:7], s21 offen sc1
  s_mov_b64 exec, -1
  v_subrev_u32 v7, 2097152, v154
  v_cmp_le_u32 vcc, s26, v7
  v_add_u32 v155, 4096, v154
  s_and_saveexec_b64 s[24:25], vcc
  buffer_store_dwordx4 v[44:47], v154, s[4:7], s22 offen sc1
  s_mov_b64 exec, s[24:25]
  v_subrev_u32 v7, 2097152, v155
  v_cmp_le_u32 vcc, s26, v7
  v_add_u32 v156, 4096, v155
  s_and_saveexec_b64 s[24:25], vcc
  buffer_store_dwordx4 v[44:47], v155, s[4:7], s22 offen sc1
  s_mov_b64 exec, s[24:25]
  v_subrev_u32 v7, 2097152, v156
  v_cmp_le_u32 vcc, s26, v7
  v_add_u32 v157, 4096, v156
  s_and_saveexec_b64 s[24:25], vcc
  buffer_store_dwordx4 v[44:47], v156, s[4:7], s22 offen sc1
  s_mov_b64 exec, s[24:25]
  v_subrev_u32 v7, 2097152, v157
  v_cmp_le_u32 vcc, s26, v7
  v_add_u32 v158, 4096, v157
  s_and_saveexec_b64 s[24:25], vcc
  buffer_store_dwordx4 v[44:47], v157, s[4:7], s22 offen sc1
  s_mov_b64 exec, s[24:25]
  v_subrev_u32 v7, 2097152, v158
  v_cmp_le_u32 vcc, s26, v7
  v_add_u32 v159, 4096, v158
  s_and_saveexec_b64 s[24:25], vcc
  buffer_store_dwordx4 v[44:47], v158, s[4:7], s22 offen sc1
  s_mov_b64 exec, s[24:25]
  s_sub_u32 s46, s44, 4
  s_lshr_b32 s47, s46, 1
  s_and_b32 s46, s46, 1
  s_mov_b32 s51, s47
  s_and_b32 s52, s45, 1
  s_lshr_b32 s53, s45, 1
  s_lshl4_add_u32 s53, s46, s53
  v_and_b32 v1, 63, v0
  v_lshrrev_b32 v18, 6, v0
  s_nop 0
  v_readfirstlane_b32 s23, v18
  s_lshl_b32 s24, s23, 12
  s_add_u32 s25, s24, 16384
  s_lshr_b32 s26, s23, 1
  s_mul_i32 s26, s26, 8192
  v_lshlrev_b32 v8, 4, v1
  v_add_u32 v8, s26, v8
  v_add_u32 v9, 0x10000, v8
  v_bfe_u32 v18, v1, 2, 2
  v_lshrrev_b32 v19, 5, v1
  v_lshl_add_u32 v19, v19, 3, v18
  v_mul_u32_u24 v19, 256, v19
  v_bfe_u32 v20, v1, 4, 1
  v_lshlrev_b32 v20, 2, v20
  v_and_b32 v21, 1, v1
  v_lshl_add_u32 v20, v21, 1, v20
  v_bfe_u32 v21, v1, 1, 1
  v_add_u32 v20, v20, v21
  v_lshl_add_u32 v19, v20, 3, v19
  v_add_u32 v19, 16384, v19
  s_and_b32 s26, s23, 1
  s_mul_i32 s26, s26, 2
  s_add_u32 s27, s26, 0
  v_xor_b32 v20, s27, v18
  v_lshl_add_u32 v10, v20, 6, v19
  v_add_u32 v14, 0x10000, v10
  s_add_u32 s27, s26, 1
  v_xor_b32 v20, s27, v18
  v_lshl_add_u32 v11, v20, 6, v19
  v_add_u32 v15, 0x10000, v11
  s_mov_b32 s54, 16
.g_s:
  s_mov_b32 s34, 0
  s_movk_i32 s20, 8192
  s_mov_b32 s21, 65536
  s_mov_b32 s19, 4
  s_mov_b32 s8, s70
  s_mov_b32 s9, s71
  s_mov_b32 s10, 0x800000
  s_cmp_eq_u32 s51, 1
  s_cselect_b32 s8, s72, s8
  s_cselect_b32 s9, s73, s9
  s_lshl_b32 s6, s21, 2
  s_mul_i32 s33, s52, s6
  s_add_u32 s33, s33, s34
  s_add_u32 s4, s94, s33
  s_addc_u32 s5, s95, 0
  s_mov_b32 s6, s6
  s_mov_b32 s7, 0x20000
  s_lshl_b32 s33, s53, 8
  s_add_u32 s8, s8, s33
  s_addc_u32 s9, s9, 0
  s_sub_u32 s10, s10, s33
  s_mov_b32 s11, 0x20000
  s_mul_i32 s26, s23, s21
  v_lshl_add_u32 v2, v1, 4, s26
  v_mov_b32 v3, v2
  v_lshrrev_b32 v18, 4, v1
  s_lshl_b32 s26, s23, 4
  v_add_u32 v19, s26, v18
  v_mul_lo_u32 v19, v19, s20
  v_and_b32 v20, 15, v1
  v_lshlrev_b32 v21, 2, v18
  v_xor_b32 v21, v21, v20
  v_lshl_add_u32 v4, v21, 4, v19
  s_lshl_b32 s26, s20, 2
  s_sub_u32 s26, s26, 1024
  v_add_u32 v5, s26, v4
  v_add_u32 v6, s26, v5
  v_add_u32 v7, s26, v6
  s_lshl_b32 s18, s20, 6
  s_mov_b32 s16, 0
  s_mov_b32 s17, 0
  s_mov_b32 s3, s51
  s_mov_b32 s31, s52
  s_mov_b32 s32, s53
  s_mov_b32 s22, 262144
  s_mov_b32 s35, 25165824
  s_mov_b32 s36, s82
  s_mov_b32 s37, s83
  s_cmp_eq_u32 s3, 1
  s_cselect_b32 s35, 41943040, s35
  s_cmp_eq_u32 s3, 3
  s_cselect_b32 s35, 75497472, s35
  s_cselect_b32 s22, 229376, s22
  s_cmp_eq_u32 s3, 4
  s_cselect_b32 s35, 90177536, s35
  s_cselect_b32 s22, 65536, s22
  s_cselect_b32 s36, s86, s36
  s_cselect_b32 s37, s87, s37
  s_lshl_b32 s33, s32, 9
  s_add_u32 s36, s36, s33
  s_addc_u32 s37, s37, 0
  s_movk_i32 s38, 512
  s_mov_b32 s39, 0x20000
  s_lshl_b32 s14, s22, 2
  s_mul_i32 s34, s31, s14
  s_add_u32 s35, s35, s34
  s_lshl_b32 s34, s32, 13
  s_add_u32 s35, s35, s34
  s_add_u32 s12, s94, s35
  s_addc_u32 s13, s95, 0
  s_mov_b32 s14, s14
  s_mov_b32 s15, 0x20000
  s_cmp_eq_u32 s3, 1
  s_cbranch_scc1 .g_sv
  s_add_u32 m0, s24, 0
  s_nop 0
  buffer_load_dwordx4 v2, s[4:7], s16 offen offset:0 lds
  buffer_load_dwordx4 v2, s[4:7], s16 offen offset:1024 lds
  buffer_load_dwordx4 v3, s[4:7], s16 offen offset:2048 lds
  buffer_load_dwordx4 v3, s[4:7], s16 offen offset:3072 lds
  s_add_u32 s16, s16, 4096
  s_add_u32 m0, s25, 0
  s_nop 0
  buffer_load_dwordx4 v4, s[8:11], s17 offen offset:0 lds
  buffer_load_dwordx4 v5, s[8:11], s17 offen offset:1024 lds
  buffer_load_dwordx4 v6, s[8:11], s17 offen offset:2048 lds
  buffer_load_dwordx4 v7, s[8:11], s17 offen offset:3072 lds
  s_add_u32 s17, s17, s18
  s_add_u32 m0, s24, 32768
  s_nop 0
  buffer_load_dwordx4 v2, s[4:7], s16 offen offset:0 lds
  buffer_load_dwordx4 v2, s[4:7], s16 offen offset:1024 lds
  buffer_load_dwordx4 v3, s[4:7], s16 offen offset:2048 lds
  buffer_load_dwordx4 v3, s[4:7], s16 offen offset:3072 lds
  s_add_u32 s16, s16, 4096
  s_add_u32 m0, s25, 32768
  s_nop 0
  buffer_load_dwordx4 v4, s[8:11], s17 offen offset:0 lds
  buffer_load_dwordx4 v5, s[8:11], s17 offen offset:1024 lds
  buffer_load_dwordx4 v6, s[8:11], s17 offen offset:2048 lds
  buffer_load_dwordx4 v7, s[8:11], s17 offen offset:3072 lds
  s_add_u32 s17, s17, s18
  s_add_u32 m0, s24, 65536
  s_nop 0
  buffer_load_dwordx4 v2, s[4:7], s16 offen offset:0 lds
  buffer_load_dwordx4 v2, s[4:7], s16 offen offset:1024 lds
  buffer_load_dwordx4 v3, s[4:7], s16 offen offset:2048 lds
  buffer_load_dwordx4 v3, s[4:7], s16 offen offset:3072 lds
  s_add_u32 s16, s16, 4096
  s_add_u32 m0, s25, 65536
  s_nop 0
  buffer_load_dwordx4 v4, s[8:11], s17 offen offset:0 lds
  buffer_load_dwordx4 v5, s[8:11], s17 offen offset:1024 lds
  buffer_load_dwordx4 v6, s[8:11], s17 offen offset:2048 lds
  buffer_load_dwordx4 v7, s[8:11], s17 offen offset:3072 lds
  s_add_u32 s17, s17, s18
  s_add_u32 m0, s24, 98304
  s_nop 0
  buffer_load_dwordx4 v2, s[4:7], s16 offen offset:0 lds
  buffer_load_dwordx4 v2, s[4:7], s16 offen offset:1024 lds
  buffer_load_dwordx4 v3, s[4:7], s16 offen offset:2048 lds
  buffer_load_dwordx4 v3, s[4:7], s16 offen offset:3072 lds
  s_add_u32 s16, s16, 4096
  v_accvgpr_write_b32 a0, 0
  v_accvgpr_write_b32 a1, 0
  v_accvgpr_write_b32 a2, 0
  v_accvgpr_write_b32 a3, 0
  v_accvgpr_write_b32 a4, 0
  v_accvgpr_write_b32 a5, 0
  v_accvgpr_write_b32 a6, 0
  v_accvgpr_write_b32 a7, 0
  v_accvgpr_write_b32 a8, 0
  v_accvgpr_write_b32 a9, 0
  v_accvgpr_write_b32 a10, 0
  v_accvgpr_write_b32 a11, 0
  v_accvgpr_write_b32 a12, 0
  v_accvgpr_write_b32 a13, 0
  v_accvgpr_write_b32 a14, 0
  v_accvgpr_write_b32 a15, 0
  v_accvgpr_write_b32 a16, 0
  v_accvgpr_write_b32 a17, 0
  v_accvgpr_write_b32 a18, 0
  v_accvgpr_write_b32 a19, 0
  v_accvgpr_write_b32 a20, 0
  v_accvgpr_write_b32 a21, 0
  v_accvgpr_write_b32 a22, 0
  v_accvgpr_write_b32 a23, 0
  v_accvgpr_write_b32 a24, 0
  v_accvgpr_write_b32 a25, 0
  v_accvgpr_write_b32 a26, 0
  v_accvgpr_write_b32 a27, 0
  v_accvgpr_write_b32 a28, 0
  v_accvgpr_write_b32 a29, 0
  v_accvgpr_write_b32 a30, 0
  v_accvgpr_write_b32 a31, 0
  v_accvgpr_write_b32 a32, 0
  v_accvgpr_write_b32 a33, 0
  v_accvgpr_write_b32 a34, 0
  v_accvgpr_write_b32 a35, 0
  v_accvgpr_write_b32 a36, 0
  v_accvgpr_write_b32 a37, 0
  v_accvgpr_write_b32 a38, 0
  v_accvgpr_write_b32 a39, 0
  v_accvgpr_write_b32 a40, 0
  v_accvgpr_write_b32 a41, 0
  v_accvgpr_write_b32 a42, 0
  v_accvgpr_write_b32 a43, 0
  v_accvgpr_write_b32 a44, 0
  v_accvgpr_write_b32 a45, 0
  v_accvgpr_write_b32 a46, 0
  v_accvgpr_write_b32 a47, 0
  v_accvgpr_write_b32 a48, 0
  v_accvgpr_write_b32 a49, 0
  v_accvgpr_write_b32 a50, 0
  v_accvgpr_write_b32 a51, 0
  v_accvgpr_write_b32 a52, 0
  v_accvgpr_write_b32 a53, 0
  v_accvgpr_write_b32 a54, 0
  v_accvgpr_write_b32 a55, 0
  v_accvgpr_write_b32 a56, 0
  v_accvgpr_write_b32 a57, 0
  v_accvgpr_write_b32 a58, 0
  v_accvgpr_write_b32 a59, 0
  v_accvgpr_write_b32 a60, 0
  v_accvgpr_write_b32 a61, 0
  v_accvgpr_write_b32 a62, 0
  v_accvgpr_write_b32 a63, 0
  s_waitcnt vmcnt(20)
  s_barrier
  ds_read_b128 v[64:67], v8 offset:0
  ds_read_b64_tr_b16 v[80:81], v10 offset:0
  ds_read_b64_tr_b16 v[82:83], v10 offset:1024
  ds_read_b64_tr_b16 v[84:85], v11 offset:0
  ds_read_b64_tr_b16 v[86:87], v11 offset:1024
  ds_read_b128 v[68:71], v8 offset:4096
.gl28:
  s_sub_u32 s19, s19, 1
  s_waitcnt lgkmcnt(0)
  v_mfma_f32_32x32x16_bf16 a[0:15], v[80:83], v[64:67], a[0:15]
  ds_read_b128 v[96:99], v8 offset:1024
  ds_read_b64_tr_b16 v[112:113], v10 offset:4096
  ds_read_b64_tr_b16 v[114:115], v10 offset:5120
  v_mfma_f32_32x32x16_bf16 a[16:31], v[84:87], v[64:67], a[16:31]
  ds_read_b64_tr_b16 v[116:117], v11 offset:4096
  ds_read_b64_tr_b16 v[118:119], v11 offset:5120
  ds_read_b128 v[100:103], v8 offset:5120
  s_add_u32 m0, s25, 98304
  v_mfma_f32_32x32x16_bf16 a[32:47], v[80:83], v[68:71], a[32:47]
  buffer_load_dwordx4 v4, s[8:11], s17 offen offset:0 lds
  v_mfma_f32_32x32x16_bf16 a[48:63], v[84:87], v[68:71], a[48:63]
  buffer_load_dwordx4 v5, s[8:11], s17 offen offset:1024 lds
  s_waitcnt lgkmcnt(0)
  v_mfma_f32_32x32x16_bf16 a[0:15], v[112:115], v[96:99], a[0:15]
  ds_read_b128 v[64:67], v8 offset:2048
  ds_read_b64_tr_b16 v[80:81], v10 offset:8192
  ds_read_b64_tr_b16 v[82:83], v10 offset:9216
  v_mfma_f32_32x32x16_bf16 a[16:31], v[116:119], v[96:99], a[16:31]
  ds_read_b64_tr_b16 v[84:85], v11 offset:8192
  ds_read_b64_tr_b16 v[86:87], v11 offset:9216
  ds_read_b128 v[68:71], v8 offset:6144
  v_mfma_f32_32x32x16_bf16 a[32:47], v[112:115], v[100:103], a[32:47]
  buffer_load_dwordx4 v6, s[8:11], s17 offen offset:2048 lds
  v_mfma_f32_32x32x16_bf16 a[48:63], v[116:119], v[100:103], a[48:63]
  buffer_load_dwordx4 v7, s[8:11], s17 offen offset:3072 lds
  s_add_u32 s17, s17, s18
  s_waitcnt lgkmcnt(0)
  v_mfma_f32_32x32x16_bf16 a[0:15], v[80:83], v[64:67], a[0:15]
  ds_read_b128 v[96:99], v8 offset:3072
  ds_read_b64_tr_b16 v[112:113], v10 offset:12288
  ds_read_b64_tr_b16 v[114:115], v10 offset:13312
  v_mfma_f32_32x32x16_bf16 a[16:31], v[84:87], v[64:67], a[16:31]
  ds_read_b64_tr_b16 v[116:117], v11 offset:12288
  ds_read_b64_tr_b16 v[118:119], v11 offset:13312
  ds_read_b128 v[100:103], v8 offset:7168
  v_mfma_f32_32x32x16_bf16 a[32:47], v[80:83], v[68:71], a[32:47]
  v_mfma_f32_32x32x16_bf16 a[48:63], v[84:87], v[68:71], a[48:63]
  s_waitcnt lgkmcnt(0)
  v_mfma_f32_32x32x16_bf16 a[0:15], v[112:115], v[96:99], a[0:15]
  s_waitcnt vmcnt(16)
  s_barrier
  s_cmp_eq_u32 s19, 0
  s_cselect_b32 s6, 0, s6
  s_cselect_b32 s10, 0, s10
  ds_read_b128 v[64:67], v8 offset:32768
  ds_read_b64_tr_b16 v[80:81], v10 offset:32768
  ds_read_b64_tr_b16 v[82:83], v10 offset:33792
  s_add_u32 m0, s24, 0
  v_mfma_f32_32x32x16_bf16 a[16:31], v[116:119], v[96:99], a[16:31]
  ds_read_b64_tr_b16 v[84:85], v11 offset:32768
  ds_read_b64_tr_b16 v[86:87], v11 offset:33792
  ds_read_b128 v[68:71], v8 offset:36864
  buffer_load_dwordx4 v2, s[4:7], s16 offen offset:0 lds
  v_mfma_f32_32x32x16_bf16 a[32:47], v[112:115], v[100:103], a[32:47]
  buffer_load_dwordx4 v2, s[4:7], s16 offen offset:1024 lds
  buffer_load_dwordx4 v3, s[4:7], s16 offen offset:2048 lds
  v_mfma_f32_32x32x16_bf16 a[48:63], v[116:119], v[100:103], a[48:63]
  buffer_load_dwordx4 v3, s[4:7], s16 offen offset:3072 lds
  s_add_u32 s16, s16, 4096
  s_waitcnt lgkmcnt(0)
  v_mfma_f32_32x32x16_bf16 a[0:15], v[80:83], v[64:67], a[0:15]
  ds_read_b128 v[96:99], v8 offset:33792
  ds_read_b64_tr_b16 v[112:113], v10 offset:36864
  ds_read_b64_tr_b16 v[114:115], v10 offset:37888
  v_mfma_f32_32x32x16_bf16 a[16:31], v[84:87], v[64:67], a[16:31]
  ds_read_b64_tr_b16 v[116:117], v11 offset:36864
  ds_read_b64_tr_b16 v[118:119], v11 offset:37888
  ds_read_b128 v[100:103], v8 offset:37888
  s_add_u32 m0, s25, 0
  v_mfma_f32_32x32x16_bf16 a[32:47], v[80:83], v[68:71], a[32:47]
  buffer_load_dwordx4 v4, s[8:11], s17 offen offset:0 lds
  v_mfma_f32_32x32x16_bf16 a[48:63], v[84:87], v[68:71], a[48:63]
  buffer_load_dwordx4 v5, s[8:11], s17 offen offset:1024 lds
  s_waitcnt lgkmcnt(0)
  v_mfma_f32_32x32x16_bf16 a[0:15], v[112:115], v[96:99], a[0:15]
  ds_read_b128 v[64:67], v8 offset:34816
  ds_read_b64_tr_b16 v[80:81], v10 offset:40960
  ds_read_b64_tr_b16 v[82:83], v10 offset:41984
  v_mfma_f32_32x32x16_bf16 a[16:31], v[116:119], v[96:99], a[16:31]
  ds_read_b64_tr_b16 v[84:85], v11 offset:40960
  ds_read_b64_tr_b16 v[86:87], v11 offset:41984
  ds_read_b128 v[68:71], v8 offset:38912
  v_mfma_f32_32x32x16_bf16 a[32:47], v[112:115], v[100:103], a[32:47]
  buffer_load_dwordx4 v6, s[8:11], s17 offen offset:2048 lds
  v_mfma_f32_32x32x16_bf16 a[48:63], v[116:119], v[100:103], a[48:63]
  buffer_load_dwordx4 v7, s[8:11], s17 offen offset:3072 lds
  s_add_u32 s17, s17, s18
  s_waitcnt lgkmcnt(0)
  v_mfma_f32_32x32x16_bf16 a[0:15], v[80:83], v[64:67], a[0:15]
  ds_read_b128 v[96:99], v8 offset:35840
  ds_read_b64_tr_b16 v[112:113], v10 offset:45056
  ds_read_b64_tr_b16 v[114:115], v10 offset:46080
  v_mfma_f32_32x32x16_bf16 a[16:31], v[84:87], v[64:67], a[16:31]
  ds_read_b64_tr_b16 v[116:117], v11 offset:45056
  ds_read_b64_tr_b16 v[118:119], v11 offset:46080
  ds_read_b128 v[100:103], v8 offset:39936
  v_mfma_f32_32x32x16_bf16 a[32:47], v[80:83], v[68:71], a[32:47]
  v_mfma_f32_32x32x16_bf16 a[48:63], v[84:87], v[68:71], a[48:63]
  s_waitcnt lgkmcnt(0)
  v_mfma_f32_32x32x16_bf16 a[0:15], v[112:115], v[96:99], a[0:15]
  s_waitcnt vmcnt(16)
  s_barrier
  ds_read_b128 v[64:67], v9 offset:0
  ds_read_b64_tr_b16 v[80:81], v14 offset:0
  ds_read_b64_tr_b16 v[82:83], v14 offset:1024
  s_add_u32 m0, s24, 32768
  v_mfma_f32_32x32x16_bf16 a[16:31], v[116:119], v[96:99], a[16:31]
  ds_read_b64_tr_b16 v[84:85], v15 offset:0
  ds_read_b64_tr_b16 v[86:87], v15 offset:1024
  ds_read_b128 v[68:71], v9 offset:4096
  buffer_load_dwordx4 v2, s[4:7], s16 offen offset:0 lds
  v_mfma_f32_32x32x16_bf16 a[32:47], v[112:115], v[100:103], a[32:47]
  buffer_load_dwordx4 v2, s[4:7], s16 offen offset:1024 lds
  buffer_load_dwordx4 v3, s[4:7], s16 offen offset:2048 lds
  v_mfma_f32_32x32x16_bf16 a[48:63], v[116:119], v[100:103], a[48:63]
  buffer_load_dwordx4 v3, s[4:7], s16 offen offset:3072 lds
  s_add_u32 s16, s16, 4096
  s_waitcnt lgkmcnt(0)
  v_mfma_f32_32x32x16_bf16 a[0:15], v[80:83], v[64:67], a[0:15]
  ds_read_b128 v[96:99], v9 offset:1024
  ds_read_b64_tr_b16 v[112:113], v14 offset:4096
  ds_read_b64_tr_b16 v[114:115], v14 offset:5120
  v_mfma_f32_32x32x16_bf16 a[16:31], v[84:87], v[64:67], a[16:31]
  ds_read_b64_tr_b16 v[116:117], v15 offset:4096
  ds_read_b64_tr_b16 v[118:119], v15 offset:5120
  ds_read_b128 v[100:103], v9 offset:5120
  s_add_u32 m0, s25, 32768
  v_mfma_f32_32x32x16_bf16 a[32:47], v[80:83], v[68:71], a[32:47]
  buffer_load_dwordx4 v4, s[8:11], s17 offen offset:0 lds
  v_mfma_f32_32x32x16_bf16 a[48:63], v[84:87], v[68:71], a[48:63]
  buffer_load_dwordx4 v5, s[8:11], s17 offen offset:1024 lds
  s_waitcnt lgkmcnt(0)
  v_mfma_f32_32x32x16_bf16 a[0:15], v[112:115], v[96:99], a[0:15]
  ds_read_b128 v[64:67], v9 offset:2048
  ds_read_b64_tr_b16 v[80:81], v14 offset:8192
  ds_read_b64_tr_b16 v[82:83], v14 offset:9216
  v_mfma_f32_32x32x16_bf16 a[16:31], v[116:119], v[96:99], a[16:31]
  ds_read_b64_tr_b16 v[84:85], v15 offset:8192
  ds_read_b64_tr_b16 v[86:87], v15 offset:9216
  ds_read_b128 v[68:71], v9 offset:6144
  v_mfma_f32_32x32x16_bf16 a[32:47], v[112:115], v[100:103], a[32:47]
  buffer_load_dwordx4 v6, s[8:11], s17 offen offset:2048 lds
  v_mfma_f32_32x32x16_bf16 a[48:63], v[116:119], v[100:103], a[48:63]
  buffer_load_dwordx4 v7, s[8:11], s17 offen offset:3072 lds
  s_add_u32 s17, s17, s18
  s_waitcnt lgkmcnt(0)
  v_mfma_f32_32x32x16_bf16 a[0:15], v[80:83], v[64:67], a[0:15]
  ds_read_b128 v[96:99], v9 offset:3072
  ds_read_b64_tr_b16 v[112:113], v14 offset:12288
  ds_read_b64_tr_b16 v[114:115], v14 offset:13312
  v_mfma_f32_32x32x16_bf16 a[16:31], v[84:87], v[64:67], a[16:31]
  ds_read_b64_tr_b16 v[116:117], v15 offset:12288
  ds_read_b64_tr_b16 v[118:119], v15 offset:13312
  ds_read_b128 v[100:103], v9 offset:7168
  v_mfma_f32_32x32x16_bf16 a[32:47], v[80:83], v[68:71], a[32:47]
  v_mfma_f32_32x32x16_bf16 a[48:63], v[84:87], v[68:71], a[48:63]
  s_waitcnt lgkmcnt(0)
  v_mfma_f32_32x32x16_bf16 a[0:15], v[112:115], v[96:99], a[0:15]
  s_waitcnt vmcnt(16)
  s_barrier
  ds_read_b128 v[64:67], v9 offset:32768
  ds_read_b64_tr_b16 v[80:81], v14 offset:32768
  ds_read_b64_tr_b16 v[82:83], v14 offset:33792
  s_add_u32 m0, s24, 65536
  v_mfma_f32_32x32x16_bf16 a[16:31], v[116:119], v[96:99], a[16:31]
  ds_read_b64_tr_b16 v[84:85], v15 offset:32768
  ds_read_b64_tr_b16 v[86:87], v15 offset:33792
  ds_read_b128 v[68:71], v9 offset:36864
  buffer_load_dwordx4 v2, s[4:7], s16 offen offset:0 lds
  v_mfma_f32_32x32x16_bf16 a[32:47], v[112:115], v[100:103], a[32:47]
  buffer_load_dwordx4 v2, s[4:7], s16 offen offset:1024 lds
  buffer_load_dwordx4 v3, s[4:7], s16 offen offset:2048 lds
  v_mfma_f32_32x32x16_bf16 a[48:63], v[116:119], v[100:103], a[48:63]
  buffer_load_dwordx4 v3, s[4:7], s16 offen offset:3072 lds
  s_add_u32 s16, s16, 4096
  s_waitcnt lgkmcnt(0)
  v_mfma_f32_32x32x16_bf16 a[0:15], v[80:83], v[64:67], a[0:15]
  ds_read_b128 v[96:99], v9 offset:33792
  ds_read_b64_tr_b16 v[112:113], v14 offset:36864
  ds_read_b64_tr_b16 v[114:115], v14 offset:37888
  v_mfma_f32_32x32x16_bf16 a[16:31], v[84:87], v[64:67], a[16:31]
  ds_read_b64_tr_b16 v[116:117], v15 offset:36864
  ds_read_b64_tr_b16 v[118:119], v15 offset:37888
  ds_read_b128 v[100:103], v9 offset:37888
  s_add_u32 m0, s25, 65536
  v_mfma_f32_32x32x16_bf16 a[32:47], v[80:83], v[68:71], a[32:47]
  buffer_load_dwordx4 v4, s[8:11], s17 offen offset:0 lds
  v_mfma_f32_32x32x16_bf16 a[48:63], v[84:87], v[68:71], a[48:63]
  buffer_load_dwordx4 v5, s[8:11], s17 offen offset:1024 lds
  s_waitcnt lgkmcnt(0)
  v_mfma_f32_32x32x16_bf16 a[0:15], v[112:115], v[96:99], a[0:15]
  ds_read_b128 v[64:67], v9 offset:34816
  ds_read_b64_tr_b16 v[80:81], v14 offset:40960
  ds_read_b64_tr_b16 v[82:83], v14 offset:41984
  v_mfma_f32_32x32x16_bf16 a[16:31], v[116:119], v[96:99], a[16:31]
  ds_read_b64_tr_b16 v[84:85], v15 offset:40960
  ds_read_b64_tr_b16 v[86:87], v15 offset:41984
  ds_read_b128 v[68:71], v9 offset:38912
  v_mfma_f32_32x32x16_bf16 a[32:47], v[112:115], v[100:103], a[32:47]
  buffer_load_dwordx4 v6, s[8:11], s17 offen offset:2048 lds
  v_mfma_f32_32x32x16_bf16 a[48:63], v[116:119], v[100:103], a[48:63]
  buffer_load_dwordx4 v7, s[8:11], s17 offen offset:3072 lds
  s_add_u32 s17, s17, s18
  s_waitcnt lgkmcnt(0)
  v_mfma_f32_32x32x16_bf16 a[0:15], v[80:83], v[64:67], a[0:15]
  ds_read_b128 v[96:99], v9 offset:35840
  ds_read_b64_tr_b16 v[112:113], v14 offset:45056
  ds_read_b64_tr_b16 v[114:115], v14 offset:46080
  v_mfma_f32_32x32x16_bf16 a[16:31], v[84:87], v[64:67], a[16:31]
  ds_read_b64_tr_b16 v[116:117], v15 offset:45056
  ds_read_b64_tr_b16 v[118:119], v15 offset:46080
  ds_read_b128 v[100:103], v9 offset:39936
  v_mfma_f32_32x32x16_bf16 a[32:47], v[80:83], v[68:71], a[32:47]
  v_mfma_f32_32x32x16_bf16 a[48:63], v[84:87], v[68:71], a[48:63]
  s_waitcnt lgkmcnt(0)
  v_mfma_f32_32x32x16_bf16 a[0:15], v[112:115], v[96:99], a[0:15]
  s_waitcnt vmcnt(16)
  s_barrier
  ds_read_b128 v[64:67], v8 offset:0
  ds_read_b64_tr_b16 v[80:81], v10 offset:0
  ds_read_b64_tr_b16 v[82:83], v10 offset:1024
  s_add_u32 m0, s24, 98304
  v_mfma_f32_32x32x16_bf16 a[16:31], v[116:119], v[96:99], a[16:31]
  ds_read_b64_tr_b16 v[84:85], v11 offset:0
  ds_read_b64_tr_b16 v[86:87], v11 offset:1024
  ds_read_b128 v[68:71], v8 offset:4096
  buffer_load_dwordx4 v2, s[4:7], s16 offen offset:0 lds
  v_mfma_f32_32x32x16_bf16 a[32:47], v[112:115], v[100:103], a[32:47]
  buffer_load_dwordx4 v2, s[4:7], s16 offen offset:1024 lds
  buffer_load_dwordx4 v3, s[4:7], s16 offen offset:2048 lds
  v_mfma_f32_32x32x16_bf16 a[48:63], v[116:119], v[100:103], a[48:63]
  buffer_load_dwordx4 v3, s[4:7], s16 offen offset:3072 lds
  s_add_u32 s16, s16, 4096
  s_cmp_lg_u32 s19, 0
  s_cbranch_scc1 .gl28
  s_waitcnt vmcnt(0) lgkmcnt(0)
  s_nop 7
  s_nop 3
  s_branch .g_se
.g_sv:
  s_add_u32 m0, s24, 0
  s_nop 0
  buffer_load_dwordx4 v2, s[4:7], s16 offen offset:0 lds
  buffer_load_dwordx4 v2, s[4:7], s16 offen offset:1024 lds
  buffer_load_dwordx4 v3, s[4:7], s16 offen offset:2048 lds
  buffer_load_dwordx4 v3, s[4:7], s16 offen offset:3072 lds
  s_add_u32 s16, s16, 4096
  s_add_u32 m0, s25, 0
  s_nop 0
  buffer_load_dwordx4 v4, s[8:11], s17 offen offset:0 lds
  buffer_load_dwordx4 v5, s[8:11], s17 offen offset:1024 lds
  buffer_load_dwordx4 v6, s[8:11], s17 offen offset:2048 lds
  buffer_load_dwordx4 v7, s[8:11], s17 offen offset:3072 lds
  s_add_u32 s17, s17, s18
  s_add_u32 m0, s24, 32768
  s_nop 0
  buffer_load_dwordx4 v2, s[4:7], s16 offen offset:0 lds
  buffer_load_dwordx4 v2, s[4:7], s16 offen offset:1024 lds
  buffer_load_dwordx4 v3, s[4:7], s16 offen offset:2048 lds
  buffer_load_dwordx4 v3, s[4:7], s16 offen offset:3072 lds
  s_add_u32 s16, s16, 4096
  s_add_u32 m0, s25, 32768
  s_nop 0
  buffer_load_dwordx4 v4, s[8:11], s17 offen offset:0 lds
  buffer_load_dwordx4 v5, s[8:11], s17 offen offset:1024 lds
  buffer_load_dwordx4 v6, s[8:11], s17 offen offset:2048 lds
  buffer_load_dwordx4 v7, s[8:11], s17 offen offset:3072 lds
  s_add_u32 s17, s17, s18
  s_add_u32 m0, s24, 65536
  s_nop 0
  buffer_load_dwordx4 v2, s[4:7], s16 offen offset:0 lds
  buffer_load_dwordx4 v2, s[4:7], s16 offen offset:1024 lds
  buffer_load_dwordx4 v3, s[4:7], s16 offen offset:2048 lds
  buffer_load_dwordx4 v3, s[4:7], s16 offen offset:3072 lds
  s_add_u32 s16, s16, 4096
  s_add_u32 m0, s25, 65536
  s_nop 0
  buffer_load_dwordx4 v4, s[8:11], s17 offen offset:0 lds
  buffer_load_dwordx4 v5, s[8:11], s17 offen offset:1024 lds
  buffer_load_dwordx4 v6, s[8:11], s17 offen offset:2048 lds
  buffer_load_dwordx4 v7, s[8:11], s17 offen offset:3072 lds
  s_add_u32 s17, s17, s18
  s_add_u32 m0, s24, 98304
  s_nop 0
  buffer_load_dwordx4 v2, s[4:7], s16 offen offset:0 lds
  buffer_load_dwordx4 v2, s[4:7], s16 offen offset:1024 lds
  buffer_load_dwordx4 v3, s[4:7], s16 offen offset:2048 lds
  buffer_load_dwordx4 v3, s[4:7], s16 offen offset:3072 lds
  s_add_u32 s16, s16, 4096
  v_accvgpr_write_b32 a0, 0
  v_accvgpr_write_b32 a1, 0
  v_accvgpr_write_b32 a2, 0
  v_accvgpr_write_b32 a3, 0
  v_accvgpr_write_b32 a4, 0
  v_accvgpr_write_b32 a5, 0
  v_accvgpr_write_b32 a6, 0
  v_accvgpr_write_b32 a7, 0
  v_accvgpr_write_b32 a8, 0
  v_accvgpr_write_b32 a9, 0
  v_accvgpr_write_b32 a10, 0
  v_accvgpr_write_b32 a11, 0
  v_accvgpr_write_b32 a12, 0
  v_accvgpr_write_b32 a13, 0
  v_accvgpr_write_b32 a14, 0
  v_accvgpr_write_b32 a15, 0
  v_accvgpr_write_b32 a16, 0
  v_accvgpr_write_b32 a17, 0
  v_accvgpr_write_b32 a18, 0
  v_accvgpr_write_b32 a19, 0
  v_accvgpr_write_b32 a20, 0
  v_accvgpr_write_b32 a21, 0
  v_accvgpr_write_b32 a22, 0
  v_accvgpr_write_b32 a23, 0
  v_accvgpr_write_b32 a24, 0
  v_accvgpr_write_b32 a25, 0
  v_accvgpr_write_b32 a26, 0
  v_accvgpr_write_b32 a27, 0
  v_accvgpr_write_b32 a28, 0
  v_accvgpr_write_b32 a29, 0
  v_accvgpr_write_b32 a30, 0
  v_accvgpr_write_b32 a31, 0
  v_accvgpr_write_b32 a32, 0
  v_accvgpr_write_b32 a33, 0
  v_accvgpr_write_b32 a34, 0
  v_accvgpr_write_b32 a35, 0
  v_accvgpr_write_b32 a36, 0
  v_accvgpr_write_b32 a37, 0
  v_accvgpr_write_b32 a38, 0
  v_accvgpr_write_b32 a39, 0
  v_accvgpr_write_b32 a40, 0
  v_accvgpr_write_b32 a41, 0
  v_accvgpr_write_b32 a42, 0
  v_accvgpr_write_b32 a43, 0
  v_accvgpr_write_b32 a44, 0
  v_accvgpr_write_b32 a45, 0
  v_accvgpr_write_b32 a46, 0
  v_accvgpr_write_b32 a47, 0
  v_accvgpr_write_b32 a48, 0
  v_accvgpr_write_b32 a49, 0
  v_accvgpr_write_b32 a50, 0
  v_accvgpr_write_b32 a51, 0
  v_accvgpr_write_b32 a52, 0
  v_accvgpr_write_b32 a53, 0
  v_accvgpr_write_b32 a54, 0
  v_accvgpr_write_b32 a55, 0
  v_accvgpr_write_b32 a56, 0
  v_accvgpr_write_b32 a57, 0
  v_accvgpr_write_b32 a58, 0
  v_accvgpr_write_b32 a59, 0
  v_accvgpr_write_b32 a60, 0
  v_accvgpr_write_b32 a61, 0
  v_accvgpr_write_b32 a62, 0
  v_accvgpr_write_b32 a63, 0
  s_waitcnt vmcnt(20)
  s_barrier
  ds_read_b128 v[64:67], v8 offset:0
  ds_read_b64_tr_b16 v[80:81], v10 offset:0
  ds_read_b64_tr_b16 v[82:83], v10 offset:1024
  ds_read_b64_tr_b16 v[84:85], v11 offset:0
  ds_read_b64_tr_b16 v[86:87], v11 offset:1024
  ds_read_b128 v[68:71], v8 offset:4096
.gl29:
  s_sub_u32 s19, s19, 1
  s_waitcnt lgkmcnt(0)
  v_mfma_f32_32x32x16_bf16 a[0:15], v[64:67], v[80:83], a[0:15]
  ds_read_b128 v[96:99], v8 offset:1024
  ds_read_b64_tr_b16 v[112:113], v10 offset:4096
  ds_read_b64_tr_b16 v[114:115], v10 offset:5120
  v_mfma_f32_32x32x16_bf16 a[16:31], v[64:67], v[84:87], a[16:31]
  ds_read_b64_tr_b16 v[116:117], v11 offset:4096
  ds_read_b64_tr_b16 v[118:119], v11 offset:5120
  ds_read_b128 v[100:103], v8 offset:5120
  s_add_u32 m0, s25, 98304
  v_mfma_f32_32x32x16_bf16 a[32:47], v[68:71], v[80:83], a[32:47]
  buffer_load_dwordx4 v4, s[8:11], s17 offen offset:0 lds
  v_mfma_f32_32x32x16_bf16 a[48:63], v[68:71], v[84:87], a[48:63]
  buffer_load_dwordx4 v5, s[8:11], s17 offen offset:1024 lds
  s_waitcnt lgkmcnt(0)
  v_mfma_f32_32x32x16_bf16 a[0:15], v[96:99], v[112:115], a[0:15]
  ds_read_b128 v[64:67], v8 offset:2048
  ds_read_b64_tr_b16 v[80:81], v10 offset:8192
  ds_read_b64_tr_b16 v[82:83], v10 offset:9216
  v_mfma_f32_32x32x16_bf16 a[16:31], v[96:99], v[116:119], a[16:31]
  ds_read_b64_tr_b16 v[84:85], v11 offset:8192
  ds_read_b64_tr_b16 v[86:87], v11 offset:9216
  ds_read_b128 v[68:71], v8 offset:6144
  v_mfma_f32_32x32x16_bf16 a[32:47], v[100:103], v[112:115], a[32:47]
  buffer_load_dwordx4 v6, s[8:11], s17 offen offset:2048 lds
  v_mfma_f32_32x32x16_bf16 a[48:63], v[100:103], v[116:119], a[48:63]
  buffer_load_dwordx4 v7, s[8:11], s17 offen offset:3072 lds
  s_add_u32 s17, s17, s18
  s_waitcnt lgkmcnt(0)
  v_mfma_f32_32x32x16_bf16 a[0:15], v[64:67], v[80:83], a[0:15]
  ds_read_b128 v[96:99], v8 offset:3072
  ds_read_b64_tr_b16 v[112:113], v10 offset:12288
  ds_read_b64_tr_b16 v[114:115], v10 offset:13312
  v_mfma_f32_32x32x16_bf16 a[16:31], v[64:67], v[84:87], a[16:31]
  ds_read_b64_tr_b16 v[116:117], v11 offset:12288
  ds_read_b64_tr_b16 v[118:119], v11 offset:13312
  ds_read_b128 v[100:103], v8 offset:7168
  v_mfma_f32_32x32x16_bf16 a[32:47], v[68:71], v[80:83], a[32:47]
  v_mfma_f32_32x32x16_bf16 a[48:63], v[68:71], v[84:87], a[48:63]
  s_waitcnt lgkmcnt(0)
  v_mfma_f32_32x32x16_bf16 a[0:15], v[96:99], v[112:115], a[0:15]
  s_waitcnt vmcnt(16)
  s_barrier
  s_cmp_eq_u32 s19, 0
  s_cselect_b32 s6, 0, s6
  s_cselect_b32 s10, 0, s10
  ds_read_b128 v[64:67], v8 offset:32768
  ds_read_b64_tr_b16 v[80:81], v10 offset:32768
  ds_read_b64_tr_b16 v[82:83], v10 offset:33792
  s_add_u32 m0, s24, 0
  v_mfma_f32_32x32x16_bf16 a[16:31], v[96:99], v[116:119], a[16:31]
  ds_read_b64_tr_b16 v[84:85], v11 offset:32768
  ds_read_b64_tr_b16 v[86:87], v11 offset:33792
  ds_read_b128 v[68:71], v8 offset:36864
  buffer_load_dwordx4 v2, s[4:7], s16 offen offset:0 lds
  v_mfma_f32_32x32x16_bf16 a[32:47], v[100:103], v[112:115], a[32:47]
  buffer_load_dwordx4 v2, s[4:7], s16 offen offset:1024 lds
  buffer_load_dwordx4 v3, s[4:7], s16 offen offset:2048 lds
  v_mfma_f32_32x32x16_bf16 a[48:63], v[100:103], v[116:119], a[48:63]
  buffer_load_dwordx4 v3, s[4:7], s16 offen offset:3072 lds
  s_add_u32 s16, s16, 4096
  s_waitcnt lgkmcnt(0)
  v_mfma_f32_32x32x16_bf16 a[0:15], v[64:67], v[80:83], a[0:15]
  ds_read_b128 v[96:99], v8 offset:33792
  ds_read_b64_tr_b16 v[112:113], v10 offset:36864
  ds_read_b64_tr_b16 v[114:115], v10 offset:37888
  v_mfma_f32_32x32x16_bf16 a[16:31], v[64:67], v[84:87], a[16:31]
  ds_read_b64_tr_b16 v[116:117], v11 offset:36864
  ds_read_b64_tr_b16 v[118:119], v11 offset:37888
  ds_read_b128 v[100:103], v8 offset:37888
  s_add_u32 m0, s25, 0
  v_mfma_f32_32x32x16_bf16 a[32:47], v[68:71], v[80:83], a[32:47]
  buffer_load_dwordx4 v4, s[8:11], s17 offen offset:0 lds
  v_mfma_f32_32x32x16_bf16 a[48:63], v[68:71], v[84:87], a[48:63]
  buffer_load_dwordx4 v5, s[8:11], s17 offen offset:1024 lds
  s_waitcnt lgkmcnt(0)
  v_mfma_f32_32x32x16_bf16 a[0:15], v[96:99], v[112:115], a[0:15]
  ds_read_b128 v[64:67], v8 offset:34816
  ds_read_b64_tr_b16 v[80:81], v10 offset:40960
  ds_read_b64_tr_b16 v[82:83], v10 offset:41984
  v_mfma_f32_32x32x16_bf16 a[16:31], v[96:99], v[116:119], a[16:31]
  ds_read_b64_tr_b16 v[84:85], v11 offset:40960
  ds_read_b64_tr_b16 v[86:87], v11 offset:41984
  ds_read_b128 v[68:71], v8 offset:38912
  v_mfma_f32_32x32x16_bf16 a[32:47], v[100:103], v[112:115], a[32:47]
  buffer_load_dwordx4 v6, s[8:11], s17 offen offset:2048 lds
  v_mfma_f32_32x32x16_bf16 a[48:63], v[100:103], v[116:119], a[48:63]
  buffer_load_dwordx4 v7, s[8:11], s17 offen offset:3072 lds
  s_add_u32 s17, s17, s18
  s_waitcnt lgkmcnt(0)
  v_mfma_f32_32x32x16_bf16 a[0:15], v[64:67], v[80:83], a[0:15]
  ds_read_b128 v[96:99], v8 offset:35840
  ds_read_b64_tr_b16 v[112:113], v10 offset:45056
  ds_read_b64_tr_b16 v[114:115], v10 offset:46080
  v_mfma_f32_32x32x16_bf16 a[16:31], v[64:67], v[84:87], a[16:31]
  ds_read_b64_tr_b16 v[116:117], v11 offset:45056
  ds_read_b64_tr_b16 v[118:119], v11 offset:46080
  ds_read_b128 v[100:103], v8 offset:39936
  v_mfma_f32_32x32x16_bf16 a[32:47], v[68:71], v[80:83], a[32:47]
  v_mfma_f32_32x32x16_bf16 a[48:63], v[68:71], v[84:87], a[48:63]
  s_waitcnt lgkmcnt(0)
  v_mfma_f32_32x32x16_bf16 a[0:15], v[96:99], v[112:115], a[0:15]
  s_waitcnt vmcnt(16)
  s_barrier
  ds_read_b128 v[64:67], v9 offset:0
  ds_read_b64_tr_b16 v[80:81], v14 offset:0
  ds_read_b64_tr_b16 v[82:83], v14 offset:1024
  s_add_u32 m0, s24, 32768
  v_mfma_f32_32x32x16_bf16 a[16:31], v[96:99], v[116:119], a[16:31]
  ds_read_b64_tr_b16 v[84:85], v15 offset:0
  ds_read_b64_tr_b16 v[86:87], v15 offset:1024
  ds_read_b128 v[68:71], v9 offset:4096
  buffer_load_dwordx4 v2, s[4:7], s16 offen offset:0 lds
  v_mfma_f32_32x32x16_bf16 a[32:47], v[100:103], v[112:115], a[32:47]
  buffer_load_dwordx4 v2, s[4:7], s16 offen offset:1024 lds
  buffer_load_dwordx4 v3, s[4:7], s16 offen offset:2048 lds
  v_mfma_f32_32x32x16_bf16 a[48:63], v[100:103], v[116:119], a[48:63]
  buffer_load_dwordx4 v3, s[4:7], s16 offen offset:3072 lds
  s_add_u32 s16, s16, 4096
  s_waitcnt lgkmcnt(0)
  v_mfma_f32_32x32x16_bf16 a[0:15], v[64:67], v[80:83], a[0:15]
  ds_read_b128 v[96:99], v9 offset:1024
  ds_read_b64_tr_b16 v[112:113], v14 offset:4096
  ds_read_b64_tr_b16 v[114:115], v14 offset:5120
  v_mfma_f32_32x32x16_bf16 a[16:31], v[64:67], v[84:87], a[16:31]
  ds_read_b64_tr_b16 v[116:117], v15 offset:4096
  ds_read_b64_tr_b16 v[118:119], v15 offset:5120
  ds_read_b128 v[100:103], v9 offset:5120
  s_add_u32 m0, s25, 32768
  v_mfma_f32_32x32x16_bf16 a[32:47], v[68:71], v[80:83], a[32:47]
  buffer_load_dwordx4 v4, s[8:11], s17 offen offset:0 lds
  v_mfma_f32_32x32x16_bf16 a[48:63], v[68:71], v[84:87], a[48:63]
  buffer_load_dwordx4 v5, s[8:11], s17 offen offset:1024 lds
  s_waitcnt lgkmcnt(0)
  v_mfma_f32_32x32x16_bf16 a[0:15], v[96:99], v[112:115], a[0:15]
  ds_read_b128 v[64:67], v9 offset:2048
  ds_read_b64_tr_b16 v[80:81], v14 offset:8192
  ds_read_b64_tr_b16 v[82:83], v14 offset:9216
  v_mfma_f32_32x32x16_bf16 a[16:31], v[96:99], v[116:119], a[16:31]
  ds_read_b64_tr_b16 v[84:85], v15 offset:8192
  ds_read_b64_tr_b16 v[86:87], v15 offset:9216
  ds_read_b128 v[68:71], v9 offset:6144
  v_mfma_f32_32x32x16_bf16 a[32:47], v[100:103], v[112:115], a[32:47]
  buffer_load_dwordx4 v6, s[8:11], s17 offen offset:2048 lds
  v_mfma_f32_32x32x16_bf16 a[48:63], v[100:103], v[116:119], a[48:63]
  buffer_load_dwordx4 v7, s[8:11], s17 offen offset:3072 lds
  s_add_u32 s17, s17, s18
  s_waitcnt lgkmcnt(0)
  v_mfma_f32_32x32x16_bf16 a[0:15], v[64:67], v[80:83], a[0:15]
  ds_read_b128 v[96:99], v9 offset:3072
  ds_read_b64_tr_b16 v[112:113], v14 offset:12288
  ds_read_b64_tr_b16 v[114:115], v14 offset:13312
  v_mfma_f32_32x32x16_bf16 a[16:31], v[64:67], v[84:87], a[16:31]
  ds_read_b64_tr_b16 v[116:117], v15 offset:12288
  ds_read_b64_tr_b16 v[118:119], v15 offset:13312
  ds_read_b128 v[100:103], v9 offset:7168
  v_mfma_f32_32x32x16_bf16 a[32:47], v[68:71], v[80:83], a[32:47]
  v_mfma_f32_32x32x16_bf16 a[48:63], v[68:71], v[84:87], a[48:63]
  s_waitcnt lgkmcnt(0)
  v_mfma_f32_32x32x16_bf16 a[0:15], v[96:99], v[112:115], a[0:15]
  s_waitcnt vmcnt(16)
  s_barrier
  ds_read_b128 v[64:67], v9 offset:32768
  ds_read_b64_tr_b16 v[80:81], v14 offset:32768
  ds_read_b64_tr_b16 v[82:83], v14 offset:33792
  s_add_u32 m0, s24, 65536
  v_mfma_f32_32x32x16_bf16 a[16:31], v[96:99], v[116:119], a[16:31]
  ds_read_b64_tr_b16 v[84:85], v15 offset:32768
  ds_read_b64_tr_b16 v[86:87], v15 offset:33792
  ds_read_b128 v[68:71], v9 offset:36864
  buffer_load_dwordx4 v2, s[4:7], s16 offen offset:0 lds
  v_mfma_f32_32x32x16_bf16 a[32:47], v[100:103], v[112:115], a[32:47]
  buffer_load_dwordx4 v2, s[4:7], s16 offen offset:1024 lds
  buffer_load_dwordx4 v3, s[4:7], s16 offen offset:2048 lds
  v_mfma_f32_32x32x16_bf16 a[48:63], v[100:103], v[116:119], a[48:63]
  buffer_load_dwordx4 v3, s[4:7], s16 offen offset:3072 lds
  s_add_u32 s16, s16, 4096
  s_waitcnt lgkmcnt(0)
  v_mfma_f32_32x32x16_bf16 a[0:15], v[64:67], v[80:83], a[0:15]
  ds_read_b128 v[96:99], v9 offset:33792
  ds_read_b64_tr_b16 v[112:113], v14 offset:36864
  ds_read_b64_tr_b16 v[114:115], v14 offset:37888
  v_mfma_f32_32x32x16_bf16 a[16:31], v[64:67], v[84:87], a[16:31]
  ds_read_b64_tr_b16 v[116:117], v15 offset:36864
  ds_read_b64_tr_b16 v[118:119], v15 offset:37888
  ds_read_b128 v[100:103], v9 offset:37888
  s_add_u32 m0, s25, 65536
  v_mfma_f32_32x32x16_bf16 a[32:47], v[68:71], v[80:83], a[32:47]
  buffer_load_dwordx4 v4, s[8:11], s17 offen offset:0 lds
  v_mfma_f32_32x32x16_bf16 a[48:63], v[68:71], v[84:87], a[48:63]
  buffer_load_dwordx4 v5, s[8:11], s17 offen offset:1024 lds
  s_waitcnt lgkmcnt(0)
  v_mfma_f32_32x32x16_bf16 a[0:15], v[96:99], v[112:115], a[0:15]
  ds_read_b128 v[64:67], v9 offset:34816
  ds_read_b64_tr_b16 v[80:81], v14 offset:40960
  ds_read_b64_tr_b16 v[82:83], v14 offset:41984
  v_mfma_f32_32x32x16_bf16 a[16:31], v[96:99], v[116:119], a[16:31]
  ds_read_b64_tr_b16 v[84:85], v15 offset:40960
  ds_read_b64_tr_b16 v[86:87], v15 offset:41984
  ds_read_b128 v[68:71], v9 offset:38912
  v_mfma_f32_32x32x16_bf16 a[32:47], v[100:103], v[112:115], a[32:47]
  buffer_load_dwordx4 v6, s[8:11], s17 offen offset:2048 lds
  v_mfma_f32_32x32x16_bf16 a[48:63], v[100:103], v[116:119], a[48:63]
  buffer_load_dwordx4 v7, s[8:11], s17 offen offset:3072 lds
  s_add_u32 s17, s17, s18
  s_waitcnt lgkmcnt(0)
  v_mfma_f32_32x32x16_bf16 a[0:15], v[64:67], v[80:83], a[0:15]
  ds_read_b128 v[96:99], v9 offset:35840
  ds_read_b64_tr_b16 v[112:113], v14 offset:45056
  ds_read_b64_tr_b16 v[114:115], v14 offset:46080
  v_mfma_f32_32x32x16_bf16 a[16:31], v[64:67], v[84:87], a[16:31]
  ds_read_b64_tr_b16 v[116:117], v15 offset:45056
  ds_read_b64_tr_b16 v[118:119], v15 offset:46080
  ds_read_b128 v[100:103], v9 offset:39936
  v_mfma_f32_32x32x16_bf16 a[32:47], v[68:71], v[80:83], a[32:47]
  v_mfma_f32_32x32x16_bf16 a[48:63], v[68:71], v[84:87], a[48:63]
  s_waitcnt lgkmcnt(0)
  v_mfma_f32_32x32x16_bf16 a[0:15], v[96:99], v[112:115], a[0:15]
  s_waitcnt vmcnt(16)
  s_barrier
  ds_read_b128 v[64:67], v8 offset:0
  ds_read_b64_tr_b16 v[80:81], v10 offset:0
  ds_read_b64_tr_b16 v[82:83], v10 offset:1024
  s_add_u32 m0, s24, 98304
  v_mfma_f32_32x32x16_bf16 a[16:31], v[96:99], v[116:119], a[16:31]
  ds_read_b64_tr_b16 v[84:85], v11 offset:0
  ds_read_b64_tr_b16 v[86:87], v11 offset:1024
  ds_read_b128 v[68:71], v8 offset:4096
  buffer_load_dwordx4 v2, s[4:7], s16 offen offset:0 lds
  v_mfma_f32_32x32x16_bf16 a[32:47], v[100:103], v[112:115], a[32:47]
  buffer_load_dwordx4 v2, s[4:7], s16 offen offset:1024 lds
  buffer_load_dwordx4 v3, s[4:7], s16 offen offset:2048 lds
  v_mfma_f32_32x32x16_bf16 a[48:63], v[100:103], v[116:119], a[48:63]
  buffer_load_dwordx4 v3, s[4:7], s16 offen offset:3072 lds
  s_add_u32 s16, s16, 4096
  s_cmp_lg_u32 s19, 0
  s_cbranch_scc1 .gl29
  s_waitcnt vmcnt(0) lgkmcnt(0)
  s_nop 7
  s_nop 3
.g_se:
  s_lshr_b32 s26, s23, 1
  s_mul_i32 s26, s26, 2
  s_mul_i32 s26, s26, s22
  s_and_b32 s27, s23, 1
  s_mul_i32 s28, s27, 4096
  s_add_u32 s26, s26, s28
  v_lshlrev_b32 v18, 4, v1
  v_accvgpr_read_b32 v24, a0
  v_accvgpr_read_b32 v25, a1
  v_accvgpr_read_b32 v26, a2
  v_accvgpr_read_b32 v27, a3
  v_accvgpr_read_b32 v28, a4
  v_accvgpr_read_b32 v29, a5
  v_accvgpr_read_b32 v30, a6
  v_accvgpr_read_b32 v31, a7
  v_cvt_pk_bf16_f32 v40, v24, v25
  v_cvt_pk_bf16_f32 v42, v28, v29
  v_cvt_pk_bf16_f32 v41, v26, v27
  v_cvt_pk_bf16_f32 v43, v30, v31
  buffer_store_dwordx4 v[40:43], v18, s[12:15], s26 offen offset:0 sc1
  v_accvgpr_read_b32 v44, a8
  v_accvgpr_read_b32 v45, a9
  v_accvgpr_read_b32 v46, a10
  v_accvgpr_read_b32 v47, a11
  v_accvgpr_read_b32 v48, a12
  v_accvgpr_read_b32 v49, a13
  v_accvgpr_read_b32 v50, a14
  v_accvgpr_read_b32 v51, a15
  v_cvt_pk_bf16_f32 v60, v44, v45
  v_cvt_pk_bf16_f32 v62, v48, v49
  v_cvt_pk_bf16_f32 v61, v46, v47
  v_cvt_pk_bf16_f32 v63, v50, v51
  buffer_store_dwordx4 v[60:63], v18, s[12:15], s26 offen offset:1024 sc1
  v_accvgpr_read_b32 v24, a16
  v_accvgpr_read_b32 v25, a17
  v_accvgpr_read_b32 v26, a18
  v_accvgpr_read_b32 v27, a19
  v_accvgpr_read_b32 v28, a20
  v_accvgpr_read_b32 v29, a21
  v_accvgpr_read_b32 v30, a22
  v_accvgpr_read_b32 v31, a23
  v_cvt_pk_bf16_f32 v40, v24, v25
  v_cvt_pk_bf16_f32 v42, v28, v29
  v_cvt_pk_bf16_f32 v41, v26, v27
  v_cvt_pk_bf16_f32 v43, v30, v31
  buffer_store_dwordx4 v[40:43], v18, s[12:15], s26 offen offset:2048 sc1
  v_accvgpr_read_b32 v44, a24
  v_accvgpr_read_b32 v45, a25
  v_accvgpr_read_b32 v46, a26
  v_accvgpr_read_b32 v47, a27
  v_accvgpr_read_b32 v48, a28
  v_accvgpr_read_b32 v49, a29
  v_accvgpr_read_b32 v50, a30
  v_accvgpr_read_b32 v51, a31
  v_cvt_pk_bf16_f32 v60, v44, v45
  v_cvt_pk_bf16_f32 v62, v48, v49
  v_cvt_pk_bf16_f32 v61, v46, v47
  v_cvt_pk_bf16_f32 v63, v50, v51
  buffer_store_dwordx4 v[60:63], v18, s[12:15], s26 offen offset:3072 sc1
  s_add_u32 s26, s26, s22
  v_accvgpr_read_b32 v24, a32
  v_accvgpr_read_b32 v25, a33
  v_accvgpr_read_b32 v26, a34
  v_accvgpr_read_b32 v27, a35
  v_accvgpr_read_b32 v28, a36
  v_accvgpr_read_b32 v29, a37
  v_accvgpr_read_b32 v30, a38
  v_accvgpr_read_b32 v31, a39
  v_cvt_pk_bf16_f32 v40, v24, v25
  v_cvt_pk_bf16_f32 v42, v28, v29
  v_cvt_pk_bf16_f32 v41, v26, v27
  v_cvt_pk_bf16_f32 v43, v30, v31
  buffer_store_dwordx4 v[40:43], v18, s[12:15], s26 offen offset:0 sc1
  v_accvgpr_read_b32 v44, a40
  v_accvgpr_read_b32 v45, a41
  v_accvgpr_read_b32 v46, a42
  v_accvgpr_read_b32 v47, a43
  v_accvgpr_read_b32 v48, a44
  v_accvgpr_read_b32 v49, a45
  v_accvgpr_read_b32 v50, a46
  v_accvgpr_read_b32 v51, a47
  v_cvt_pk_bf16_f32 v60, v44, v45
  v_cvt_pk_bf16_f32 v62, v48, v49
  v_cvt_pk_bf16_f32 v61, v46, v47
  v_cvt_pk_bf16_f32 v63, v50, v51
  buffer_store_dwordx4 v[60:63], v18, s[12:15], s26 offen offset:1024 sc1
  v_accvgpr_read_b32 v24, a48
  v_accvgpr_read_b32 v25, a49
  v_accvgpr_read_b32 v26, a50
  v_accvgpr_read_b32 v27, a51
  v_accvgpr_read_b32 v28, a52
  v_accvgpr_read_b32 v29, a53
  v_accvgpr_read_b32 v30, a54
  v_accvgpr_read_b32 v31, a55
  v_cvt_pk_bf16_f32 v40, v24, v25
  v_cvt_pk_bf16_f32 v42, v28, v29
  v_cvt_pk_bf16_f32 v41, v26, v27
  v_cvt_pk_bf16_f32 v43, v30, v31
  buffer_store_dwordx4 v[40:43], v18, s[12:15], s26 offen offset:2048 sc1
  v_accvgpr_read_b32 v44, a56
  v_accvgpr_read_b32 v45, a57
  v_accvgpr_read_b32 v46, a58
  v_accvgpr_read_b32 v47, a59
  v_accvgpr_read_b32 v48, a60
  v_accvgpr_read_b32 v49, a61
  v_accvgpr_read_b32 v50, a62
  v_accvgpr_read_b32 v51, a63
  v_cvt_pk_bf16_f32 v60, v44, v45
  v_cvt_pk_bf16_f32 v62, v48, v49
  v_cvt_pk_bf16_f32 v61, v46, v47
  v_cvt_pk_bf16_f32 v63, v50, v51
  buffer_store_dwordx4 v[60:63], v18, s[12:15], s26 offen offset:3072 sc1
  s_add_u32 s26, s26, s22
  s_waitcnt vmcnt(0)
  s_barrier
  s_mov_b32 s55, 0
  s_cmp_lg_u32 s23, 0
  s_cbranch_scc1 .g_s1
  v_mov_b32 v18, 1
  s_mov_b64 exec, 1
  buffer_atomic_add v18, off, s[96:99], s54 sc0 sc1
  s_mov_b64 exec, -1
  s_waitcnt vmcnt(0)
  v_readfirstlane_b32 s27, v18
  s_lshl4_add_u32 s27, s27, s54
  s_cmp_lg_u32 s27, 2048
  s_cbranch_scc1 .g_s1
  v_mov_b32 v18, 128
  v_lshlrev_b32 v245, 7, v1
  s_add_u32 s40, s94, 119537664
  s_addc_u32 s41, s95, 0
  s_mov_b32 s42, 40960
  s_mov_b32 s43, 0x20000
  s_mov_b32 s27, 0
  buffer_store_dword v18, v245, s[40:43], s27 offen offset:4 sc0 sc1
  s_mov_b32 s27, 8192
  buffer_store_dword v18, v245, s[40:43], s27 offen offset:4 sc0 sc1
  s_mov_b32 s27, 16384
  buffer_store_dword v18, v245, s[40:43], s27 offen offset:4 sc0 sc1
  s_mov_b32 s27, 24576
  buffer_store_dword v18, v245, s[40:43], s27 offen offset:4 sc0 sc1
  s_mov_b32 s27, 32768
  buffer_store_dword v18, v245, s[40:43], s27 offen offset:4 sc0 sc1
.g_s1:
  s_add_u32 s52, s52, 2
  s_add_u32 s54, s54, 4
  s_cmp_lt_u32 s54, 24
  s_cbranch_scc1 .g_s
  s_cmp_ge_u32 s45, 16
  s_cbranch_scc1 .g_nw
  s_sub_u32 s26, s44, 4
  s_lshl4_add_u32 s26, s26, s45
  s_lshl2_add_u32 s26, s26, s23
  s_mul_i32 s26, s26, 28672
  v_lshl_add_u32 v245, v1, 6, s26
  s_add_u32 s40, s84, 0
  s_addc_u32 s41, s85, 0
  s_mov_b32 s42, 7340032
  s_mov_b32 s43, 0x20000
  s_movk_i32 s26, 0
  buffer_load_dword v246, v245, s[40:43], s26 offen
  s_movk_i32 s26, 4096
  buffer_load_dword v247, v245, s[40:43], s26 offen
  s_movk_i32 s26, 8192
  buffer_load_dword v248, v245, s[40:43], s26 offen
  s_movk_i32 s26, 12288
  buffer_load_dword v249, v245, s[40:43], s26 offen
  s_movk_i32 s26, 16384
  buffer_load_dword v250, v245, s[40:43], s26 offen
  s_movk_i32 s26, 20480
  buffer_load_dword v251, v245, s[40:43], s26 offen
  s_movk_i32 s26, 24576
  buffer_load_dword v252, v245, s[40:43], s26 offen
.g_nw:
.g_ns:
  buffer_load_dword v18, off, s[96:99], 0 offset:16 sc0 sc1
  s_sub_u32 s50, s50, 1
  s_cbranch_scc1 .g_end
  s_waitcnt vmcnt(0)
  v_readfirstlane_b32 s27, v18
  s_cmp_lg_u32 s27, 128
  s_cbranch_scc1 .g_ns
  v_and_b32 v1, 63, v0
  v_lshrrev_b32 v18, 6, v0
  s_nop 0
  v_readfirstlane_b32 s23, v18
  s_lshl_b32 s24, s23, 12
  s_add_u32 s25, s24, 16384
  s_lshr_b32 s26, s23, 1
  s_mul_i32 s26, s26, 2048
  v_lshlrev_b32 v8, 4, v1
  v_add_u32 v8, s26, v8
  v_add_u32 v9, 0x10000, v8
  v_bfe_u32 v18, v1, 2, 2
  v_lshrrev_b32 v19, 5, v1
  v_lshl_add_u32 v19, v19, 3, v18
  v_mul_u32_u24 v19, 512, v19
  v_bfe_u32 v20, v1, 4, 1
  v_lshlrev_b32 v20, 2, v20
  v_and_b32 v21, 1, v1
  v_lshl_add_u32 v20, v21, 1, v20
  v_bfe_u32 v21, v1, 1, 1
  v_add_u32 v20, v20, v21
  v_lshl_add_u32 v19, v20, 3, v19
  v_add_u32 v19, 16384, v19
  s_and_b32 s26, s23, 1
  s_mul_i32 s26, s26, 4
  s_add_u32 s27, s26, 0
  v_xor_b32 v20, s27, v18
  v_lshl_add_u32 v10, v20, 6, v19
  v_add_u32 v14, 0x10000, v10
  s_add_u32 s27, s26, 1
  v_xor_b32 v20, s27, v18
  v_lshl_add_u32 v11, v20, 6, v19
  v_add_u32 v15, 0x10000, v11
  s_add_u32 s27, s26, 2
  v_xor_b32 v20, s27, v18
  v_lshl_add_u32 v12, v20, 6, v19
  v_add_u32 v16, 0x10000, v12
  s_add_u32 s27, s26, 3
  v_xor_b32 v20, s27, v18
  v_lshl_add_u32 v13, v20, 6, v19
  v_add_u32 v17, 0x10000, v13
  s_mov_b32 s48, 1
  s_cmp_eq_u32 s45, 0
  s_cselect_b32 s60, 1640721424, s60
  s_cselect_b32 s61, 135, s61
  s_cmp_eq_u32 s45, 1
  s_cselect_b32 s60, 1707895888, s60
  s_cselect_b32 s61, 151, s61
  s_cmp_eq_u32 s45, 2
  s_cselect_b32 s60, 713911440, s60
  s_cselect_b32 s61, 165166, s61
  s_cmp_eq_u32 s45, 3
  s_cselect_b32 s60, 781085904, s60
  s_cselect_b32 s61, 181566, s61
  s_cmp_eq_u32 s45, 4
  s_cselect_b32 s60, 310905104, s60
  s_cselect_b32 s61, 143929934, s61
  s_cmp_eq_u32 s45, 5
  s_cselect_b32 s60, 378079568, s60
  s_cselect_b32 s61, 160723550, s61
  s_cmp_eq_u32 s45, 6
  s_cselect_b32 s60, 445254032, s60
  s_cselect_b32 s61, 177517166, s61
  s_cmp_eq_u32 s45, 7
  s_cselect_b32 s60, 512428496, s60
  s_cselect_b32 s61, 194310782, s61
  s_cmp_eq_u32 s45, 8
  s_cselect_b32 s60, 542642179, s60
  s_cselect_b32 s61, 0, s61
  s_cmp_eq_u32 s45, 9
  s_cselect_b32 s60, 609816643, s60
  s_cselect_b32 s61, 0, s61
  s_cmp_eq_u32 s45, 10
  s_cselect_b32 s60, 676868227, s60
  s_cselect_b32 s61, 0, s61
  s_cmp_eq_u32 s45, 11
  s_cselect_b32 s60, 744042691, s60
  s_cselect_b32 s61, 0, s61
  s_cmp_eq_u32 s45, 12
  s_cselect_b32 s60, 542658819, s60
  s_cselect_b32 s61, 0, s61
  s_cmp_eq_u32 s45, 13
  s_cselect_b32 s60, 609833283, s60
  s_cselect_b32 s61, 0, s61
  s_cmp_eq_u32 s45, 14
  s_cselect_b32 s60, 2601034115, s60
  s_cselect_b32 s61, 165126, s61
  s_cmp_eq_u32 s45, 15
  s_cselect_b32 s60, 2668208139, s60
  s_cselect_b32 s61, 181526, s61
  s_cmp_eq_u32 s45, 16
  s_cselect_b32 s60, 2695515160, s60
  s_cselect_b32 s61, 138506, s61
  s_cmp_eq_u32 s45, 17
  s_cselect_b32 s60, 2762689624, s60
  s_cselect_b32 s61, 154906, s61
  s_cmp_eq_u32 s45, 18
  s_cselect_b32 s60, 2829864088, s60
  s_cselect_b32 s61, 171306, s61
  s_cmp_eq_u32 s45, 19
  s_cselect_b32 s60, 2897038552, s60
  s_cselect_b32 s61, 187706, s61
  s_cmp_eq_u32 s45, 20
  s_cselect_b32 s60, 1630424344, s60
  s_cselect_b32 s61, 129, s61
  s_cmp_eq_u32 s45, 21
  s_cselect_b32 s60, 1697148248, s60
  s_cselect_b32 s61, 145, s61
  s_cmp_eq_u32 s45, 22
  s_cselect_b32 s60, 1764322712, s60
  s_cselect_b32 s61, 161, s61
  s_cmp_eq_u32 s45, 23
  s_cselect_b32 s60, 1831497176, s60
  s_cselect_b32 s61, 177, s61
  s_cmp_eq_u32 s45, 24
  s_cselect_b32 s60, 2198372427, s60
  s_cselect_b32 s61, 148126216, s61
  s_cmp_eq_u32 s45, 25
  s_cselect_b32 s60, 2265546891, s60
  s_cselect_b32 s61, 164919832, s61
  s_cmp_eq_u32 s45, 26
  s_cselect_b32 s60, 2332721355, s60
  s_cselect_b32 s61, 181713448, s61
  s_cmp_eq_u32 s45, 27
  s_cselect_b32 s60, 2399895819, s60
  s_cselect_b32 s61, 198507064, s61
  s_cmp_eq_u32 s45, 28
  s_cselect_b32 s60, 1393328459, s60
  s_cselect_b32 s61, 129, s61
  s_cmp_eq_u32 s45, 29
  s_cselect_b32 s60, 1460502923, s60
  s_cselect_b32 s61, 145, s61
  s_cmp_eq_u32 s45, 30
  s_cselect_b32 s60, 2207154195, s60
  s_cselect_b32 s61, 171302, s61
  s_cmp_eq_u32 s45, 31
  s_cselect_b32 s60, 2274328659, s60
  s_cselect_b32 s61, 187702, s61
.g_b:
  s_bfe_u32 s56, s60, 0x10009
  s_and_b32 s56, s56, s55
  s_xor_b32 s56, s56, 1
  s_cbranch_scc0 .g_epi
  s_and_b32 s51, s60, 7
  s_bfe_u32 s52, s60, 0x30003
  s_bfe_u32 s53, s60, 0x30006
  s_lshr_b64 s[60:61], s[60:61], 10
  s_sub_u32 s27, s44, 4
  s_cmp_eq_u32 s51, 2
  s_cbranch_scc1 .g_Q
  s_cmp_eq_u32 s51, 3
  s_cbranch_scc1 .g_H
  s_cmp_eq_u32 s51, 4
  s_cbranch_scc1 .g_B
  s_cmp_lg_u32 s51, 0
  s_cbranch_scc1 .g_fin
  s_mov_b32 s51, s47
  s_lshl3_add_u32 s53, s46, s53
  s_branch .g_run
.g_Q:
  s_lshl2_add_u32 s53, s27, s53
  s_branch .g_run
.g_H:
  s_lshl1_add_u32 s52, s52, s46
  s_mul_i32 s26, s47, 7
  s_add_u32 s53, s53, s26
  s_branch .g_run
.g_B:
  s_lshl1_add_u32 s52, s52, s46
  s_lshl1_add_u32 s53, s47, s53
  s_lshl_b32 s26, s52, 2
.g_Bw:
  buffer_load_dword v18, off, s[96:99], s26 offset:48 sc0 sc1
  s_sub_u32 s50, s50, 1
  s_cbranch_scc1 .g_end
  s_waitcnt vmcnt(0)
  v_readfirstlane_b32 s27, v18
  s_cmp_lg_u32 s27, 56
  s_cbranch_scc1 .g_Bw
  s_branch .g_run
.g_fin:
  s_lshl2_add_u32 s47, s27, s53
  s_lshl_b32 s46, s52, 2
.g_eng:
  s_lshl_b32 s26, s23, 21
  s_lshl_b32 s27, s47, 7
  s_add_u32 s26, s26, s27
  s_sub_u32 s28, 0x800000, s26
  s_add_u32 s8, s74, s26
  s_addc_u32 s9, s75, 0
  s_mov_b32 s10, s28
  s_mov_b32 s11, 0x20000
  s_add_u32 s4, s94, 0
  s_addc_u32 s5, s95, 0
  s_mov_b32 s6, 266338304
  s_mov_b32 s7, 0x20000
  s_sub_u32 s28, 0x400000, s27
  s_add_u32 s12, s90, s27
  s_addc_u32 s13, s91, 0
  s_mov_b32 s14, s28
  s_mov_b32 s15, 0x20000
  s_lshl_b32 s57, s47, 7
  s_sub_u32 s57, s57, s62
  s_add_u32 s57, s57, 105472000
  v_mov_b32 v17, 159744
  s_cmp_lg_u32 s23, 0
  s_cbranch_scc1 .en_j1
  buffer_load_dword v13, off, s[4:7], s57 sc1
  s_waitcnt vmcnt(0)
  ds_write_b32 v17, v13
  s_waitcnt lgkmcnt(0)
.en_j1:
  s_barrier
  ds_read_b32 v13, v17
  s_waitcnt lgkmcnt(0)
  v_readfirstlane_b32 s26, v13
  s_add_u32 s26, s26, s46
  s_cmp_ge_i32 s26, 63
  s_cbranch_scc1 .g_end
  s_barrier
  v_lshrrev_b32 v2, 2, v1
  v_and_b32 v3, 3, v1
  v_lshlrev_b32 v3, 4, v3
  v_lshl_add_u32 v5, v2, 11, v3
  v_and_b32 v2, 3, v2
  v_lshrrev_b32 v3, 5, v1
  v_lshl_add_u32 v2, v3, 3, v2
  v_lshlrev_b32 v2, 6, v2
  v_bfe_u32 v4, v1, 4, 1
  v_lshl_add_u32 v2, v4, 5, v2
  v_and_b32 v4, 1, v1
  v_lshl_add_u32 v2, v4, 4, v2
  v_bfe_u32 v4, v1, 1, 1
  v_lshl_add_u32 v2, v4, 3, v2
  s_bfe_u32 s25, s45, 0x20002
  s_lshl2_add_u32 s25, s45, s25
  s_lshl_b32 s25, s25, 12
  s_mul_i32 s24, s23, 31744
  v_add_u32 v6, s24, v2
  s_add_u32 m0, s24, 1024
  s_add_u32 s26, s25, 0
  s_and_b32 s26, s26, 0xffff
  s_lshl_b32 s26, s26, 5
  buffer_load_dwordx4 v5, s[8:11], s26 offen offset:0 lds
  s_add_u32 m0, s24, 1984
  s_add_u32 s26, s25, 0
  s_and_b32 s26, s26, 0xffff
  s_lshl_b32 s26, s26, 5
  buffer_load_dwordx4 v5, s[8:11], s26 offen offset:64 lds
  s_add_u32 m0, s24, 3072
  s_add_u32 s26, s25, 1024
  s_and_b32 s26, s26, 0xffff
  s_lshl_b32 s26, s26, 5
  buffer_load_dwordx4 v5, s[8:11], s26 offen offset:0 lds
  s_add_u32 m0, s24, 4096
  s_add_u32 s26, s25, 2048
  s_and_b32 s26, s26, 0xffff
  s_lshl_b32 s26, s26, 5
  buffer_load_dwordx4 v5, s[8:11], s26 offen offset:0 lds
  s_add_u32 m0, s24, 5056
  s_add_u32 s26, s25, 2048
  s_and_b32 s26, s26, 0xffff
  s_lshl_b32 s26, s26, 5
  buffer_load_dwordx4 v5, s[8:11], s26 offen offset:64 lds
  s_add_u32 m0, s24, 6144
  s_add_u32 s26, s25, 3072
  s_and_b32 s26, s26, 0xffff
  s_lshl_b32 s26, s26, 5
  buffer_load_dwordx4 v5, s[8:11], s26 offen offset:0 lds
  s_add_u32 m0, s24, 7168
  s_add_u32 s26, s25, 4096
  s_and_b32 s26, s26, 0xffff
  s_lshl_b32 s26, s26, 5
  buffer_load_dwordx4 v5, s[8:11], s26 offen offset:0 lds
  s_add_u32 m0, s24, 8128
  s_add_u32 s26, s25, 4096
  s_and_b32 s26, s26, 0xffff
  s_lshl_b32 s26, s26, 5
  buffer_load_dwordx4 v5, s[8:11], s26 offen offset:64 lds
  s_add_u32 m0, s24, 9216
  s_add_u32 s26, s25, 5120
  s_and_b32 s26, s26, 0xffff
  s_lshl_b32 s26, s26, 5
  buffer_load_dwordx4 v5, s[8:11], s26 offen offset:0 lds
  s_add_u32 m0, s24, 10240
  s_add_u32 s26, s25, 6144
  s_and_b32 s26, s26, 0xffff
  s_lshl_b32 s26, s26, 5
  buffer_load_dwordx4 v5, s[8:11], s26 offen offset:0 lds
  s_add_u32 m0, s24, 11200
  s_add_u32 s26, s25, 6144
  s_and_b32 s26, s26, 0xffff
  s_lshl_b32 s26, s26, 5
  buffer_load_dwordx4 v5, s[8:11], s26 offen offset:64 lds
  s_add_u32 m0, s24, 12288
  s_add_u32 s26, s25, 7168
  s_and_b32 s26, s26, 0xffff
  s_lshl_b32 s26, s26, 5
  buffer_load_dwordx4 v5, s[8:11], s26 offen offset:0 lds
  s_add_u32 m0, s24, 13312
  s_add_u32 s26, s25, 8192
  s_and_b32 s26, s26, 0xffff
  s_lshl_b32 s26, s26, 5
  buffer_load_dwordx4 v5, s[8:11], s26 offen offset:0 lds
  s_add_u32 m0, s24, 14272
  s_add_u32 s26, s25, 8192
  s_and_b32 s26, s26, 0xffff
  s_lshl_b32 s26, s26, 5
  buffer_load_dwordx4 v5, s[8:11], s26 offen offset:64 lds
  s_add_u32 m0, s24, 15360
  s_add_u32 s26, s25, 9216
  s_and_b32 s26, s26, 0xffff
  s_lshl_b32 s26, s26, 5
  buffer_load_dwordx4 v5, s[8:11], s26 offen offset:0 lds
  s_add_u32 m0, s24, 16384
  s_add_u32 s26, s25, 10240
  s_and_b32 s26, s26, 0xffff
  s_lshl_b32 s26, s26, 5
  buffer_load_dwordx4 v5, s[8:11], s26 offen offset:0 lds
  s_add_u32 m0, s24, 17344
  s_add_u32 s26, s25, 10240
  s_and_b32 s26, s26, 0xffff
  s_lshl_b32 s26, s26, 5
  buffer_load_dwordx4 v5, s[8:11], s26 offen offset:64 lds
  s_add_u32 m0, s24, 18432
  s_add_u32 s26, s25, 11264
  s_and_b32 s26, s26, 0xffff
  s_lshl_b32 s26, s26, 5
  buffer_load_dwordx4 v5, s[8:11], s26 offen offset:0 lds
  s_add_u32 m0, s24, 19456
  s_add_u32 s26, s25, 12288
  s_and_b32 s26, s26, 0xffff
  s_lshl_b32 s26, s26, 5
  buffer_load_dwordx4 v5, s[8:11], s26 offen offset:0 lds
  s_add_u32 m0, s24, 20416
  s_add_u32 s26, s25, 12288
  s_and_b32 s26, s26, 0xffff
  s_lshl_b32 s26, s26, 5
  buffer_load_dwordx4 v5, s[8:11], s26 offen offset:64 lds
  s_add_u32 m0, s24, 21504
  s_add_u32 s26, s25, 13312
  s_and_b32 s26, s26, 0xffff
  s_lshl_b32 s26, s26, 5
  buffer_load_dwordx4 v5, s[8:11], s26 offen offset:0 lds
  s_add_u32 m0, s24, 22528
  s_add_u32 s26, s25, 14336
  s_and_b32 s26, s26, 0xffff
  s_lshl_b32 s26, s26, 5
  buffer_load_dwordx4 v5, s[8:11], s26 offen offset:0 lds
  s_add_u32 m0, s24, 23488
  s_add_u32 s26, s25, 14336
  s_and_b32 s26, s26, 0xffff
  s_lshl_b32 s26, s26, 5
  buffer_load_dwordx4 v5, s[8:11], s26 offen offset:64 lds
  s_add_u32 m0, s24, 24576
  s_add_u32 s26, s25, 15360
  s_and_b32 s26, s26, 0xffff
  s_lshl_b32 s26, s26, 5
  buffer_load_dwordx4 v5, s[8:11], s26 offen offset:0 lds
  s_add_u32 m0, s24, 25600
  s_add_u32 s26, s25, 16384
  s_and_b32 s26, s26, 0xffff
  s_lshl_b32 s26, s26, 5
  buffer_load_dwordx4 v5, s[8:11], s26 offen offset:0 lds
  s_add_u32 m0, s24, 26560
  s_add_u32 s26, s25, 16384
  s_and_b32 s26, s26, 0xffff
  s_lshl_b32 s26, s26, 5
  buffer_load_dwordx4 v5, s[8:11], s26 offen offset:64 lds
  s_add_u32 m0, s24, 27648
  s_add_u32 s26, s25, 17408
  s_and_b32 s26, s26, 0xffff
  s_lshl_b32 s26, s26, 5
  buffer_load_dwordx4 v5, s[8:11], s26 offen offset:0 lds
  s_add_u32 m0, s24, 28672
  s_add_u32 s26, s25, 18432
  s_and_b32 s26, s26, 0xffff
  s_lshl_b32 s26, s26, 5
  buffer_load_dwordx4 v5, s[8:11], s26 offen offset:0 lds
  s_add_u32 m0, s24, 29632
  s_add_u32 s26, s25, 18432
  s_and_b32 s26, s26, 0xffff
  s_lshl_b32 s26, s26, 5
  buffer_load_dwordx4 v5, s[8:11], s26 offen offset:64 lds
  s_add_u32 m0, s24, 30720
  s_add_u32 s26, s25, 19456
  s_and_b32 s26, s26, 0xffff
  s_lshl_b32 s26, s26, 5
  buffer_load_dwordx4 v5, s[8:11], s26 offen offset:0 lds
  s_lshl_b32 s26, s23, 16
  s_add_u32 s26, s26, 58720256
  v_lshl_add_u32 v7, v1, 4, s26
  s_lshl_b32 s26, s23, 13
  s_add_u32 s26, s26, 126976
  v_lshl_add_u32 v8, v1, 4, s26
  s_lshl_b32 s26, s23, 11
  s_add_u32 s26, s26, 126976
  v_lshl_add_u32 v9, v1, 4, s26
  v_and_b32 v12, 31, v1
  v_lshlrev_b32 v10, 11, v12
  v_lshl_add_u32 v10, v3, 4, v10
  s_lshl_b32 s28, s23, 5
  v_add_u32 v10, s28, v10
  s_lshl2_add_u32 s26, s47, s23
  s_lshl_b32 s26, s26, 10
  s_add_u32 s26, s26, 90177536
  v_lshl_add_u32 v11, v1, 4, s26
  v_lshlrev_b32 v12, 2, v12
  v_add_u32 v12, 102760448, v12
  s_waitcnt vmcnt(15)
  ds_read_b64_tr_b16 a[0:1], v6 offset:1024
  ds_read_b64_tr_b16 a[2:3], v6 offset:1280
  ds_read_b64_tr_b16 v[60:61], v6 offset:2048
  ds_read_b64_tr_b16 v[62:63], v6 offset:2304
  ds_read_b64_tr_b16 a[4:5], v6 offset:3072
  ds_read_b64_tr_b16 a[6:7], v6 offset:3328
  ds_read_b64_tr_b16 a[8:9], v6 offset:4096
  ds_read_b64_tr_b16 a[10:11], v6 offset:4352
  ds_read_b64_tr_b16 v[64:65], v6 offset:5120
  ds_read_b64_tr_b16 v[66:67], v6 offset:5376
  ds_read_b64_tr_b16 a[12:13], v6 offset:6144
  ds_read_b64_tr_b16 a[14:15], v6 offset:6400
  ds_read_b64_tr_b16 a[16:17], v6 offset:7168
  ds_read_b64_tr_b16 a[18:19], v6 offset:7424
  ds_read_b64_tr_b16 v[68:69], v6 offset:8192
  ds_read_b64_tr_b16 v[70:71], v6 offset:8448
  ds_read_b64_tr_b16 a[20:21], v6 offset:9216
  ds_read_b64_tr_b16 a[22:23], v6 offset:9472
  ds_read_b64_tr_b16 a[24:25], v6 offset:10240
  ds_read_b64_tr_b16 a[26:27], v6 offset:10496
  ds_read_b64_tr_b16 v[72:73], v6 offset:11264
  ds_read_b64_tr_b16 v[74:75], v6 offset:11520
  ds_read_b64_tr_b16 a[28:29], v6 offset:12288
  ds_read_b64_tr_b16 a[30:31], v6 offset:12544
  ds_read_b64_tr_b16 a[32:33], v6 offset:13312
  ds_read_b64_tr_b16 a[34:35], v6 offset:13568
  ds_read_b64_tr_b16 v[76:77], v6 offset:14336
  ds_read_b64_tr_b16 v[78:79], v6 offset:14592
  ds_read_b64_tr_b16 a[36:37], v6 offset:15360
  ds_read_b64_tr_b16 a[38:39], v6 offset:15616
  s_waitcnt lgkmcnt(0)
  s_add_u32 m0, s24, 1024
  s_add_u32 s26, s25, 20480
  s_and_b32 s26, s26, 0xffff
  s_lshl_b32 s26, s26, 5
  buffer_load_dwordx4 v5, s[8:11], s26 offen offset:0 lds
  s_add_u32 m0, s24, 1984
  s_add_u32 s26, s25, 20480
  s_and_b32 s26, s26, 0xffff
  s_lshl_b32 s26, s26, 5
  buffer_load_dwordx4 v5, s[8:11], s26 offen offset:64 lds
  s_add_u32 m0, s24, 3072
  s_add_u32 s26, s25, 21504
  s_and_b32 s26, s26, 0xffff
  s_lshl_b32 s26, s26, 5
  buffer_load_dwordx4 v5, s[8:11], s26 offen offset:0 lds
  s_add_u32 m0, s24, 4096
  s_add_u32 s26, s25, 22528
  s_and_b32 s26, s26, 0xffff
  s_lshl_b32 s26, s26, 5
  buffer_load_dwordx4 v5, s[8:11], s26 offen offset:0 lds
  s_add_u32 m0, s24, 5056
  s_add_u32 s26, s25, 22528
  s_and_b32 s26, s26, 0xffff
  s_lshl_b32 s26, s26, 5
  buffer_load_dwordx4 v5, s[8:11], s26 offen offset:64 lds
  s_add_u32 m0, s24, 6144
  s_add_u32 s26, s25, 23552
  s_and_b32 s26, s26, 0xffff
  s_lshl_b32 s26, s26, 5
  buffer_load_dwordx4 v5, s[8:11], s26 offen offset:0 lds
  s_add_u32 m0, s24, 7168
  s_add_u32 s26, s25, 24576
  s_and_b32 s26, s26, 0xffff
  s_lshl_b32 s26, s26, 5
  buffer_load_dwordx4 v5, s[8:11], s26 offen offset:0 lds
  s_add_u32 m0, s24, 8128
  s_add_u32 s26, s25, 24576
  s_and_b32 s26, s26, 0xffff
  s_lshl_b32 s26, s26, 5
  buffer_load_dwordx4 v5, s[8:11], s26 offen offset:64 lds
  s_add_u32 m0, s24, 9216
  s_add_u32 s26, s25, 25600
  s_and_b32 s26, s26, 0xffff
  s_lshl_b32 s26, s26, 5
  buffer_load_dwordx4 v5, s[8:11], s26 offen offset:0 lds
  s_add_u32 m0, s24, 10240
  s_add_u32 s26, s25, 26624
  s_and_b32 s26, s26, 0xffff
  s_lshl_b32 s26, s26, 5
  buffer_load_dwordx4 v5, s[8:11], s26 offen offset:0 lds
  s_add_u32 m0, s24, 11200
  s_add_u32 s26, s25, 26624
  s_and_b32 s26, s26, 0xffff
  s_lshl_b32 s26, s26, 5
  buffer_load_dwordx4 v5, s[8:11], s26 offen offset:64 lds
  s_add_u32 m0, s24, 12288
  s_add_u32 s26, s25, 27648
  s_and_b32 s26, s26, 0xffff
  s_lshl_b32 s26, s26, 5
  buffer_load_dwordx4 v5, s[8:11], s26 offen offset:0 lds
  s_add_u32 m0, s24, 13312
  s_add_u32 s26, s25, 28672
  s_and_b32 s26, s26, 0xffff
  s_lshl_b32 s26, s26, 5
  buffer_load_dwordx4 v5, s[8:11], s26 offen offset:0 lds
  s_add_u32 m0, s24, 14272
  s_add_u32 s26, s25, 28672
  s_and_b32 s26, s26, 0xffff
  s_lshl_b32 s26, s26, 5
  buffer_load_dwordx4 v5, s[8:11], s26 offen offset:64 lds
  s_add_u32 m0, s24, 15360
  s_add_u32 s26, s25, 29696
  s_and_b32 s26, s26, 0xffff
  s_lshl_b32 s26, s26, 5
  buffer_load_dwordx4 v5, s[8:11], s26 offen offset:0 lds
  s_waitcnt vmcnt(15)
  ds_read_b64_tr_b16 a[40:41], v6 offset:16384
  ds_read_b64_tr_b16 a[42:43], v6 offset:16640
  ds_read_b64_tr_b16 v[80:81], v6 offset:17408
  ds_read_b64_tr_b16 v[82:83], v6 offset:17664
  ds_read_b64_tr_b16 a[44:45], v6 offset:18432
  ds_read_b64_tr_b16 a[46:47], v6 offset:18688
  ds_read_b64_tr_b16 a[48:49], v6 offset:19456
  ds_read_b64_tr_b16 a[50:51], v6 offset:19712
  ds_read_b64_tr_b16 v[84:85], v6 offset:20480
  ds_read_b64_tr_b16 v[86:87], v6 offset:20736
  ds_read_b64_tr_b16 a[52:53], v6 offset:21504
  ds_read_b64_tr_b16 a[54:55], v6 offset:21760
  ds_read_b64_tr_b16 a[56:57], v6 offset:22528
  ds_read_b64_tr_b16 a[58:59], v6 offset:22784
  ds_read_b64_tr_b16 v[88:89], v6 offset:23552
  ds_read_b64_tr_b16 v[90:91], v6 offset:23808
  ds_read_b64_tr_b16 a[60:61], v6 offset:24576
  ds_read_b64_tr_b16 a[62:63], v6 offset:24832
  ds_read_b64_tr_b16 a[64:65], v6 offset:25600
  ds_read_b64_tr_b16 a[66:67], v6 offset:25856
  ds_read_b64_tr_b16 v[92:93], v6 offset:26624
  ds_read_b64_tr_b16 v[94:95], v6 offset:26880
  ds_read_b64_tr_b16 a[68:69], v6 offset:27648
  ds_read_b64_tr_b16 a[70:71], v6 offset:27904
  ds_read_b64_tr_b16 a[72:73], v6 offset:28672
  ds_read_b64_tr_b16 a[74:75], v6 offset:28928
  ds_read_b64_tr_b16 v[96:97], v6 offset:29696
  ds_read_b64_tr_b16 v[98:99], v6 offset:29952
  ds_read_b64_tr_b16 a[76:77], v6 offset:30720
  ds_read_b64_tr_b16 a[78:79], v6 offset:30976
  s_waitcnt lgkmcnt(0)
  s_add_u32 m0, s24, 16384
  s_add_u32 s26, s25, 30720
  s_and_b32 s26, s26, 0xffff
  s_lshl_b32 s26, s26, 5
  buffer_load_dwordx4 v5, s[8:11], s26 offen offset:0 lds
  s_add_u32 m0, s24, 17344
  s_add_u32 s26, s25, 30720
  s_and_b32 s26, s26, 0xffff
  s_lshl_b32 s26, s26, 5
  buffer_load_dwordx4 v5, s[8:11], s26 offen offset:64 lds
  s_add_u32 m0, s24, 18432
  s_add_u32 s26, s25, 31744
  s_and_b32 s26, s26, 0xffff
  s_lshl_b32 s26, s26, 5
  buffer_load_dwordx4 v5, s[8:11], s26 offen offset:0 lds
  s_add_u32 m0, s24, 19456
  s_add_u32 s26, s25, 32768
  s_and_b32 s26, s26, 0xffff
  s_lshl_b32 s26, s26, 5
  buffer_load_dwordx4 v5, s[8:11], s26 offen offset:0 lds
  s_add_u32 m0, s24, 20416
  s_add_u32 s26, s25, 32768
  s_and_b32 s26, s26, 0xffff
  s_lshl_b32 s26, s26, 5
  buffer_load_dwordx4 v5, s[8:11], s26 offen offset:64 lds
  s_add_u32 m0, s24, 21504
  s_add_u32 s26, s25, 33792
  s_and_b32 s26, s26, 0xffff
  s_lshl_b32 s26, s26, 5
  buffer_load_dwordx4 v5, s[8:11], s26 offen offset:0 lds
  s_add_u32 m0, s24, 22528
  s_add_u32 s26, s25, 34816
  s_and_b32 s26, s26, 0xffff
  s_lshl_b32 s26, s26, 5
  buffer_load_dwordx4 v5, s[8:11], s26 offen offset:0 lds
  s_add_u32 m0, s24, 23488
  s_add_u32 s26, s25, 34816
  s_and_b32 s26, s26, 0xffff
  s_lshl_b32 s26, s26, 5
  buffer_load_dwordx4 v5, s[8:11], s26 offen offset:64 lds
  s_add_u32 m0, s24, 24576
  s_add_u32 s26, s25, 35840
  s_and_b32 s26, s26, 0xffff
  s_lshl_b32 s26, s26, 5
  buffer_load_dwordx4 v5, s[8:11], s26 offen offset:0 lds
  s_add_u32 m0, s24, 25600
  s_add_u32 s26, s25, 36864
  s_and_b32 s26, s26, 0xffff
  s_lshl_b32 s26, s26, 5
  buffer_load_dwordx4 v5, s[8:11], s26 offen offset:0 lds
  s_add_u32 m0, s24, 26560
  s_add_u32 s26, s25, 36864
  s_and_b32 s26, s26, 0xffff
  s_lshl_b32 s26, s26, 5
  buffer_load_dwordx4 v5, s[8:11], s26 offen offset:64 lds
  s_add_u32 m0, s24, 27648
  s_add_u32 s26, s25, 37888
  s_and_b32 s26, s26, 0xffff
  s_lshl_b32 s26, s26, 5
  buffer_load_dwordx4 v5, s[8:11], s26 offen offset:0 lds
  s_add_u32 m0, s24, 28672
  s_add_u32 s26, s25, 38912
  s_and_b32 s26, s26, 0xffff
  s_lshl_b32 s26, s26, 5
  buffer_load_dwordx4 v5, s[8:11], s26 offen offset:0 lds
  s_add_u32 m0, s24, 29632
  s_add_u32 s26, s25, 38912
  s_and_b32 s26, s26, 0xffff
  s_lshl_b32 s26, s26, 5
  buffer_load_dwordx4 v5, s[8:11], s26 offen offset:64 lds
  s_add_u32 m0, s24, 30720
  s_add_u32 s26, s25, 39936
  s_and_b32 s26, s26, 0xffff
  s_lshl_b32 s26, s26, 5
  buffer_load_dwordx4 v5, s[8:11], s26 offen offset:0 lds
  s_waitcnt vmcnt(15)
  ds_read_b64_tr_b16 a[80:81], v6 offset:1024
  ds_read_b64_tr_b16 a[82:83], v6 offset:1280
  ds_read_b64_tr_b16 v[100:101], v6 offset:2048
  ds_read_b64_tr_b16 v[102:103], v6 offset:2304
  ds_read_b64_tr_b16 a[84:85], v6 offset:3072
  ds_read_b64_tr_b16 a[86:87], v6 offset:3328
  ds_read_b64_tr_b16 a[88:89], v6 offset:4096
  ds_read_b64_tr_b16 a[90:91], v6 offset:4352
  ds_read_b64_tr_b16 v[104:105], v6 offset:5120
  ds_read_b64_tr_b16 v[106:107], v6 offset:5376
  ds_read_b64_tr_b16 a[92:93], v6 offset:6144
  ds_read_b64_tr_b16 a[94:95], v6 offset:6400
  ds_read_b64_tr_b16 a[96:97], v6 offset:7168
  ds_read_b64_tr_b16 a[98:99], v6 offset:7424
  ds_read_b64_tr_b16 v[108:109], v6 offset:8192
  ds_read_b64_tr_b16 v[110:111], v6 offset:8448
  ds_read_b64_tr_b16 a[100:101], v6 offset:9216
  ds_read_b64_tr_b16 a[102:103], v6 offset:9472
  ds_read_b64_tr_b16 a[104:105], v6 offset:10240
  ds_read_b64_tr_b16 a[106:107], v6 offset:10496
  ds_read_b64_tr_b16 v[112:113], v6 offset:11264
  ds_read_b64_tr_b16 v[114:115], v6 offset:11520
  ds_read_b64_tr_b16 a[108:109], v6 offset:12288
  ds_read_b64_tr_b16 a[110:111], v6 offset:12544
  ds_read_b64_tr_b16 a[112:113], v6 offset:13312
  ds_read_b64_tr_b16 a[114:115], v6 offset:13568
  ds_read_b64_tr_b16 v[116:117], v6 offset:14336
  ds_read_b64_tr_b16 v[118:119], v6 offset:14592
  ds_read_b64_tr_b16 a[116:117], v6 offset:15360
  ds_read_b64_tr_b16 a[118:119], v6 offset:15616
  s_waitcnt lgkmcnt(0)
  s_add_u32 m0, s24, 1024
  s_add_u32 s26, s25, 40960
  s_and_b32 s26, s26, 0xffff
  s_lshl_b32 s26, s26, 5
  buffer_load_dwordx4 v5, s[8:11], s26 offen offset:0 lds
  s_add_u32 m0, s24, 1984
  s_add_u32 s26, s25, 40960
  s_and_b32 s26, s26, 0xffff
  s_lshl_b32 s26, s26, 5
  buffer_load_dwordx4 v5, s[8:11], s26 offen offset:64 lds
  s_add_u32 m0, s24, 3072
  s_add_u32 s26, s25, 41984
  s_and_b32 s26, s26, 0xffff
  s_lshl_b32 s26, s26, 5
  buffer_load_dwordx4 v5, s[8:11], s26 offen offset:0 lds
  s_add_u32 m0, s24, 4096
  s_add_u32 s26, s25, 43008
  s_and_b32 s26, s26, 0xffff
  s_lshl_b32 s26, s26, 5
  buffer_load_dwordx4 v5, s[8:11], s26 offen offset:0 lds
  s_add_u32 m0, s24, 5056
  s_add_u32 s26, s25, 43008
  s_and_b32 s26, s26, 0xffff
  s_lshl_b32 s26, s26, 5
  buffer_load_dwordx4 v5, s[8:11], s26 offen offset:64 lds
  s_add_u32 m0, s24, 6144
  s_add_u32 s26, s25, 44032
  s_and_b32 s26, s26, 0xffff
  s_lshl_b32 s26, s26, 5
  buffer_load_dwordx4 v5, s[8:11], s26 offen offset:0 lds
  s_add_u32 m0, s24, 7168
  s_add_u32 s26, s25, 45056
  s_and_b32 s26, s26, 0xffff
  s_lshl_b32 s26, s26, 5
  buffer_load_dwordx4 v5, s[8:11], s26 offen offset:0 lds
  s_add_u32 m0, s24, 8128
  s_add_u32 s26, s25, 45056
  s_and_b32 s26, s26, 0xffff
  s_lshl_b32 s26, s26, 5
  buffer_load_dwordx4 v5, s[8:11], s26 offen offset:64 lds
  s_add_u32 m0, s24, 9216
  s_add_u32 s26, s25, 46080
  s_and_b32 s26, s26, 0xffff
  s_lshl_b32 s26, s26, 5
  buffer_load_dwordx4 v5, s[8:11], s26 offen offset:0 lds
  s_add_u32 m0, s24, 10240
  s_add_u32 s26, s25, 47104
  s_and_b32 s26, s26, 0xffff
  s_lshl_b32 s26, s26, 5
  buffer_load_dwordx4 v5, s[8:11], s26 offen offset:0 lds
  s_add_u32 m0, s24, 11200
  s_add_u32 s26, s25, 47104
  s_and_b32 s26, s26, 0xffff
  s_lshl_b32 s26, s26, 5
  buffer_load_dwordx4 v5, s[8:11], s26 offen offset:64 lds
  s_add_u32 m0, s24, 12288
  s_add_u32 s26, s25, 48128
  s_and_b32 s26, s26, 0xffff
  s_lshl_b32 s26, s26, 5
  buffer_load_dwordx4 v5, s[8:11], s26 offen offset:0 lds
  s_add_u32 m0, s24, 13312
  s_add_u32 s26, s25, 49152
  s_and_b32 s26, s26, 0xffff
  s_lshl_b32 s26, s26, 5
  buffer_load_dwordx4 v5, s[8:11], s26 offen offset:0 lds
  s_add_u32 m0, s24, 14272
  s_add_u32 s26, s25, 49152
  s_and_b32 s26, s26, 0xffff
  s_lshl_b32 s26, s26, 5
  buffer_load_dwordx4 v5, s[8:11], s26 offen offset:64 lds
  s_add_u32 m0, s24, 15360
  s_add_u32 s26, s25, 50176
  s_and_b32 s26, s26, 0xffff
  s_lshl_b32 s26, s26, 5
  buffer_load_dwordx4 v5, s[8:11], s26 offen offset:0 lds
  s_waitcnt vmcnt(15)
  ds_read_b64_tr_b16 a[120:121], v6 offset:16384
  ds_read_b64_tr_b16 a[122:123], v6 offset:16640
  ds_read_b64_tr_b16 v[120:121], v6 offset:17408
  ds_read_b64_tr_b16 v[122:123], v6 offset:17664
  ds_read_b64_tr_b16 a[124:125], v6 offset:18432
  ds_read_b64_tr_b16 a[126:127], v6 offset:18688
  ds_read_b64_tr_b16 a[128:129], v6 offset:19456
  ds_read_b64_tr_b16 a[130:131], v6 offset:19712
  ds_read_b64_tr_b16 v[124:125], v6 offset:20480
  ds_read_b64_tr_b16 v[126:127], v6 offset:20736
  ds_read_b64_tr_b16 a[132:133], v6 offset:21504
  ds_read_b64_tr_b16 a[134:135], v6 offset:21760
  ds_read_b64_tr_b16 a[136:137], v6 offset:22528
  ds_read_b64_tr_b16 a[138:139], v6 offset:22784
  ds_read_b64_tr_b16 v[128:129], v6 offset:23552
  ds_read_b64_tr_b16 v[130:131], v6 offset:23808
  ds_read_b64_tr_b16 a[140:141], v6 offset:24576
  ds_read_b64_tr_b16 a[142:143], v6 offset:24832
  ds_read_b64_tr_b16 a[144:145], v6 offset:25600
  ds_read_b64_tr_b16 a[146:147], v6 offset:25856
  ds_read_b64_tr_b16 v[132:133], v6 offset:26624
  ds_read_b64_tr_b16 v[134:135], v6 offset:26880
  ds_read_b64_tr_b16 a[148:149], v6 offset:27648
  ds_read_b64_tr_b16 a[150:151], v6 offset:27904
  ds_read_b64_tr_b16 a[152:153], v6 offset:28672
  ds_read_b64_tr_b16 a[154:155], v6 offset:28928
  ds_read_b64_tr_b16 v[136:137], v6 offset:29696
  ds_read_b64_tr_b16 v[138:139], v6 offset:29952
  ds_read_b64_tr_b16 a[156:157], v6 offset:30720
  ds_read_b64_tr_b16 a[158:159], v6 offset:30976
  s_waitcnt lgkmcnt(0)
  s_add_u32 m0, s24, 16384
  s_add_u32 s26, s25, 51200
  s_and_b32 s26, s26, 0xffff
  s_lshl_b32 s26, s26, 5
  buffer_load_dwordx4 v5, s[8:11], s26 offen offset:0 lds
  s_add_u32 m0, s24, 17344
  s_add_u32 s26, s25, 51200
  s_and_b32 s26, s26, 0xffff
  s_lshl_b32 s26, s26, 5
  buffer_load_dwordx4 v5, s[8:11], s26 offen offset:64 lds
  s_add_u32 m0, s24, 18432
  s_add_u32 s26, s25, 52224
  s_and_b32 s26, s26, 0xffff
  s_lshl_b32 s26, s26, 5
  buffer_load_dwordx4 v5, s[8:11], s26 offen offset:0 lds
  s_add_u32 m0, s24, 19456
  s_add_u32 s26, s25, 53248
  s_and_b32 s26, s26, 0xffff
  s_lshl_b32 s26, s26, 5
  buffer_load_dwordx4 v5, s[8:11], s26 offen offset:0 lds
  s_add_u32 m0, s24, 20416
  s_add_u32 s26, s25, 53248
  s_and_b32 s26, s26, 0xffff
  s_lshl_b32 s26, s26, 5
  buffer_load_dwordx4 v5, s[8:11], s26 offen offset:64 lds
  s_add_u32 m0, s24, 21504
  s_add_u32 s26, s25, 54272
  s_and_b32 s26, s26, 0xffff
  s_lshl_b32 s26, s26, 5
  buffer_load_dwordx4 v5, s[8:11], s26 offen offset:0 lds
  s_add_u32 m0, s24, 22528
  s_add_u32 s26, s25, 55296
  s_and_b32 s26, s26, 0xffff
  s_lshl_b32 s26, s26, 5
  buffer_load_dwordx4 v5, s[8:11], s26 offen offset:0 lds
  s_add_u32 m0, s24, 23488
  s_add_u32 s26, s25, 55296
  s_and_b32 s26, s26, 0xffff
  s_lshl_b32 s26, s26, 5
  buffer_load_dwordx4 v5, s[8:11], s26 offen offset:64 lds
  s_add_u32 m0, s24, 24576
  s_add_u32 s26, s25, 56320
  s_and_b32 s26, s26, 0xffff
  s_lshl_b32 s26, s26, 5
  buffer_load_dwordx4 v5, s[8:11], s26 offen offset:0 lds
  s_add_u32 m0, s24, 25600
  s_add_u32 s26, s25, 57344
  s_and_b32 s26, s26, 0xffff
  s_lshl_b32 s26, s26, 5
  buffer_load_dwordx4 v5, s[8:11], s26 offen offset:0 lds
  s_add_u32 m0, s24, 26560
  s_add_u32 s26, s25, 57344
  s_and_b32 s26, s26, 0xffff
  s_lshl_b32 s26, s26, 5
  buffer_load_dwordx4 v5, s[8:11], s26 offen offset:64 lds
  s_add_u32 m0, s24, 27648
  s_add_u32 s26, s25, 58368
  s_and_b32 s26, s26, 0xffff
  s_lshl_b32 s26, s26, 5
  buffer_load_dwordx4 v5, s[8:11], s26 offen offset:0 lds
  s_add_u32 m0, s24, 28672
  s_add_u32 s26, s25, 59392
  s_and_b32 s26, s26, 0xffff
  s_lshl_b32 s26, s26, 5
  buffer_load_dwordx4 v5, s[8:11], s26 offen offset:0 lds
  s_add_u32 m0, s24, 29632
  s_add_u32 s26, s25, 59392
  s_and_b32 s26, s26, 0xffff
  s_lshl_b32 s26, s26, 5
  buffer_load_dwordx4 v5, s[8:11], s26 offen offset:64 lds
  s_add_u32 m0, s24, 30720
  s_add_u32 s26, s25, 60416
  s_and_b32 s26, s26, 0xffff
  s_lshl_b32 s26, s26, 5
  buffer_load_dwordx4 v5, s[8:11], s26 offen offset:0 lds
  s_waitcnt vmcnt(15)
  ds_read_b64_tr_b16 a[160:161], v6 offset:1024
  ds_read_b64_tr_b16 a[162:163], v6 offset:1280
  ds_read_b64_tr_b16 v[140:141], v6 offset:2048
  ds_read_b64_tr_b16 v[142:143], v6 offset:2304
  ds_read_b64_tr_b16 a[164:165], v6 offset:3072
  ds_read_b64_tr_b16 a[166:167], v6 offset:3328
  ds_read_b64_tr_b16 a[168:169], v6 offset:4096
  ds_read_b64_tr_b16 a[170:171], v6 offset:4352
  ds_read_b64_tr_b16 v[144:145], v6 offset:5120
  ds_read_b64_tr_b16 v[146:147], v6 offset:5376
  ds_read_b64_tr_b16 a[172:173], v6 offset:6144
  ds_read_b64_tr_b16 a[174:175], v6 offset:6400
  ds_read_b64_tr_b16 a[176:177], v6 offset:7168
  ds_read_b64_tr_b16 a[178:179], v6 offset:7424
  ds_read_b64_tr_b16 v[148:149], v6 offset:8192
  ds_read_b64_tr_b16 v[150:151], v6 offset:8448
  ds_read_b64_tr_b16 a[180:181], v6 offset:9216
  ds_read_b64_tr_b16 a[182:183], v6 offset:9472
  ds_read_b64_tr_b16 a[184:185], v6 offset:10240
  ds_read_b64_tr_b16 a[186:187], v6 offset:10496
  ds_read_b64_tr_b16 v[152:153], v6 offset:11264
  ds_read_b64_tr_b16 v[154:155], v6 offset:11520
  ds_read_b64_tr_b16 a[188:189], v6 offset:12288
  ds_read_b64_tr_b16 a[190:191], v6 offset:12544
  ds_read_b64_tr_b16 a[192:193], v6 offset:13312
  ds_read_b64_tr_b16 a[194:195], v6 offset:13568
  ds_read_b64_tr_b16 v[156:157], v6 offset:14336
  ds_read_b64_tr_b16 v[158:159], v6 offset:14592
  ds_read_b64_tr_b16 a[196:197], v6 offset:15360
  ds_read_b64_tr_b16 a[198:199], v6 offset:15616
  s_waitcnt lgkmcnt(0)
  s_add_u32 m0, s24, 1024
  s_add_u32 s26, s25, 61440
  s_and_b32 s26, s26, 0xffff
  s_lshl_b32 s26, s26, 5
  buffer_load_dwordx4 v5, s[8:11], s26 offen offset:0 lds
  s_add_u32 m0, s24, 1984
  s_add_u32 s26, s25, 61440
  s_and_b32 s26, s26, 0xffff
  s_lshl_b32 s26, s26, 5
  buffer_load_dwordx4 v5, s[8:11], s26 offen offset:64 lds
  s_add_u32 m0, s24, 3072
  s_add_u32 s26, s25, 62464
  s_and_b32 s26, s26, 0xffff
  s_lshl_b32 s26, s26, 5
  buffer_load_dwordx4 v5, s[8:11], s26 offen offset:0 lds
  s_add_u32 m0, s24, 4096
  s_add_u32 s26, s25, 63488
  s_and_b32 s26, s26, 0xffff
  s_lshl_b32 s26, s26, 5
  buffer_load_dwordx4 v5, s[8:11], s26 offen offset:0 lds
  s_add_u32 m0, s24, 5056
  s_add_u32 s26, s25, 63488
  s_and_b32 s26, s26, 0xffff
  s_lshl_b32 s26, s26, 5
  buffer_load_dwordx4 v5, s[8:11], s26 offen offset:64 lds
  s_add_u32 m0, s24, 6144
  s_add_u32 s26, s25, 64512
  s_and_b32 s26, s26, 0xffff
  s_lshl_b32 s26, s26, 5
  buffer_load_dwordx4 v5, s[8:11], s26 offen offset:0 lds
  s_add_u32 m0, s24, 7104
  s_add_u32 s26, s25, 64512
  s_and_b32 s26, s26, 0xffff
  s_lshl_b32 s26, s26, 5
  buffer_load_dwordx4 v5, s[8:11], s26 offen offset:64 lds
  s_waitcnt vmcnt(7)
  ds_read_b64_tr_b16 a[200:201], v6 offset:16384
  ds_read_b64_tr_b16 a[202:203], v6 offset:16640
  ds_read_b64_tr_b16 v[160:161], v6 offset:17408
  ds_read_b64_tr_b16 v[162:163], v6 offset:17664
  ds_read_b64_tr_b16 a[204:205], v6 offset:18432
  ds_read_b64_tr_b16 a[206:207], v6 offset:18688
  ds_read_b64_tr_b16 a[208:209], v6 offset:19456
  ds_read_b64_tr_b16 a[210:211], v6 offset:19712
  ds_read_b64_tr_b16 v[164:165], v6 offset:20480
  ds_read_b64_tr_b16 v[166:167], v6 offset:20736
  ds_read_b64_tr_b16 a[212:213], v6 offset:21504
  ds_read_b64_tr_b16 a[214:215], v6 offset:21760
  ds_read_b64_tr_b16 a[216:217], v6 offset:22528
  ds_read_b64_tr_b16 a[218:219], v6 offset:22784
  ds_read_b64_tr_b16 v[168:169], v6 offset:23552
  ds_read_b64_tr_b16 v[170:171], v6 offset:23808
  ds_read_b64_tr_b16 a[220:221], v6 offset:24576
  ds_read_b64_tr_b16 a[222:223], v6 offset:24832
  ds_read_b64_tr_b16 a[224:225], v6 offset:25600
  ds_read_b64_tr_b16 a[226:227], v6 offset:25856
  ds_read_b64_tr_b16 v[172:173], v6 offset:26624
  ds_read_b64_tr_b16 v[174:175], v6 offset:26880
  ds_read_b64_tr_b16 a[228:229], v6 offset:27648
  ds_read_b64_tr_b16 a[230:231], v6 offset:27904
  ds_read_b64_tr_b16 a[232:233], v6 offset:28672
  ds_read_b64_tr_b16 a[234:235], v6 offset:28928
  ds_read_b64_tr_b16 v[176:177], v6 offset:29696
  ds_read_b64_tr_b16 v[178:179], v6 offset:29952
  ds_read_b64_tr_b16 a[236:237], v6 offset:30720
  ds_read_b64_tr_b16 a[238:239], v6 offset:30976
  s_waitcnt lgkmcnt(0)
  s_waitcnt vmcnt(0)
  ds_read_b64_tr_b16 a[240:241], v6 offset:1024
  ds_read_b64_tr_b16 a[242:243], v6 offset:1280
  ds_read_b64_tr_b16 v[180:181], v6 offset:2048
  ds_read_b64_tr_b16 v[182:183], v6 offset:2304
  ds_read_b64_tr_b16 a[244:245], v6 offset:3072
  ds_read_b64_tr_b16 a[246:247], v6 offset:3328
  ds_read_b64_tr_b16 a[248:249], v6 offset:4096
  ds_read_b64_tr_b16 a[250:251], v6 offset:4352
  ds_read_b64_tr_b16 v[184:185], v6 offset:5120
  ds_read_b64_tr_b16 v[186:187], v6 offset:5376
  ds_read_b64_tr_b16 a[252:253], v6 offset:6144
  ds_read_b64_tr_b16 a[254:255], v6 offset:6400
  ds_read_b64_tr_b16 v[188:189], v6 offset:7168
  ds_read_b64_tr_b16 v[190:191], v6 offset:7424
  s_waitcnt lgkmcnt(0)
  v_add_u32 v5, 64, v5
  s_add_u32 m0, s24, 0
  s_add_u32 s26, s25, 1024
  s_and_b32 s26, s26, 0xffff
  s_lshl_b32 s26, s26, 5
  buffer_load_dwordx4 v5, s[8:11], s26 offen offset:0 lds
  s_add_u32 m0, s24, 1024
  s_add_u32 s26, s25, 3072
  s_and_b32 s26, s26, 0xffff
  s_lshl_b32 s26, s26, 5
  buffer_load_dwordx4 v5, s[8:11], s26 offen offset:0 lds
  s_add_u32 m0, s24, 2048
  s_add_u32 s26, s25, 5120
  s_and_b32 s26, s26, 0xffff
  s_lshl_b32 s26, s26, 5
  buffer_load_dwordx4 v5, s[8:11], s26 offen offset:0 lds
  s_add_u32 m0, s24, 3072
  s_add_u32 s26, s25, 7168
  s_and_b32 s26, s26, 0xffff
  s_lshl_b32 s26, s26, 5
  buffer_load_dwordx4 v5, s[8:11], s26 offen offset:0 lds
  s_add_u32 m0, s24, 4096
  s_add_u32 s26, s25, 9216
  s_and_b32 s26, s26, 0xffff
  s_lshl_b32 s26, s26, 5
  buffer_load_dwordx4 v5, s[8:11], s26 offen offset:0 lds
  s_add_u32 m0, s24, 5120
  s_add_u32 s26, s25, 11264
  s_and_b32 s26, s26, 0xffff
  s_lshl_b32 s26, s26, 5
  buffer_load_dwordx4 v5, s[8:11], s26 offen offset:0 lds
  s_add_u32 m0, s24, 6144
  s_add_u32 s26, s25, 13312
  s_and_b32 s26, s26, 0xffff
  s_lshl_b32 s26, s26, 5
  buffer_load_dwordx4 v5, s[8:11], s26 offen offset:0 lds
  s_add_u32 m0, s24, 7168
  s_add_u32 s26, s25, 15360
  s_and_b32 s26, s26, 0xffff
  s_lshl_b32 s26, s26, 5
  buffer_load_dwordx4 v5, s[8:11], s26 offen offset:0 lds
  s_add_u32 m0, s24, 8192
  s_add_u32 s26, s25, 17408
  s_and_b32 s26, s26, 0xffff
  s_lshl_b32 s26, s26, 5
  buffer_load_dwordx4 v5, s[8:11], s26 offen offset:0 lds
  s_add_u32 m0, s24, 9216
  s_add_u32 s26, s25, 19456
  s_and_b32 s26, s26, 0xffff
  s_lshl_b32 s26, s26, 5
  buffer_load_dwordx4 v5, s[8:11], s26 offen offset:0 lds
  s_add_u32 m0, s24, 10240
  s_add_u32 s26, s25, 21504
  s_and_b32 s26, s26, 0xffff
  s_lshl_b32 s26, s26, 5
  buffer_load_dwordx4 v5, s[8:11], s26 offen offset:0 lds
  s_add_u32 m0, s24, 11264
  s_add_u32 s26, s25, 23552
  s_and_b32 s26, s26, 0xffff
  s_lshl_b32 s26, s26, 5
  buffer_load_dwordx4 v5, s[8:11], s26 offen offset:0 lds
  s_add_u32 m0, s24, 12288
  s_add_u32 s26, s25, 25600
  s_and_b32 s26, s26, 0xffff
  s_lshl_b32 s26, s26, 5
  buffer_load_dwordx4 v5, s[8:11], s26 offen offset:0 lds
  s_add_u32 m0, s24, 13312
  s_add_u32 s26, s25, 27648
  s_and_b32 s26, s26, 0xffff
  s_lshl_b32 s26, s26, 5
  buffer_load_dwordx4 v5, s[8:11], s26 offen offset:0 lds
  s_add_u32 m0, s24, 14336
  s_add_u32 s26, s25, 29696
  s_and_b32 s26, s26, 0xffff
  s_lshl_b32 s26, s26, 5
  buffer_load_dwordx4 v5, s[8:11], s26 offen offset:0 lds
  s_add_u32 m0, s24, 15360
  s_add_u32 s26, s25, 31744
  s_and_b32 s26, s26, 0xffff
  s_lshl_b32 s26, s26, 5
  buffer_load_dwordx4 v5, s[8:11], s26 offen offset:0 lds
  s_add_u32 m0, s24, 16384
  s_add_u32 s26, s25, 33792
  s_and_b32 s26, s26, 0xffff
  s_lshl_b32 s26, s26, 5
  buffer_load_dwordx4 v5, s[8:11], s26 offen offset:0 lds
  s_add_u32 m0, s24, 17408
  s_add_u32 s26, s25, 35840
  s_and_b32 s26, s26, 0xffff
  s_lshl_b32 s26, s26, 5
  buffer_load_dwordx4 v5, s[8:11], s26 offen offset:0 lds
  s_add_u32 m0, s24, 18432
  s_add_u32 s26, s25, 37888
  s_and_b32 s26, s26, 0xffff
  s_lshl_b32 s26, s26, 5
  buffer_load_dwordx4 v5, s[8:11], s26 offen offset:0 lds
  s_add_u32 m0, s24, 19456
  s_add_u32 s26, s25, 39936
  s_and_b32 s26, s26, 0xffff
  s_lshl_b32 s26, s26, 5
  buffer_load_dwordx4 v5, s[8:11], s26 offen offset:0 lds
  s_add_u32 m0, s24, 20480
  s_add_u32 s26, s25, 41984
  s_and_b32 s26, s26, 0xffff
  s_lshl_b32 s26, s26, 5
  buffer_load_dwordx4 v5, s[8:11], s26 offen offset:0 lds
  s_add_u32 m0, s24, 21504
  s_add_u32 s26, s25, 44032
  s_and_b32 s26, s26, 0xffff
  s_lshl_b32 s26, s26, 5
  buffer_load_dwordx4 v5, s[8:11], s26 offen offset:0 lds
  s_add_u32 m0, s24, 22528
  s_add_u32 s26, s25, 46080
  s_and_b32 s26, s26, 0xffff
  s_lshl_b32 s26, s26, 5
  buffer_load_dwordx4 v5, s[8:11], s26 offen offset:0 lds
  s_add_u32 m0, s24, 23552
  s_add_u32 s26, s25, 48128
  s_and_b32 s26, s26, 0xffff
  s_lshl_b32 s26, s26, 5
  buffer_load_dwordx4 v5, s[8:11], s26 offen offset:0 lds
  s_add_u32 m0, s24, 24576
  s_add_u32 s26, s25, 50176
  s_and_b32 s26, s26, 0xffff
  s_lshl_b32 s26, s26, 5
  buffer_load_dwordx4 v5, s[8:11], s26 offen offset:0 lds
  s_add_u32 m0, s24, 25600
  s_add_u32 s26, s25, 52224
  s_and_b32 s26, s26, 0xffff
  s_lshl_b32 s26, s26, 5
  buffer_load_dwordx4 v5, s[8:11], s26 offen offset:0 lds
  s_add_u32 m0, s24, 26624
  s_add_u32 s26, s25, 54272
  s_and_b32 s26, s26, 0xffff
  s_lshl_b32 s26, s26, 5
  buffer_load_dwordx4 v5, s[8:11], s26 offen offset:0 lds
  s_add_u32 m0, s24, 27648
  s_add_u32 s26, s25, 56320
  s_and_b32 s26, s26, 0xffff
  s_lshl_b32 s26, s26, 5
  buffer_load_dwordx4 v5, s[8:11], s26 offen offset:0 lds
  s_add_u32 m0, s24, 28672
  s_add_u32 s26, s25, 58368
  s_and_b32 s26, s26, 0xffff
  s_lshl_b32 s26, s26, 5
  buffer_load_dwordx4 v5, s[8:11], s26 offen offset:0 lds
  s_add_u32 m0, s24, 29696
  s_add_u32 s26, s25, 60416
  s_and_b32 s26, s26, 0xffff
  s_lshl_b32 s26, s26, 5
  buffer_load_dwordx4 v5, s[8:11], s26 offen offset:0 lds
  s_add_u32 m0, s24, 30720
  s_add_u32 s26, s25, 62464
  s_and_b32 s26, s26, 0xffff
  s_lshl_b32 s26, s26, 5
  buffer_load_dwordx4 v5, s[8:11], s26 offen offset:0 lds
  s_lshl4_add_u32 s58, s23, s57
  v_mov_b32 v18, 2
  s_mov_b64 exec, 1
  buffer_atomic_add v18, off, s[4:7], s58 sc0 sc1
  s_mov_b64 exec, -1
  s_lshl2_add_u32 s26, s23, 159744
  v_mov_b32 v19, s26
  s_barrier
  s_waitcnt vmcnt(0)
  v_readfirstlane_b32 s26, v18
  s_nop 0
  v_mov_b32 v18, s26
  ds_write_b32 v19, v18
  s_waitcnt lgkmcnt(0)
  s_barrier
  ds_read_b32 v13, v17
  s_waitcnt lgkmcnt(0)
  v_readfirstlane_b32 s46, v13
  s_add_u32 s46, s46, 1
  s_add_u32 s48, s46, 1
  s_cmp_ge_u32 s46, 64
  s_cbranch_scc1 .g_end
.en_poll:
  s_lshl_b32 s26, s46, 7
  s_sub_u32 s26, s26, s62
  s_add_u32 s26, s26, 105455616
  s_cmp_lg_u32 s23, 0
  s_cbranch_scc1 .en_p2
.en_p1:
  buffer_load_dword v13, off, s[4:7], s26 sc1
  s_sub_u32 s50, s50, 1
  s_cbranch_scc1 .g_end
  s_waitcnt vmcnt(0)
  v_readfirstlane_b32 s27, v13
  s_cmp_lg_u32 s27, 35
  s_cbranch_scc1 .en_p1
.en_p2:
  s_barrier
  s_lshl_b32 s16, s46, 18
  s_add_u32 s17, s25, 0
  s_and_b32 s17, s17, 0xffff
  s_add_u32 s17, s17, s16
  buffer_load_dwordx4 v[192:195], v7, s[4:7], s17 offen offset:0
  buffer_load_dwordx4 v[196:199], v7, s[4:7], s17 offen offset:1024
  buffer_load_dwordx4 v[200:203], v7, s[4:7], s17 offen offset:2048
  buffer_load_dwordx4 v[204:207], v7, s[4:7], s17 offen offset:3072
  s_add_u32 s17, s25, 4096
  s_and_b32 s17, s17, 0xffff
  s_add_u32 s17, s17, s16
  buffer_load_dwordx4 v[208:211], v7, s[4:7], s17 offen offset:0
  buffer_load_dwordx4 v[212:215], v7, s[4:7], s17 offen offset:1024
  buffer_load_dwordx4 v[216:219], v7, s[4:7], s17 offen offset:2048
  buffer_load_dwordx4 v[220:223], v7, s[4:7], s17 offen offset:3072
  s_add_u32 s17, s25, 8192
  s_and_b32 s17, s17, 0xffff
  s_add_u32 s17, s17, s16
  buffer_load_dwordx4 v[224:227], v7, s[4:7], s17 offen offset:0
  buffer_load_dwordx4 v[228:231], v7, s[4:7], s17 offen offset:1024
  buffer_load_dwordx4 v[232:235], v7, s[4:7], s17 offen offset:2048
  buffer_load_dwordx4 v[236:239], v7, s[4:7], s17 offen offset:3072
  s_add_u32 s17, s25, 12288
  s_and_b32 s17, s17, 0xffff
  s_add_u32 s17, s17, s16
  buffer_load_dwordx4 v[240:243], v7, s[4:7], s17 offen offset:0
  buffer_load_dwordx4 v[244:247], v7, s[4:7], s17 offen offset:1024
  buffer_load_dwordx4 v[248:251], v7, s[4:7], s17 offen offset:2048
  buffer_load_dwordx4 v[252:255], v7, s[4:7], s17 offen offset:3072
.en_seg:
  v_mov_b32 v18, 1
  s_min_u32 s48, s48, 64
  s_lshl_b32 s26, s48, 7
  s_sub_u32 s26, s26, s62
  s_add_u32 s26, s26, 105455616
  s_lshl_b32 s18, s46, 16
  s_lshl_b32 s19, s46, 7
  buffer_load_dword v13, off, s[4:7], s26 sc1
  buffer_load_dwordx4 v[2:5], v11, s[4:7], s18 offen
  buffer_load_dword v16, v12, s[4:7], s19 offen sc0 sc1
  s_mov_b64 exec, 1
  buffer_atomic_add v18, off, s[4:7], s58 sc0 sc1
  s_mov_b64 exec, -1
  ds_read_b64_tr_b16 v[20:21], v6 offset:0
  ds_read_b64_tr_b16 v[22:23], v6 offset:256
  s_waitcnt vmcnt(19)
  v_mfma_f32_32x32x16_bf16 v[28:43], a[0:3], v[192:195], 0
  v_mfma_f32_32x32x16_bf16 v[44:59], v[60:63], v[192:195], 0
  s_waitcnt vmcnt(18)
  v_mfma_f32_32x32x16_bf16 v[28:43], a[4:7], v[196:199], v[28:43]
  s_waitcnt lgkmcnt(0)
  v_mfma_f32_32x32x16_bf16 v[44:59], v[20:23], v[196:199], v[44:59]
  ds_read_b64_tr_b16 v[24:25], v6 offset:1024
  ds_read_b64_tr_b16 v[26:27], v6 offset:1280
  s_add_u32 s17, s25, 16384
  s_and_b32 s17, s17, 0xffff
  s_add_u32 s17, s17, s16
  buffer_load_dwordx4 v[192:195], v7, s[4:7], s17 offen offset:0
  s_waitcnt vmcnt(18)
  v_mfma_f32_32x32x16_bf16 v[28:43], a[8:11], v[200:203], v[28:43]
  v_mfma_f32_32x32x16_bf16 v[44:59], v[64:67], v[200:203], v[44:59]
  buffer_load_dwordx4 v[196:199], v7, s[4:7], s17 offen offset:1024
  s_waitcnt vmcnt(18)
  v_mfma_f32_32x32x16_bf16 v[28:43], a[12:15], v[204:207], v[28:43]
  s_waitcnt lgkmcnt(0)
  v_mfma_f32_32x32x16_bf16 v[44:59], v[24:27], v[204:207], v[44:59]
  ds_read_b64_tr_b16 v[20:21], v6 offset:2048
  ds_read_b64_tr_b16 v[22:23], v6 offset:2304
  buffer_load_dwordx4 v[200:203], v7, s[4:7], s17 offen offset:2048
  s_waitcnt vmcnt(18)
  v_mfma_f32_32x32x16_bf16 v[28:43], a[16:19], v[208:211], v[28:43]
  v_mfma_f32_32x32x16_bf16 v[44:59], v[68:71], v[208:211], v[44:59]
  buffer_load_dwordx4 v[204:207], v7, s[4:7], s17 offen offset:3072
  s_waitcnt vmcnt(18)
  v_mfma_f32_32x32x16_bf16 v[28:43], a[20:23], v[212:215], v[28:43]
  s_waitcnt lgkmcnt(0)
  v_mfma_f32_32x32x16_bf16 v[44:59], v[20:23], v[212:215], v[44:59]
  ds_read_b64_tr_b16 v[24:25], v6 offset:3072
  ds_read_b64_tr_b16 v[26:27], v6 offset:3328
  s_add_u32 s17, s25, 20480
  s_and_b32 s17, s17, 0xffff
  s_add_u32 s17, s17, s16
  buffer_load_dwordx4 v[208:211], v7, s[4:7], s17 offen offset:0
  s_waitcnt vmcnt(18)
  v_mfma_f32_32x32x16_bf16 v[28:43], a[24:27], v[216:219], v[28:43]
  v_mfma_f32_32x32x16_bf16 v[44:59], v[72:75], v[216:219], v[44:59]
  buffer_load_dwordx4 v[212:215], v7, s[4:7], s17 offen offset:1024
  s_waitcnt vmcnt(18)
  v_mfma_f32_32x32x16_bf16 v[28:43], a[28:31], v[220:223], v[28:43]
  s_waitcnt lgkmcnt(0)
  v_mfma_f32_32x32x16_bf16 v[44:59], v[24:27], v[220:223], v[44:59]
  ds_read_b64_tr_b16 v[20:21], v6 offset:4096
  ds_read_b64_tr_b16 v[22:23], v6 offset:4352
  buffer_load_dwordx4 v[216:219], v7, s[4:7], s17 offen offset:2048
  s_waitcnt vmcnt(18)
  v_mfma_f32_32x32x16_bf16 v[28:43], a[32:35], v[224:227], v[28:43]
  v_mfma_f32_32x32x16_bf16 v[44:59], v[76:79], v[224:227], v[44:59]
  buffer_load_dwordx4 v[220:223], v7, s[4:7], s17 offen offset:3072
  s_waitcnt vmcnt(18)
  v_mfma_f32_32x32x16_bf16 v[28:43], a[36:39], v[228:231], v[28:43]
  s_waitcnt lgkmcnt(0)
  v_mfma_f32_32x32x16_bf16 v[44:59], v[20:23], v[228:231], v[44:59]
  ds_read_b64_tr_b16 v[24:25], v6 offset:5120
  ds_read_b64_tr_b16 v[26:27], v6 offset:5376
  s_add_u32 s17, s25, 24576
  s_and_b32 s17, s17, 0xffff
  s_add_u32 s17, s17, s16
  buffer_load_dwordx4 v[224:227], v7, s[4:7], s17 offen offset:0
  s_waitcnt vmcnt(18)
  v_mfma_f32_32x32x16_bf16 v[28:43], a[40:43], v[232:235], v[28:43]
  v_mfma_f32_32x32x16_bf16 v[44:59], v[80:83], v[232:235], v[44:59]
  buffer_load_dwordx4 v[228:231], v7, s[4:7], s17 offen offset:1024
  s_waitcnt vmcnt(18)
  v_mfma_f32_32x32x16_bf16 v[28:43], a[44:47], v[236:239], v[28:43]
  s_waitcnt lgkmcnt(0)
  v_mfma_f32_32x32x16_bf16 v[44:59], v[24:27], v[236:239], v[44:59]
  ds_read_b64_tr_b16 v[20:21], v6 offset:6144
  ds_read_b64_tr_b16 v[22:23], v6 offset:6400
  buffer_load_dwordx4 v[232:235], v7, s[4:7], s17 offen offset:2048
  s_waitcnt vmcnt(18)
  v_mfma_f32_32x32x16_bf16 v[28:43], a[48:51], v[240:243], v[28:43]
  v_mfma_f32_32x32x16_bf16 v[44:59], v[84:87], v[240:243], v[44:59]
  buffer_load_dwordx4 v[236:239], v7, s[4:7], s17 offen offset:3072
  s_waitcnt vmcnt(18)
  v_mfma_f32_32x32x16_bf16 v[28:43], a[52:55], v[244:247], v[28:43]
  s_waitcnt lgkmcnt(0)
  v_mfma_f32_32x32x16_bf16 v[44:59], v[20:23], v[244:247], v[44:59]
  ds_read_b64_tr_b16 v[24:25], v6 offset:7168
  ds_read_b64_tr_b16 v[26:27], v6 offset:7424
  s_add_u32 s17, s25, 28672
  s_and_b32 s17, s17, 0xffff
  s_add_u32 s17, s17, s16
  buffer_load_dwordx4 v[240:243], v7, s[4:7], s17 offen offset:0
  s_waitcnt vmcnt(18)
  v_mfma_f32_32x32x16_bf16 v[28:43], a[56:59], v[248:251], v[28:43]
  v_mfma_f32_32x32x16_bf16 v[44:59], v[88:91], v[248:251], v[44:59]
  buffer_load_dwordx4 v[244:247], v7, s[4:7], s17 offen offset:1024
  s_waitcnt vmcnt(18)
  v_mfma_f32_32x32x16_bf16 v[28:43], a[60:63], v[252:255], v[28:43]
  s_waitcnt lgkmcnt(0)
  v_mfma_f32_32x32x16_bf16 v[44:59], v[24:27], v[252:255], v[44:59]
  ds_read_b64_tr_b16 v[20:21], v6 offset:8192
  ds_read_b64_tr_b16 v[22:23], v6 offset:8448
  buffer_load_dwordx4 v[248:251], v7, s[4:7], s17 offen offset:2048
  s_waitcnt vmcnt(14)
  v_mfma_f32_32x32x16_bf16 v[28:43], a[64:67], v[192:195], v[28:43]
  v_mfma_f32_32x32x16_bf16 v[44:59], v[92:95], v[192:195], v[44:59]
  buffer_load_dwordx4 v[252:255], v7, s[4:7], s17 offen offset:3072
  s_waitcnt vmcnt(14)
  v_mfma_f32_32x32x16_bf16 v[28:43], a[68:71], v[196:199], v[28:43]
  s_waitcnt lgkmcnt(0)
  v_mfma_f32_32x32x16_bf16 v[44:59], v[20:23], v[196:199], v[44:59]
  ds_read_b64_tr_b16 v[24:25], v6 offset:9216
  ds_read_b64_tr_b16 v[26:27], v6 offset:9472
  s_add_u32 s17, s25, 32768
  s_and_b32 s17, s17, 0xffff
  s_add_u32 s17, s17, s16
  buffer_load_dwordx4 v[192:195], v7, s[4:7], s17 offen offset:0
  s_waitcnt vmcnt(14)
  v_mfma_f32_32x32x16_bf16 v[28:43], a[72:75], v[200:203], v[28:43]
  v_mfma_f32_32x32x16_bf16 v[44:59], v[96:99], v[200:203], v[44:59]
  buffer_load_dwordx4 v[196:199], v7, s[4:7], s17 offen offset:1024
  s_waitcnt vmcnt(14)
  v_mfma_f32_32x32x16_bf16 v[28:43], a[76:79], v[204:207], v[28:43]
  s_waitcnt lgkmcnt(0)
  v_mfma_f32_32x32x16_bf16 v[44:59], v[24:27], v[204:207], v[44:59]
  ds_read_b64_tr_b16 v[20:21], v6 offset:10240
  ds_read_b64_tr_b16 v[22:23], v6 offset:10496
  buffer_load_dwordx4 v[200:203], v7, s[4:7], s17 offen offset:2048
  s_waitcnt vmcnt(14)
  v_mfma_f32_32x32x16_bf16 v[28:43], a[80:83], v[208:211], v[28:43]
  v_mfma_f32_32x32x16_bf16 v[44:59], v[100:103], v[208:211], v[44:59]
  buffer_load_dwordx4 v[204:207], v7, s[4:7], s17 offen offset:3072
  s_waitcnt vmcnt(14)
  v_mfma_f32_32x32x16_bf16 v[28:43], a[84:87], v[212:215], v[28:43]
  s_waitcnt lgkmcnt(0)
  v_mfma_f32_32x32x16_bf16 v[44:59], v[20:23], v[212:215], v[44:59]
  ds_read_b64_tr_b16 v[24:25], v6 offset:11264
  ds_read_b64_tr_b16 v[26:27], v6 offset:11520
  s_add_u32 s17, s25, 36864
  s_and_b32 s17, s17, 0xffff
  s_add_u32 s17, s17, s16
  buffer_load_dwordx4 v[208:211], v7, s[4:7], s17 offen offset:0
  s_waitcnt vmcnt(14)
  v_mfma_f32_32x32x16_bf16 v[28:43], a[88:91], v[216:219], v[28:43]
  v_mfma_f32_32x32x16_bf16 v[44:59], v[104:107], v[216:219], v[44:59]
  ds_write_b32 v19, v13 offset:64
  buffer_load_dwordx4 v[212:215], v7, s[4:7], s17 offen offset:1024
  s_waitcnt vmcnt(14)
  v_mfma_f32_32x32x16_bf16 v[28:43], a[92:95], v[220:223], v[28:43]
  s_waitcnt lgkmcnt(0)
  v_mfma_f32_32x32x16_bf16 v[44:59], v[24:27], v[220:223], v[44:59]
  ds_read_b64_tr_b16 v[20:21], v6 offset:12288
  ds_read_b64_tr_b16 v[22:23], v6 offset:12544
  buffer_load_dwordx4 v[216:219], v7, s[4:7], s17 offen offset:2048
  s_waitcnt vmcnt(14)
  v_mfma_f32_32x32x16_bf16 v[28:43], a[96:99], v[224:227], v[28:43]
  v_mfma_f32_32x32x16_bf16 v[44:59], v[108:111], v[224:227], v[44:59]
  s_barrier
  ds_read_b32 v13, v17 offset:64
  buffer_load_dwordx4 v[220:223], v7, s[4:7], s17 offen offset:3072
  s_waitcnt vmcnt(14)
  v_mfma_f32_32x32x16_bf16 v[28:43], a[100:103], v[228:231], v[28:43]
  s_waitcnt lgkmcnt(0)
  v_mfma_f32_32x32x16_bf16 v[44:59], v[20:23], v[228:231], v[44:59]
  ds_read_b64_tr_b16 v[24:25], v6 offset:13312
  ds_read_b64_tr_b16 v[26:27], v6 offset:13568
  s_add_u32 s17, s25, 40960
  s_and_b32 s17, s17, 0xffff
  s_add_u32 s17, s17, s16
  buffer_load_dwordx4 v[224:227], v7, s[4:7], s17 offen offset:0
  s_waitcnt vmcnt(14)
  v_mfma_f32_32x32x16_bf16 v[28:43], a[104:107], v[232:235], v[28:43]
  v_mfma_f32_32x32x16_bf16 v[44:59], v[112:115], v[232:235], v[44:59]
  buffer_load_dwordx4 v[228:231], v7, s[4:7], s17 offen offset:1024
  s_waitcnt vmcnt(14)
  v_mfma_f32_32x32x16_bf16 v[28:43], a[108:111], v[236:239], v[28:43]
  s_waitcnt lgkmcnt(0)
  v_mfma_f32_32x32x16_bf16 v[44:59], v[24:27], v[236:239], v[44:59]
  ds_read_b64_tr_b16 v[20:21], v6 offset:14336
  ds_read_b64_tr_b16 v[22:23], v6 offset:14592
  buffer_load_dwordx4 v[232:235], v7, s[4:7], s17 offen offset:2048
  s_waitcnt vmcnt(14)
  v_mfma_f32_32x32x16_bf16 v[28:43], a[112:115], v[240:243], v[28:43]
  v_mfma_f32_32x32x16_bf16 v[44:59], v[116:119], v[240:243], v[44:59]
  buffer_load_dwordx4 v[236:239], v7, s[4:7], s17 offen offset:3072
  s_waitcnt vmcnt(14)
  v_mfma_f32_32x32x16_bf16 v[28:43], a[116:119], v[244:247], v[28:43]
  s_waitcnt lgkmcnt(0)
  v_mfma_f32_32x32x16_bf16 v[44:59], v[20:23], v[244:247], v[44:59]
  ds_read_b64_tr_b16 v[24:25], v6 offset:15360
  ds_read_b64_tr_b16 v[26:27], v6 offset:15616
  s_add_u32 s17, s25, 45056
  s_and_b32 s17, s17, 0xffff
  s_add_u32 s17, s17, s16
  buffer_load_dwordx4 v[240:243], v7, s[4:7], s17 offen offset:0
  s_waitcnt vmcnt(14)
  v_mfma_f32_32x32x16_bf16 v[28:43], a[120:123], v[248:251], v[28:43]
  v_mfma_f32_32x32x16_bf16 v[44:59], v[120:123], v[248:251], v[44:59]
  buffer_load_dwordx4 v[244:247], v7, s[4:7], s17 offen offset:1024
  s_waitcnt vmcnt(14)
  v_mfma_f32_32x32x16_bf16 v[28:43], a[124:127], v[252:255], v[28:43]
  s_waitcnt lgkmcnt(0)
  v_mfma_f32_32x32x16_bf16 v[44:59], v[24:27], v[252:255], v[44:59]
  ds_read_b64_tr_b16 v[20:21], v6 offset:16384
  ds_read_b64_tr_b16 v[22:23], v6 offset:16640
  buffer_load_dwordx4 v[248:251], v7, s[4:7], s17 offen offset:2048
  s_waitcnt vmcnt(14)
  v_mfma_f32_32x32x16_bf16 v[28:43], a[128:131], v[192:195], v[28:43]
  v_mfma_f32_32x32x16_bf16 v[44:59], v[124:127], v[192:195], v[44:59]
  buffer_load_dwordx4 v[252:255], v7, s[4:7], s17 offen offset:3072
  s_waitcnt vmcnt(14)
  v_mfma_f32_32x32x16_bf16 v[28:43], a[132:135], v[196:199], v[28:43]
  s_waitcnt lgkmcnt(0)
  v_mfma_f32_32x32x16_bf16 v[44:59], v[20:23], v[196:199], v[44:59]
  ds_read_b64_tr_b16 v[24:25], v6 offset:17408
  ds_read_b64_tr_b16 v[26:27], v6 offset:17664
  s_add_u32 s17, s25, 49152
  s_and_b32 s17, s17, 0xffff
  s_add_u32 s17, s17, s16
  buffer_load_dwordx4 v[192:195], v7, s[4:7], s17 offen offset:0
  s_waitcnt vmcnt(14)
  v_mfma_f32_32x32x16_bf16 v[28:43], a[136:139], v[200:203], v[28:43]
  v_mfma_f32_32x32x16_bf16 v[44:59], v[128:131], v[200:203], v[44:59]
  buffer_load_dwordx4 v[196:199], v7, s[4:7], s17 offen offset:1024
  s_waitcnt vmcnt(14)
  v_mfma_f32_32x32x16_bf16 v[28:43], a[140:143], v[204:207], v[28:43]
  s_waitcnt lgkmcnt(0)
  v_mfma_f32_32x32x16_bf16 v[44:59], v[24:27], v[204:207], v[44:59]
  ds_read_b64_tr_b16 v[20:21], v6 offset:18432
  ds_read_b64_tr_b16 v[22:23], v6 offset:18688
  buffer_load_dwordx4 v[200:203], v7, s[4:7], s17 offen offset:2048
  s_waitcnt vmcnt(14)
  v_mfma_f32_32x32x16_bf16 v[28:43], a[144:147], v[208:211], v[28:43]
  v_mfma_f32_32x32x16_bf16 v[44:59], v[132:135], v[208:211], v[44:59]
  buffer_load_dwordx4 v[204:207], v7, s[4:7], s17 offen offset:3072
  s_waitcnt vmcnt(14)
  v_mfma_f32_32x32x16_bf16 v[28:43], a[148:151], v[212:215], v[28:43]
  s_waitcnt lgkmcnt(0)
  v_mfma_f32_32x32x16_bf16 v[44:59], v[20:23], v[212:215], v[44:59]
  ds_read_b64_tr_b16 v[24:25], v6 offset:19456
  ds_read_b64_tr_b16 v[26:27], v6 offset:19712
  s_add_u32 s17, s25, 53248
  s_and_b32 s17, s17, 0xffff
  s_add_u32 s17, s17, s16
  buffer_load_dwordx4 v[208:211], v7, s[4:7], s17 offen offset:0
  s_waitcnt vmcnt(14)
  v_mfma_f32_32x32x16_bf16 v[28:43], a[152:155], v[216:219], v[28:43]
  v_mfma_f32_32x32x16_bf16 v[44:59], v[136:139], v[216:219], v[44:59]
  buffer_load_dwordx4 v[212:215], v7, s[4:7], s17 offen offset:1024
  s_waitcnt vmcnt(14)
  v_mfma_f32_32x32x16_bf16 v[28:43], a[156:159], v[220:223], v[28:43]
  s_waitcnt lgkmcnt(0)
  v_mfma_f32_32x32x16_bf16 v[44:59], v[24:27], v[220:223], v[44:59]
  ds_read_b64_tr_b16 v[20:21], v6 offset:20480
  ds_read_b64_tr_b16 v[22:23], v6 offset:20736
  buffer_load_dwordx4 v[216:219], v7, s[4:7], s17 offen offset:2048
  s_waitcnt vmcnt(14)
  v_mfma_f32_32x32x16_bf16 v[28:43], a[160:163], v[224:227], v[28:43]
  v_mfma_f32_32x32x16_bf16 v[44:59], v[140:143], v[224:227], v[44:59]
  buffer_load_dwordx4 v[220:223], v7, s[4:7], s17 offen offset:3072
  s_waitcnt vmcnt(14)
  v_mfma_f32_32x32x16_bf16 v[28:43], a[164:167], v[228:231], v[28:43]
  s_waitcnt lgkmcnt(0)
  v_mfma_f32_32x32x16_bf16 v[44:59], v[20:23], v[228:231], v[44:59]
  ds_read_b64_tr_b16 v[24:25], v6 offset:21504
  ds_read_b64_tr_b16 v[26:27], v6 offset:21760
  s_add_u32 s17, s25, 57344
  s_and_b32 s17, s17, 0xffff
  s_add_u32 s17, s17, s16
  buffer_load_dwordx4 v[224:227], v7, s[4:7], s17 offen offset:0
  s_waitcnt vmcnt(14)
  v_mfma_f32_32x32x16_bf16 v[28:43], a[168:171], v[232:235], v[28:43]
  v_mfma_f32_32x32x16_bf16 v[44:59], v[144:147], v[232:235], v[44:59]
  buffer_load_dwordx4 v[228:231], v7, s[4:7], s17 offen offset:1024
  s_waitcnt vmcnt(14)
  v_mfma_f32_32x32x16_bf16 v[28:43], a[172:175], v[236:239], v[28:43]
  s_waitcnt lgkmcnt(0)
  v_mfma_f32_32x32x16_bf16 v[44:59], v[24:27], v[236:239], v[44:59]
  ds_read_b64_tr_b16 v[20:21], v6 offset:22528
  ds_read_b64_tr_b16 v[22:23], v6 offset:22784
  buffer_load_dwordx4 v[232:235], v7, s[4:7], s17 offen offset:2048
  s_waitcnt vmcnt(14)
  v_mfma_f32_32x32x16_bf16 v[28:43], a[176:179], v[240:243], v[28:43]
  v_mfma_f32_32x32x16_bf16 v[44:59], v[148:151], v[240:243], v[44:59]
  buffer_load_dwordx4 v[236:239], v7, s[4:7], s17 offen offset:3072
  s_waitcnt vmcnt(14)
  v_mfma_f32_32x32x16_bf16 v[28:43], a[180:183], v[244:247], v[28:43]
  s_waitcnt lgkmcnt(0)
  v_mfma_f32_32x32x16_bf16 v[44:59], v[20:23], v[244:247], v[44:59]
  ds_read_b64_tr_b16 v[24:25], v6 offset:23552
  ds_read_b64_tr_b16 v[26:27], v6 offset:23808
  s_add_u32 s17, s25, 61440
  s_and_b32 s17, s17, 0xffff
  s_add_u32 s17, s17, s16
  buffer_load_dwordx4 v[240:243], v7, s[4:7], s17 offen offset:0
  s_waitcnt vmcnt(14)
  v_mfma_f32_32x32x16_bf16 v[28:43], a[184:187], v[248:251], v[28:43]
  v_mfma_f32_32x32x16_bf16 v[44:59], v[152:155], v[248:251], v[44:59]
  buffer_load_dwordx4 v[244:247], v7, s[4:7], s17 offen offset:1024
  s_waitcnt vmcnt(14)
  v_mfma_f32_32x32x16_bf16 v[28:43], a[188:191], v[252:255], v[28:43]
  s_waitcnt lgkmcnt(0)
  v_mfma_f32_32x32x16_bf16 v[44:59], v[24:27], v[252:255], v[44:59]
  ds_read_b64_tr_b16 v[20:21], v6 offset:24576
  ds_read_b64_tr_b16 v[22:23], v6 offset:24832
  buffer_load_dwordx4 v[248:251], v7, s[4:7], s17 offen offset:2048
  s_waitcnt vmcnt(14)
  v_mfma_f32_32x32x16_bf16 v[28:43], a[192:195], v[192:195], v[28:43]
  v_mfma_f32_32x32x16_bf16 v[44:59], v[156:159], v[192:195], v[44:59]
  buffer_load_dwordx4 v[252:255], v7, s[4:7], s17 offen offset:3072
  v_readfirstlane_b32 s27, v13
  s_lshl_b32 s16, s48, 18
  s_cmp_lt_u32 s48, 64
  s_cselect_b32 s27, s27, 0
  s_cmp_lg_u32 s27, 35
  s_cbranch_scc1 .en_np
  s_waitcnt vmcnt(14)
  v_mfma_f32_32x32x16_bf16 v[28:43], a[196:199], v[196:199], v[28:43]
  s_waitcnt lgkmcnt(0)
  v_mfma_f32_32x32x16_bf16 v[44:59], v[20:23], v[196:199], v[44:59]
  ds_read_b64_tr_b16 v[24:25], v6 offset:25600
  ds_read_b64_tr_b16 v[26:27], v6 offset:25856
  s_add_u32 s17, s25, 0
  s_and_b32 s17, s17, 0xffff
  s_add_u32 s17, s17, s16
  buffer_load_dwordx4 v[192:195], v7, s[4:7], s17 offen offset:0
  s_waitcnt vmcnt(14)
  v_mfma_f32_32x32x16_bf16 v[28:43], a[200:203], v[200:203], v[28:43]
  v_mfma_f32_32x32x16_bf16 v[44:59], v[160:163], v[200:203], v[44:59]
  buffer_load_dwordx4 v[196:199], v7, s[4:7], s17 offen offset:1024
  s_waitcnt vmcnt(14)
  v_mfma_f32_32x32x16_bf16 v[28:43], a[204:207], v[204:207], v[28:43]
  s_waitcnt lgkmcnt(0)
  v_mfma_f32_32x32x16_bf16 v[44:59], v[24:27], v[204:207], v[44:59]
  ds_read_b64_tr_b16 v[20:21], v6 offset:26624
  ds_read_b64_tr_b16 v[22:23], v6 offset:26880
  buffer_load_dwordx4 v[200:203], v7, s[4:7], s17 offen offset:2048
  s_waitcnt vmcnt(14)
  v_mfma_f32_32x32x16_bf16 v[28:43], a[208:211], v[208:211], v[28:43]
  v_mfma_f32_32x32x16_bf16 v[44:59], v[164:167], v[208:211], v[44:59]
  buffer_load_dwordx4 v[204:207], v7, s[4:7], s17 offen offset:3072
  s_waitcnt vmcnt(14)
  v_mfma_f32_32x32x16_bf16 v[28:43], a[212:215], v[212:215], v[28:43]
  s_waitcnt lgkmcnt(0)
  v_mfma_f32_32x32x16_bf16 v[44:59], v[20:23], v[212:215], v[44:59]
  ds_read_b64_tr_b16 v[24:25], v6 offset:27648
  ds_read_b64_tr_b16 v[26:27], v6 offset:27904
  s_add_u32 s17, s25, 4096
  s_and_b32 s17, s17, 0xffff
  s_add_u32 s17, s17, s16
  buffer_load_dwordx4 v[208:211], v7, s[4:7], s17 offen offset:0
  s_waitcnt vmcnt(14)
  v_mfma_f32_32x32x16_bf16 v[28:43], a[216:219], v[216:219], v[28:43]
  v_mfma_f32_32x32x16_bf16 v[44:59], v[168:171], v[216:219], v[44:59]
  buffer_load_dwordx4 v[212:215], v7, s[4:7], s17 offen offset:1024
  s_waitcnt vmcnt(14)
  v_mfma_f32_32x32x16_bf16 v[28:43], a[220:223], v[220:223], v[28:43]
  s_waitcnt lgkmcnt(0)
  v_mfma_f32_32x32x16_bf16 v[44:59], v[24:27], v[220:223], v[44:59]
  ds_read_b64_tr_b16 v[20:21], v6 offset:28672
  ds_read_b64_tr_b16 v[22:23], v6 offset:28928
  buffer_load_dwordx4 v[216:219], v7, s[4:7], s17 offen offset:2048
  s_waitcnt vmcnt(14)
  v_mfma_f32_32x32x16_bf16 v[28:43], a[224:227], v[224:227], v[28:43]
  v_mfma_f32_32x32x16_bf16 v[44:59], v[172:175], v[224:227], v[44:59]
  buffer_load_dwordx4 v[220:223], v7, s[4:7], s17 offen offset:3072
  s_waitcnt vmcnt(14)
  v_mfma_f32_32x32x16_bf16 v[28:43], a[228:231], v[228:231], v[28:43]
  s_waitcnt lgkmcnt(0)
  v_mfma_f32_32x32x16_bf16 v[44:59], v[20:23], v[228:231], v[44:59]
  ds_read_b64_tr_b16 v[24:25], v6 offset:29696
  ds_read_b64_tr_b16 v[26:27], v6 offset:29952
  s_add_u32 s17, s25, 8192
  s_and_b32 s17, s17, 0xffff
  s_add_u32 s17, s17, s16
  buffer_load_dwordx4 v[224:227], v7, s[4:7], s17 offen offset:0
  s_waitcnt vmcnt(14)
  v_mfma_f32_32x32x16_bf16 v[28:43], a[232:235], v[232:235], v[28:43]
  v_mfma_f32_32x32x16_bf16 v[44:59], v[176:179], v[232:235], v[44:59]
  buffer_load_dwordx4 v[228:231], v7, s[4:7], s17 offen offset:1024
  s_waitcnt vmcnt(14)
  v_mfma_f32_32x32x16_bf16 v[28:43], a[236:239], v[236:239], v[28:43]
  s_waitcnt lgkmcnt(0)
  v_mfma_f32_32x32x16_bf16 v[44:59], v[24:27], v[236:239], v[44:59]
  ds_read_b64_tr_b16 v[20:21], v6 offset:30720
  ds_read_b64_tr_b16 v[22:23], v6 offset:30976
  buffer_load_dwordx4 v[232:235], v7, s[4:7], s17 offen offset:2048
  s_waitcnt vmcnt(14)
  v_mfma_f32_32x32x16_bf16 v[28:43], a[240:243], v[240:243], v[28:43]
  v_mfma_f32_32x32x16_bf16 v[44:59], v[180:183], v[240:243], v[44:59]
  buffer_load_dwordx4 v[236:239], v7, s[4:7], s17 offen offset:3072
  s_waitcnt vmcnt(14)
  v_mfma_f32_32x32x16_bf16 v[28:43], a[244:247], v[244:247], v[28:43]
  s_waitcnt lgkmcnt(0)
  v_mfma_f32_32x32x16_bf16 v[44:59], v[20:23], v[244:247], v[44:59]
  s_add_u32 s17, s25, 12288
  s_and_b32 s17, s17, 0xffff
  s_add_u32 s17, s17, s16
  buffer_load_dwordx4 v[240:243], v7, s[4:7], s17 offen offset:0
  s_waitcnt vmcnt(14)
  v_mfma_f32_32x32x16_bf16 v[28:43], a[248:251], v[248:251], v[28:43]
  v_mfma_f32_32x32x16_bf16 v[44:59], v[184:187], v[248:251], v[44:59]
  buffer_load_dwordx4 v[244:247], v7, s[4:7], s17 offen offset:1024
  s_waitcnt vmcnt(14)
  v_mfma_f32_32x32x16_bf16 v[28:43], a[252:255], v[252:255], v[28:43]
  v_mfma_f32_32x32x16_bf16 v[44:59], v[188:191], v[252:255], v[44:59]
  buffer_load_dwordx4 v[248:251], v7, s[4:7], s17 offen offset:2048
  s_nop 1
  buffer_load_dwordx4 v[252:255], v7, s[4:7], s17 offen offset:3072
  s_branch .en_red
.en_np:
  s_waitcnt vmcnt(14)
  v_mfma_f32_32x32x16_bf16 v[28:43], a[196:199], v[196:199], v[28:43]
  s_waitcnt lgkmcnt(0)
  v_mfma_f32_32x32x16_bf16 v[44:59], v[20:23], v[196:199], v[44:59]
  ds_read_b64_tr_b16 v[24:25], v6 offset:25600
  ds_read_b64_tr_b16 v[26:27], v6 offset:25856
  s_waitcnt vmcnt(13)
  v_mfma_f32_32x32x16_bf16 v[28:43], a[200:203], v[200:203], v[28:43]
  v_mfma_f32_32x32x16_bf16 v[44:59], v[160:163], v[200:203], v[44:59]
  s_waitcnt vmcnt(12)
  v_mfma_f32_32x32x16_bf16 v[28:43], a[204:207], v[204:207], v[28:43]
  s_waitcnt lgkmcnt(0)
  v_mfma_f32_32x32x16_bf16 v[44:59], v[24:27], v[204:207], v[44:59]
  ds_read_b64_tr_b16 v[20:21], v6 offset:26624
  ds_read_b64_tr_b16 v[22:23], v6 offset:26880
  s_waitcnt vmcnt(11)
  v_mfma_f32_32x32x16_bf16 v[28:43], a[208:211], v[208:211], v[28:43]
  v_mfma_f32_32x32x16_bf16 v[44:59], v[164:167], v[208:211], v[44:59]
  s_waitcnt vmcnt(10)
  v_mfma_f32_32x32x16_bf16 v[28:43], a[212:215], v[212:215], v[28:43]
  s_waitcnt lgkmcnt(0)
  v_mfma_f32_32x32x16_bf16 v[44:59], v[20:23], v[212:215], v[44:59]
  ds_read_b64_tr_b16 v[24:25], v6 offset:27648
  ds_read_b64_tr_b16 v[26:27], v6 offset:27904
  s_waitcnt vmcnt(9)
  v_mfma_f32_32x32x16_bf16 v[28:43], a[216:219], v[216:219], v[28:43]
  v_mfma_f32_32x32x16_bf16 v[44:59], v[168:171], v[216:219], v[44:59]
  s_waitcnt vmcnt(8)
  v_mfma_f32_32x32x16_bf16 v[28:43], a[220:223], v[220:223], v[28:43]
  s_waitcnt lgkmcnt(0)
  v_mfma_f32_32x32x16_bf16 v[44:59], v[24:27], v[220:223], v[44:59]
  ds_read_b64_tr_b16 v[20:21], v6 offset:28672
  ds_read_b64_tr_b16 v[22:23], v6 offset:28928
  s_waitcnt vmcnt(7)
  v_mfma_f32_32x32x16_bf16 v[28:43], a[224:227], v[224:227], v[28:43]
  v_mfma_f32_32x32x16_bf16 v[44:59], v[172:175], v[224:227], v[44:59]
  s_waitcnt vmcnt(6)
  v_mfma_f32_32x32x16_bf16 v[28:43], a[228:231], v[228:231], v[28:43]
  s_waitcnt lgkmcnt(0)
  v_mfma_f32_32x32x16_bf16 v[44:59], v[20:23], v[228:231], v[44:59]
  ds_read_b64_tr_b16 v[24:25], v6 offset:29696
  ds_read_b64_tr_b16 v[26:27], v6 offset:29952
  s_waitcnt vmcnt(5)
  v_mfma_f32_32x32x16_bf16 v[28:43], a[232:235], v[232:235], v[28:43]
  v_mfma_f32_32x32x16_bf16 v[44:59], v[176:179], v[232:235], v[44:59]
  s_waitcnt vmcnt(4)
  v_mfma_f32_32x32x16_bf16 v[28:43], a[236:239], v[236:239], v[28:43]
  s_waitcnt lgkmcnt(0)
  v_mfma_f32_32x32x16_bf16 v[44:59], v[24:27], v[236:239], v[44:59]
  ds_read_b64_tr_b16 v[20:21], v6 offset:30720
  ds_read_b64_tr_b16 v[22:23], v6 offset:30976
  s_waitcnt vmcnt(3)
  v_mfma_f32_32x32x16_bf16 v[28:43], a[240:243], v[240:243], v[28:43]
  v_mfma_f32_32x32x16_bf16 v[44:59], v[180:183], v[240:243], v[44:59]
  s_waitcnt vmcnt(2)
  v_mfma_f32_32x32x16_bf16 v[28:43], a[244:247], v[244:247], v[28:43]
  s_waitcnt lgkmcnt(0)
  v_mfma_f32_32x32x16_bf16 v[44:59], v[20:23], v[244:247], v[44:59]
  s_waitcnt vmcnt(1)
  v_mfma_f32_32x32x16_bf16 v[28:43], a[248:251], v[248:251], v[28:43]
  v_mfma_f32_32x32x16_bf16 v[44:59], v[184:187], v[248:251], v[44:59]
  s_waitcnt vmcnt(0)
  v_mfma_f32_32x32x16_bf16 v[28:43], a[252:255], v[252:255], v[28:43]
  v_mfma_f32_32x32x16_bf16 v[44:59], v[188:191], v[252:255], v[44:59]
.en_red:
  s_mov_b64 exec, 1
  ds_write_b32 v19, v18
  s_mov_b64 exec, -1
  v_lshlrev_b32 v20, 16, v2
  v_and_b32 v21, 0xffff0000, v2
  v_lshlrev_b32 v22, 16, v3
  v_and_b32 v23, 0xffff0000, v3
  v_lshlrev_b32 v24, 16, v4
  v_and_b32 v25, 0xffff0000, v4
  v_lshlrev_b32 v26, 16, v5
  v_and_b32 v27, 0xffff0000, v5
  s_nop 3
  ds_write_b128 v8, v[28:31] offset:0
  ds_write_b128 v8, v[32:35] offset:1024
  ds_write_b128 v8, v[36:39] offset:2048
  ds_write_b128 v8, v[40:43] offset:3072
  ds_write_b128 v8, v[44:47] offset:4096
  ds_write_b128 v8, v[48:51] offset:5120
  ds_write_b128 v8, v[52:55] offset:6144
  ds_write_b128 v8, v[56:59] offset:7168
  s_waitcnt lgkmcnt(0)
  s_barrier
  ds_read_b32 v13, v17
  ds_read_b128 v[28:31], v9 offset:0
  ds_read_b128 v[32:35], v9 offset:1024
  ds_read_b128 v[36:39], v9 offset:8192
  ds_read_b128 v[40:43], v9 offset:9216
  ds_read_b128 v[44:47], v9 offset:16384
  ds_read_b128 v[48:51], v9 offset:17408
  ds_read_b128 v[52:55], v9 offset:24576
  ds_read_b128 v[56:59], v9 offset:25600
  s_waitcnt lgkmcnt(4)
  v_pk_add_f32 v[28:29], v[28:29], v[36:37]
  v_pk_add_f32 v[30:31], v[30:31], v[38:39]
  v_pk_add_f32 v[32:33], v[32:33], v[40:41]
  v_pk_add_f32 v[34:35], v[34:35], v[42:43]
  s_waitcnt lgkmcnt(2)
  v_pk_add_f32 v[28:29], v[28:29], v[44:45]
  v_pk_add_f32 v[30:31], v[30:31], v[46:47]
  v_pk_add_f32 v[32:33], v[32:33], v[48:49]
  v_pk_add_f32 v[34:35], v[34:35], v[50:51]
  s_waitcnt lgkmcnt(0)
  v_pk_add_f32 v[28:29], v[28:29], v[52:53]
  v_pk_add_f32 v[30:31], v[30:31], v[54:55]
  v_pk_add_f32 v[32:33], v[32:33], v[56:57]
  v_pk_add_f32 v[34:35], v[34:35], v[58:59]
  v_sub_f32 v28, v28, v20
  v_sub_f32 v29, v29, v21
  v_sub_f32 v30, v30, v22
  v_sub_f32 v31, v31, v23
  v_sub_f32 v32, v32, v24
  v_sub_f32 v33, v33, v25
  v_sub_f32 v34, v34, v26
  v_sub_f32 v35, v35, v27
  v_fmac_f32 v20, v16, v28
  v_fmac_f32 v21, v16, v29
  v_fmac_f32 v22, v16, v30
  v_fmac_f32 v23, v16, v31
  v_fmac_f32 v24, v16, v32
  v_fmac_f32 v25, v16, v33
  v_fmac_f32 v26, v16, v34
  v_fmac_f32 v27, v16, v35
  v_cvt_pk_bf16_f32 v2, v20, v21
  v_cvt_pk_bf16_f32 v3, v22, v23
  v_cvt_pk_bf16_f32 v4, v24, v25
  v_cvt_pk_bf16_f32 v5, v26, v27
  buffer_store_dwordx4 v[2:5], v10, s[12:15], s18 offen
  s_mov_b32 s46, s48
  v_readfirstlane_b32 s48, v13
  s_add_u32 s48, s48, 1
  s_cmp_eq_u32 s27, 35
  s_cbranch_scc1 .en_seg
  s_cmp_lt_u32 s46, 64
  s_cbranch_scc1 .en_poll
.g_end:
  s_endpgm
.g_run:
  s_barrier
  s_mov_b32 s34, 0
  s_movk_i32 s20, 8192
  s_mov_b32 s21, 65536
  s_mov_b32 s19, 8
  s_mov_b32 s8, s70
  s_mov_b32 s9, s71
  s_mov_b32 s10, 0x800000
  s_cmp_eq_u32 s51, 1
  s_cselect_b32 s8, s72, s8
  s_cselect_b32 s9, s73, s9
  s_cmp_eq_u32 s51, 2
  s_cselect_b32 s8, s68, s8
  s_cselect_b32 s9, s69, s9
  s_cmp_eq_u32 s51, 3
  s_cselect_b32 s8, s80, s8
  s_cselect_b32 s9, s81, s9
  s_cselect_b32 s34, 4194304, s34
  s_cselect_b32 s20, 7168, s20
  s_cselect_b32 s10, 0x700000, s10
  s_cmp_eq_u32 s51, 4
  s_cselect_b32 s8, s84, s8
  s_cselect_b32 s9, s85, s9
  s_cselect_b32 s34, 75497472, s34
  s_cselect_b32 s20, 2048, s20
  s_cselect_b32 s10, 0x700000, s10
  s_cselect_b32 s21, 229376, s21
  s_cselect_b32 s19, 28, s19
  s_lshl_b32 s6, s21, 3
  s_mul_i32 s33, s52, s6
  s_add_u32 s33, s33, s34
  s_add_u32 s4, s94, s33
  s_addc_u32 s5, s95, 0
  s_mov_b32 s6, s6
  s_mov_b32 s7, 0x20000
  s_lshl_b32 s33, s53, 9
  s_add_u32 s8, s8, s33
  s_addc_u32 s9, s9, 0
  s_sub_u32 s10, s10, s33
  s_mov_b32 s11, 0x20000
  s_lshl_b32 s26, s23, 1
  s_mul_i32 s26, s26, s21
  v_lshl_add_u32 v2, v1, 4, s26
  s_sub_u32 s27, s21, 2048
  v_add_u32 v3, s27, v2
  v_lshrrev_b32 v18, 5, v1
  s_lshl_b32 s26, s23, 3
  v_add_u32 v19, s26, v18
  v_mul_lo_u32 v19, v19, s20
  v_and_b32 v20, 31, v1
  s_lshl_b32 s26, s20, 1
  s_sub_u32 s26, s26, 1024
  s_lshl_b32 s18, s20, 5
  s_and_b32 s27, s23, 1
  s_lshl_b32 s27, s27, 1
  v_xor_b32 v20, s27, v20
  v_add_u32 v21, 0, v18
  v_lshlrev_b32 v21, 2, v21
  v_xor_b32 v21, v21, v20
  v_lshl_add_u32 v4, v21, 4, v19
  v_add_u32 v19, s26, v19
  v_add_u32 v21, 2, v18
  v_lshlrev_b32 v21, 2, v21
  v_xor_b32 v21, v21, v20
  v_lshl_add_u32 v5, v21, 4, v19
  v_add_u32 v19, s26, v19
  v_add_u32 v21, 0, v18
  v_lshlrev_b32 v21, 2, v21
  v_xor_b32 v21, v21, v20
  v_lshl_add_u32 v6, v21, 4, v19
  v_add_u32 v19, s26, v19
  v_add_u32 v21, 2, v18
  v_lshlrev_b32 v21, 2, v21
  v_xor_b32 v21, v21, v20
  v_lshl_add_u32 v7, v21, 4, v19
  v_add_u32 v19, s26, v19
  s_mov_b32 s16, 0
  s_mov_b32 s17, 0
  s_add_u32 m0, s24, 0
  s_nop 0
  buffer_load_dwordx4 v2, s[4:7], s16 offen offset:0 lds
  buffer_load_dwordx4 v2, s[4:7], s16 offen offset:1024 lds
  buffer_load_dwordx4 v3, s[4:7], s16 offen offset:2048 lds
  buffer_load_dwordx4 v3, s[4:7], s16 offen offset:3072 lds
  s_add_u32 s16, s16, 2048
  s_add_u32 m0, s25, 0
  s_nop 0
  buffer_load_dwordx4 v4, s[8:11], s17 offen offset:0 lds
  buffer_load_dwordx4 v5, s[8:11], s17 offen offset:1024 lds
  buffer_load_dwordx4 v6, s[8:11], s17 offen offset:2048 lds
  buffer_load_dwordx4 v7, s[8:11], s17 offen offset:3072 lds
  s_add_u32 s17, s17, s18
  s_add_u32 m0, s24, 32768
  s_nop 0
  buffer_load_dwordx4 v2, s[4:7], s16 offen offset:0 lds
  buffer_load_dwordx4 v2, s[4:7], s16 offen offset:1024 lds
  buffer_load_dwordx4 v3, s[4:7], s16 offen offset:2048 lds
  buffer_load_dwordx4 v3, s[4:7], s16 offen offset:3072 lds
  s_add_u32 s16, s16, 2048
  s_add_u32 m0, s25, 32768
  s_nop 0
  buffer_load_dwordx4 v4, s[8:11], s17 offen offset:0 lds
  buffer_load_dwordx4 v5, s[8:11], s17 offen offset:1024 lds
  buffer_load_dwordx4 v6, s[8:11], s17 offen offset:2048 lds
  buffer_load_dwordx4 v7, s[8:11], s17 offen offset:3072 lds
  s_add_u32 s17, s17, s18
  s_add_u32 m0, s24, 65536
  s_nop 0
  buffer_load_dwordx4 v2, s[4:7], s16 offen offset:0 lds
  buffer_load_dwordx4 v2, s[4:7], s16 offen offset:1024 lds
  buffer_load_dwordx4 v3, s[4:7], s16 offen offset:2048 lds
  buffer_load_dwordx4 v3, s[4:7], s16 offen offset:3072 lds
  s_add_u32 s16, s16, 2048
  s_add_u32 m0, s25, 65536
  s_nop 0
  buffer_load_dwordx4 v4, s[8:11], s17 offen offset:0 lds
  buffer_load_dwordx4 v5, s[8:11], s17 offen offset:1024 lds
  buffer_load_dwordx4 v6, s[8:11], s17 offen offset:2048 lds
  buffer_load_dwordx4 v7, s[8:11], s17 offen offset:3072 lds
  s_add_u32 s17, s17, s18
  s_add_u32 m0, s24, 98304
  s_nop 0
  buffer_load_dwordx4 v2, s[4:7], s16 offen offset:0 lds
  buffer_load_dwordx4 v2, s[4:7], s16 offen offset:1024 lds
  buffer_load_dwordx4 v3, s[4:7], s16 offen offset:2048 lds
  buffer_load_dwordx4 v3, s[4:7], s16 offen offset:3072 lds
  s_add_u32 s16, s16, 2048
  s_add_u32 m0, s25, 98304
  s_nop 0
  buffer_load_dwordx4 v4, s[8:11], s17 offen offset:0 lds
  buffer_load_dwordx4 v5, s[8:11], s17 offen offset:1024 lds
  buffer_load_dwordx4 v6, s[8:11], s17 offen offset:2048 lds
  buffer_load_dwordx4 v7, s[8:11], s17 offen offset:3072 lds
  s_add_u32 s17, s17, s18
  s_cmp_eq_u32 s55, 0
  s_cbranch_scc1 .g_go
.g_epi:
  s_lshl2_add_u32 s54, s31, 16
  s_cmp_eq_u32 s3, 2
  s_cbranch_scc1 .g_eq
  s_cmp_eq_u32 s3, 3
  s_cbranch_scc1 .g_eg
  s_cmp_eq_u32 s3, 4
  s_cbranch_scc1 .g_eb
  s_lshr_b32 s26, s23, 1
  s_mul_i32 s26, s26, 1
  s_mul_i32 s26, s26, s22
  s_and_b32 s27, s23, 1
  s_mul_i32 s28, s27, 8192
  s_add_u32 s26, s26, s28
  v_lshlrev_b32 v18, 4, v1
  v_accvgpr_read_b32 v24, a0
  v_accvgpr_read_b32 v25, a1
  v_accvgpr_read_b32 v26, a2
  v_accvgpr_read_b32 v27, a3
  v_accvgpr_read_b32 v28, a4
  v_accvgpr_read_b32 v29, a5
  v_accvgpr_read_b32 v30, a6
  v_accvgpr_read_b32 v31, a7
  v_cvt_pk_bf16_f32 v40, v24, v25
  v_cvt_pk_bf16_f32 v42, v28, v29
  v_cvt_pk_bf16_f32 v41, v26, v27
  v_cvt_pk_bf16_f32 v43, v30, v31
  s_nop 0
  v_permlane16_swap_b32 v40, v42
  v_permlane16_swap_b32 v41, v43
  buffer_store_dwordx4 v[40:43], v18, s[12:15], s26 offen offset:0 sc1
  v_accvgpr_read_b32 v44, a8
  v_accvgpr_read_b32 v45, a9
  v_accvgpr_read_b32 v46, a10
  v_accvgpr_read_b32 v47, a11
  v_accvgpr_read_b32 v48, a12
  v_accvgpr_read_b32 v49, a13
  v_accvgpr_read_b32 v50, a14
  v_accvgpr_read_b32 v51, a15
  v_cvt_pk_bf16_f32 v60, v44, v45
  v_cvt_pk_bf16_f32 v62, v48, v49
  v_cvt_pk_bf16_f32 v61, v46, v47
  v_cvt_pk_bf16_f32 v63, v50, v51
  s_nop 0
  v_permlane16_swap_b32 v60, v62
  v_permlane16_swap_b32 v61, v63
  buffer_store_dwordx4 v[60:63], v18, s[12:15], s26 offen offset:1024 sc1
  v_accvgpr_read_b32 v24, a16
  v_accvgpr_read_b32 v25, a17
  v_accvgpr_read_b32 v26, a18
  v_accvgpr_read_b32 v27, a19
  v_accvgpr_read_b32 v28, a20
  v_accvgpr_read_b32 v29, a21
  v_accvgpr_read_b32 v30, a22
  v_accvgpr_read_b32 v31, a23
  v_cvt_pk_bf16_f32 v40, v24, v25
  v_cvt_pk_bf16_f32 v42, v28, v29
  v_cvt_pk_bf16_f32 v41, v26, v27
  v_cvt_pk_bf16_f32 v43, v30, v31
  s_nop 0
  v_permlane16_swap_b32 v40, v42
  v_permlane16_swap_b32 v41, v43
  buffer_store_dwordx4 v[40:43], v18, s[12:15], s26 offen offset:2048 sc1
  v_accvgpr_read_b32 v44, a24
  v_accvgpr_read_b32 v45, a25
  v_accvgpr_read_b32 v46, a26
  v_accvgpr_read_b32 v47, a27
  v_accvgpr_read_b32 v48, a28
  v_accvgpr_read_b32 v49, a29
  v_accvgpr_read_b32 v50, a30
  v_accvgpr_read_b32 v51, a31
  v_cvt_pk_bf16_f32 v60, v44, v45
  v_cvt_pk_bf16_f32 v62, v48, v49
  v_cvt_pk_bf16_f32 v61, v46, v47
  v_cvt_pk_bf16_f32 v63, v50, v51
  s_nop 0
  v_permlane16_swap_b32 v60, v62
  v_permlane16_swap_b32 v61, v63
  buffer_store_dwordx4 v[60:63], v18, s[12:15], s26 offen offset:3072 sc1
  s_add_u32 s27, s26, 4096
  v_accvgpr_read_b32 v24, a32
  v_accvgpr_read_b32 v25, a33
  v_accvgpr_read_b32 v26, a34
  v_accvgpr_read_b32 v27, a35
  v_accvgpr_read_b32 v28, a36
  v_accvgpr_read_b32 v29, a37
  v_accvgpr_read_b32 v30, a38
  v_accvgpr_read_b32 v31, a39
  v_cvt_pk_bf16_f32 v40, v24, v25
  v_cvt_pk_bf16_f32 v42, v28, v29
  v_cvt_pk_bf16_f32 v41, v26, v27
  v_cvt_pk_bf16_f32 v43, v30, v31
  s_nop 0
  v_permlane16_swap_b32 v40, v42
  v_permlane16_swap_b32 v41, v43
  buffer_store_dwordx4 v[40:43], v18, s[12:15], s27 offen offset:0 sc1
  v_accvgpr_read_b32 v44, a40
  v_accvgpr_read_b32 v45, a41
  v_accvgpr_read_b32 v46, a42
  v_accvgpr_read_b32 v47, a43
  v_accvgpr_read_b32 v48, a44
  v_accvgpr_read_b32 v49, a45
  v_accvgpr_read_b32 v50, a46
  v_accvgpr_read_b32 v51, a47
  v_cvt_pk_bf16_f32 v60, v44, v45
  v_cvt_pk_bf16_f32 v62, v48, v49
  v_cvt_pk_bf16_f32 v61, v46, v47
  v_cvt_pk_bf16_f32 v63, v50, v51
  s_nop 0
  v_permlane16_swap_b32 v60, v62
  v_permlane16_swap_b32 v61, v63
  buffer_store_dwordx4 v[60:63], v18, s[12:15], s27 offen offset:1024 sc1
  v_accvgpr_read_b32 v24, a48
  v_accvgpr_read_b32 v25, a49
  v_accvgpr_read_b32 v26, a50
  v_accvgpr_read_b32 v27, a51
  v_accvgpr_read_b32 v28, a52
  v_accvgpr_read_b32 v29, a53
  v_accvgpr_read_b32 v30, a54
  v_accvgpr_read_b32 v31, a55
  v_cvt_pk_bf16_f32 v40, v24, v25
  v_cvt_pk_bf16_f32 v42, v28, v29
  v_cvt_pk_bf16_f32 v41, v26, v27
  v_cvt_pk_bf16_f32 v43, v30, v31
  s_nop 0
  v_permlane16_swap_b32 v40, v42
  v_permlane16_swap_b32 v41, v43
  buffer_store_dwordx4 v[40:43], v18, s[12:15], s27 offen offset:2048 sc1
  v_accvgpr_read_b32 v44, a56
  v_accvgpr_read_b32 v45, a57
  v_accvgpr_read_b32 v46, a58
  v_accvgpr_read_b32 v47, a59
  v_accvgpr_read_b32 v48, a60
  v_accvgpr_read_b32 v49, a61
  v_accvgpr_read_b32 v50, a62
  v_accvgpr_read_b32 v51, a63
  v_cvt_pk_bf16_f32 v60, v44, v45
  v_cvt_pk_bf16_f32 v62, v48, v49
  v_cvt_pk_bf16_f32 v61, v46, v47
  v_cvt_pk_bf16_f32 v63, v50, v51
  s_nop 0
  v_permlane16_swap_b32 v60, v62
  v_permlane16_swap_b32 v61, v63
  buffer_store_dwordx4 v[60:63], v18, s[12:15], s27 offen offset:3072 sc1
  s_lshl1_add_u32 s26, s22, s26
  v_accvgpr_read_b32 v24, a64
  v_accvgpr_read_b32 v25, a65
  v_accvgpr_read_b32 v26, a66
  v_accvgpr_read_b32 v27, a67
  v_accvgpr_read_b32 v28, a68
  v_accvgpr_read_b32 v29, a69
  v_accvgpr_read_b32 v30, a70
  v_accvgpr_read_b32 v31, a71
  v_cvt_pk_bf16_f32 v40, v24, v25
  v_cvt_pk_bf16_f32 v42, v28, v29
  v_cvt_pk_bf16_f32 v41, v26, v27
  v_cvt_pk_bf16_f32 v43, v30, v31
  s_nop 0
  v_permlane16_swap_b32 v40, v42
  v_permlane16_swap_b32 v41, v43
  buffer_store_dwordx4 v[40:43], v18, s[12:15], s26 offen offset:0 sc1
  v_accvgpr_read_b32 v44, a72
  v_accvgpr_read_b32 v45, a73
  v_accvgpr_read_b32 v46, a74
  v_accvgpr_read_b32 v47, a75
  v_accvgpr_read_b32 v48, a76
  v_accvgpr_read_b32 v49, a77
  v_accvgpr_read_b32 v50, a78
  v_accvgpr_read_b32 v51, a79
  v_cvt_pk_bf16_f32 v60, v44, v45
  v_cvt_pk_bf16_f32 v62, v48, v49
  v_cvt_pk_bf16_f32 v61, v46, v47
  v_cvt_pk_bf16_f32 v63, v50, v51
  s_nop 0
  v_permlane16_swap_b32 v60, v62
  v_permlane16_swap_b32 v61, v63
  buffer_store_dwordx4 v[60:63], v18, s[12:15], s26 offen offset:1024 sc1
  v_accvgpr_read_b32 v24, a80
  v_accvgpr_read_b32 v25, a81
  v_accvgpr_read_b32 v26, a82
  v_accvgpr_read_b32 v27, a83
  v_accvgpr_read_b32 v28, a84
  v_accvgpr_read_b32 v29, a85
  v_accvgpr_read_b32 v30, a86
  v_accvgpr_read_b32 v31, a87
  v_cvt_pk_bf16_f32 v40, v24, v25
  v_cvt_pk_bf16_f32 v42, v28, v29
  v_cvt_pk_bf16_f32 v41, v26, v27
  v_cvt_pk_bf16_f32 v43, v30, v31
  s_nop 0
  v_permlane16_swap_b32 v40, v42
  v_permlane16_swap_b32 v41, v43
  buffer_store_dwordx4 v[40:43], v18, s[12:15], s26 offen offset:2048 sc1
  v_accvgpr_read_b32 v44, a88
  v_accvgpr_read_b32 v45, a89
  v_accvgpr_read_b32 v46, a90
  v_accvgpr_read_b32 v47, a91
  v_accvgpr_read_b32 v48, a92
  v_accvgpr_read_b32 v49, a93
  v_accvgpr_read_b32 v50, a94
  v_accvgpr_read_b32 v51, a95
  v_cvt_pk_bf16_f32 v60, v44, v45
  v_cvt_pk_bf16_f32 v62, v48, v49
  v_cvt_pk_bf16_f32 v61, v46, v47
  v_cvt_pk_bf16_f32 v63, v50, v51
  s_nop 0
  v_permlane16_swap_b32 v60, v62
  v_permlane16_swap_b32 v61, v63
  buffer_store_dwordx4 v[60:63], v18, s[12:15], s26 offen offset:3072 sc1
  s_add_u32 s27, s26, 4096
  v_accvgpr_read_b32 v24, a96
  v_accvgpr_read_b32 v25, a97
  v_accvgpr_read_b32 v26, a98
  v_accvgpr_read_b32 v27, a99
  v_accvgpr_read_b32 v28, a100
  v_accvgpr_read_b32 v29, a101
  v_accvgpr_read_b32 v30, a102
  v_accvgpr_read_b32 v31, a103
  v_cvt_pk_bf16_f32 v40, v24, v25
  v_cvt_pk_bf16_f32 v42, v28, v29
  v_cvt_pk_bf16_f32 v41, v26, v27
  v_cvt_pk_bf16_f32 v43, v30, v31
  s_nop 0
  v_permlane16_swap_b32 v40, v42
  v_permlane16_swap_b32 v41, v43
  buffer_store_dwordx4 v[40:43], v18, s[12:15], s27 offen offset:0 sc1
  v_accvgpr_read_b32 v44, a104
  v_accvgpr_read_b32 v45, a105
  v_accvgpr_read_b32 v46, a106
  v_accvgpr_read_b32 v47, a107
  v_accvgpr_read_b32 v48, a108
  v_accvgpr_read_b32 v49, a109
  v_accvgpr_read_b32 v50, a110
  v_accvgpr_read_b32 v51, a111
  v_cvt_pk_bf16_f32 v60, v44, v45
  v_cvt_pk_bf16_f32 v62, v48, v49
  v_cvt_pk_bf16_f32 v61, v46, v47
  v_cvt_pk_bf16_f32 v63, v50, v51
  s_nop 0
  v_permlane16_swap_b32 v60, v62
  v_permlane16_swap_b32 v61, v63
  buffer_store_dwordx4 v[60:63], v18, s[12:15], s27 offen offset:1024 sc1
  v_accvgpr_read_b32 v24, a112
  v_accvgpr_read_b32 v25, a113
  v_accvgpr_read_b32 v26, a114
  v_accvgpr_read_b32 v27, a115
  v_accvgpr_read_b32 v28, a116
  v_accvgpr_read_b32 v29, a117
  v_accvgpr_read_b32 v30, a118
  v_accvgpr_read_b32 v31, a119
  v_cvt_pk_bf16_f32 v40, v24, v25
  v_cvt_pk_bf16_f32 v42, v28, v29
  v_cvt_pk_bf16_f32 v41, v26, v27
  v_cvt_pk_bf16_f32 v43, v30, v31
  s_nop 0
  v_permlane16_swap_b32 v40, v42
  v_permlane16_swap_b32 v41, v43
  buffer_store_dwordx4 v[40:43], v18, s[12:15], s27 offen offset:2048 sc1
  v_accvgpr_read_b32 v44, a120
  v_accvgpr_read_b32 v45, a121
  v_accvgpr_read_b32 v46, a122
  v_accvgpr_read_b32 v47, a123
  v_accvgpr_read_b32 v48, a124
  v_accvgpr_read_b32 v49, a125
  v_accvgpr_read_b32 v50, a126
  v_accvgpr_read_b32 v51, a127
  v_cvt_pk_bf16_f32 v60, v44, v45
  v_cvt_pk_bf16_f32 v62, v48, v49
  v_cvt_pk_bf16_f32 v61, v46, v47
  v_cvt_pk_bf16_f32 v63, v50, v51
  s_nop 0
  v_permlane16_swap_b32 v60, v62
  v_permlane16_swap_b32 v61, v63
  buffer_store_dwordx4 v[60:63], v18, s[12:15], s27 offen offset:3072 sc1
  s_lshl1_add_u32 s26, s22, s26
  v_accvgpr_read_b32 v24, a128
  v_accvgpr_read_b32 v25, a129
  v_accvgpr_read_b32 v26, a130
  v_accvgpr_read_b32 v27, a131
  v_accvgpr_read_b32 v28, a132
  v_accvgpr_read_b32 v29, a133
  v_accvgpr_read_b32 v30, a134
  v_accvgpr_read_b32 v31, a135
  v_cvt_pk_bf16_f32 v40, v24, v25
  v_cvt_pk_bf16_f32 v42, v28, v29
  v_cvt_pk_bf16_f32 v41, v26, v27
  v_cvt_pk_bf16_f32 v43, v30, v31
  s_nop 0
  v_permlane16_swap_b32 v40, v42
  v_permlane16_swap_b32 v41, v43
  buffer_store_dwordx4 v[40:43], v18, s[12:15], s26 offen offset:0 sc1
  v_accvgpr_read_b32 v44, a136
  v_accvgpr_read_b32 v45, a137
  v_accvgpr_read_b32 v46, a138
  v_accvgpr_read_b32 v47, a139
  v_accvgpr_read_b32 v48, a140
  v_accvgpr_read_b32 v49, a141
  v_accvgpr_read_b32 v50, a142
  v_accvgpr_read_b32 v51, a143
  v_cvt_pk_bf16_f32 v60, v44, v45
  v_cvt_pk_bf16_f32 v62, v48, v49
  v_cvt_pk_bf16_f32 v61, v46, v47
  v_cvt_pk_bf16_f32 v63, v50, v51
  s_nop 0
  v_permlane16_swap_b32 v60, v62
  v_permlane16_swap_b32 v61, v63
  buffer_store_dwordx4 v[60:63], v18, s[12:15], s26 offen offset:1024 sc1
  v_accvgpr_read_b32 v24, a144
  v_accvgpr_read_b32 v25, a145
  v_accvgpr_read_b32 v26, a146
  v_accvgpr_read_b32 v27, a147
  v_accvgpr_read_b32 v28, a148
  v_accvgpr_read_b32 v29, a149
  v_accvgpr_read_b32 v30, a150
  v_accvgpr_read_b32 v31, a151
  v_cvt_pk_bf16_f32 v40, v24, v25
  v_cvt_pk_bf16_f32 v42, v28, v29
  v_cvt_pk_bf16_f32 v41, v26, v27
  v_cvt_pk_bf16_f32 v43, v30, v31
  s_nop 0
  v_permlane16_swap_b32 v40, v42
  v_permlane16_swap_b32 v41, v43
  buffer_store_dwordx4 v[40:43], v18, s[12:15], s26 offen offset:2048 sc1
  v_accvgpr_read_b32 v44, a152
  v_accvgpr_read_b32 v45, a153
  v_accvgpr_read_b32 v46, a154
  v_accvgpr_read_b32 v47, a155
  v_accvgpr_read_b32 v48, a156
  v_accvgpr_read_b32 v49, a157
  v_accvgpr_read_b32 v50, a158
  v_accvgpr_read_b32 v51, a159
  v_cvt_pk_bf16_f32 v60, v44, v45
  v_cvt_pk_bf16_f32 v62, v48, v49
  v_cvt_pk_bf16_f32 v61, v46, v47
  v_cvt_pk_bf16_f32 v63, v50, v51
  s_nop 0
  v_permlane16_swap_b32 v60, v62
  v_permlane16_swap_b32 v61, v63
  buffer_store_dwordx4 v[60:63], v18, s[12:15], s26 offen offset:3072 sc1
  s_add_u32 s27, s26, 4096
  v_accvgpr_read_b32 v24, a160
  v_accvgpr_read_b32 v25, a161
  v_accvgpr_read_b32 v26, a162
  v_accvgpr_read_b32 v27, a163
  v_accvgpr_read_b32 v28, a164
  v_accvgpr_read_b32 v29, a165
  v_accvgpr_read_b32 v30, a166
  v_accvgpr_read_b32 v31, a167
  v_cvt_pk_bf16_f32 v40, v24, v25
  v_cvt_pk_bf16_f32 v42, v28, v29
  v_cvt_pk_bf16_f32 v41, v26, v27
  v_cvt_pk_bf16_f32 v43, v30, v31
  s_nop 0
  v_permlane16_swap_b32 v40, v42
  v_permlane16_swap_b32 v41, v43
  buffer_store_dwordx4 v[40:43], v18, s[12:15], s27 offen offset:0 sc1
  v_accvgpr_read_b32 v44, a168
  v_accvgpr_read_b32 v45, a169
  v_accvgpr_read_b32 v46, a170
  v_accvgpr_read_b32 v47, a171
  v_accvgpr_read_b32 v48, a172
  v_accvgpr_read_b32 v49, a173
  v_accvgpr_read_b32 v50, a174
  v_accvgpr_read_b32 v51, a175
  v_cvt_pk_bf16_f32 v60, v44, v45
  v_cvt_pk_bf16_f32 v62, v48, v49
  v_cvt_pk_bf16_f32 v61, v46, v47
  v_cvt_pk_bf16_f32 v63, v50, v51
  s_nop 0
  v_permlane16_swap_b32 v60, v62
  v_permlane16_swap_b32 v61, v63
  buffer_store_dwordx4 v[60:63], v18, s[12:15], s27 offen offset:1024 sc1
  v_accvgpr_read_b32 v24, a176
  v_accvgpr_read_b32 v25, a177
  v_accvgpr_read_b32 v26, a178
  v_accvgpr_read_b32 v27, a179
  v_accvgpr_read_b32 v28, a180
  v_accvgpr_read_b32 v29, a181
  v_accvgpr_read_b32 v30, a182
  v_accvgpr_read_b32 v31, a183
  v_cvt_pk_bf16_f32 v40, v24, v25
  v_cvt_pk_bf16_f32 v42, v28, v29
  v_cvt_pk_bf16_f32 v41, v26, v27
  v_cvt_pk_bf16_f32 v43, v30, v31
  s_nop 0
  v_permlane16_swap_b32 v40, v42
  v_permlane16_swap_b32 v41, v43
  buffer_store_dwordx4 v[40:43], v18, s[12:15], s27 offen offset:2048 sc1
  v_accvgpr_read_b32 v44, a184
  v_accvgpr_read_b32 v45, a185
  v_accvgpr_read_b32 v46, a186
  v_accvgpr_read_b32 v47, a187
  v_accvgpr_read_b32 v48, a188
  v_accvgpr_read_b32 v49, a189
  v_accvgpr_read_b32 v50, a190
  v_accvgpr_read_b32 v51, a191
  v_cvt_pk_bf16_f32 v60, v44, v45
  v_cvt_pk_bf16_f32 v62, v48, v49
  v_cvt_pk_bf16_f32 v61, v46, v47
  v_cvt_pk_bf16_f32 v63, v50, v51
  s_nop 0
  v_permlane16_swap_b32 v60, v62
  v_permlane16_swap_b32 v61, v63
  buffer_store_dwordx4 v[60:63], v18, s[12:15], s27 offen offset:3072 sc1
  s_lshl1_add_u32 s26, s22, s26
  v_accvgpr_read_b32 v24, a192
  v_accvgpr_read_b32 v25, a193
  v_accvgpr_read_b32 v26, a194
  v_accvgpr_read_b32 v27, a195
  v_accvgpr_read_b32 v28, a196
  v_accvgpr_read_b32 v29, a197
  v_accvgpr_read_b32 v30, a198
  v_accvgpr_read_b32 v31, a199
  v_cvt_pk_bf16_f32 v40, v24, v25
  v_cvt_pk_bf16_f32 v42, v28, v29
  v_cvt_pk_bf16_f32 v41, v26, v27
  v_cvt_pk_bf16_f32 v43, v30, v31
  s_nop 0
  v_permlane16_swap_b32 v40, v42
  v_permlane16_swap_b32 v41, v43
  buffer_store_dwordx4 v[40:43], v18, s[12:15], s26 offen offset:0 sc1
  v_accvgpr_read_b32 v44, a200
  v_accvgpr_read_b32 v45, a201
  v_accvgpr_read_b32 v46, a202
  v_accvgpr_read_b32 v47, a203
  v_accvgpr_read_b32 v48, a204
  v_accvgpr_read_b32 v49, a205
  v_accvgpr_read_b32 v50, a206
  v_accvgpr_read_b32 v51, a207
  v_cvt_pk_bf16_f32 v60, v44, v45
  v_cvt_pk_bf16_f32 v62, v48, v49
  v_cvt_pk_bf16_f32 v61, v46, v47
  v_cvt_pk_bf16_f32 v63, v50, v51
  s_nop 0
  v_permlane16_swap_b32 v60, v62
  v_permlane16_swap_b32 v61, v63
  buffer_store_dwordx4 v[60:63], v18, s[12:15], s26 offen offset:1024 sc1
  v_accvgpr_read_b32 v24, a208
  v_accvgpr_read_b32 v25, a209
  v_accvgpr_read_b32 v26, a210
  v_accvgpr_read_b32 v27, a211
  v_accvgpr_read_b32 v28, a212
  v_accvgpr_read_b32 v29, a213
  v_accvgpr_read_b32 v30, a214
  v_accvgpr_read_b32 v31, a215
  v_cvt_pk_bf16_f32 v40, v24, v25
  v_cvt_pk_bf16_f32 v42, v28, v29
  v_cvt_pk_bf16_f32 v41, v26, v27
  v_cvt_pk_bf16_f32 v43, v30, v31
  s_nop 0
  v_permlane16_swap_b32 v40, v42
  v_permlane16_swap_b32 v41, v43
  buffer_store_dwordx4 v[40:43], v18, s[12:15], s26 offen offset:2048 sc1
  v_accvgpr_read_b32 v44, a216
  v_accvgpr_read_b32 v45, a217
  v_accvgpr_read_b32 v46, a218
  v_accvgpr_read_b32 v47, a219
  v_accvgpr_read_b32 v48, a220
  v_accvgpr_read_b32 v49, a221
  v_accvgpr_read_b32 v50, a222
  v_accvgpr_read_b32 v51, a223
  v_cvt_pk_bf16_f32 v60, v44, v45
  v_cvt_pk_bf16_f32 v62, v48, v49
  v_cvt_pk_bf16_f32 v61, v46, v47
  v_cvt_pk_bf16_f32 v63, v50, v51
  s_nop 0
  v_permlane16_swap_b32 v60, v62
  v_permlane16_swap_b32 v61, v63
  buffer_store_dwordx4 v[60:63], v18, s[12:15], s26 offen offset:3072 sc1
  s_add_u32 s27, s26, 4096
  v_accvgpr_read_b32 v24, a224
  v_accvgpr_read_b32 v25, a225
  v_accvgpr_read_b32 v26, a226
  v_accvgpr_read_b32 v27, a227
  v_accvgpr_read_b32 v28, a228
  v_accvgpr_read_b32 v29, a229
  v_accvgpr_read_b32 v30, a230
  v_accvgpr_read_b32 v31, a231
  v_cvt_pk_bf16_f32 v40, v24, v25
  v_cvt_pk_bf16_f32 v42, v28, v29
  v_cvt_pk_bf16_f32 v41, v26, v27
  v_cvt_pk_bf16_f32 v43, v30, v31
  s_nop 0
  v_permlane16_swap_b32 v40, v42
  v_permlane16_swap_b32 v41, v43
  buffer_store_dwordx4 v[40:43], v18, s[12:15], s27 offen offset:0 sc1
  v_accvgpr_read_b32 v44, a232
  v_accvgpr_read_b32 v45, a233
  v_accvgpr_read_b32 v46, a234
  v_accvgpr_read_b32 v47, a235
  v_accvgpr_read_b32 v48, a236
  v_accvgpr_read_b32 v49, a237
  v_accvgpr_read_b32 v50, a238
  v_accvgpr_read_b32 v51, a239
  v_cvt_pk_bf16_f32 v60, v44, v45
  v_cvt_pk_bf16_f32 v62, v48, v49
  v_cvt_pk_bf16_f32 v61, v46, v47
  v_cvt_pk_bf16_f32 v63, v50, v51
  s_nop 0
  v_permlane16_swap_b32 v60, v62
  v_permlane16_swap_b32 v61, v63
  buffer_store_dwordx4 v[60:63], v18, s[12:15], s27 offen offset:1024 sc1
  v_accvgpr_read_b32 v24, a240
  v_accvgpr_read_b32 v25, a241
  v_accvgpr_read_b32 v26, a242
  v_accvgpr_read_b32 v27, a243
  v_accvgpr_read_b32 v28, a244
  v_accvgpr_read_b32 v29, a245
  v_accvgpr_read_b32 v30, a246
  v_accvgpr_read_b32 v31, a247
  v_cvt_pk_bf16_f32 v40, v24, v25
  v_cvt_pk_bf16_f32 v42, v28, v29
  v_cvt_pk_bf16_f32 v41, v26, v27
  v_cvt_pk_bf16_f32 v43, v30, v31
  s_nop 0
  v_permlane16_swap_b32 v40, v42
  v_permlane16_swap_b32 v41, v43
  buffer_store_dwordx4 v[40:43], v18, s[12:15], s27 offen offset:2048 sc1
  v_accvgpr_read_b32 v44, a248
  v_accvgpr_read_b32 v45, a249
  v_accvgpr_read_b32 v46, a250
  v_accvgpr_read_b32 v47, a251
  v_accvgpr_read_b32 v48, a252
  v_accvgpr_read_b32 v49, a253
  v_accvgpr_read_b32 v50, a254
  v_accvgpr_read_b32 v51, a255
  v_cvt_pk_bf16_f32 v60, v44, v45
  v_cvt_pk_bf16_f32 v62, v48, v49
  v_cvt_pk_bf16_f32 v61, v46, v47
  v_cvt_pk_bf16_f32 v63, v50, v51
  s_nop 0
  v_permlane16_swap_b32 v60, v62
  v_permlane16_swap_b32 v61, v63
  buffer_store_dwordx4 v[60:63], v18, s[12:15], s27 offen offset:3072 sc1
  s_lshl1_add_u32 s26, s22, s26
  s_branch .g_ed
.g_eg:
  s_add_u32 s54, s54, 32
  s_lshr_b32 s26, s23, 1
  s_mul_i32 s26, s26, 1
  s_mul_i32 s26, s26, s22
  s_and_b32 s27, s23, 1
  s_mul_i32 s28, s27, 8192
  s_add_u32 s26, s26, s28
  v_lshlrev_b32 v18, 4, v1
  v_lshrrev_b32 v19, 4, v1
  v_lshlrev_b32 v19, 3, v19
  s_mul_i32 s28, s27, 256
  buffer_load_dwordx2 v[64:65], v19, s[36:39], s28 offen offset:0
  buffer_load_dwordx2 v[66:67], v19, s[36:39], s28 offen offset:32
  buffer_load_dwordx2 v[68:69], v19, s[36:39], s28 offen offset:64
  buffer_load_dwordx2 v[70:71], v19, s[36:39], s28 offen offset:96
  buffer_load_dwordx2 v[72:73], v19, s[36:39], s28 offen offset:128
  buffer_load_dwordx2 v[74:75], v19, s[36:39], s28 offen offset:160
  buffer_load_dwordx2 v[76:77], v19, s[36:39], s28 offen offset:192
  buffer_load_dwordx2 v[78:79], v19, s[36:39], s28 offen offset:224
  s_waitcnt vmcnt(0)
  v_lshlrev_b32 v128, 16, v64
  v_and_b32 v129, 0xffff0000, v64
  v_lshlrev_b32 v130, 16, v65
  v_and_b32 v131, 0xffff0000, v65
  v_lshlrev_b32 v136, 16, v66
  v_and_b32 v137, 0xffff0000, v66
  v_lshlrev_b32 v138, 16, v67
  v_and_b32 v139, 0xffff0000, v67
  v_lshlrev_b32 v144, 16, v68
  v_and_b32 v145, 0xffff0000, v68
  v_lshlrev_b32 v146, 16, v69
  v_and_b32 v147, 0xffff0000, v69
  v_lshlrev_b32 v152, 16, v70
  v_and_b32 v153, 0xffff0000, v70
  v_lshlrev_b32 v154, 16, v71
  v_and_b32 v155, 0xffff0000, v71
  v_lshlrev_b32 v160, 16, v72
  v_and_b32 v161, 0xffff0000, v72
  v_lshlrev_b32 v162, 16, v73
  v_and_b32 v163, 0xffff0000, v73
  v_lshlrev_b32 v168, 16, v74
  v_and_b32 v169, 0xffff0000, v74
  v_lshlrev_b32 v170, 16, v75
  v_and_b32 v171, 0xffff0000, v75
  v_lshlrev_b32 v176, 16, v76
  v_and_b32 v177, 0xffff0000, v76
  v_lshlrev_b32 v178, 16, v77
  v_and_b32 v179, 0xffff0000, v77
  v_lshlrev_b32 v184, 16, v78
  v_and_b32 v185, 0xffff0000, v78
  v_lshlrev_b32 v186, 16, v79
  v_and_b32 v187, 0xffff0000, v79
  s_mov_b32 s40, 3222493025
  s_mov_b32 s41, 3222493025
  s_mov_b32 s42, 3184710632
  s_mov_b32 s43, 3184710632
  v_mov_b32 v20, 3222493025
  v_mov_b32 v21, 3222493025
  v_accvgpr_read_b32 v24, a0
  v_accvgpr_read_b32 v25, a1
  v_accvgpr_read_b32 v26, a2
  v_accvgpr_read_b32 v27, a3
  v_accvgpr_read_b32 v28, a4
  v_accvgpr_read_b32 v29, a5
  v_accvgpr_read_b32 v30, a6
  v_accvgpr_read_b32 v31, a7
  v_pk_add_f32 v[24:25], v[24:25], v[128:129]
  v_pk_add_f32 v[26:27], v[26:27], v[130:131]
  v_pk_add_f32 v[28:29], v[28:29], v[128:129]
  v_pk_add_f32 v[30:31], v[30:31], v[130:131]
  v_pk_mul_f32 v[32:33], v[24:25], v[24:25]
  v_pk_mul_f32 v[34:35], v[26:27], v[26:27]
  v_pk_mul_f32 v[36:37], v[28:29], v[28:29]
  v_pk_mul_f32 v[38:39], v[30:31], v[30:31]
  v_pk_fma_f32 v[32:33], v[32:33], s[42:43], v[20:21]
  v_pk_fma_f32 v[34:35], v[34:35], s[42:43], v[20:21]
  v_pk_fma_f32 v[36:37], v[36:37], s[42:43], v[20:21]
  v_pk_fma_f32 v[38:39], v[38:39], s[42:43], v[20:21]
  v_pk_mul_f32 v[32:33], v[32:33], v[24:25]
  v_pk_mul_f32 v[34:35], v[34:35], v[26:27]
  v_pk_mul_f32 v[36:37], v[36:37], v[28:29]
  v_pk_mul_f32 v[38:39], v[38:39], v[30:31]
  v_exp_f32 v32, v32
  v_exp_f32 v33, v33
  v_exp_f32 v34, v34
  v_exp_f32 v35, v35
  v_exp_f32 v36, v36
  v_exp_f32 v37, v37
  v_exp_f32 v38, v38
  v_exp_f32 v39, v39
  v_pk_add_f32 v[32:33], v[32:33], 1.0 op_sel_hi:[1,0]
  v_pk_add_f32 v[34:35], v[34:35], 1.0 op_sel_hi:[1,0]
  v_pk_add_f32 v[36:37], v[36:37], 1.0 op_sel_hi:[1,0]
  v_pk_add_f32 v[38:39], v[38:39], 1.0 op_sel_hi:[1,0]
  v_rcp_f32 v32, v32
  v_rcp_f32 v33, v33
  v_rcp_f32 v34, v34
  v_rcp_f32 v35, v35
  v_rcp_f32 v36, v36
  v_rcp_f32 v37, v37
  v_rcp_f32 v38, v38
  v_rcp_f32 v39, v39
  v_pk_mul_f32 v[24:25], v[32:33], v[24:25]
  v_pk_mul_f32 v[26:27], v[34:35], v[26:27]
  v_pk_mul_f32 v[28:29], v[36:37], v[28:29]
  v_pk_mul_f32 v[30:31], v[38:39], v[30:31]
  v_cvt_pk_bf16_f32 v40, v24, v25
  v_cvt_pk_bf16_f32 v42, v28, v29
  v_cvt_pk_bf16_f32 v41, v26, v27
  v_cvt_pk_bf16_f32 v43, v30, v31
  s_nop 0
  v_permlane16_swap_b32 v40, v42
  v_permlane16_swap_b32 v41, v43
  buffer_store_dwordx4 v[40:43], v18, s[12:15], s26 offen offset:0 sc1
  v_accvgpr_read_b32 v44, a8
  v_accvgpr_read_b32 v45, a9
  v_accvgpr_read_b32 v46, a10
  v_accvgpr_read_b32 v47, a11
  v_accvgpr_read_b32 v48, a12
  v_accvgpr_read_b32 v49, a13
  v_accvgpr_read_b32 v50, a14
  v_accvgpr_read_b32 v51, a15
  v_pk_add_f32 v[44:45], v[44:45], v[136:137]
  v_pk_add_f32 v[46:47], v[46:47], v[138:139]
  v_pk_add_f32 v[48:49], v[48:49], v[136:137]
  v_pk_add_f32 v[50:51], v[50:51], v[138:139]
  v_pk_mul_f32 v[52:53], v[44:45], v[44:45]
  v_pk_mul_f32 v[54:55], v[46:47], v[46:47]
  v_pk_mul_f32 v[56:57], v[48:49], v[48:49]
  v_pk_mul_f32 v[58:59], v[50:51], v[50:51]
  v_pk_fma_f32 v[52:53], v[52:53], s[42:43], v[20:21]
  v_pk_fma_f32 v[54:55], v[54:55], s[42:43], v[20:21]
  v_pk_fma_f32 v[56:57], v[56:57], s[42:43], v[20:21]
  v_pk_fma_f32 v[58:59], v[58:59], s[42:43], v[20:21]
  v_pk_mul_f32 v[52:53], v[52:53], v[44:45]
  v_pk_mul_f32 v[54:55], v[54:55], v[46:47]
  v_pk_mul_f32 v[56:57], v[56:57], v[48:49]
  v_pk_mul_f32 v[58:59], v[58:59], v[50:51]
  v_exp_f32 v52, v52
  v_exp_f32 v53, v53
  v_exp_f32 v54, v54
  v_exp_f32 v55, v55
  v_exp_f32 v56, v56
  v_exp_f32 v57, v57
  v_exp_f32 v58, v58
  v_exp_f32 v59, v59
  v_pk_add_f32 v[52:53], v[52:53], 1.0 op_sel_hi:[1,0]
  v_pk_add_f32 v[54:55], v[54:55], 1.0 op_sel_hi:[1,0]
  v_pk_add_f32 v[56:57], v[56:57], 1.0 op_sel_hi:[1,0]
  v_pk_add_f32 v[58:59], v[58:59], 1.0 op_sel_hi:[1,0]
  v_rcp_f32 v52, v52
  v_rcp_f32 v53, v53
  v_rcp_f32 v54, v54
  v_rcp_f32 v55, v55
  v_rcp_f32 v56, v56
  v_rcp_f32 v57, v57
  v_rcp_f32 v58, v58
  v_rcp_f32 v59, v59
  v_pk_mul_f32 v[44:45], v[52:53], v[44:45]
  v_pk_mul_f32 v[46:47], v[54:55], v[46:47]
  v_pk_mul_f32 v[48:49], v[56:57], v[48:49]
  v_pk_mul_f32 v[50:51], v[58:59], v[50:51]
  v_cvt_pk_bf16_f32 v60, v44, v45
  v_cvt_pk_bf16_f32 v62, v48, v49
  v_cvt_pk_bf16_f32 v61, v46, v47
  v_cvt_pk_bf16_f32 v63, v50, v51
  s_nop 0
  v_permlane16_swap_b32 v60, v62
  v_permlane16_swap_b32 v61, v63
  buffer_store_dwordx4 v[60:63], v18, s[12:15], s26 offen offset:1024 sc1
  v_accvgpr_read_b32 v24, a16
  v_accvgpr_read_b32 v25, a17
  v_accvgpr_read_b32 v26, a18
  v_accvgpr_read_b32 v27, a19
  v_accvgpr_read_b32 v28, a20
  v_accvgpr_read_b32 v29, a21
  v_accvgpr_read_b32 v30, a22
  v_accvgpr_read_b32 v31, a23
  v_pk_add_f32 v[24:25], v[24:25], v[144:145]
  v_pk_add_f32 v[26:27], v[26:27], v[146:147]
  v_pk_add_f32 v[28:29], v[28:29], v[144:145]
  v_pk_add_f32 v[30:31], v[30:31], v[146:147]
  v_pk_mul_f32 v[32:33], v[24:25], v[24:25]
  v_pk_mul_f32 v[34:35], v[26:27], v[26:27]
  v_pk_mul_f32 v[36:37], v[28:29], v[28:29]
  v_pk_mul_f32 v[38:39], v[30:31], v[30:31]
  v_pk_fma_f32 v[32:33], v[32:33], s[42:43], v[20:21]
  v_pk_fma_f32 v[34:35], v[34:35], s[42:43], v[20:21]
  v_pk_fma_f32 v[36:37], v[36:37], s[42:43], v[20:21]
  v_pk_fma_f32 v[38:39], v[38:39], s[42:43], v[20:21]
  v_pk_mul_f32 v[32:33], v[32:33], v[24:25]
  v_pk_mul_f32 v[34:35], v[34:35], v[26:27]
  v_pk_mul_f32 v[36:37], v[36:37], v[28:29]
  v_pk_mul_f32 v[38:39], v[38:39], v[30:31]
  v_exp_f32 v32, v32
  v_exp_f32 v33, v33
  v_exp_f32 v34, v34
  v_exp_f32 v35, v35
  v_exp_f32 v36, v36
  v_exp_f32 v37, v37
  v_exp_f32 v38, v38
  v_exp_f32 v39, v39
  v_pk_add_f32 v[32:33], v[32:33], 1.0 op_sel_hi:[1,0]
  v_pk_add_f32 v[34:35], v[34:35], 1.0 op_sel_hi:[1,0]
  v_pk_add_f32 v[36:37], v[36:37], 1.0 op_sel_hi:[1,0]
  v_pk_add_f32 v[38:39], v[38:39], 1.0 op_sel_hi:[1,0]
  v_rcp_f32 v32, v32
  v_rcp_f32 v33, v33
  v_rcp_f32 v34, v34
  v_rcp_f32 v35, v35
  v_rcp_f32 v36, v36
  v_rcp_f32 v37, v37
  v_rcp_f32 v38, v38
  v_rcp_f32 v39, v39
  v_pk_mul_f32 v[24:25], v[32:33], v[24:25]
  v_pk_mul_f32 v[26:27], v[34:35], v[26:27]
  v_pk_mul_f32 v[28:29], v[36:37], v[28:29]
  v_pk_mul_f32 v[30:31], v[38:39], v[30:31]
  v_cvt_pk_bf16_f32 v40, v24, v25
  v_cvt_pk_bf16_f32 v42, v28, v29
  v_cvt_pk_bf16_f32 v41, v26, v27
  v_cvt_pk_bf16_f32 v43, v30, v31
  s_nop 0
  v_permlane16_swap_b32 v40, v42
  v_permlane16_swap_b32 v41, v43
  buffer_store_dwordx4 v[40:43], v18, s[12:15], s26 offen offset:2048 sc1
  v_accvgpr_read_b32 v44, a24
  v_accvgpr_read_b32 v45, a25
  v_accvgpr_read_b32 v46, a26
  v_accvgpr_read_b32 v47, a27
  v_accvgpr_read_b32 v48, a28
  v_accvgpr_read_b32 v49, a29
  v_accvgpr_read_b32 v50, a30
  v_accvgpr_read_b32 v51, a31
  v_pk_add_f32 v[44:45], v[44:45], v[152:153]
  v_pk_add_f32 v[46:47], v[46:47], v[154:155]
  v_pk_add_f32 v[48:49], v[48:49], v[152:153]
  v_pk_add_f32 v[50:51], v[50:51], v[154:155]
  v_pk_mul_f32 v[52:53], v[44:45], v[44:45]
  v_pk_mul_f32 v[54:55], v[46:47], v[46:47]
  v_pk_mul_f32 v[56:57], v[48:49], v[48:49]
  v_pk_mul_f32 v[58:59], v[50:51], v[50:51]
  v_pk_fma_f32 v[52:53], v[52:53], s[42:43], v[20:21]
  v_pk_fma_f32 v[54:55], v[54:55], s[42:43], v[20:21]
  v_pk_fma_f32 v[56:57], v[56:57], s[42:43], v[20:21]
  v_pk_fma_f32 v[58:59], v[58:59], s[42:43], v[20:21]
  v_pk_mul_f32 v[52:53], v[52:53], v[44:45]
  v_pk_mul_f32 v[54:55], v[54:55], v[46:47]
  v_pk_mul_f32 v[56:57], v[56:57], v[48:49]
  v_pk_mul_f32 v[58:59], v[58:59], v[50:51]
  v_exp_f32 v52, v52
  v_exp_f32 v53, v53
  v_exp_f32 v54, v54
  v_exp_f32 v55, v55
  v_exp_f32 v56, v56
  v_exp_f32 v57, v57
  v_exp_f32 v58, v58
  v_exp_f32 v59, v59
  v_pk_add_f32 v[52:53], v[52:53], 1.0 op_sel_hi:[1,0]
  v_pk_add_f32 v[54:55], v[54:55], 1.0 op_sel_hi:[1,0]
  v_pk_add_f32 v[56:57], v[56:57], 1.0 op_sel_hi:[1,0]
  v_pk_add_f32 v[58:59], v[58:59], 1.0 op_sel_hi:[1,0]
  v_rcp_f32 v52, v52
  v_rcp_f32 v53, v53
  v_rcp_f32 v54, v54
  v_rcp_f32 v55, v55
  v_rcp_f32 v56, v56
  v_rcp_f32 v57, v57
  v_rcp_f32 v58, v58
  v_rcp_f32 v59, v59
  v_pk_mul_f32 v[44:45], v[52:53], v[44:45]
  v_pk_mul_f32 v[46:47], v[54:55], v[46:47]
  v_pk_mul_f32 v[48:49], v[56:57], v[48:49]
  v_pk_mul_f32 v[50:51], v[58:59], v[50:51]
  v_cvt_pk_bf16_f32 v60, v44, v45
  v_cvt_pk_bf16_f32 v62, v48, v49
  v_cvt_pk_bf16_f32 v61, v46, v47
  v_cvt_pk_bf16_f32 v63, v50, v51
  s_nop 0
  v_permlane16_swap_b32 v60, v62
  v_permlane16_swap_b32 v61, v63
  buffer_store_dwordx4 v[60:63], v18, s[12:15], s26 offen offset:3072 sc1
  s_add_u32 s27, s26, 4096
  v_accvgpr_read_b32 v24, a32
  v_accvgpr_read_b32 v25, a33
  v_accvgpr_read_b32 v26, a34
  v_accvgpr_read_b32 v27, a35
  v_accvgpr_read_b32 v28, a36
  v_accvgpr_read_b32 v29, a37
  v_accvgpr_read_b32 v30, a38
  v_accvgpr_read_b32 v31, a39
  v_pk_add_f32 v[24:25], v[24:25], v[160:161]
  v_pk_add_f32 v[26:27], v[26:27], v[162:163]
  v_pk_add_f32 v[28:29], v[28:29], v[160:161]
  v_pk_add_f32 v[30:31], v[30:31], v[162:163]
  v_pk_mul_f32 v[32:33], v[24:25], v[24:25]
  v_pk_mul_f32 v[34:35], v[26:27], v[26:27]
  v_pk_mul_f32 v[36:37], v[28:29], v[28:29]
  v_pk_mul_f32 v[38:39], v[30:31], v[30:31]
  v_pk_fma_f32 v[32:33], v[32:33], s[42:43], v[20:21]
  v_pk_fma_f32 v[34:35], v[34:35], s[42:43], v[20:21]
  v_pk_fma_f32 v[36:37], v[36:37], s[42:43], v[20:21]
  v_pk_fma_f32 v[38:39], v[38:39], s[42:43], v[20:21]
  v_pk_mul_f32 v[32:33], v[32:33], v[24:25]
  v_pk_mul_f32 v[34:35], v[34:35], v[26:27]
  v_pk_mul_f32 v[36:37], v[36:37], v[28:29]
  v_pk_mul_f32 v[38:39], v[38:39], v[30:31]
  v_exp_f32 v32, v32
  v_exp_f32 v33, v33
  v_exp_f32 v34, v34
  v_exp_f32 v35, v35
  v_exp_f32 v36, v36
  v_exp_f32 v37, v37
  v_exp_f32 v38, v38
  v_exp_f32 v39, v39
  v_pk_add_f32 v[32:33], v[32:33], 1.0 op_sel_hi:[1,0]
  v_pk_add_f32 v[34:35], v[34:35], 1.0 op_sel_hi:[1,0]
  v_pk_add_f32 v[36:37], v[36:37], 1.0 op_sel_hi:[1,0]
  v_pk_add_f32 v[38:39], v[38:39], 1.0 op_sel_hi:[1,0]
  v_rcp_f32 v32, v32
  v_rcp_f32 v33, v33
  v_rcp_f32 v34, v34
  v_rcp_f32 v35, v35
  v_rcp_f32 v36, v36
  v_rcp_f32 v37, v37
  v_rcp_f32 v38, v38
  v_rcp_f32 v39, v39
  v_pk_mul_f32 v[24:25], v[32:33], v[24:25]
  v_pk_mul_f32 v[26:27], v[34:35], v[26:27]
  v_pk_mul_f32 v[28:29], v[36:37], v[28:29]
  v_pk_mul_f32 v[30:31], v[38:39], v[30:31]
  v_cvt_pk_bf16_f32 v40, v24, v25
  v_cvt_pk_bf16_f32 v42, v28, v29
  v_cvt_pk_bf16_f32 v41, v26, v27
  v_cvt_pk_bf16_f32 v43, v30, v31
  s_nop 0
  v_permlane16_swap_b32 v40, v42
  v_permlane16_swap_b32 v41, v43
  buffer_store_dwordx4 v[40:43], v18, s[12:15], s27 offen offset:0 sc1
  v_accvgpr_read_b32 v44, a40
  v_accvgpr_read_b32 v45, a41
  v_accvgpr_read_b32 v46, a42
  v_accvgpr_read_b32 v47, a43
  v_accvgpr_read_b32 v48, a44
  v_accvgpr_read_b32 v49, a45
  v_accvgpr_read_b32 v50, a46
  v_accvgpr_read_b32 v51, a47
  v_pk_add_f32 v[44:45], v[44:45], v[168:169]
  v_pk_add_f32 v[46:47], v[46:47], v[170:171]
  v_pk_add_f32 v[48:49], v[48:49], v[168:169]
  v_pk_add_f32 v[50:51], v[50:51], v[170:171]
  v_pk_mul_f32 v[52:53], v[44:45], v[44:45]
  v_pk_mul_f32 v[54:55], v[46:47], v[46:47]
  v_pk_mul_f32 v[56:57], v[48:49], v[48:49]
  v_pk_mul_f32 v[58:59], v[50:51], v[50:51]
  v_pk_fma_f32 v[52:53], v[52:53], s[42:43], v[20:21]
  v_pk_fma_f32 v[54:55], v[54:55], s[42:43], v[20:21]
  v_pk_fma_f32 v[56:57], v[56:57], s[42:43], v[20:21]
  v_pk_fma_f32 v[58:59], v[58:59], s[42:43], v[20:21]
  v_pk_mul_f32 v[52:53], v[52:53], v[44:45]
  v_pk_mul_f32 v[54:55], v[54:55], v[46:47]
  v_pk_mul_f32 v[56:57], v[56:57], v[48:49]
  v_pk_mul_f32 v[58:59], v[58:59], v[50:51]
  v_exp_f32 v52, v52
  v_exp_f32 v53, v53
  v_exp_f32 v54, v54
  v_exp_f32 v55, v55
  v_exp_f32 v56, v56
  v_exp_f32 v57, v57
  v_exp_f32 v58, v58
  v_exp_f32 v59, v59
  v_pk_add_f32 v[52:53], v[52:53], 1.0 op_sel_hi:[1,0]
  v_pk_add_f32 v[54:55], v[54:55], 1.0 op_sel_hi:[1,0]
  v_pk_add_f32 v[56:57], v[56:57], 1.0 op_sel_hi:[1,0]
  v_pk_add_f32 v[58:59], v[58:59], 1.0 op_sel_hi:[1,0]
  v_rcp_f32 v52, v52
  v_rcp_f32 v53, v53
  v_rcp_f32 v54, v54
  v_rcp_f32 v55, v55
  v_rcp_f32 v56, v56
  v_rcp_f32 v57, v57
  v_rcp_f32 v58, v58
  v_rcp_f32 v59, v59
  v_pk_mul_f32 v[44:45], v[52:53], v[44:45]
  v_pk_mul_f32 v[46:47], v[54:55], v[46:47]
  v_pk_mul_f32 v[48:49], v[56:57], v[48:49]
  v_pk_mul_f32 v[50:51], v[58:59], v[50:51]
  v_cvt_pk_bf16_f32 v60, v44, v45
  v_cvt_pk_bf16_f32 v62, v48, v49
  v_cvt_pk_bf16_f32 v61, v46, v47
  v_cvt_pk_bf16_f32 v63, v50, v51
  s_nop 0
  v_permlane16_swap_b32 v60, v62
  v_permlane16_swap_b32 v61, v63
  buffer_store_dwordx4 v[60:63], v18, s[12:15], s27 offen offset:1024 sc1
  v_accvgpr_read_b32 v24, a48
  v_accvgpr_read_b32 v25, a49
  v_accvgpr_read_b32 v26, a50
  v_accvgpr_read_b32 v27, a51
  v_accvgpr_read_b32 v28, a52
  v_accvgpr_read_b32 v29, a53
  v_accvgpr_read_b32 v30, a54
  v_accvgpr_read_b32 v31, a55
  v_pk_add_f32 v[24:25], v[24:25], v[176:177]
  v_pk_add_f32 v[26:27], v[26:27], v[178:179]
  v_pk_add_f32 v[28:29], v[28:29], v[176:177]
  v_pk_add_f32 v[30:31], v[30:31], v[178:179]
  v_pk_mul_f32 v[32:33], v[24:25], v[24:25]
  v_pk_mul_f32 v[34:35], v[26:27], v[26:27]
  v_pk_mul_f32 v[36:37], v[28:29], v[28:29]
  v_pk_mul_f32 v[38:39], v[30:31], v[30:31]
  v_pk_fma_f32 v[32:33], v[32:33], s[42:43], v[20:21]
  v_pk_fma_f32 v[34:35], v[34:35], s[42:43], v[20:21]
  v_pk_fma_f32 v[36:37], v[36:37], s[42:43], v[20:21]
  v_pk_fma_f32 v[38:39], v[38:39], s[42:43], v[20:21]
  v_pk_mul_f32 v[32:33], v[32:33], v[24:25]
  v_pk_mul_f32 v[34:35], v[34:35], v[26:27]
  v_pk_mul_f32 v[36:37], v[36:37], v[28:29]
  v_pk_mul_f32 v[38:39], v[38:39], v[30:31]
  v_exp_f32 v32, v32
  v_exp_f32 v33, v33
  v_exp_f32 v34, v34
  v_exp_f32 v35, v35
  v_exp_f32 v36, v36
  v_exp_f32 v37, v37
  v_exp_f32 v38, v38
  v_exp_f32 v39, v39
  v_pk_add_f32 v[32:33], v[32:33], 1.0 op_sel_hi:[1,0]
  v_pk_add_f32 v[34:35], v[34:35], 1.0 op_sel_hi:[1,0]
  v_pk_add_f32 v[36:37], v[36:37], 1.0 op_sel_hi:[1,0]
  v_pk_add_f32 v[38:39], v[38:39], 1.0 op_sel_hi:[1,0]
  v_rcp_f32 v32, v32
  v_rcp_f32 v33, v33
  v_rcp_f32 v34, v34
  v_rcp_f32 v35, v35
  v_rcp_f32 v36, v36
  v_rcp_f32 v37, v37
  v_rcp_f32 v38, v38
  v_rcp_f32 v39, v39
  v_pk_mul_f32 v[24:25], v[32:33], v[24:25]
  v_pk_mul_f32 v[26:27], v[34:35], v[26:27]
  v_pk_mul_f32 v[28:29], v[36:37], v[28:29]
  v_pk_mul_f32 v[30:31], v[38:39], v[30:31]
  v_cvt_pk_bf16_f32 v40, v24, v25
  v_cvt_pk_bf16_f32 v42, v28, v29
  v_cvt_pk_bf16_f32 v41, v26, v27
  v_cvt_pk_bf16_f32 v43, v30, v31
  s_nop 0
  v_permlane16_swap_b32 v40, v42
  v_permlane16_swap_b32 v41, v43
  buffer_store_dwordx4 v[40:43], v18, s[12:15], s27 offen offset:2048 sc1
  v_accvgpr_read_b32 v44, a56
  v_accvgpr_read_b32 v45, a57
  v_accvgpr_read_b32 v46, a58
  v_accvgpr_read_b32 v47, a59
  v_accvgpr_read_b32 v48, a60
  v_accvgpr_read_b32 v49, a61
  v_accvgpr_read_b32 v50, a62
  v_accvgpr_read_b32 v51, a63
  v_pk_add_f32 v[44:45], v[44:45], v[184:185]
  v_pk_add_f32 v[46:47], v[46:47], v[186:187]
  v_pk_add_f32 v[48:49], v[48:49], v[184:185]
  v_pk_add_f32 v[50:51], v[50:51], v[186:187]
  v_pk_mul_f32 v[52:53], v[44:45], v[44:45]
  v_pk_mul_f32 v[54:55], v[46:47], v[46:47]
  v_pk_mul_f32 v[56:57], v[48:49], v[48:49]
  v_pk_mul_f32 v[58:59], v[50:51], v[50:51]
  v_pk_fma_f32 v[52:53], v[52:53], s[42:43], v[20:21]
  v_pk_fma_f32 v[54:55], v[54:55], s[42:43], v[20:21]
  v_pk_fma_f32 v[56:57], v[56:57], s[42:43], v[20:21]
  v_pk_fma_f32 v[58:59], v[58:59], s[42:43], v[20:21]
  v_pk_mul_f32 v[52:53], v[52:53], v[44:45]
  v_pk_mul_f32 v[54:55], v[54:55], v[46:47]
  v_pk_mul_f32 v[56:57], v[56:57], v[48:49]
  v_pk_mul_f32 v[58:59], v[58:59], v[50:51]
  v_exp_f32 v52, v52
  v_exp_f32 v53, v53
  v_exp_f32 v54, v54
  v_exp_f32 v55, v55
  v_exp_f32 v56, v56
  v_exp_f32 v57, v57
  v_exp_f32 v58, v58
  v_exp_f32 v59, v59
  v_pk_add_f32 v[52:53], v[52:53], 1.0 op_sel_hi:[1,0]
  v_pk_add_f32 v[54:55], v[54:55], 1.0 op_sel_hi:[1,0]
  v_pk_add_f32 v[56:57], v[56:57], 1.0 op_sel_hi:[1,0]
  v_pk_add_f32 v[58:59], v[58:59], 1.0 op_sel_hi:[1,0]
  v_rcp_f32 v52, v52
  v_rcp_f32 v53, v53
  v_rcp_f32 v54, v54
  v_rcp_f32 v55, v55
  v_rcp_f32 v56, v56
  v_rcp_f32 v57, v57
  v_rcp_f32 v58, v58
  v_rcp_f32 v59, v59
  v_pk_mul_f32 v[44:45], v[52:53], v[44:45]
  v_pk_mul_f32 v[46:47], v[54:55], v[46:47]
  v_pk_mul_f32 v[48:49], v[56:57], v[48:49]
  v_pk_mul_f32 v[50:51], v[58:59], v[50:51]
  v_cvt_pk_bf16_f32 v60, v44, v45
  v_cvt_pk_bf16_f32 v62, v48, v49
  v_cvt_pk_bf16_f32 v61, v46, v47
  v_cvt_pk_bf16_f32 v63, v50, v51
  s_nop 0
  v_permlane16_swap_b32 v60, v62
  v_permlane16_swap_b32 v61, v63
  buffer_store_dwordx4 v[60:63], v18, s[12:15], s27 offen offset:3072 sc1
  s_lshl1_add_u32 s26, s22, s26
  v_accvgpr_read_b32 v24, a64
  v_accvgpr_read_b32 v25, a65
  v_accvgpr_read_b32 v26, a66
  v_accvgpr_read_b32 v27, a67
  v_accvgpr_read_b32 v28, a68
  v_accvgpr_read_b32 v29, a69
  v_accvgpr_read_b32 v30, a70
  v_accvgpr_read_b32 v31, a71
  v_pk_add_f32 v[24:25], v[24:25], v[128:129]
  v_pk_add_f32 v[26:27], v[26:27], v[130:131]
  v_pk_add_f32 v[28:29], v[28:29], v[128:129]
  v_pk_add_f32 v[30:31], v[30:31], v[130:131]
  v_pk_mul_f32 v[32:33], v[24:25], v[24:25]
  v_pk_mul_f32 v[34:35], v[26:27], v[26:27]
  v_pk_mul_f32 v[36:37], v[28:29], v[28:29]
  v_pk_mul_f32 v[38:39], v[30:31], v[30:31]
  v_pk_fma_f32 v[32:33], v[32:33], s[42:43], v[20:21]
  v_pk_fma_f32 v[34:35], v[34:35], s[42:43], v[20:21]
  v_pk_fma_f32 v[36:37], v[36:37], s[42:43], v[20:21]
  v_pk_fma_f32 v[38:39], v[38:39], s[42:43], v[20:21]
  v_pk_mul_f32 v[32:33], v[32:33], v[24:25]
  v_pk_mul_f32 v[34:35], v[34:35], v[26:27]
  v_pk_mul_f32 v[36:37], v[36:37], v[28:29]
  v_pk_mul_f32 v[38:39], v[38:39], v[30:31]
  v_exp_f32 v32, v32
  v_exp_f32 v33, v33
  v_exp_f32 v34, v34
  v_exp_f32 v35, v35
  v_exp_f32 v36, v36
  v_exp_f32 v37, v37
  v_exp_f32 v38, v38
  v_exp_f32 v39, v39
  v_pk_add_f32 v[32:33], v[32:33], 1.0 op_sel_hi:[1,0]
  v_pk_add_f32 v[34:35], v[34:35], 1.0 op_sel_hi:[1,0]
  v_pk_add_f32 v[36:37], v[36:37], 1.0 op_sel_hi:[1,0]
  v_pk_add_f32 v[38:39], v[38:39], 1.0 op_sel_hi:[1,0]
  v_rcp_f32 v32, v32
  v_rcp_f32 v33, v33
  v_rcp_f32 v34, v34
  v_rcp_f32 v35, v35
  v_rcp_f32 v36, v36
  v_rcp_f32 v37, v37
  v_rcp_f32 v38, v38
  v_rcp_f32 v39, v39
  v_pk_mul_f32 v[24:25], v[32:33], v[24:25]
  v_pk_mul_f32 v[26:27], v[34:35], v[26:27]
  v_pk_mul_f32 v[28:29], v[36:37], v[28:29]
  v_pk_mul_f32 v[30:31], v[38:39], v[30:31]
  v_cvt_pk_bf16_f32 v40, v24, v25
  v_cvt_pk_bf16_f32 v42, v28, v29
  v_cvt_pk_bf16_f32 v41, v26, v27
  v_cvt_pk_bf16_f32 v43, v30, v31
  s_nop 0
  v_permlane16_swap_b32 v40, v42
  v_permlane16_swap_b32 v41, v43
  buffer_store_dwordx4 v[40:43], v18, s[12:15], s26 offen offset:0 sc1
  v_accvgpr_read_b32 v44, a72
  v_accvgpr_read_b32 v45, a73
  v_accvgpr_read_b32 v46, a74
  v_accvgpr_read_b32 v47, a75
  v_accvgpr_read_b32 v48, a76
  v_accvgpr_read_b32 v49, a77
  v_accvgpr_read_b32 v50, a78
  v_accvgpr_read_b32 v51, a79
  v_pk_add_f32 v[44:45], v[44:45], v[136:137]
  v_pk_add_f32 v[46:47], v[46:47], v[138:139]
  v_pk_add_f32 v[48:49], v[48:49], v[136:137]
  v_pk_add_f32 v[50:51], v[50:51], v[138:139]
  v_pk_mul_f32 v[52:53], v[44:45], v[44:45]
  v_pk_mul_f32 v[54:55], v[46:47], v[46:47]
  v_pk_mul_f32 v[56:57], v[48:49], v[48:49]
  v_pk_mul_f32 v[58:59], v[50:51], v[50:51]
  v_pk_fma_f32 v[52:53], v[52:53], s[42:43], v[20:21]
  v_pk_fma_f32 v[54:55], v[54:55], s[42:43], v[20:21]
  v_pk_fma_f32 v[56:57], v[56:57], s[42:43], v[20:21]
  v_pk_fma_f32 v[58:59], v[58:59], s[42:43], v[20:21]
  v_pk_mul_f32 v[52:53], v[52:53], v[44:45]
  v_pk_mul_f32 v[54:55], v[54:55], v[46:47]
  v_pk_mul_f32 v[56:57], v[56:57], v[48:49]
  v_pk_mul_f32 v[58:59], v[58:59], v[50:51]
  v_exp_f32 v52, v52
  v_exp_f32 v53, v53
  v_exp_f32 v54, v54
  v_exp_f32 v55, v55
  v_exp_f32 v56, v56
  v_exp_f32 v57, v57
  v_exp_f32 v58, v58
  v_exp_f32 v59, v59
  v_pk_add_f32 v[52:53], v[52:53], 1.0 op_sel_hi:[1,0]
  v_pk_add_f32 v[54:55], v[54:55], 1.0 op_sel_hi:[1,0]
  v_pk_add_f32 v[56:57], v[56:57], 1.0 op_sel_hi:[1,0]
  v_pk_add_f32 v[58:59], v[58:59], 1.0 op_sel_hi:[1,0]
  v_rcp_f32 v52, v52
  v_rcp_f32 v53, v53
  v_rcp_f32 v54, v54
  v_rcp_f32 v55, v55
  v_rcp_f32 v56, v56
  v_rcp_f32 v57, v57
  v_rcp_f32 v58, v58
  v_rcp_f32 v59, v59
  v_pk_mul_f32 v[44:45], v[52:53], v[44:45]
  v_pk_mul_f32 v[46:47], v[54:55], v[46:47]
  v_pk_mul_f32 v[48:49], v[56:57], v[48:49]
  v_pk_mul_f32 v[50:51], v[58:59], v[50:51]
  v_cvt_pk_bf16_f32 v60, v44, v45
  v_cvt_pk_bf16_f32 v62, v48, v49
  v_cvt_pk_bf16_f32 v61, v46, v47
  v_cvt_pk_bf16_f32 v63, v50, v51
  s_nop 0
  v_permlane16_swap_b32 v60, v62
  v_permlane16_swap_b32 v61, v63
  buffer_store_dwordx4 v[60:63], v18, s[12:15], s26 offen offset:1024 sc1
  v_accvgpr_read_b32 v24, a80
  v_accvgpr_read_b32 v25, a81
  v_accvgpr_read_b32 v26, a82
  v_accvgpr_read_b32 v27, a83
  v_accvgpr_read_b32 v28, a84
  v_accvgpr_read_b32 v29, a85
  v_accvgpr_read_b32 v30, a86
  v_accvgpr_read_b32 v31, a87
  v_pk_add_f32 v[24:25], v[24:25], v[144:145]
  v_pk_add_f32 v[26:27], v[26:27], v[146:147]
  v_pk_add_f32 v[28:29], v[28:29], v[144:145]
  v_pk_add_f32 v[30:31], v[30:31], v[146:147]
  v_pk_mul_f32 v[32:33], v[24:25], v[24:25]
  v_pk_mul_f32 v[34:35], v[26:27], v[26:27]
  v_pk_mul_f32 v[36:37], v[28:29], v[28:29]
  v_pk_mul_f32 v[38:39], v[30:31], v[30:31]
  v_pk_fma_f32 v[32:33], v[32:33], s[42:43], v[20:21]
  v_pk_fma_f32 v[34:35], v[34:35], s[42:43], v[20:21]
  v_pk_fma_f32 v[36:37], v[36:37], s[42:43], v[20:21]
  v_pk_fma_f32 v[38:39], v[38:39], s[42:43], v[20:21]
  v_pk_mul_f32 v[32:33], v[32:33], v[24:25]
  v_pk_mul_f32 v[34:35], v[34:35], v[26:27]
  v_pk_mul_f32 v[36:37], v[36:37], v[28:29]
  v_pk_mul_f32 v[38:39], v[38:39], v[30:31]
  v_exp_f32 v32, v32
  v_exp_f32 v33, v33
  v_exp_f32 v34, v34
  v_exp_f32 v35, v35
  v_exp_f32 v36, v36
  v_exp_f32 v37, v37
  v_exp_f32 v38, v38
  v_exp_f32 v39, v39
  v_pk_add_f32 v[32:33], v[32:33], 1.0 op_sel_hi:[1,0]
  v_pk_add_f32 v[34:35], v[34:35], 1.0 op_sel_hi:[1,0]
  v_pk_add_f32 v[36:37], v[36:37], 1.0 op_sel_hi:[1,0]
  v_pk_add_f32 v[38:39], v[38:39], 1.0 op_sel_hi:[1,0]
  v_rcp_f32 v32, v32
  v_rcp_f32 v33, v33
  v_rcp_f32 v34, v34
  v_rcp_f32 v35, v35
  v_rcp_f32 v36, v36
  v_rcp_f32 v37, v37
  v_rcp_f32 v38, v38
  v_rcp_f32 v39, v39
  v_pk_mul_f32 v[24:25], v[32:33], v[24:25]
  v_pk_mul_f32 v[26:27], v[34:35], v[26:27]
  v_pk_mul_f32 v[28:29], v[36:37], v[28:29]
  v_pk_mul_f32 v[30:31], v[38:39], v[30:31]
  v_cvt_pk_bf16_f32 v40, v24, v25
  v_cvt_pk_bf16_f32 v42, v28, v29
  v_cvt_pk_bf16_f32 v41, v26, v27
  v_cvt_pk_bf16_f32 v43, v30, v31
  s_nop 0
  v_permlane16_swap_b32 v40, v42
  v_permlane16_swap_b32 v41, v43
  buffer_store_dwordx4 v[40:43], v18, s[12:15], s26 offen offset:2048 sc1
  v_accvgpr_read_b32 v44, a88
  v_accvgpr_read_b32 v45, a89
  v_accvgpr_read_b32 v46, a90
  v_accvgpr_read_b32 v47, a91
  v_accvgpr_read_b32 v48, a92
  v_accvgpr_read_b32 v49, a93
  v_accvgpr_read_b32 v50, a94
  v_accvgpr_read_b32 v51, a95
  v_pk_add_f32 v[44:45], v[44:45], v[152:153]
  v_pk_add_f32 v[46:47], v[46:47], v[154:155]
  v_pk_add_f32 v[48:49], v[48:49], v[152:153]
  v_pk_add_f32 v[50:51], v[50:51], v[154:155]
  v_pk_mul_f32 v[52:53], v[44:45], v[44:45]
  v_pk_mul_f32 v[54:55], v[46:47], v[46:47]
  v_pk_mul_f32 v[56:57], v[48:49], v[48:49]
  v_pk_mul_f32 v[58:59], v[50:51], v[50:51]
  v_pk_fma_f32 v[52:53], v[52:53], s[42:43], v[20:21]
  v_pk_fma_f32 v[54:55], v[54:55], s[42:43], v[20:21]
  v_pk_fma_f32 v[56:57], v[56:57], s[42:43], v[20:21]
  v_pk_fma_f32 v[58:59], v[58:59], s[42:43], v[20:21]
  v_pk_mul_f32 v[52:53], v[52:53], v[44:45]
  v_pk_mul_f32 v[54:55], v[54:55], v[46:47]
  v_pk_mul_f32 v[56:57], v[56:57], v[48:49]
  v_pk_mul_f32 v[58:59], v[58:59], v[50:51]
  v_exp_f32 v52, v52
  v_exp_f32 v53, v53
  v_exp_f32 v54, v54
  v_exp_f32 v55, v55
  v_exp_f32 v56, v56
  v_exp_f32 v57, v57
  v_exp_f32 v58, v58
  v_exp_f32 v59, v59
  v_pk_add_f32 v[52:53], v[52:53], 1.0 op_sel_hi:[1,0]
  v_pk_add_f32 v[54:55], v[54:55], 1.0 op_sel_hi:[1,0]
  v_pk_add_f32 v[56:57], v[56:57], 1.0 op_sel_hi:[1,0]
  v_pk_add_f32 v[58:59], v[58:59], 1.0 op_sel_hi:[1,0]
  v_rcp_f32 v52, v52
  v_rcp_f32 v53, v53
  v_rcp_f32 v54, v54
  v_rcp_f32 v55, v55
  v_rcp_f32 v56, v56
  v_rcp_f32 v57, v57
  v_rcp_f32 v58, v58
  v_rcp_f32 v59, v59
  v_pk_mul_f32 v[44:45], v[52:53], v[44:45]
  v_pk_mul_f32 v[46:47], v[54:55], v[46:47]
  v_pk_mul_f32 v[48:49], v[56:57], v[48:49]
  v_pk_mul_f32 v[50:51], v[58:59], v[50:51]
  v_cvt_pk_bf16_f32 v60, v44, v45
  v_cvt_pk_bf16_f32 v62, v48, v49
  v_cvt_pk_bf16_f32 v61, v46, v47
  v_cvt_pk_bf16_f32 v63, v50, v51
  s_nop 0
  v_permlane16_swap_b32 v60, v62
  v_permlane16_swap_b32 v61, v63
  buffer_store_dwordx4 v[60:63], v18, s[12:15], s26 offen offset:3072 sc1
  s_add_u32 s27, s26, 4096
  v_accvgpr_read_b32 v24, a96
  v_accvgpr_read_b32 v25, a97
  v_accvgpr_read_b32 v26, a98
  v_accvgpr_read_b32 v27, a99
  v_accvgpr_read_b32 v28, a100
  v_accvgpr_read_b32 v29, a101
  v_accvgpr_read_b32 v30, a102
  v_accvgpr_read_b32 v31, a103
  v_pk_add_f32 v[24:25], v[24:25], v[160:161]
  v_pk_add_f32 v[26:27], v[26:27], v[162:163]
  v_pk_add_f32 v[28:29], v[28:29], v[160:161]
  v_pk_add_f32 v[30:31], v[30:31], v[162:163]
  v_pk_mul_f32 v[32:33], v[24:25], v[24:25]
  v_pk_mul_f32 v[34:35], v[26:27], v[26:27]
  v_pk_mul_f32 v[36:37], v[28:29], v[28:29]
  v_pk_mul_f32 v[38:39], v[30:31], v[30:31]
  v_pk_fma_f32 v[32:33], v[32:33], s[42:43], v[20:21]
  v_pk_fma_f32 v[34:35], v[34:35], s[42:43], v[20:21]
  v_pk_fma_f32 v[36:37], v[36:37], s[42:43], v[20:21]
  v_pk_fma_f32 v[38:39], v[38:39], s[42:43], v[20:21]
  v_pk_mul_f32 v[32:33], v[32:33], v[24:25]
  v_pk_mul_f32 v[34:35], v[34:35], v[26:27]
  v_pk_mul_f32 v[36:37], v[36:37], v[28:29]
  v_pk_mul_f32 v[38:39], v[38:39], v[30:31]
  v_exp_f32 v32, v32
  v_exp_f32 v33, v33
  v_exp_f32 v34, v34
  v_exp_f32 v35, v35
  v_exp_f32 v36, v36
  v_exp_f32 v37, v37
  v_exp_f32 v38, v38
  v_exp_f32 v39, v39
  v_pk_add_f32 v[32:33], v[32:33], 1.0 op_sel_hi:[1,0]
  v_pk_add_f32 v[34:35], v[34:35], 1.0 op_sel_hi:[1,0]
  v_pk_add_f32 v[36:37], v[36:37], 1.0 op_sel_hi:[1,0]
  v_pk_add_f32 v[38:39], v[38:39], 1.0 op_sel_hi:[1,0]
  v_rcp_f32 v32, v32
  v_rcp_f32 v33, v33
  v_rcp_f32 v34, v34
  v_rcp_f32 v35, v35
  v_rcp_f32 v36, v36
  v_rcp_f32 v37, v37
  v_rcp_f32 v38, v38
  v_rcp_f32 v39, v39
  v_pk_mul_f32 v[24:25], v[32:33], v[24:25]
  v_pk_mul_f32 v[26:27], v[34:35], v[26:27]
  v_pk_mul_f32 v[28:29], v[36:37], v[28:29]
  v_pk_mul_f32 v[30:31], v[38:39], v[30:31]
  v_cvt_pk_bf16_f32 v40, v24, v25
  v_cvt_pk_bf16_f32 v42, v28, v29
  v_cvt_pk_bf16_f32 v41, v26, v27
  v_cvt_pk_bf16_f32 v43, v30, v31
  s_nop 0
  v_permlane16_swap_b32 v40, v42
  v_permlane16_swap_b32 v41, v43
  buffer_store_dwordx4 v[40:43], v18, s[12:15], s27 offen offset:0 sc1
  v_accvgpr_read_b32 v44, a104
  v_accvgpr_read_b32 v45, a105
  v_accvgpr_read_b32 v46, a106
  v_accvgpr_read_b32 v47, a107
  v_accvgpr_read_b32 v48, a108
  v_accvgpr_read_b32 v49, a109
  v_accvgpr_read_b32 v50, a110
  v_accvgpr_read_b32 v51, a111
  v_pk_add_f32 v[44:45], v[44:45], v[168:169]
  v_pk_add_f32 v[46:47], v[46:47], v[170:171]
  v_pk_add_f32 v[48:49], v[48:49], v[168:169]
  v_pk_add_f32 v[50:51], v[50:51], v[170:171]
  v_pk_mul_f32 v[52:53], v[44:45], v[44:45]
  v_pk_mul_f32 v[54:55], v[46:47], v[46:47]
  v_pk_mul_f32 v[56:57], v[48:49], v[48:49]
  v_pk_mul_f32 v[58:59], v[50:51], v[50:51]
  v_pk_fma_f32 v[52:53], v[52:53], s[42:43], v[20:21]
  v_pk_fma_f32 v[54:55], v[54:55], s[42:43], v[20:21]
  v_pk_fma_f32 v[56:57], v[56:57], s[42:43], v[20:21]
  v_pk_fma_f32 v[58:59], v[58:59], s[42:43], v[20:21]
  v_pk_mul_f32 v[52:53], v[52:53], v[44:45]
  v_pk_mul_f32 v[54:55], v[54:55], v[46:47]
  v_pk_mul_f32 v[56:57], v[56:57], v[48:49]
  v_pk_mul_f32 v[58:59], v[58:59], v[50:51]
  v_exp_f32 v52, v52
  v_exp_f32 v53, v53
  v_exp_f32 v54, v54
  v_exp_f32 v55, v55
  v_exp_f32 v56, v56
  v_exp_f32 v57, v57
  v_exp_f32 v58, v58
  v_exp_f32 v59, v59
  v_pk_add_f32 v[52:53], v[52:53], 1.0 op_sel_hi:[1,0]
  v_pk_add_f32 v[54:55], v[54:55], 1.0 op_sel_hi:[1,0]
  v_pk_add_f32 v[56:57], v[56:57], 1.0 op_sel_hi:[1,0]
  v_pk_add_f32 v[58:59], v[58:59], 1.0 op_sel_hi:[1,0]
  v_rcp_f32 v52, v52
  v_rcp_f32 v53, v53
  v_rcp_f32 v54, v54
  v_rcp_f32 v55, v55
  v_rcp_f32 v56, v56
  v_rcp_f32 v57, v57
  v_rcp_f32 v58, v58
  v_rcp_f32 v59, v59
  v_pk_mul_f32 v[44:45], v[52:53], v[44:45]
  v_pk_mul_f32 v[46:47], v[54:55], v[46:47]
  v_pk_mul_f32 v[48:49], v[56:57], v[48:49]
  v_pk_mul_f32 v[50:51], v[58:59], v[50:51]
  v_cvt_pk_bf16_f32 v60, v44, v45
  v_cvt_pk_bf16_f32 v62, v48, v49
  v_cvt_pk_bf16_f32 v61, v46, v47
  v_cvt_pk_bf16_f32 v63, v50, v51
  s_nop 0
  v_permlane16_swap_b32 v60, v62
  v_permlane16_swap_b32 v61, v63
  buffer_store_dwordx4 v[60:63], v18, s[12:15], s27 offen offset:1024 sc1
  v_accvgpr_read_b32 v24, a112
  v_accvgpr_read_b32 v25, a113
  v_accvgpr_read_b32 v26, a114
  v_accvgpr_read_b32 v27, a115
  v_accvgpr_read_b32 v28, a116
  v_accvgpr_read_b32 v29, a117
  v_accvgpr_read_b32 v30, a118
  v_accvgpr_read_b32 v31, a119
  v_pk_add_f32 v[24:25], v[24:25], v[176:177]
  v_pk_add_f32 v[26:27], v[26:27], v[178:179]
  v_pk_add_f32 v[28:29], v[28:29], v[176:177]
  v_pk_add_f32 v[30:31], v[30:31], v[178:179]
  v_pk_mul_f32 v[32:33], v[24:25], v[24:25]
  v_pk_mul_f32 v[34:35], v[26:27], v[26:27]
  v_pk_mul_f32 v[36:37], v[28:29], v[28:29]
  v_pk_mul_f32 v[38:39], v[30:31], v[30:31]
  v_pk_fma_f32 v[32:33], v[32:33], s[42:43], v[20:21]
  v_pk_fma_f32 v[34:35], v[34:35], s[42:43], v[20:21]
  v_pk_fma_f32 v[36:37], v[36:37], s[42:43], v[20:21]
  v_pk_fma_f32 v[38:39], v[38:39], s[42:43], v[20:21]
  v_pk_mul_f32 v[32:33], v[32:33], v[24:25]
  v_pk_mul_f32 v[34:35], v[34:35], v[26:27]
  v_pk_mul_f32 v[36:37], v[36:37], v[28:29]
  v_pk_mul_f32 v[38:39], v[38:39], v[30:31]
  v_exp_f32 v32, v32
  v_exp_f32 v33, v33
  v_exp_f32 v34, v34
  v_exp_f32 v35, v35
  v_exp_f32 v36, v36
  v_exp_f32 v37, v37
  v_exp_f32 v38, v38
  v_exp_f32 v39, v39
  v_pk_add_f32 v[32:33], v[32:33], 1.0 op_sel_hi:[1,0]
  v_pk_add_f32 v[34:35], v[34:35], 1.0 op_sel_hi:[1,0]
  v_pk_add_f32 v[36:37], v[36:37], 1.0 op_sel_hi:[1,0]
  v_pk_add_f32 v[38:39], v[38:39], 1.0 op_sel_hi:[1,0]
  v_rcp_f32 v32, v32
  v_rcp_f32 v33, v33
  v_rcp_f32 v34, v34
  v_rcp_f32 v35, v35
  v_rcp_f32 v36, v36
  v_rcp_f32 v37, v37
  v_rcp_f32 v38, v38
  v_rcp_f32 v39, v39
  v_pk_mul_f32 v[24:25], v[32:33], v[24:25]
  v_pk_mul_f32 v[26:27], v[34:35], v[26:27]
  v_pk_mul_f32 v[28:29], v[36:37], v[28:29]
  v_pk_mul_f32 v[30:31], v[38:39], v[30:31]
  v_cvt_pk_bf16_f32 v40, v24, v25
  v_cvt_pk_bf16_f32 v42, v28, v29
  v_cvt_pk_bf16_f32 v41, v26, v27
  v_cvt_pk_bf16_f32 v43, v30, v31
  s_nop 0
  v_permlane16_swap_b32 v40, v42
  v_permlane16_swap_b32 v41, v43
  buffer_store_dwordx4 v[40:43], v18, s[12:15], s27 offen offset:2048 sc1
  v_accvgpr_read_b32 v44, a120
  v_accvgpr_read_b32 v45, a121
  v_accvgpr_read_b32 v46, a122
  v_accvgpr_read_b32 v47, a123
  v_accvgpr_read_b32 v48, a124
  v_accvgpr_read_b32 v49, a125
  v_accvgpr_read_b32 v50, a126
  v_accvgpr_read_b32 v51, a127
  v_pk_add_f32 v[44:45], v[44:45], v[184:185]
  v_pk_add_f32 v[46:47], v[46:47], v[186:187]
  v_pk_add_f32 v[48:49], v[48:49], v[184:185]
  v_pk_add_f32 v[50:51], v[50:51], v[186:187]
  v_pk_mul_f32 v[52:53], v[44:45], v[44:45]
  v_pk_mul_f32 v[54:55], v[46:47], v[46:47]
  v_pk_mul_f32 v[56:57], v[48:49], v[48:49]
  v_pk_mul_f32 v[58:59], v[50:51], v[50:51]
  v_pk_fma_f32 v[52:53], v[52:53], s[42:43], v[20:21]
  v_pk_fma_f32 v[54:55], v[54:55], s[42:43], v[20:21]
  v_pk_fma_f32 v[56:57], v[56:57], s[42:43], v[20:21]
  v_pk_fma_f32 v[58:59], v[58:59], s[42:43], v[20:21]
  v_pk_mul_f32 v[52:53], v[52:53], v[44:45]
  v_pk_mul_f32 v[54:55], v[54:55], v[46:47]
  v_pk_mul_f32 v[56:57], v[56:57], v[48:49]
  v_pk_mul_f32 v[58:59], v[58:59], v[50:51]
  v_exp_f32 v52, v52
  v_exp_f32 v53, v53
  v_exp_f32 v54, v54
  v_exp_f32 v55, v55
  v_exp_f32 v56, v56
  v_exp_f32 v57, v57
  v_exp_f32 v58, v58
  v_exp_f32 v59, v59
  v_pk_add_f32 v[52:53], v[52:53], 1.0 op_sel_hi:[1,0]
  v_pk_add_f32 v[54:55], v[54:55], 1.0 op_sel_hi:[1,0]
  v_pk_add_f32 v[56:57], v[56:57], 1.0 op_sel_hi:[1,0]
  v_pk_add_f32 v[58:59], v[58:59], 1.0 op_sel_hi:[1,0]
  v_rcp_f32 v52, v52
  v_rcp_f32 v53, v53
  v_rcp_f32 v54, v54
  v_rcp_f32 v55, v55
  v_rcp_f32 v56, v56
  v_rcp_f32 v57, v57
  v_rcp_f32 v58, v58
  v_rcp_f32 v59, v59
  v_pk_mul_f32 v[44:45], v[52:53], v[44:45]
  v_pk_mul_f32 v[46:47], v[54:55], v[46:47]
  v_pk_mul_f32 v[48:49], v[56:57], v[48:49]
  v_pk_mul_f32 v[50:51], v[58:59], v[50:51]
  v_cvt_pk_bf16_f32 v60, v44, v45
  v_cvt_pk_bf16_f32 v62, v48, v49
  v_cvt_pk_bf16_f32 v61, v46, v47
  v_cvt_pk_bf16_f32 v63, v50, v51
  s_nop 0
  v_permlane16_swap_b32 v60, v62
  v_permlane16_swap_b32 v61, v63
  buffer_store_dwordx4 v[60:63], v18, s[12:15], s27 offen offset:3072 sc1
  s_lshl1_add_u32 s26, s22, s26
  v_accvgpr_read_b32 v24, a128
  v_accvgpr_read_b32 v25, a129
  v_accvgpr_read_b32 v26, a130
  v_accvgpr_read_b32 v27, a131
  v_accvgpr_read_b32 v28, a132
  v_accvgpr_read_b32 v29, a133
  v_accvgpr_read_b32 v30, a134
  v_accvgpr_read_b32 v31, a135
  v_pk_add_f32 v[24:25], v[24:25], v[128:129]
  v_pk_add_f32 v[26:27], v[26:27], v[130:131]
  v_pk_add_f32 v[28:29], v[28:29], v[128:129]
  v_pk_add_f32 v[30:31], v[30:31], v[130:131]
  v_pk_mul_f32 v[32:33], v[24:25], v[24:25]
  v_pk_mul_f32 v[34:35], v[26:27], v[26:27]
  v_pk_mul_f32 v[36:37], v[28:29], v[28:29]
  v_pk_mul_f32 v[38:39], v[30:31], v[30:31]
  v_pk_fma_f32 v[32:33], v[32:33], s[42:43], v[20:21]
  v_pk_fma_f32 v[34:35], v[34:35], s[42:43], v[20:21]
  v_pk_fma_f32 v[36:37], v[36:37], s[42:43], v[20:21]
  v_pk_fma_f32 v[38:39], v[38:39], s[42:43], v[20:21]
  v_pk_mul_f32 v[32:33], v[32:33], v[24:25]
  v_pk_mul_f32 v[34:35], v[34:35], v[26:27]
  v_pk_mul_f32 v[36:37], v[36:37], v[28:29]
  v_pk_mul_f32 v[38:39], v[38:39], v[30:31]
  v_exp_f32 v32, v32
  v_exp_f32 v33, v33
  v_exp_f32 v34, v34
  v_exp_f32 v35, v35
  v_exp_f32 v36, v36
  v_exp_f32 v37, v37
  v_exp_f32 v38, v38
  v_exp_f32 v39, v39
  v_pk_add_f32 v[32:33], v[32:33], 1.0 op_sel_hi:[1,0]
  v_pk_add_f32 v[34:35], v[34:35], 1.0 op_sel_hi:[1,0]
  v_pk_add_f32 v[36:37], v[36:37], 1.0 op_sel_hi:[1,0]
  v_pk_add_f32 v[38:39], v[38:39], 1.0 op_sel_hi:[1,0]
  v_rcp_f32 v32, v32
  v_rcp_f32 v33, v33
  v_rcp_f32 v34, v34
  v_rcp_f32 v35, v35
  v_rcp_f32 v36, v36
  v_rcp_f32 v37, v37
  v_rcp_f32 v38, v38
  v_rcp_f32 v39, v39
  v_pk_mul_f32 v[24:25], v[32:33], v[24:25]
  v_pk_mul_f32 v[26:27], v[34:35], v[26:27]
  v_pk_mul_f32 v[28:29], v[36:37], v[28:29]
  v_pk_mul_f32 v[30:31], v[38:39], v[30:31]
  v_cvt_pk_bf16_f32 v40, v24, v25
  v_cvt_pk_bf16_f32 v42, v28, v29
  v_cvt_pk_bf16_f32 v41, v26, v27
  v_cvt_pk_bf16_f32 v43, v30, v31
  s_nop 0
  v_permlane16_swap_b32 v40, v42
  v_permlane16_swap_b32 v41, v43
  buffer_store_dwordx4 v[40:43], v18, s[12:15], s26 offen offset:0 sc1
  v_accvgpr_read_b32 v44, a136
  v_accvgpr_read_b32 v45, a137
  v_accvgpr_read_b32 v46, a138
  v_accvgpr_read_b32 v47, a139
  v_accvgpr_read_b32 v48, a140
  v_accvgpr_read_b32 v49, a141
  v_accvgpr_read_b32 v50, a142
  v_accvgpr_read_b32 v51, a143
  v_pk_add_f32 v[44:45], v[44:45], v[136:137]
  v_pk_add_f32 v[46:47], v[46:47], v[138:139]
  v_pk_add_f32 v[48:49], v[48:49], v[136:137]
  v_pk_add_f32 v[50:51], v[50:51], v[138:139]
  v_pk_mul_f32 v[52:53], v[44:45], v[44:45]
  v_pk_mul_f32 v[54:55], v[46:47], v[46:47]
  v_pk_mul_f32 v[56:57], v[48:49], v[48:49]
  v_pk_mul_f32 v[58:59], v[50:51], v[50:51]
  v_pk_fma_f32 v[52:53], v[52:53], s[42:43], v[20:21]
  v_pk_fma_f32 v[54:55], v[54:55], s[42:43], v[20:21]
  v_pk_fma_f32 v[56:57], v[56:57], s[42:43], v[20:21]
  v_pk_fma_f32 v[58:59], v[58:59], s[42:43], v[20:21]
  v_pk_mul_f32 v[52:53], v[52:53], v[44:45]
  v_pk_mul_f32 v[54:55], v[54:55], v[46:47]
  v_pk_mul_f32 v[56:57], v[56:57], v[48:49]
  v_pk_mul_f32 v[58:59], v[58:59], v[50:51]
  v_exp_f32 v52, v52
  v_exp_f32 v53, v53
  v_exp_f32 v54, v54
  v_exp_f32 v55, v55
  v_exp_f32 v56, v56
  v_exp_f32 v57, v57
  v_exp_f32 v58, v58
  v_exp_f32 v59, v59
  v_pk_add_f32 v[52:53], v[52:53], 1.0 op_sel_hi:[1,0]
  v_pk_add_f32 v[54:55], v[54:55], 1.0 op_sel_hi:[1,0]
  v_pk_add_f32 v[56:57], v[56:57], 1.0 op_sel_hi:[1,0]
  v_pk_add_f32 v[58:59], v[58:59], 1.0 op_sel_hi:[1,0]
  v_rcp_f32 v52, v52
  v_rcp_f32 v53, v53
  v_rcp_f32 v54, v54
  v_rcp_f32 v55, v55
  v_rcp_f32 v56, v56
  v_rcp_f32 v57, v57
  v_rcp_f32 v58, v58
  v_rcp_f32 v59, v59
  v_pk_mul_f32 v[44:45], v[52:53], v[44:45]
  v_pk_mul_f32 v[46:47], v[54:55], v[46:47]
  v_pk_mul_f32 v[48:49], v[56:57], v[48:49]
  v_pk_mul_f32 v[50:51], v[58:59], v[50:51]
  v_cvt_pk_bf16_f32 v60, v44, v45
  v_cvt_pk_bf16_f32 v62, v48, v49
  v_cvt_pk_bf16_f32 v61, v46, v47
  v_cvt_pk_bf16_f32 v63, v50, v51
  s_nop 0
  v_permlane16_swap_b32 v60, v62
  v_permlane16_swap_b32 v61, v63
  buffer_store_dwordx4 v[60:63], v18, s[12:15], s26 offen offset:1024 sc1
  v_accvgpr_read_b32 v24, a144
  v_accvgpr_read_b32 v25, a145
  v_accvgpr_read_b32 v26, a146
  v_accvgpr_read_b32 v27, a147
  v_accvgpr_read_b32 v28, a148
  v_accvgpr_read_b32 v29, a149
  v_accvgpr_read_b32 v30, a150
  v_accvgpr_read_b32 v31, a151
  v_pk_add_f32 v[24:25], v[24:25], v[144:145]
  v_pk_add_f32 v[26:27], v[26:27], v[146:147]
  v_pk_add_f32 v[28:29], v[28:29], v[144:145]
  v_pk_add_f32 v[30:31], v[30:31], v[146:147]
  v_pk_mul_f32 v[32:33], v[24:25], v[24:25]
  v_pk_mul_f32 v[34:35], v[26:27], v[26:27]
  v_pk_mul_f32 v[36:37], v[28:29], v[28:29]
  v_pk_mul_f32 v[38:39], v[30:31], v[30:31]
  v_pk_fma_f32 v[32:33], v[32:33], s[42:43], v[20:21]
  v_pk_fma_f32 v[34:35], v[34:35], s[42:43], v[20:21]
  v_pk_fma_f32 v[36:37], v[36:37], s[42:43], v[20:21]
  v_pk_fma_f32 v[38:39], v[38:39], s[42:43], v[20:21]
  v_pk_mul_f32 v[32:33], v[32:33], v[24:25]
  v_pk_mul_f32 v[34:35], v[34:35], v[26:27]
  v_pk_mul_f32 v[36:37], v[36:37], v[28:29]
  v_pk_mul_f32 v[38:39], v[38:39], v[30:31]
  v_exp_f32 v32, v32
  v_exp_f32 v33, v33
  v_exp_f32 v34, v34
  v_exp_f32 v35, v35
  v_exp_f32 v36, v36
  v_exp_f32 v37, v37
  v_exp_f32 v38, v38
  v_exp_f32 v39, v39
  v_pk_add_f32 v[32:33], v[32:33], 1.0 op_sel_hi:[1,0]
  v_pk_add_f32 v[34:35], v[34:35], 1.0 op_sel_hi:[1,0]
  v_pk_add_f32 v[36:37], v[36:37], 1.0 op_sel_hi:[1,0]
  v_pk_add_f32 v[38:39], v[38:39], 1.0 op_sel_hi:[1,0]
  v_rcp_f32 v32, v32
  v_rcp_f32 v33, v33
  v_rcp_f32 v34, v34
  v_rcp_f32 v35, v35
  v_rcp_f32 v36, v36
  v_rcp_f32 v37, v37
  v_rcp_f32 v38, v38
  v_rcp_f32 v39, v39
  v_pk_mul_f32 v[24:25], v[32:33], v[24:25]
  v_pk_mul_f32 v[26:27], v[34:35], v[26:27]
  v_pk_mul_f32 v[28:29], v[36:37], v[28:29]
  v_pk_mul_f32 v[30:31], v[38:39], v[30:31]
  v_cvt_pk_bf16_f32 v40, v24, v25
  v_cvt_pk_bf16_f32 v42, v28, v29
  v_cvt_pk_bf16_f32 v41, v26, v27
  v_cvt_pk_bf16_f32 v43, v30, v31
  s_nop 0
  v_permlane16_swap_b32 v40, v42
  v_permlane16_swap_b32 v41, v43
  buffer_store_dwordx4 v[40:43], v18, s[12:15], s26 offen offset:2048 sc1
  v_accvgpr_read_b32 v44, a152
  v_accvgpr_read_b32 v45, a153
  v_accvgpr_read_b32 v46, a154
  v_accvgpr_read_b32 v47, a155
  v_accvgpr_read_b32 v48, a156
  v_accvgpr_read_b32 v49, a157
  v_accvgpr_read_b32 v50, a158
  v_accvgpr_read_b32 v51, a159
  v_pk_add_f32 v[44:45], v[44:45], v[152:153]
  v_pk_add_f32 v[46:47], v[46:47], v[154:155]
  v_pk_add_f32 v[48:49], v[48:49], v[152:153]
  v_pk_add_f32 v[50:51], v[50:51], v[154:155]
  v_pk_mul_f32 v[52:53], v[44:45], v[44:45]
  v_pk_mul_f32 v[54:55], v[46:47], v[46:47]
  v_pk_mul_f32 v[56:57], v[48:49], v[48:49]
  v_pk_mul_f32 v[58:59], v[50:51], v[50:51]
  v_pk_fma_f32 v[52:53], v[52:53], s[42:43], v[20:21]
  v_pk_fma_f32 v[54:55], v[54:55], s[42:43], v[20:21]
  v_pk_fma_f32 v[56:57], v[56:57], s[42:43], v[20:21]
  v_pk_fma_f32 v[58:59], v[58:59], s[42:43], v[20:21]
  v_pk_mul_f32 v[52:53], v[52:53], v[44:45]
  v_pk_mul_f32 v[54:55], v[54:55], v[46:47]
  v_pk_mul_f32 v[56:57], v[56:57], v[48:49]
  v_pk_mul_f32 v[58:59], v[58:59], v[50:51]
  v_exp_f32 v52, v52
  v_exp_f32 v53, v53
  v_exp_f32 v54, v54
  v_exp_f32 v55, v55
  v_exp_f32 v56, v56
  v_exp_f32 v57, v57
  v_exp_f32 v58, v58
  v_exp_f32 v59, v59
  v_pk_add_f32 v[52:53], v[52:53], 1.0 op_sel_hi:[1,0]
  v_pk_add_f32 v[54:55], v[54:55], 1.0 op_sel_hi:[1,0]
  v_pk_add_f32 v[56:57], v[56:57], 1.0 op_sel_hi:[1,0]
  v_pk_add_f32 v[58:59], v[58:59], 1.0 op_sel_hi:[1,0]
  v_rcp_f32 v52, v52
  v_rcp_f32 v53, v53
  v_rcp_f32 v54, v54
  v_rcp_f32 v55, v55
  v_rcp_f32 v56, v56
  v_rcp_f32 v57, v57
  v_rcp_f32 v58, v58
  v_rcp_f32 v59, v59
  v_pk_mul_f32 v[44:45], v[52:53], v[44:45]
  v_pk_mul_f32 v[46:47], v[54:55], v[46:47]
  v_pk_mul_f32 v[48:49], v[56:57], v[48:49]
  v_pk_mul_f32 v[50:51], v[58:59], v[50:51]
  v_cvt_pk_bf16_f32 v60, v44, v45
  v_cvt_pk_bf16_f32 v62, v48, v49
  v_cvt_pk_bf16_f32 v61, v46, v47
  v_cvt_pk_bf16_f32 v63, v50, v51
  s_nop 0
  v_permlane16_swap_b32 v60, v62
  v_permlane16_swap_b32 v61, v63
  buffer_store_dwordx4 v[60:63], v18, s[12:15], s26 offen offset:3072 sc1
  s_add_u32 s27, s26, 4096
  v_accvgpr_read_b32 v24, a160
  v_accvgpr_read_b32 v25, a161
  v_accvgpr_read_b32 v26, a162
  v_accvgpr_read_b32 v27, a163
  v_accvgpr_read_b32 v28, a164
  v_accvgpr_read_b32 v29, a165
  v_accvgpr_read_b32 v30, a166
  v_accvgpr_read_b32 v31, a167
  v_pk_add_f32 v[24:25], v[24:25], v[160:161]
  v_pk_add_f32 v[26:27], v[26:27], v[162:163]
  v_pk_add_f32 v[28:29], v[28:29], v[160:161]
  v_pk_add_f32 v[30:31], v[30:31], v[162:163]
  v_pk_mul_f32 v[32:33], v[24:25], v[24:25]
  v_pk_mul_f32 v[34:35], v[26:27], v[26:27]
  v_pk_mul_f32 v[36:37], v[28:29], v[28:29]
  v_pk_mul_f32 v[38:39], v[30:31], v[30:31]
  v_pk_fma_f32 v[32:33], v[32:33], s[42:43], v[20:21]
  v_pk_fma_f32 v[34:35], v[34:35], s[42:43], v[20:21]
  v_pk_fma_f32 v[36:37], v[36:37], s[42:43], v[20:21]
  v_pk_fma_f32 v[38:39], v[38:39], s[42:43], v[20:21]
  v_pk_mul_f32 v[32:33], v[32:33], v[24:25]
  v_pk_mul_f32 v[34:35], v[34:35], v[26:27]
  v_pk_mul_f32 v[36:37], v[36:37], v[28:29]
  v_pk_mul_f32 v[38:39], v[38:39], v[30:31]
  v_exp_f32 v32, v32
  v_exp_f32 v33, v33
  v_exp_f32 v34, v34
  v_exp_f32 v35, v35
  v_exp_f32 v36, v36
  v_exp_f32 v37, v37
  v_exp_f32 v38, v38
  v_exp_f32 v39, v39
  v_pk_add_f32 v[32:33], v[32:33], 1.0 op_sel_hi:[1,0]
  v_pk_add_f32 v[34:35], v[34:35], 1.0 op_sel_hi:[1,0]
  v_pk_add_f32 v[36:37], v[36:37], 1.0 op_sel_hi:[1,0]
  v_pk_add_f32 v[38:39], v[38:39], 1.0 op_sel_hi:[1,0]
  v_rcp_f32 v32, v32
  v_rcp_f32 v33, v33
  v_rcp_f32 v34, v34
  v_rcp_f32 v35, v35
  v_rcp_f32 v36, v36
  v_rcp_f32 v37, v37
  v_rcp_f32 v38, v38
  v_rcp_f32 v39, v39
  v_pk_mul_f32 v[24:25], v[32:33], v[24:25]
  v_pk_mul_f32 v[26:27], v[34:35], v[26:27]
  v_pk_mul_f32 v[28:29], v[36:37], v[28:29]
  v_pk_mul_f32 v[30:31], v[38:39], v[30:31]
  v_cvt_pk_bf16_f32 v40, v24, v25
  v_cvt_pk_bf16_f32 v42, v28, v29
  v_cvt_pk_bf16_f32 v41, v26, v27
  v_cvt_pk_bf16_f32 v43, v30, v31
  s_nop 0
  v_permlane16_swap_b32 v40, v42
  v_permlane16_swap_b32 v41, v43
  buffer_store_dwordx4 v[40:43], v18, s[12:15], s27 offen offset:0 sc1
  v_accvgpr_read_b32 v44, a168
  v_accvgpr_read_b32 v45, a169
  v_accvgpr_read_b32 v46, a170
  v_accvgpr_read_b32 v47, a171
  v_accvgpr_read_b32 v48, a172
  v_accvgpr_read_b32 v49, a173
  v_accvgpr_read_b32 v50, a174
  v_accvgpr_read_b32 v51, a175
  v_pk_add_f32 v[44:45], v[44:45], v[168:169]
  v_pk_add_f32 v[46:47], v[46:47], v[170:171]
  v_pk_add_f32 v[48:49], v[48:49], v[168:169]
  v_pk_add_f32 v[50:51], v[50:51], v[170:171]
  v_pk_mul_f32 v[52:53], v[44:45], v[44:45]
  v_pk_mul_f32 v[54:55], v[46:47], v[46:47]
  v_pk_mul_f32 v[56:57], v[48:49], v[48:49]
  v_pk_mul_f32 v[58:59], v[50:51], v[50:51]
  v_pk_fma_f32 v[52:53], v[52:53], s[42:43], v[20:21]
  v_pk_fma_f32 v[54:55], v[54:55], s[42:43], v[20:21]
  v_pk_fma_f32 v[56:57], v[56:57], s[42:43], v[20:21]
  v_pk_fma_f32 v[58:59], v[58:59], s[42:43], v[20:21]
  v_pk_mul_f32 v[52:53], v[52:53], v[44:45]
  v_pk_mul_f32 v[54:55], v[54:55], v[46:47]
  v_pk_mul_f32 v[56:57], v[56:57], v[48:49]
  v_pk_mul_f32 v[58:59], v[58:59], v[50:51]
  v_exp_f32 v52, v52
  v_exp_f32 v53, v53
  v_exp_f32 v54, v54
  v_exp_f32 v55, v55
  v_exp_f32 v56, v56
  v_exp_f32 v57, v57
  v_exp_f32 v58, v58
  v_exp_f32 v59, v59
  v_pk_add_f32 v[52:53], v[52:53], 1.0 op_sel_hi:[1,0]
  v_pk_add_f32 v[54:55], v[54:55], 1.0 op_sel_hi:[1,0]
  v_pk_add_f32 v[56:57], v[56:57], 1.0 op_sel_hi:[1,0]
  v_pk_add_f32 v[58:59], v[58:59], 1.0 op_sel_hi:[1,0]
  v_rcp_f32 v52, v52
  v_rcp_f32 v53, v53
  v_rcp_f32 v54, v54
  v_rcp_f32 v55, v55
  v_rcp_f32 v56, v56
  v_rcp_f32 v57, v57
  v_rcp_f32 v58, v58
  v_rcp_f32 v59, v59
  v_pk_mul_f32 v[44:45], v[52:53], v[44:45]
  v_pk_mul_f32 v[46:47], v[54:55], v[46:47]
  v_pk_mul_f32 v[48:49], v[56:57], v[48:49]
  v_pk_mul_f32 v[50:51], v[58:59], v[50:51]
  v_cvt_pk_bf16_f32 v60, v44, v45
  v_cvt_pk_bf16_f32 v62, v48, v49
  v_cvt_pk_bf16_f32 v61, v46, v47
  v_cvt_pk_bf16_f32 v63, v50, v51
  s_nop 0
  v_permlane16_swap_b32 v60, v62
  v_permlane16_swap_b32 v61, v63
  buffer_store_dwordx4 v[60:63], v18, s[12:15], s27 offen offset:1024 sc1
  v_accvgpr_read_b32 v24, a176
  v_accvgpr_read_b32 v25, a177
  v_accvgpr_read_b32 v26, a178
  v_accvgpr_read_b32 v27, a179
  v_accvgpr_read_b32 v28, a180
  v_accvgpr_read_b32 v29, a181
  v_accvgpr_read_b32 v30, a182
  v_accvgpr_read_b32 v31, a183
  v_pk_add_f32 v[24:25], v[24:25], v[176:177]
  v_pk_add_f32 v[26:27], v[26:27], v[178:179]
  v_pk_add_f32 v[28:29], v[28:29], v[176:177]
  v_pk_add_f32 v[30:31], v[30:31], v[178:179]
  v_pk_mul_f32 v[32:33], v[24:25], v[24:25]
  v_pk_mul_f32 v[34:35], v[26:27], v[26:27]
  v_pk_mul_f32 v[36:37], v[28:29], v[28:29]
  v_pk_mul_f32 v[38:39], v[30:31], v[30:31]
  v_pk_fma_f32 v[32:33], v[32:33], s[42:43], v[20:21]
  v_pk_fma_f32 v[34:35], v[34:35], s[42:43], v[20:21]
  v_pk_fma_f32 v[36:37], v[36:37], s[42:43], v[20:21]
  v_pk_fma_f32 v[38:39], v[38:39], s[42:43], v[20:21]
  v_pk_mul_f32 v[32:33], v[32:33], v[24:25]
  v_pk_mul_f32 v[34:35], v[34:35], v[26:27]
  v_pk_mul_f32 v[36:37], v[36:37], v[28:29]
  v_pk_mul_f32 v[38:39], v[38:39], v[30:31]
  v_exp_f32 v32, v32
  v_exp_f32 v33, v33
  v_exp_f32 v34, v34
  v_exp_f32 v35, v35
  v_exp_f32 v36, v36
  v_exp_f32 v37, v37
  v_exp_f32 v38, v38
  v_exp_f32 v39, v39
  v_pk_add_f32 v[32:33], v[32:33], 1.0 op_sel_hi:[1,0]
  v_pk_add_f32 v[34:35], v[34:35], 1.0 op_sel_hi:[1,0]
  v_pk_add_f32 v[36:37], v[36:37], 1.0 op_sel_hi:[1,0]
  v_pk_add_f32 v[38:39], v[38:39], 1.0 op_sel_hi:[1,0]
  v_rcp_f32 v32, v32
  v_rcp_f32 v33, v33
  v_rcp_f32 v34, v34
  v_rcp_f32 v35, v35
  v_rcp_f32 v36, v36
  v_rcp_f32 v37, v37
  v_rcp_f32 v38, v38
  v_rcp_f32 v39, v39
  v_pk_mul_f32 v[24:25], v[32:33], v[24:25]
  v_pk_mul_f32 v[26:27], v[34:35], v[26:27]
  v_pk_mul_f32 v[28:29], v[36:37], v[28:29]
  v_pk_mul_f32 v[30:31], v[38:39], v[30:31]
  v_cvt_pk_bf16_f32 v40, v24, v25
  v_cvt_pk_bf16_f32 v42, v28, v29
  v_cvt_pk_bf16_f32 v41, v26, v27
  v_cvt_pk_bf16_f32 v43, v30, v31
  s_nop 0
  v_permlane16_swap_b32 v40, v42
  v_permlane16_swap_b32 v41, v43
  buffer_store_dwordx4 v[40:43], v18, s[12:15], s27 offen offset:2048 sc1
  v_accvgpr_read_b32 v44, a184
  v_accvgpr_read_b32 v45, a185
  v_accvgpr_read_b32 v46, a186
  v_accvgpr_read_b32 v47, a187
  v_accvgpr_read_b32 v48, a188
  v_accvgpr_read_b32 v49, a189
  v_accvgpr_read_b32 v50, a190
  v_accvgpr_read_b32 v51, a191
  v_pk_add_f32 v[44:45], v[44:45], v[184:185]
  v_pk_add_f32 v[46:47], v[46:47], v[186:187]
  v_pk_add_f32 v[48:49], v[48:49], v[184:185]
  v_pk_add_f32 v[50:51], v[50:51], v[186:187]
  v_pk_mul_f32 v[52:53], v[44:45], v[44:45]
  v_pk_mul_f32 v[54:55], v[46:47], v[46:47]
  v_pk_mul_f32 v[56:57], v[48:49], v[48:49]
  v_pk_mul_f32 v[58:59], v[50:51], v[50:51]
  v_pk_fma_f32 v[52:53], v[52:53], s[42:43], v[20:21]
  v_pk_fma_f32 v[54:55], v[54:55], s[42:43], v[20:21]
  v_pk_fma_f32 v[56:57], v[56:57], s[42:43], v[20:21]
  v_pk_fma_f32 v[58:59], v[58:59], s[42:43], v[20:21]
  v_pk_mul_f32 v[52:53], v[52:53], v[44:45]
  v_pk_mul_f32 v[54:55], v[54:55], v[46:47]
  v_pk_mul_f32 v[56:57], v[56:57], v[48:49]
  v_pk_mul_f32 v[58:59], v[58:59], v[50:51]
  v_exp_f32 v52, v52
  v_exp_f32 v53, v53
  v_exp_f32 v54, v54
  v_exp_f32 v55, v55
  v_exp_f32 v56, v56
  v_exp_f32 v57, v57
  v_exp_f32 v58, v58
  v_exp_f32 v59, v59
  v_pk_add_f32 v[52:53], v[52:53], 1.0 op_sel_hi:[1,0]
  v_pk_add_f32 v[54:55], v[54:55], 1.0 op_sel_hi:[1,0]
  v_pk_add_f32 v[56:57], v[56:57], 1.0 op_sel_hi:[1,0]
  v_pk_add_f32 v[58:59], v[58:59], 1.0 op_sel_hi:[1,0]
  v_rcp_f32 v52, v52
  v_rcp_f32 v53, v53
  v_rcp_f32 v54, v54
  v_rcp_f32 v55, v55
  v_rcp_f32 v56, v56
  v_rcp_f32 v57, v57
  v_rcp_f32 v58, v58
  v_rcp_f32 v59, v59
  v_pk_mul_f32 v[44:45], v[52:53], v[44:45]
  v_pk_mul_f32 v[46:47], v[54:55], v[46:47]
  v_pk_mul_f32 v[48:49], v[56:57], v[48:49]
  v_pk_mul_f32 v[50:51], v[58:59], v[50:51]
  v_cvt_pk_bf16_f32 v60, v44, v45
  v_cvt_pk_bf16_f32 v62, v48, v49
  v_cvt_pk_bf16_f32 v61, v46, v47
  v_cvt_pk_bf16_f32 v63, v50, v51
  s_nop 0
  v_permlane16_swap_b32 v60, v62
  v_permlane16_swap_b32 v61, v63
  buffer_store_dwordx4 v[60:63], v18, s[12:15], s27 offen offset:3072 sc1
  s_lshl1_add_u32 s26, s22, s26
  v_accvgpr_read_b32 v24, a192
  v_accvgpr_read_b32 v25, a193
  v_accvgpr_read_b32 v26, a194
  v_accvgpr_read_b32 v27, a195
  v_accvgpr_read_b32 v28, a196
  v_accvgpr_read_b32 v29, a197
  v_accvgpr_read_b32 v30, a198
  v_accvgpr_read_b32 v31, a199
  v_pk_add_f32 v[24:25], v[24:25], v[128:129]
  v_pk_add_f32 v[26:27], v[26:27], v[130:131]
  v_pk_add_f32 v[28:29], v[28:29], v[128:129]
  v_pk_add_f32 v[30:31], v[30:31], v[130:131]
  v_pk_mul_f32 v[32:33], v[24:25], v[24:25]
  v_pk_mul_f32 v[34:35], v[26:27], v[26:27]
  v_pk_mul_f32 v[36:37], v[28:29], v[28:29]
  v_pk_mul_f32 v[38:39], v[30:31], v[30:31]
  v_pk_fma_f32 v[32:33], v[32:33], s[42:43], v[20:21]
  v_pk_fma_f32 v[34:35], v[34:35], s[42:43], v[20:21]
  v_pk_fma_f32 v[36:37], v[36:37], s[42:43], v[20:21]
  v_pk_fma_f32 v[38:39], v[38:39], s[42:43], v[20:21]
  v_pk_mul_f32 v[32:33], v[32:33], v[24:25]
  v_pk_mul_f32 v[34:35], v[34:35], v[26:27]
  v_pk_mul_f32 v[36:37], v[36:37], v[28:29]
  v_pk_mul_f32 v[38:39], v[38:39], v[30:31]
  v_exp_f32 v32, v32
  v_exp_f32 v33, v33
  v_exp_f32 v34, v34
  v_exp_f32 v35, v35
  v_exp_f32 v36, v36
  v_exp_f32 v37, v37
  v_exp_f32 v38, v38
  v_exp_f32 v39, v39
  v_pk_add_f32 v[32:33], v[32:33], 1.0 op_sel_hi:[1,0]
  v_pk_add_f32 v[34:35], v[34:35], 1.0 op_sel_hi:[1,0]
  v_pk_add_f32 v[36:37], v[36:37], 1.0 op_sel_hi:[1,0]
  v_pk_add_f32 v[38:39], v[38:39], 1.0 op_sel_hi:[1,0]
  v_rcp_f32 v32, v32
  v_rcp_f32 v33, v33
  v_rcp_f32 v34, v34
  v_rcp_f32 v35, v35
  v_rcp_f32 v36, v36
  v_rcp_f32 v37, v37
  v_rcp_f32 v38, v38
  v_rcp_f32 v39, v39
  v_pk_mul_f32 v[24:25], v[32:33], v[24:25]
  v_pk_mul_f32 v[26:27], v[34:35], v[26:27]
  v_pk_mul_f32 v[28:29], v[36:37], v[28:29]
  v_pk_mul_f32 v[30:31], v[38:39], v[30:31]
  v_cvt_pk_bf16_f32 v40, v24, v25
  v_cvt_pk_bf16_f32 v42, v28, v29
  v_cvt_pk_bf16_f32 v41, v26, v27
  v_cvt_pk_bf16_f32 v43, v30, v31
  s_nop 0
  v_permlane16_swap_b32 v40, v42
  v_permlane16_swap_b32 v41, v43
  buffer_store_dwordx4 v[40:43], v18, s[12:15], s26 offen offset:0 sc1
  v_accvgpr_read_b32 v44, a200
  v_accvgpr_read_b32 v45, a201
  v_accvgpr_read_b32 v46, a202
  v_accvgpr_read_b32 v47, a203
  v_accvgpr_read_b32 v48, a204
  v_accvgpr_read_b32 v49, a205
  v_accvgpr_read_b32 v50, a206
  v_accvgpr_read_b32 v51, a207
  v_pk_add_f32 v[44:45], v[44:45], v[136:137]
  v_pk_add_f32 v[46:47], v[46:47], v[138:139]
  v_pk_add_f32 v[48:49], v[48:49], v[136:137]
  v_pk_add_f32 v[50:51], v[50:51], v[138:139]
  v_pk_mul_f32 v[52:53], v[44:45], v[44:45]
  v_pk_mul_f32 v[54:55], v[46:47], v[46:47]
  v_pk_mul_f32 v[56:57], v[48:49], v[48:49]
  v_pk_mul_f32 v[58:59], v[50:51], v[50:51]
  v_pk_fma_f32 v[52:53], v[52:53], s[42:43], v[20:21]
  v_pk_fma_f32 v[54:55], v[54:55], s[42:43], v[20:21]
  v_pk_fma_f32 v[56:57], v[56:57], s[42:43], v[20:21]
  v_pk_fma_f32 v[58:59], v[58:59], s[42:43], v[20:21]
  v_pk_mul_f32 v[52:53], v[52:53], v[44:45]
  v_pk_mul_f32 v[54:55], v[54:55], v[46:47]
  v_pk_mul_f32 v[56:57], v[56:57], v[48:49]
  v_pk_mul_f32 v[58:59], v[58:59], v[50:51]
  v_exp_f32 v52, v52
  v_exp_f32 v53, v53
  v_exp_f32 v54, v54
  v_exp_f32 v55, v55
  v_exp_f32 v56, v56
  v_exp_f32 v57, v57
  v_exp_f32 v58, v58
  v_exp_f32 v59, v59
  v_pk_add_f32 v[52:53], v[52:53], 1.0 op_sel_hi:[1,0]
  v_pk_add_f32 v[54:55], v[54:55], 1.0 op_sel_hi:[1,0]
  v_pk_add_f32 v[56:57], v[56:57], 1.0 op_sel_hi:[1,0]
  v_pk_add_f32 v[58:59], v[58:59], 1.0 op_sel_hi:[1,0]
  v_rcp_f32 v52, v52
  v_rcp_f32 v53, v53
  v_rcp_f32 v54, v54
  v_rcp_f32 v55, v55
  v_rcp_f32 v56, v56
  v_rcp_f32 v57, v57
  v_rcp_f32 v58, v58
  v_rcp_f32 v59, v59
  v_pk_mul_f32 v[44:45], v[52:53], v[44:45]
  v_pk_mul_f32 v[46:47], v[54:55], v[46:47]
  v_pk_mul_f32 v[48:49], v[56:57], v[48:49]
  v_pk_mul_f32 v[50:51], v[58:59], v[50:51]
  v_cvt_pk_bf16_f32 v60, v44, v45
  v_cvt_pk_bf16_f32 v62, v48, v49
  v_cvt_pk_bf16_f32 v61, v46, v47
  v_cvt_pk_bf16_f32 v63, v50, v51
  s_nop 0
  v_permlane16_swap_b32 v60, v62
  v_permlane16_swap_b32 v61, v63
  buffer_store_dwordx4 v[60:63], v18, s[12:15], s26 offen offset:1024 sc1
  v_accvgpr_read_b32 v24, a208
  v_accvgpr_read_b32 v25, a209
  v_accvgpr_read_b32 v26, a210
  v_accvgpr_read_b32 v27, a211
  v_accvgpr_read_b32 v28, a212
  v_accvgpr_read_b32 v29, a213
  v_accvgpr_read_b32 v30, a214
  v_accvgpr_read_b32 v31, a215
  v_pk_add_f32 v[24:25], v[24:25], v[144:145]
  v_pk_add_f32 v[26:27], v[26:27], v[146:147]
  v_pk_add_f32 v[28:29], v[28:29], v[144:145]
  v_pk_add_f32 v[30:31], v[30:31], v[146:147]
  v_pk_mul_f32 v[32:33], v[24:25], v[24:25]
  v_pk_mul_f32 v[34:35], v[26:27], v[26:27]
  v_pk_mul_f32 v[36:37], v[28:29], v[28:29]
  v_pk_mul_f32 v[38:39], v[30:31], v[30:31]
  v_pk_fma_f32 v[32:33], v[32:33], s[42:43], v[20:21]
  v_pk_fma_f32 v[34:35], v[34:35], s[42:43], v[20:21]
  v_pk_fma_f32 v[36:37], v[36:37], s[42:43], v[20:21]
  v_pk_fma_f32 v[38:39], v[38:39], s[42:43], v[20:21]
  v_pk_mul_f32 v[32:33], v[32:33], v[24:25]
  v_pk_mul_f32 v[34:35], v[34:35], v[26:27]
  v_pk_mul_f32 v[36:37], v[36:37], v[28:29]
  v_pk_mul_f32 v[38:39], v[38:39], v[30:31]
  v_exp_f32 v32, v32
  v_exp_f32 v33, v33
  v_exp_f32 v34, v34
  v_exp_f32 v35, v35
  v_exp_f32 v36, v36
  v_exp_f32 v37, v37
  v_exp_f32 v38, v38
  v_exp_f32 v39, v39
  v_pk_add_f32 v[32:33], v[32:33], 1.0 op_sel_hi:[1,0]
  v_pk_add_f32 v[34:35], v[34:35], 1.0 op_sel_hi:[1,0]
  v_pk_add_f32 v[36:37], v[36:37], 1.0 op_sel_hi:[1,0]
  v_pk_add_f32 v[38:39], v[38:39], 1.0 op_sel_hi:[1,0]
  v_rcp_f32 v32, v32
  v_rcp_f32 v33, v33
  v_rcp_f32 v34, v34
  v_rcp_f32 v35, v35
  v_rcp_f32 v36, v36
  v_rcp_f32 v37, v37
  v_rcp_f32 v38, v38
  v_rcp_f32 v39, v39
  v_pk_mul_f32 v[24:25], v[32:33], v[24:25]
  v_pk_mul_f32 v[26:27], v[34:35], v[26:27]
  v_pk_mul_f32 v[28:29], v[36:37], v[28:29]
  v_pk_mul_f32 v[30:31], v[38:39], v[30:31]
  v_cvt_pk_bf16_f32 v40, v24, v25
  v_cvt_pk_bf16_f32 v42, v28, v29
  v_cvt_pk_bf16_f32 v41, v26, v27
  v_cvt_pk_bf16_f32 v43, v30, v31
  s_nop 0
  v_permlane16_swap_b32 v40, v42
  v_permlane16_swap_b32 v41, v43
  buffer_store_dwordx4 v[40:43], v18, s[12:15], s26 offen offset:2048 sc1
  v_accvgpr_read_b32 v44, a216
  v_accvgpr_read_b32 v45, a217
  v_accvgpr_read_b32 v46, a218
  v_accvgpr_read_b32 v47, a219
  v_accvgpr_read_b32 v48, a220
  v_accvgpr_read_b32 v49, a221
  v_accvgpr_read_b32 v50, a222
  v_accvgpr_read_b32 v51, a223
  v_pk_add_f32 v[44:45], v[44:45], v[152:153]
  v_pk_add_f32 v[46:47], v[46:47], v[154:155]
  v_pk_add_f32 v[48:49], v[48:49], v[152:153]
  v_pk_add_f32 v[50:51], v[50:51], v[154:155]
  v_pk_mul_f32 v[52:53], v[44:45], v[44:45]
  v_pk_mul_f32 v[54:55], v[46:47], v[46:47]
  v_pk_mul_f32 v[56:57], v[48:49], v[48:49]
  v_pk_mul_f32 v[58:59], v[50:51], v[50:51]
  v_pk_fma_f32 v[52:53], v[52:53], s[42:43], v[20:21]
  v_pk_fma_f32 v[54:55], v[54:55], s[42:43], v[20:21]
  v_pk_fma_f32 v[56:57], v[56:57], s[42:43], v[20:21]
  v_pk_fma_f32 v[58:59], v[58:59], s[42:43], v[20:21]
  v_pk_mul_f32 v[52:53], v[52:53], v[44:45]
  v_pk_mul_f32 v[54:55], v[54:55], v[46:47]
  v_pk_mul_f32 v[56:57], v[56:57], v[48:49]
  v_pk_mul_f32 v[58:59], v[58:59], v[50:51]
  v_exp_f32 v52, v52
  v_exp_f32 v53, v53
  v_exp_f32 v54, v54
  v_exp_f32 v55, v55
  v_exp_f32 v56, v56
  v_exp_f32 v57, v57
  v_exp_f32 v58, v58
  v_exp_f32 v59, v59
  v_pk_add_f32 v[52:53], v[52:53], 1.0 op_sel_hi:[1,0]
  v_pk_add_f32 v[54:55], v[54:55], 1.0 op_sel_hi:[1,0]
  v_pk_add_f32 v[56:57], v[56:57], 1.0 op_sel_hi:[1,0]
  v_pk_add_f32 v[58:59], v[58:59], 1.0 op_sel_hi:[1,0]
  v_rcp_f32 v52, v52
  v_rcp_f32 v53, v53
  v_rcp_f32 v54, v54
  v_rcp_f32 v55, v55
  v_rcp_f32 v56, v56
  v_rcp_f32 v57, v57
  v_rcp_f32 v58, v58
  v_rcp_f32 v59, v59
  v_pk_mul_f32 v[44:45], v[52:53], v[44:45]
  v_pk_mul_f32 v[46:47], v[54:55], v[46:47]
  v_pk_mul_f32 v[48:49], v[56:57], v[48:49]
  v_pk_mul_f32 v[50:51], v[58:59], v[50:51]
  v_cvt_pk_bf16_f32 v60, v44, v45
  v_cvt_pk_bf16_f32 v62, v48, v49
  v_cvt_pk_bf16_f32 v61, v46, v47
  v_cvt_pk_bf16_f32 v63, v50, v51
  s_nop 0
  v_permlane16_swap_b32 v60, v62
  v_permlane16_swap_b32 v61, v63
  buffer_store_dwordx4 v[60:63], v18, s[12:15], s26 offen offset:3072 sc1
  s_add_u32 s27, s26, 4096
  v_accvgpr_read_b32 v24, a224
  v_accvgpr_read_b32 v25, a225
  v_accvgpr_read_b32 v26, a226
  v_accvgpr_read_b32 v27, a227
  v_accvgpr_read_b32 v28, a228
  v_accvgpr_read_b32 v29, a229
  v_accvgpr_read_b32 v30, a230
  v_accvgpr_read_b32 v31, a231
  v_pk_add_f32 v[24:25], v[24:25], v[160:161]
  v_pk_add_f32 v[26:27], v[26:27], v[162:163]
  v_pk_add_f32 v[28:29], v[28:29], v[160:161]
  v_pk_add_f32 v[30:31], v[30:31], v[162:163]
  v_pk_mul_f32 v[32:33], v[24:25], v[24:25]
  v_pk_mul_f32 v[34:35], v[26:27], v[26:27]
  v_pk_mul_f32 v[36:37], v[28:29], v[28:29]
  v_pk_mul_f32 v[38:39], v[30:31], v[30:31]
  v_pk_fma_f32 v[32:33], v[32:33], s[42:43], v[20:21]
  v_pk_fma_f32 v[34:35], v[34:35], s[42:43], v[20:21]
  v_pk_fma_f32 v[36:37], v[36:37], s[42:43], v[20:21]
  v_pk_fma_f32 v[38:39], v[38:39], s[42:43], v[20:21]
  v_pk_mul_f32 v[32:33], v[32:33], v[24:25]
  v_pk_mul_f32 v[34:35], v[34:35], v[26:27]
  v_pk_mul_f32 v[36:37], v[36:37], v[28:29]
  v_pk_mul_f32 v[38:39], v[38:39], v[30:31]
  v_exp_f32 v32, v32
  v_exp_f32 v33, v33
  v_exp_f32 v34, v34
  v_exp_f32 v35, v35
  v_exp_f32 v36, v36
  v_exp_f32 v37, v37
  v_exp_f32 v38, v38
  v_exp_f32 v39, v39
  v_pk_add_f32 v[32:33], v[32:33], 1.0 op_sel_hi:[1,0]
  v_pk_add_f32 v[34:35], v[34:35], 1.0 op_sel_hi:[1,0]
  v_pk_add_f32 v[36:37], v[36:37], 1.0 op_sel_hi:[1,0]
  v_pk_add_f32 v[38:39], v[38:39], 1.0 op_sel_hi:[1,0]
  v_rcp_f32 v32, v32
  v_rcp_f32 v33, v33
  v_rcp_f32 v34, v34
  v_rcp_f32 v35, v35
  v_rcp_f32 v36, v36
  v_rcp_f32 v37, v37
  v_rcp_f32 v38, v38
  v_rcp_f32 v39, v39
  v_pk_mul_f32 v[24:25], v[32:33], v[24:25]
  v_pk_mul_f32 v[26:27], v[34:35], v[26:27]
  v_pk_mul_f32 v[28:29], v[36:37], v[28:29]
  v_pk_mul_f32 v[30:31], v[38:39], v[30:31]
  v_cvt_pk_bf16_f32 v40, v24, v25
  v_cvt_pk_bf16_f32 v42, v28, v29
  v_cvt_pk_bf16_f32 v41, v26, v27
  v_cvt_pk_bf16_f32 v43, v30, v31
  s_nop 0
  v_permlane16_swap_b32 v40, v42
  v_permlane16_swap_b32 v41, v43
  buffer_store_dwordx4 v[40:43], v18, s[12:15], s27 offen offset:0 sc1
  v_accvgpr_read_b32 v44, a232
  v_accvgpr_read_b32 v45, a233
  v_accvgpr_read_b32 v46, a234
  v_accvgpr_read_b32 v47, a235
  v_accvgpr_read_b32 v48, a236
  v_accvgpr_read_b32 v49, a237
  v_accvgpr_read_b32 v50, a238
  v_accvgpr_read_b32 v51, a239
  v_pk_add_f32 v[44:45], v[44:45], v[168:169]
  v_pk_add_f32 v[46:47], v[46:47], v[170:171]
  v_pk_add_f32 v[48:49], v[48:49], v[168:169]
  v_pk_add_f32 v[50:51], v[50:51], v[170:171]
  v_pk_mul_f32 v[52:53], v[44:45], v[44:45]
  v_pk_mul_f32 v[54:55], v[46:47], v[46:47]
  v_pk_mul_f32 v[56:57], v[48:49], v[48:49]
  v_pk_mul_f32 v[58:59], v[50:51], v[50:51]
  v_pk_fma_f32 v[52:53], v[52:53], s[42:43], v[20:21]
  v_pk_fma_f32 v[54:55], v[54:55], s[42:43], v[20:21]
  v_pk_fma_f32 v[56:57], v[56:57], s[42:43], v[20:21]
  v_pk_fma_f32 v[58:59], v[58:59], s[42:43], v[20:21]
  v_pk_mul_f32 v[52:53], v[52:53], v[44:45]
  v_pk_mul_f32 v[54:55], v[54:55], v[46:47]
  v_pk_mul_f32 v[56:57], v[56:57], v[48:49]
  v_pk_mul_f32 v[58:59], v[58:59], v[50:51]
  v_exp_f32 v52, v52
  v_exp_f32 v53, v53
  v_exp_f32 v54, v54
  v_exp_f32 v55, v55
  v_exp_f32 v56, v56
  v_exp_f32 v57, v57
  v_exp_f32 v58, v58
  v_exp_f32 v59, v59
  v_pk_add_f32 v[52:53], v[52:53], 1.0 op_sel_hi:[1,0]
  v_pk_add_f32 v[54:55], v[54:55], 1.0 op_sel_hi:[1,0]
  v_pk_add_f32 v[56:57], v[56:57], 1.0 op_sel_hi:[1,0]
  v_pk_add_f32 v[58:59], v[58:59], 1.0 op_sel_hi:[1,0]
  v_rcp_f32 v52, v52
  v_rcp_f32 v53, v53
  v_rcp_f32 v54, v54
  v_rcp_f32 v55, v55
  v_rcp_f32 v56, v56
  v_rcp_f32 v57, v57
  v_rcp_f32 v58, v58
  v_rcp_f32 v59, v59
  v_pk_mul_f32 v[44:45], v[52:53], v[44:45]
  v_pk_mul_f32 v[46:47], v[54:55], v[46:47]
  v_pk_mul_f32 v[48:49], v[56:57], v[48:49]
  v_pk_mul_f32 v[50:51], v[58:59], v[50:51]
  v_cvt_pk_bf16_f32 v60, v44, v45
  v_cvt_pk_bf16_f32 v62, v48, v49
  v_cvt_pk_bf16_f32 v61, v46, v47
  v_cvt_pk_bf16_f32 v63, v50, v51
  s_nop 0
  v_permlane16_swap_b32 v60, v62
  v_permlane16_swap_b32 v61, v63
  buffer_store_dwordx4 v[60:63], v18, s[12:15], s27 offen offset:1024 sc1
  v_accvgpr_read_b32 v24, a240
  v_accvgpr_read_b32 v25, a241
  v_accvgpr_read_b32 v26, a242
  v_accvgpr_read_b32 v27, a243
  v_accvgpr_read_b32 v28, a244
  v_accvgpr_read_b32 v29, a245
  v_accvgpr_read_b32 v30, a246
  v_accvgpr_read_b32 v31, a247
  v_pk_add_f32 v[24:25], v[24:25], v[176:177]
  v_pk_add_f32 v[26:27], v[26:27], v[178:179]
  v_pk_add_f32 v[28:29], v[28:29], v[176:177]
  v_pk_add_f32 v[30:31], v[30:31], v[178:179]
  v_pk_mul_f32 v[32:33], v[24:25], v[24:25]
  v_pk_mul_f32 v[34:35], v[26:27], v[26:27]
  v_pk_mul_f32 v[36:37], v[28:29], v[28:29]
  v_pk_mul_f32 v[38:39], v[30:31], v[30:31]
  v_pk_fma_f32 v[32:33], v[32:33], s[42:43], v[20:21]
  v_pk_fma_f32 v[34:35], v[34:35], s[42:43], v[20:21]
  v_pk_fma_f32 v[36:37], v[36:37], s[42:43], v[20:21]
  v_pk_fma_f32 v[38:39], v[38:39], s[42:43], v[20:21]
  v_pk_mul_f32 v[32:33], v[32:33], v[24:25]
  v_pk_mul_f32 v[34:35], v[34:35], v[26:27]
  v_pk_mul_f32 v[36:37], v[36:37], v[28:29]
  v_pk_mul_f32 v[38:39], v[38:39], v[30:31]
  v_exp_f32 v32, v32
  v_exp_f32 v33, v33
  v_exp_f32 v34, v34
  v_exp_f32 v35, v35
  v_exp_f32 v36, v36
  v_exp_f32 v37, v37
  v_exp_f32 v38, v38
  v_exp_f32 v39, v39
  v_pk_add_f32 v[32:33], v[32:33], 1.0 op_sel_hi:[1,0]
  v_pk_add_f32 v[34:35], v[34:35], 1.0 op_sel_hi:[1,0]
  v_pk_add_f32 v[36:37], v[36:37], 1.0 op_sel_hi:[1,0]
  v_pk_add_f32 v[38:39], v[38:39], 1.0 op_sel_hi:[1,0]
  v_rcp_f32 v32, v32
  v_rcp_f32 v33, v33
  v_rcp_f32 v34, v34
  v_rcp_f32 v35, v35
  v_rcp_f32 v36, v36
  v_rcp_f32 v37, v37
  v_rcp_f32 v38, v38
  v_rcp_f32 v39, v39
  v_pk_mul_f32 v[24:25], v[32:33], v[24:25]
  v_pk_mul_f32 v[26:27], v[34:35], v[26:27]
  v_pk_mul_f32 v[28:29], v[36:37], v[28:29]
  v_pk_mul_f32 v[30:31], v[38:39], v[30:31]
  v_cvt_pk_bf16_f32 v40, v24, v25
  v_cvt_pk_bf16_f32 v42, v28, v29
  v_cvt_pk_bf16_f32 v41, v26, v27
  v_cvt_pk_bf16_f32 v43, v30, v31
  s_nop 0
  v_permlane16_swap_b32 v40, v42
  v_permlane16_swap_b32 v41, v43
  buffer_store_dwordx4 v[40:43], v18, s[12:15], s27 offen offset:2048 sc1
  v_accvgpr_read_b32 v44, a248
  v_accvgpr_read_b32 v45, a249
  v_accvgpr_read_b32 v46, a250
  v_accvgpr_read_b32 v47, a251
  v_accvgpr_read_b32 v48, a252
  v_accvgpr_read_b32 v49, a253
  v_accvgpr_read_b32 v50, a254
  v_accvgpr_read_b32 v51, a255
  v_pk_add_f32 v[44:45], v[44:45], v[184:185]
  v_pk_add_f32 v[46:47], v[46:47], v[186:187]
  v_pk_add_f32 v[48:49], v[48:49], v[184:185]
  v_pk_add_f32 v[50:51], v[50:51], v[186:187]
  v_pk_mul_f32 v[52:53], v[44:45], v[44:45]
  v_pk_mul_f32 v[54:55], v[46:47], v[46:47]
  v_pk_mul_f32 v[56:57], v[48:49], v[48:49]
  v_pk_mul_f32 v[58:59], v[50:51], v[50:51]
  v_pk_fma_f32 v[52:53], v[52:53], s[42:43], v[20:21]
  v_pk_fma_f32 v[54:55], v[54:55], s[42:43], v[20:21]
  v_pk_fma_f32 v[56:57], v[56:57], s[42:43], v[20:21]
  v_pk_fma_f32 v[58:59], v[58:59], s[42:43], v[20:21]
  v_pk_mul_f32 v[52:53], v[52:53], v[44:45]
  v_pk_mul_f32 v[54:55], v[54:55], v[46:47]
  v_pk_mul_f32 v[56:57], v[56:57], v[48:49]
  v_pk_mul_f32 v[58:59], v[58:59], v[50:51]
  v_exp_f32 v52, v52
  v_exp_f32 v53, v53
  v_exp_f32 v54, v54
  v_exp_f32 v55, v55
  v_exp_f32 v56, v56
  v_exp_f32 v57, v57
  v_exp_f32 v58, v58
  v_exp_f32 v59, v59
  v_pk_add_f32 v[52:53], v[52:53], 1.0 op_sel_hi:[1,0]
  v_pk_add_f32 v[54:55], v[54:55], 1.0 op_sel_hi:[1,0]
  v_pk_add_f32 v[56:57], v[56:57], 1.0 op_sel_hi:[1,0]
  v_pk_add_f32 v[58:59], v[58:59], 1.0 op_sel_hi:[1,0]
  v_rcp_f32 v52, v52
  v_rcp_f32 v53, v53
  v_rcp_f32 v54, v54
  v_rcp_f32 v55, v55
  v_rcp_f32 v56, v56
  v_rcp_f32 v57, v57
  v_rcp_f32 v58, v58
  v_rcp_f32 v59, v59
  v_pk_mul_f32 v[44:45], v[52:53], v[44:45]
  v_pk_mul_f32 v[46:47], v[54:55], v[46:47]
  v_pk_mul_f32 v[48:49], v[56:57], v[48:49]
  v_pk_mul_f32 v[50:51], v[58:59], v[50:51]
  v_cvt_pk_bf16_f32 v60, v44, v45
  v_cvt_pk_bf16_f32 v62, v48, v49
  v_cvt_pk_bf16_f32 v61, v46, v47
  v_cvt_pk_bf16_f32 v63, v50, v51
  s_nop 0
  v_permlane16_swap_b32 v60, v62
  v_permlane16_swap_b32 v61, v63
  buffer_store_dwordx4 v[60:63], v18, s[12:15], s27 offen offset:3072 sc1
  s_lshl1_add_u32 s26, s22, s26
  s_branch .g_ed
.g_eb:
  s_movk_i32 s54, 84
  s_lshr_b32 s26, s23, 1
  s_mul_i32 s26, s26, 1
  s_mul_i32 s26, s26, s22
  s_and_b32 s27, s23, 1
  s_mul_i32 s28, s27, 8192
  s_add_u32 s26, s26, s28
  v_lshlrev_b32 v18, 4, v1
  v_lshrrev_b32 v19, 4, v1
  v_lshlrev_b32 v19, 3, v19
  s_mul_i32 s28, s27, 256
  buffer_load_dwordx2 v[64:65], v19, s[36:39], s28 offen offset:0
  buffer_load_dwordx2 v[66:67], v19, s[36:39], s28 offen offset:32
  buffer_load_dwordx2 v[68:69], v19, s[36:39], s28 offen offset:64
  buffer_load_dwordx2 v[70:71], v19, s[36:39], s28 offen offset:96
  buffer_load_dwordx2 v[72:73], v19, s[36:39], s28 offen offset:128
  buffer_load_dwordx2 v[74:75], v19, s[36:39], s28 offen offset:160
  buffer_load_dwordx2 v[76:77], v19, s[36:39], s28 offen offset:192
  buffer_load_dwordx2 v[78:79], v19, s[36:39], s28 offen offset:224
  s_waitcnt vmcnt(0)
  v_lshlrev_b32 v128, 16, v64
  v_and_b32 v129, 0xffff0000, v64
  v_lshlrev_b32 v130, 16, v65
  v_and_b32 v131, 0xffff0000, v65
  v_lshlrev_b32 v136, 16, v66
  v_and_b32 v137, 0xffff0000, v66
  v_lshlrev_b32 v138, 16, v67
  v_and_b32 v139, 0xffff0000, v67
  v_lshlrev_b32 v144, 16, v68
  v_and_b32 v145, 0xffff0000, v68
  v_lshlrev_b32 v146, 16, v69
  v_and_b32 v147, 0xffff0000, v69
  v_lshlrev_b32 v152, 16, v70
  v_and_b32 v153, 0xffff0000, v70
  v_lshlrev_b32 v154, 16, v71
  v_and_b32 v155, 0xffff0000, v71
  v_lshlrev_b32 v160, 16, v72
  v_and_b32 v161, 0xffff0000, v72
  v_lshlrev_b32 v162, 16, v73
  v_and_b32 v163, 0xffff0000, v73
  v_lshlrev_b32 v168, 16, v74
  v_and_b32 v169, 0xffff0000, v74
  v_lshlrev_b32 v170, 16, v75
  v_and_b32 v171, 0xffff0000, v75
  v_lshlrev_b32 v176, 16, v76
  v_and_b32 v177, 0xffff0000, v76
  v_lshlrev_b32 v178, 16, v77
  v_and_b32 v179, 0xffff0000, v77
  v_lshlrev_b32 v184, 16, v78
  v_and_b32 v185, 0xffff0000, v78
  v_lshlrev_b32 v186, 16, v79
  v_and_b32 v187, 0xffff0000, v79
  v_accvgpr_read_b32 v24, a0
  v_accvgpr_read_b32 v25, a1
  v_accvgpr_read_b32 v26, a2
  v_accvgpr_read_b32 v27, a3
  v_accvgpr_read_b32 v28, a4
  v_accvgpr_read_b32 v29, a5
  v_accvgpr_read_b32 v30, a6
  v_accvgpr_read_b32 v31, a7
  v_pk_add_f32 v[24:25], v[24:25], v[128:129]
  v_pk_add_f32 v[26:27], v[26:27], v[130:131]
  v_pk_add_f32 v[28:29], v[28:29], v[128:129]
  v_pk_add_f32 v[30:31], v[30:31], v[130:131]
  v_cvt_pk_bf16_f32 v40, v24, v25
  v_cvt_pk_bf16_f32 v42, v28, v29
  v_cvt_pk_bf16_f32 v41, v26, v27
  v_cvt_pk_bf16_f32 v43, v30, v31
  s_nop 0
  v_permlane16_swap_b32 v40, v42
  v_permlane16_swap_b32 v41, v43
  buffer_store_dwordx4 v[40:43], v18, s[12:15], s26 offen offset:0 sc1
  v_accvgpr_read_b32 v44, a8
  v_accvgpr_read_b32 v45, a9
  v_accvgpr_read_b32 v46, a10
  v_accvgpr_read_b32 v47, a11
  v_accvgpr_read_b32 v48, a12
  v_accvgpr_read_b32 v49, a13
  v_accvgpr_read_b32 v50, a14
  v_accvgpr_read_b32 v51, a15
  v_pk_add_f32 v[44:45], v[44:45], v[136:137]
  v_pk_add_f32 v[46:47], v[46:47], v[138:139]
  v_pk_add_f32 v[48:49], v[48:49], v[136:137]
  v_pk_add_f32 v[50:51], v[50:51], v[138:139]
  v_cvt_pk_bf16_f32 v60, v44, v45
  v_cvt_pk_bf16_f32 v62, v48, v49
  v_cvt_pk_bf16_f32 v61, v46, v47
  v_cvt_pk_bf16_f32 v63, v50, v51
  s_nop 0
  v_permlane16_swap_b32 v60, v62
  v_permlane16_swap_b32 v61, v63
  buffer_store_dwordx4 v[60:63], v18, s[12:15], s26 offen offset:1024 sc1
  v_accvgpr_read_b32 v24, a16
  v_accvgpr_read_b32 v25, a17
  v_accvgpr_read_b32 v26, a18
  v_accvgpr_read_b32 v27, a19
  v_accvgpr_read_b32 v28, a20
  v_accvgpr_read_b32 v29, a21
  v_accvgpr_read_b32 v30, a22
  v_accvgpr_read_b32 v31, a23
  v_pk_add_f32 v[24:25], v[24:25], v[144:145]
  v_pk_add_f32 v[26:27], v[26:27], v[146:147]
  v_pk_add_f32 v[28:29], v[28:29], v[144:145]
  v_pk_add_f32 v[30:31], v[30:31], v[146:147]
  v_cvt_pk_bf16_f32 v40, v24, v25
  v_cvt_pk_bf16_f32 v42, v28, v29
  v_cvt_pk_bf16_f32 v41, v26, v27
  v_cvt_pk_bf16_f32 v43, v30, v31
  s_nop 0
  v_permlane16_swap_b32 v40, v42
  v_permlane16_swap_b32 v41, v43
  buffer_store_dwordx4 v[40:43], v18, s[12:15], s26 offen offset:2048 sc1
  v_accvgpr_read_b32 v44, a24
  v_accvgpr_read_b32 v45, a25
  v_accvgpr_read_b32 v46, a26
  v_accvgpr_read_b32 v47, a27
  v_accvgpr_read_b32 v48, a28
  v_accvgpr_read_b32 v49, a29
  v_accvgpr_read_b32 v50, a30
  v_accvgpr_read_b32 v51, a31
  v_pk_add_f32 v[44:45], v[44:45], v[152:153]
  v_pk_add_f32 v[46:47], v[46:47], v[154:155]
  v_pk_add_f32 v[48:49], v[48:49], v[152:153]
  v_pk_add_f32 v[50:51], v[50:51], v[154:155]
  v_cvt_pk_bf16_f32 v60, v44, v45
  v_cvt_pk_bf16_f32 v62, v48, v49
  v_cvt_pk_bf16_f32 v61, v46, v47
  v_cvt_pk_bf16_f32 v63, v50, v51
  s_nop 0
  v_permlane16_swap_b32 v60, v62
  v_permlane16_swap_b32 v61, v63
  buffer_store_dwordx4 v[60:63], v18, s[12:15], s26 offen offset:3072 sc1
  s_add_u32 s27, s26, 4096
  v_accvgpr_read_b32 v24, a32
  v_accvgpr_read_b32 v25, a33
  v_accvgpr_read_b32 v26, a34
  v_accvgpr_read_b32 v27, a35
  v_accvgpr_read_b32 v28, a36
  v_accvgpr_read_b32 v29, a37
  v_accvgpr_read_b32 v30, a38
  v_accvgpr_read_b32 v31, a39
  v_pk_add_f32 v[24:25], v[24:25], v[160:161]
  v_pk_add_f32 v[26:27], v[26:27], v[162:163]
  v_pk_add_f32 v[28:29], v[28:29], v[160:161]
  v_pk_add_f32 v[30:31], v[30:31], v[162:163]
  v_cvt_pk_bf16_f32 v40, v24, v25
  v_cvt_pk_bf16_f32 v42, v28, v29
  v_cvt_pk_bf16_f32 v41, v26, v27
  v_cvt_pk_bf16_f32 v43, v30, v31
  s_nop 0
  v_permlane16_swap_b32 v40, v42
  v_permlane16_swap_b32 v41, v43
  buffer_store_dwordx4 v[40:43], v18, s[12:15], s27 offen offset:0 sc1
  v_accvgpr_read_b32 v44, a40
  v_accvgpr_read_b32 v45, a41
  v_accvgpr_read_b32 v46, a42
  v_accvgpr_read_b32 v47, a43
  v_accvgpr_read_b32 v48, a44
  v_accvgpr_read_b32 v49, a45
  v_accvgpr_read_b32 v50, a46
  v_accvgpr_read_b32 v51, a47
  v_pk_add_f32 v[44:45], v[44:45], v[168:169]
  v_pk_add_f32 v[46:47], v[46:47], v[170:171]
  v_pk_add_f32 v[48:49], v[48:49], v[168:169]
  v_pk_add_f32 v[50:51], v[50:51], v[170:171]
  v_cvt_pk_bf16_f32 v60, v44, v45
  v_cvt_pk_bf16_f32 v62, v48, v49
  v_cvt_pk_bf16_f32 v61, v46, v47
  v_cvt_pk_bf16_f32 v63, v50, v51
  s_nop 0
  v_permlane16_swap_b32 v60, v62
  v_permlane16_swap_b32 v61, v63
  buffer_store_dwordx4 v[60:63], v18, s[12:15], s27 offen offset:1024 sc1
  v_accvgpr_read_b32 v24, a48
  v_accvgpr_read_b32 v25, a49
  v_accvgpr_read_b32 v26, a50
  v_accvgpr_read_b32 v27, a51
  v_accvgpr_read_b32 v28, a52
  v_accvgpr_read_b32 v29, a53
  v_accvgpr_read_b32 v30, a54
  v_accvgpr_read_b32 v31, a55
  v_pk_add_f32 v[24:25], v[24:25], v[176:177]
  v_pk_add_f32 v[26:27], v[26:27], v[178:179]
  v_pk_add_f32 v[28:29], v[28:29], v[176:177]
  v_pk_add_f32 v[30:31], v[30:31], v[178:179]
  v_cvt_pk_bf16_f32 v40, v24, v25
  v_cvt_pk_bf16_f32 v42, v28, v29
  v_cvt_pk_bf16_f32 v41, v26, v27
  v_cvt_pk_bf16_f32 v43, v30, v31
  s_nop 0
  v_permlane16_swap_b32 v40, v42
  v_permlane16_swap_b32 v41, v43
  buffer_store_dwordx4 v[40:43], v18, s[12:15], s27 offen offset:2048 sc1
  v_accvgpr_read_b32 v44, a56
  v_accvgpr_read_b32 v45, a57
  v_accvgpr_read_b32 v46, a58
  v_accvgpr_read_b32 v47, a59
  v_accvgpr_read_b32 v48, a60
  v_accvgpr_read_b32 v49, a61
  v_accvgpr_read_b32 v50, a62
  v_accvgpr_read_b32 v51, a63
  v_pk_add_f32 v[44:45], v[44:45], v[184:185]
  v_pk_add_f32 v[46:47], v[46:47], v[186:187]
  v_pk_add_f32 v[48:49], v[48:49], v[184:185]
  v_pk_add_f32 v[50:51], v[50:51], v[186:187]
  v_cvt_pk_bf16_f32 v60, v44, v45
  v_cvt_pk_bf16_f32 v62, v48, v49
  v_cvt_pk_bf16_f32 v61, v46, v47
  v_cvt_pk_bf16_f32 v63, v50, v51
  s_nop 0
  v_permlane16_swap_b32 v60, v62
  v_permlane16_swap_b32 v61, v63
  buffer_store_dwordx4 v[60:63], v18, s[12:15], s27 offen offset:3072 sc1
  s_lshl1_add_u32 s26, s22, s26
  v_accvgpr_read_b32 v24, a64
  v_accvgpr_read_b32 v25, a65
  v_accvgpr_read_b32 v26, a66
  v_accvgpr_read_b32 v27, a67
  v_accvgpr_read_b32 v28, a68
  v_accvgpr_read_b32 v29, a69
  v_accvgpr_read_b32 v30, a70
  v_accvgpr_read_b32 v31, a71
  v_pk_add_f32 v[24:25], v[24:25], v[128:129]
  v_pk_add_f32 v[26:27], v[26:27], v[130:131]
  v_pk_add_f32 v[28:29], v[28:29], v[128:129]
  v_pk_add_f32 v[30:31], v[30:31], v[130:131]
  v_cvt_pk_bf16_f32 v40, v24, v25
  v_cvt_pk_bf16_f32 v42, v28, v29
  v_cvt_pk_bf16_f32 v41, v26, v27
  v_cvt_pk_bf16_f32 v43, v30, v31
  s_nop 0
  v_permlane16_swap_b32 v40, v42
  v_permlane16_swap_b32 v41, v43
  buffer_store_dwordx4 v[40:43], v18, s[12:15], s26 offen offset:0 sc1
  v_accvgpr_read_b32 v44, a72
  v_accvgpr_read_b32 v45, a73
  v_accvgpr_read_b32 v46, a74
  v_accvgpr_read_b32 v47, a75
  v_accvgpr_read_b32 v48, a76
  v_accvgpr_read_b32 v49, a77
  v_accvgpr_read_b32 v50, a78
  v_accvgpr_read_b32 v51, a79
  v_pk_add_f32 v[44:45], v[44:45], v[136:137]
  v_pk_add_f32 v[46:47], v[46:47], v[138:139]
  v_pk_add_f32 v[48:49], v[48:49], v[136:137]
  v_pk_add_f32 v[50:51], v[50:51], v[138:139]
  v_cvt_pk_bf16_f32 v60, v44, v45
  v_cvt_pk_bf16_f32 v62, v48, v49
  v_cvt_pk_bf16_f32 v61, v46, v47
  v_cvt_pk_bf16_f32 v63, v50, v51
  s_nop 0
  v_permlane16_swap_b32 v60, v62
  v_permlane16_swap_b32 v61, v63
  buffer_store_dwordx4 v[60:63], v18, s[12:15], s26 offen offset:1024 sc1
  v_accvgpr_read_b32 v24, a80
  v_accvgpr_read_b32 v25, a81
  v_accvgpr_read_b32 v26, a82
  v_accvgpr_read_b32 v27, a83
  v_accvgpr_read_b32 v28, a84
  v_accvgpr_read_b32 v29, a85
  v_accvgpr_read_b32 v30, a86
  v_accvgpr_read_b32 v31, a87
  v_pk_add_f32 v[24:25], v[24:25], v[144:145]
  v_pk_add_f32 v[26:27], v[26:27], v[146:147]
  v_pk_add_f32 v[28:29], v[28:29], v[144:145]
  v_pk_add_f32 v[30:31], v[30:31], v[146:147]
  v_cvt_pk_bf16_f32 v40, v24, v25
  v_cvt_pk_bf16_f32 v42, v28, v29
  v_cvt_pk_bf16_f32 v41, v26, v27
  v_cvt_pk_bf16_f32 v43, v30, v31
  s_nop 0
  v_permlane16_swap_b32 v40, v42
  v_permlane16_swap_b32 v41, v43
  buffer_store_dwordx4 v[40:43], v18, s[12:15], s26 offen offset:2048 sc1
  v_accvgpr_read_b32 v44, a88
  v_accvgpr_read_b32 v45, a89
  v_accvgpr_read_b32 v46, a90
  v_accvgpr_read_b32 v47, a91
  v_accvgpr_read_b32 v48, a92
  v_accvgpr_read_b32 v49, a93
  v_accvgpr_read_b32 v50, a94
  v_accvgpr_read_b32 v51, a95
  v_pk_add_f32 v[44:45], v[44:45], v[152:153]
  v_pk_add_f32 v[46:47], v[46:47], v[154:155]
  v_pk_add_f32 v[48:49], v[48:49], v[152:153]
  v_pk_add_f32 v[50:51], v[50:51], v[154:155]
  v_cvt_pk_bf16_f32 v60, v44, v45
  v_cvt_pk_bf16_f32 v62, v48, v49
  v_cvt_pk_bf16_f32 v61, v46, v47
  v_cvt_pk_bf16_f32 v63, v50, v51
  s_nop 0
  v_permlane16_swap_b32 v60, v62
  v_permlane16_swap_b32 v61, v63
  buffer_store_dwordx4 v[60:63], v18, s[12:15], s26 offen offset:3072 sc1
  s_add_u32 s27, s26, 4096
  v_accvgpr_read_b32 v24, a96
  v_accvgpr_read_b32 v25, a97
  v_accvgpr_read_b32 v26, a98
  v_accvgpr_read_b32 v27, a99
  v_accvgpr_read_b32 v28, a100
  v_accvgpr_read_b32 v29, a101
  v_accvgpr_read_b32 v30, a102
  v_accvgpr_read_b32 v31, a103
  v_pk_add_f32 v[24:25], v[24:25], v[160:161]
  v_pk_add_f32 v[26:27], v[26:27], v[162:163]
  v_pk_add_f32 v[28:29], v[28:29], v[160:161]
  v_pk_add_f32 v[30:31], v[30:31], v[162:163]
  v_cvt_pk_bf16_f32 v40, v24, v25
  v_cvt_pk_bf16_f32 v42, v28, v29
  v_cvt_pk_bf16_f32 v41, v26, v27
  v_cvt_pk_bf16_f32 v43, v30, v31
  s_nop 0
  v_permlane16_swap_b32 v40, v42
  v_permlane16_swap_b32 v41, v43
  buffer_store_dwordx4 v[40:43], v18, s[12:15], s27 offen offset:0 sc1
  v_accvgpr_read_b32 v44, a104
  v_accvgpr_read_b32 v45, a105
  v_accvgpr_read_b32 v46, a106
  v_accvgpr_read_b32 v47, a107
  v_accvgpr_read_b32 v48, a108
  v_accvgpr_read_b32 v49, a109
  v_accvgpr_read_b32 v50, a110
  v_accvgpr_read_b32 v51, a111
  v_pk_add_f32 v[44:45], v[44:45], v[168:169]
  v_pk_add_f32 v[46:47], v[46:47], v[170:171]
  v_pk_add_f32 v[48:49], v[48:49], v[168:169]
  v_pk_add_f32 v[50:51], v[50:51], v[170:171]
  v_cvt_pk_bf16_f32 v60, v44, v45
  v_cvt_pk_bf16_f32 v62, v48, v49
  v_cvt_pk_bf16_f32 v61, v46, v47
  v_cvt_pk_bf16_f32 v63, v50, v51
  s_nop 0
  v_permlane16_swap_b32 v60, v62
  v_permlane16_swap_b32 v61, v63
  buffer_store_dwordx4 v[60:63], v18, s[12:15], s27 offen offset:1024 sc1
  v_accvgpr_read_b32 v24, a112
  v_accvgpr_read_b32 v25, a113
  v_accvgpr_read_b32 v26, a114
  v_accvgpr_read_b32 v27, a115
  v_accvgpr_read_b32 v28, a116
  v_accvgpr_read_b32 v29, a117
  v_accvgpr_read_b32 v30, a118
  v_accvgpr_read_b32 v31, a119
  v_pk_add_f32 v[24:25], v[24:25], v[176:177]
  v_pk_add_f32 v[26:27], v[26:27], v[178:179]
  v_pk_add_f32 v[28:29], v[28:29], v[176:177]
  v_pk_add_f32 v[30:31], v[30:31], v[178:179]
  v_cvt_pk_bf16_f32 v40, v24, v25
  v_cvt_pk_bf16_f32 v42, v28, v29
  v_cvt_pk_bf16_f32 v41, v26, v27
  v_cvt_pk_bf16_f32 v43, v30, v31
  s_nop 0
  v_permlane16_swap_b32 v40, v42
  v_permlane16_swap_b32 v41, v43
  buffer_store_dwordx4 v[40:43], v18, s[12:15], s27 offen offset:2048 sc1
  v_accvgpr_read_b32 v44, a120
  v_accvgpr_read_b32 v45, a121
  v_accvgpr_read_b32 v46, a122
  v_accvgpr_read_b32 v47, a123
  v_accvgpr_read_b32 v48, a124
  v_accvgpr_read_b32 v49, a125
  v_accvgpr_read_b32 v50, a126
  v_accvgpr_read_b32 v51, a127
  v_pk_add_f32 v[44:45], v[44:45], v[184:185]
  v_pk_add_f32 v[46:47], v[46:47], v[186:187]
  v_pk_add_f32 v[48:49], v[48:49], v[184:185]
  v_pk_add_f32 v[50:51], v[50:51], v[186:187]
  v_cvt_pk_bf16_f32 v60, v44, v45
  v_cvt_pk_bf16_f32 v62, v48, v49
  v_cvt_pk_bf16_f32 v61, v46, v47
  v_cvt_pk_bf16_f32 v63, v50, v51
  s_nop 0
  v_permlane16_swap_b32 v60, v62
  v_permlane16_swap_b32 v61, v63
  buffer_store_dwordx4 v[60:63], v18, s[12:15], s27 offen offset:3072 sc1
  s_lshl1_add_u32 s26, s22, s26
  v_accvgpr_read_b32 v24, a128
  v_accvgpr_read_b32 v25, a129
  v_accvgpr_read_b32 v26, a130
  v_accvgpr_read_b32 v27, a131
  v_accvgpr_read_b32 v28, a132
  v_accvgpr_read_b32 v29, a133
  v_accvgpr_read_b32 v30, a134
  v_accvgpr_read_b32 v31, a135
  v_pk_add_f32 v[24:25], v[24:25], v[128:129]
  v_pk_add_f32 v[26:27], v[26:27], v[130:131]
  v_pk_add_f32 v[28:29], v[28:29], v[128:129]
  v_pk_add_f32 v[30:31], v[30:31], v[130:131]
  v_cvt_pk_bf16_f32 v40, v24, v25
  v_cvt_pk_bf16_f32 v42, v28, v29
  v_cvt_pk_bf16_f32 v41, v26, v27
  v_cvt_pk_bf16_f32 v43, v30, v31
  s_nop 0
  v_permlane16_swap_b32 v40, v42
  v_permlane16_swap_b32 v41, v43
  buffer_store_dwordx4 v[40:43], v18, s[12:15], s26 offen offset:0 sc1
  v_accvgpr_read_b32 v44, a136
  v_accvgpr_read_b32 v45, a137
  v_accvgpr_read_b32 v46, a138
  v_accvgpr_read_b32 v47, a139
  v_accvgpr_read_b32 v48, a140
  v_accvgpr_read_b32 v49, a141
  v_accvgpr_read_b32 v50, a142
  v_accvgpr_read_b32 v51, a143
  v_pk_add_f32 v[44:45], v[44:45], v[136:137]
  v_pk_add_f32 v[46:47], v[46:47], v[138:139]
  v_pk_add_f32 v[48:49], v[48:49], v[136:137]
  v_pk_add_f32 v[50:51], v[50:51], v[138:139]
  v_cvt_pk_bf16_f32 v60, v44, v45
  v_cvt_pk_bf16_f32 v62, v48, v49
  v_cvt_pk_bf16_f32 v61, v46, v47
  v_cvt_pk_bf16_f32 v63, v50, v51
  s_nop 0
  v_permlane16_swap_b32 v60, v62
  v_permlane16_swap_b32 v61, v63
  buffer_store_dwordx4 v[60:63], v18, s[12:15], s26 offen offset:1024 sc1
  v_accvgpr_read_b32 v24, a144
  v_accvgpr_read_b32 v25, a145
  v_accvgpr_read_b32 v26, a146
  v_accvgpr_read_b32 v27, a147
  v_accvgpr_read_b32 v28, a148
  v_accvgpr_read_b32 v29, a149
  v_accvgpr_read_b32 v30, a150
  v_accvgpr_read_b32 v31, a151
  v_pk_add_f32 v[24:25], v[24:25], v[144:145]
  v_pk_add_f32 v[26:27], v[26:27], v[146:147]
  v_pk_add_f32 v[28:29], v[28:29], v[144:145]
  v_pk_add_f32 v[30:31], v[30:31], v[146:147]
  v_cvt_pk_bf16_f32 v40, v24, v25
  v_cvt_pk_bf16_f32 v42, v28, v29
  v_cvt_pk_bf16_f32 v41, v26, v27
  v_cvt_pk_bf16_f32 v43, v30, v31
  s_nop 0
  v_permlane16_swap_b32 v40, v42
  v_permlane16_swap_b32 v41, v43
  buffer_store_dwordx4 v[40:43], v18, s[12:15], s26 offen offset:2048 sc1
  v_accvgpr_read_b32 v44, a152
  v_accvgpr_read_b32 v45, a153
  v_accvgpr_read_b32 v46, a154
  v_accvgpr_read_b32 v47, a155
  v_accvgpr_read_b32 v48, a156
  v_accvgpr_read_b32 v49, a157
  v_accvgpr_read_b32 v50, a158
  v_accvgpr_read_b32 v51, a159
  v_pk_add_f32 v[44:45], v[44:45], v[152:153]
  v_pk_add_f32 v[46:47], v[46:47], v[154:155]
  v_pk_add_f32 v[48:49], v[48:49], v[152:153]
  v_pk_add_f32 v[50:51], v[50:51], v[154:155]
  v_cvt_pk_bf16_f32 v60, v44, v45
  v_cvt_pk_bf16_f32 v62, v48, v49
  v_cvt_pk_bf16_f32 v61, v46, v47
  v_cvt_pk_bf16_f32 v63, v50, v51
  s_nop 0
  v_permlane16_swap_b32 v60, v62
  v_permlane16_swap_b32 v61, v63
  buffer_store_dwordx4 v[60:63], v18, s[12:15], s26 offen offset:3072 sc1
  s_add_u32 s27, s26, 4096
  v_accvgpr_read_b32 v24, a160
  v_accvgpr_read_b32 v25, a161
  v_accvgpr_read_b32 v26, a162
  v_accvgpr_read_b32 v27, a163
  v_accvgpr_read_b32 v28, a164
  v_accvgpr_read_b32 v29, a165
  v_accvgpr_read_b32 v30, a166
  v_accvgpr_read_b32 v31, a167
  v_pk_add_f32 v[24:25], v[24:25], v[160:161]
  v_pk_add_f32 v[26:27], v[26:27], v[162:163]
  v_pk_add_f32 v[28:29], v[28:29], v[160:161]
  v_pk_add_f32 v[30:31], v[30:31], v[162:163]
  v_cvt_pk_bf16_f32 v40, v24, v25
  v_cvt_pk_bf16_f32 v42, v28, v29
  v_cvt_pk_bf16_f32 v41, v26, v27
  v_cvt_pk_bf16_f32 v43, v30, v31
  s_nop 0
  v_permlane16_swap_b32 v40, v42
  v_permlane16_swap_b32 v41, v43
  buffer_store_dwordx4 v[40:43], v18, s[12:15], s27 offen offset:0 sc1
  v_accvgpr_read_b32 v44, a168
  v_accvgpr_read_b32 v45, a169
  v_accvgpr_read_b32 v46, a170
  v_accvgpr_read_b32 v47, a171
  v_accvgpr_read_b32 v48, a172
  v_accvgpr_read_b32 v49, a173
  v_accvgpr_read_b32 v50, a174
  v_accvgpr_read_b32 v51, a175
  v_pk_add_f32 v[44:45], v[44:45], v[168:169]
  v_pk_add_f32 v[46:47], v[46:47], v[170:171]
  v_pk_add_f32 v[48:49], v[48:49], v[168:169]
  v_pk_add_f32 v[50:51], v[50:51], v[170:171]
  v_cvt_pk_bf16_f32 v60, v44, v45
  v_cvt_pk_bf16_f32 v62, v48, v49
  v_cvt_pk_bf16_f32 v61, v46, v47
  v_cvt_pk_bf16_f32 v63, v50, v51
  s_nop 0
  v_permlane16_swap_b32 v60, v62
  v_permlane16_swap_b32 v61, v63
  buffer_store_dwordx4 v[60:63], v18, s[12:15], s27 offen offset:1024 sc1
  v_accvgpr_read_b32 v24, a176
  v_accvgpr_read_b32 v25, a177
  v_accvgpr_read_b32 v26, a178
  v_accvgpr_read_b32 v27, a179
  v_accvgpr_read_b32 v28, a180
  v_accvgpr_read_b32 v29, a181
  v_accvgpr_read_b32 v30, a182
  v_accvgpr_read_b32 v31, a183
  v_pk_add_f32 v[24:25], v[24:25], v[176:177]
  v_pk_add_f32 v[26:27], v[26:27], v[178:179]
  v_pk_add_f32 v[28:29], v[28:29], v[176:177]
  v_pk_add_f32 v[30:31], v[30:31], v[178:179]
  v_cvt_pk_bf16_f32 v40, v24, v25
  v_cvt_pk_bf16_f32 v42, v28, v29
  v_cvt_pk_bf16_f32 v41, v26, v27
  v_cvt_pk_bf16_f32 v43, v30, v31
  s_nop 0
  v_permlane16_swap_b32 v40, v42
  v_permlane16_swap_b32 v41, v43
  buffer_store_dwordx4 v[40:43], v18, s[12:15], s27 offen offset:2048 sc1
  v_accvgpr_read_b32 v44, a184
  v_accvgpr_read_b32 v45, a185
  v_accvgpr_read_b32 v46, a186
  v_accvgpr_read_b32 v47, a187
  v_accvgpr_read_b32 v48, a188
  v_accvgpr_read_b32 v49, a189
  v_accvgpr_read_b32 v50, a190
  v_accvgpr_read_b32 v51, a191
  v_pk_add_f32 v[44:45], v[44:45], v[184:185]
  v_pk_add_f32 v[46:47], v[46:47], v[186:187]
  v_pk_add_f32 v[48:49], v[48:49], v[184:185]
  v_pk_add_f32 v[50:51], v[50:51], v[186:187]
  v_cvt_pk_bf16_f32 v60, v44, v45
  v_cvt_pk_bf16_f32 v62, v48, v49
  v_cvt_pk_bf16_f32 v61, v46, v47
  v_cvt_pk_bf16_f32 v63, v50, v51
  s_nop 0
  v_permlane16_swap_b32 v60, v62
  v_permlane16_swap_b32 v61, v63
  buffer_store_dwordx4 v[60:63], v18, s[12:15], s27 offen offset:3072 sc1
  s_lshl1_add_u32 s26, s22, s26
  v_accvgpr_read_b32 v24, a192
  v_accvgpr_read_b32 v25, a193
  v_accvgpr_read_b32 v26, a194
  v_accvgpr_read_b32 v27, a195
  v_accvgpr_read_b32 v28, a196
  v_accvgpr_read_b32 v29, a197
  v_accvgpr_read_b32 v30, a198
  v_accvgpr_read_b32 v31, a199
  v_pk_add_f32 v[24:25], v[24:25], v[128:129]
  v_pk_add_f32 v[26:27], v[26:27], v[130:131]
  v_pk_add_f32 v[28:29], v[28:29], v[128:129]
  v_pk_add_f32 v[30:31], v[30:31], v[130:131]
  v_cvt_pk_bf16_f32 v40, v24, v25
  v_cvt_pk_bf16_f32 v42, v28, v29
  v_cvt_pk_bf16_f32 v41, v26, v27
  v_cvt_pk_bf16_f32 v43, v30, v31
  s_nop 0
  v_permlane16_swap_b32 v40, v42
  v_permlane16_swap_b32 v41, v43
  buffer_store_dwordx4 v[40:43], v18, s[12:15], s26 offen offset:0 sc1
  v_accvgpr_read_b32 v44, a200
  v_accvgpr_read_b32 v45, a201
  v_accvgpr_read_b32 v46, a202
  v_accvgpr_read_b32 v47, a203
  v_accvgpr_read_b32 v48, a204
  v_accvgpr_read_b32 v49, a205
  v_accvgpr_read_b32 v50, a206
  v_accvgpr_read_b32 v51, a207
  v_pk_add_f32 v[44:45], v[44:45], v[136:137]
  v_pk_add_f32 v[46:47], v[46:47], v[138:139]
  v_pk_add_f32 v[48:49], v[48:49], v[136:137]
  v_pk_add_f32 v[50:51], v[50:51], v[138:139]
  v_cvt_pk_bf16_f32 v60, v44, v45
  v_cvt_pk_bf16_f32 v62, v48, v49
  v_cvt_pk_bf16_f32 v61, v46, v47
  v_cvt_pk_bf16_f32 v63, v50, v51
  s_nop 0
  v_permlane16_swap_b32 v60, v62
  v_permlane16_swap_b32 v61, v63
  buffer_store_dwordx4 v[60:63], v18, s[12:15], s26 offen offset:1024 sc1
  v_accvgpr_read_b32 v24, a208
  v_accvgpr_read_b32 v25, a209
  v_accvgpr_read_b32 v26, a210
  v_accvgpr_read_b32 v27, a211
  v_accvgpr_read_b32 v28, a212
  v_accvgpr_read_b32 v29, a213
  v_accvgpr_read_b32 v30, a214
  v_accvgpr_read_b32 v31, a215
  v_pk_add_f32 v[24:25], v[24:25], v[144:145]
  v_pk_add_f32 v[26:27], v[26:27], v[146:147]
  v_pk_add_f32 v[28:29], v[28:29], v[144:145]
  v_pk_add_f32 v[30:31], v[30:31], v[146:147]
  v_cvt_pk_bf16_f32 v40, v24, v25
  v_cvt_pk_bf16_f32 v42, v28, v29
  v_cvt_pk_bf16_f32 v41, v26, v27
  v_cvt_pk_bf16_f32 v43, v30, v31
  s_nop 0
  v_permlane16_swap_b32 v40, v42
  v_permlane16_swap_b32 v41, v43
  buffer_store_dwordx4 v[40:43], v18, s[12:15], s26 offen offset:2048 sc1
  v_accvgpr_read_b32 v44, a216
  v_accvgpr_read_b32 v45, a217
  v_accvgpr_read_b32 v46, a218
  v_accvgpr_read_b32 v47, a219
  v_accvgpr_read_b32 v48, a220
  v_accvgpr_read_b32 v49, a221
  v_accvgpr_read_b32 v50, a222
  v_accvgpr_read_b32 v51, a223
  v_pk_add_f32 v[44:45], v[44:45], v[152:153]
  v_pk_add_f32 v[46:47], v[46:47], v[154:155]
  v_pk_add_f32 v[48:49], v[48:49], v[152:153]
  v_pk_add_f32 v[50:51], v[50:51], v[154:155]
  v_cvt_pk_bf16_f32 v60, v44, v45
  v_cvt_pk_bf16_f32 v62, v48, v49
  v_cvt_pk_bf16_f32 v61, v46, v47
  v_cvt_pk_bf16_f32 v63, v50, v51
  s_nop 0
  v_permlane16_swap_b32 v60, v62
  v_permlane16_swap_b32 v61, v63
  buffer_store_dwordx4 v[60:63], v18, s[12:15], s26 offen offset:3072 sc1
  s_add_u32 s27, s26, 4096
  v_accvgpr_read_b32 v24, a224
  v_accvgpr_read_b32 v25, a225
  v_accvgpr_read_b32 v26, a226
  v_accvgpr_read_b32 v27, a227
  v_accvgpr_read_b32 v28, a228
  v_accvgpr_read_b32 v29, a229
  v_accvgpr_read_b32 v30, a230
  v_accvgpr_read_b32 v31, a231
  v_pk_add_f32 v[24:25], v[24:25], v[160:161]
  v_pk_add_f32 v[26:27], v[26:27], v[162:163]
  v_pk_add_f32 v[28:29], v[28:29], v[160:161]
  v_pk_add_f32 v[30:31], v[30:31], v[162:163]
  v_cvt_pk_bf16_f32 v40, v24, v25
  v_cvt_pk_bf16_f32 v42, v28, v29
  v_cvt_pk_bf16_f32 v41, v26, v27
  v_cvt_pk_bf16_f32 v43, v30, v31
  s_nop 0
  v_permlane16_swap_b32 v40, v42
  v_permlane16_swap_b32 v41, v43
  buffer_store_dwordx4 v[40:43], v18, s[12:15], s27 offen offset:0 sc1
  v_accvgpr_read_b32 v44, a232
  v_accvgpr_read_b32 v45, a233
  v_accvgpr_read_b32 v46, a234
  v_accvgpr_read_b32 v47, a235
  v_accvgpr_read_b32 v48, a236
  v_accvgpr_read_b32 v49, a237
  v_accvgpr_read_b32 v50, a238
  v_accvgpr_read_b32 v51, a239
  v_pk_add_f32 v[44:45], v[44:45], v[168:169]
  v_pk_add_f32 v[46:47], v[46:47], v[170:171]
  v_pk_add_f32 v[48:49], v[48:49], v[168:169]
  v_pk_add_f32 v[50:51], v[50:51], v[170:171]
  v_cvt_pk_bf16_f32 v60, v44, v45
  v_cvt_pk_bf16_f32 v62, v48, v49
  v_cvt_pk_bf16_f32 v61, v46, v47
  v_cvt_pk_bf16_f32 v63, v50, v51
  s_nop 0
  v_permlane16_swap_b32 v60, v62
  v_permlane16_swap_b32 v61, v63
  buffer_store_dwordx4 v[60:63], v18, s[12:15], s27 offen offset:1024 sc1
  v_accvgpr_read_b32 v24, a240
  v_accvgpr_read_b32 v25, a241
  v_accvgpr_read_b32 v26, a242
  v_accvgpr_read_b32 v27, a243
  v_accvgpr_read_b32 v28, a244
  v_accvgpr_read_b32 v29, a245
  v_accvgpr_read_b32 v30, a246
  v_accvgpr_read_b32 v31, a247
  v_pk_add_f32 v[24:25], v[24:25], v[176:177]
  v_pk_add_f32 v[26:27], v[26:27], v[178:179]
  v_pk_add_f32 v[28:29], v[28:29], v[176:177]
  v_pk_add_f32 v[30:31], v[30:31], v[178:179]
  v_cvt_pk_bf16_f32 v40, v24, v25
  v_cvt_pk_bf16_f32 v42, v28, v29
  v_cvt_pk_bf16_f32 v41, v26, v27
  v_cvt_pk_bf16_f32 v43, v30, v31
  s_nop 0
  v_permlane16_swap_b32 v40, v42
  v_permlane16_swap_b32 v41, v43
  buffer_store_dwordx4 v[40:43], v18, s[12:15], s27 offen offset:2048 sc1
  v_accvgpr_read_b32 v44, a248
  v_accvgpr_read_b32 v45, a249
  v_accvgpr_read_b32 v46, a250
  v_accvgpr_read_b32 v47, a251
  v_accvgpr_read_b32 v48, a252
  v_accvgpr_read_b32 v49, a253
  v_accvgpr_read_b32 v50, a254
  v_accvgpr_read_b32 v51, a255
  v_pk_add_f32 v[44:45], v[44:45], v[184:185]
  v_pk_add_f32 v[46:47], v[46:47], v[186:187]
  v_pk_add_f32 v[48:49], v[48:49], v[184:185]
  v_pk_add_f32 v[50:51], v[50:51], v[186:187]
  v_cvt_pk_bf16_f32 v60, v44, v45
  v_cvt_pk_bf16_f32 v62, v48, v49
  v_cvt_pk_bf16_f32 v61, v46, v47
  v_cvt_pk_bf16_f32 v63, v50, v51
  s_nop 0
  v_permlane16_swap_b32 v60, v62
  v_permlane16_swap_b32 v61, v63
  buffer_store_dwordx4 v[60:63], v18, s[12:15], s27 offen offset:3072 sc1
  s_lshl1_add_u32 s26, s22, s26
  s_sub_u32 s26, 105455616, s62
  s_add_u32 s40, s94, s26
  s_addc_u32 s41, s95, 0
  s_mov_b32 s42, 8192
  s_mov_b32 s43, 0x20000
  s_lshl_b32 s26, s31, 10
  v_lshlrev_b32 v18, 7, v1
  v_mov_b32 v19, 1
  s_waitcnt vmcnt(0)
  s_barrier
  s_cmp_lg_u32 s23, 0
  s_cbranch_scc1 .g_ed
  s_mov_b64 exec, 0xff
  buffer_atomic_add v19, v18, s[40:43], s26 offen sc1
  s_mov_b64 exec, -1
  s_branch .g_ed
.g_end2:
  s_endpgm
.g_eq:
  s_movk_i32 s54, 84
  s_add_u32 s12, s94, 0
  s_addc_u32 s13, s95, 0
  s_mov_b32 s14, 266338304
  s_mov_b32 s15, 0x20000
  v_lshlrev_b32 v232, 4, v1
  v_lshrrev_b32 v236, 5, v1
  v_and_b32 v233, 7, v1
  v_lshl_add_u32 v233, v236, 3, v233
  v_lshlrev_b32 v233, 4, v233
  v_lshlrev_b32 v234, 3, v1
  v_and_b32 v235, 31, v1
  v_lshlrev_b32 v236, 2, v236
  v_sub_u32 v235, v235, v236
  s_lshr_b32 s26, s23, 1
  s_lshl3_add_u32 s26, s31, s26
  s_add_u32 s33, s26, 2
  s_and_b32 s27, s23, 1
  s_lshl1_add_u32 s27, s32, s27
  s_and_b32 s28, s27, 24
  s_add_u32 s28, s28, s27
  s_lshl_b32 s28, s28, 10
  s_add_u32 s28, s28, s62
  s_add_u32 s28, s28, 105381888
  v_and_b32 v238, 3, v1
  v_lshl_add_u32 v238, v238, 8, s28
  v_mov_b32 v239, 0
  s_lshl_b32 s26, s26, 5
  s_add_u32 s26, s26, s27
  s_lshl_b32 s34, s26, 13
  s_lshl_b32 s35, s26, 11
  s_lshl_b32 s30, s33, 7
  s_sub_u32 s30, s30, s62
  s_add_u32 s30, s30, 105455360
  v_mov_b32 v240, 1
  s_lshl_b32 s26, s31, 2
.qa_kw:
  buffer_load_dword v236, off, s[96:99], s26 offset:16 sc0 sc1
  s_sub_u32 s50, s50, 1
  s_cbranch_scc1 .g_end2
  s_waitcnt vmcnt(0)
  v_readfirstlane_b32 s27, v236
  s_cmp_lg_u32 s27, 128
  s_cbranch_scc1 .qa_kw
  v_mov_b32 v218, 0
  v_mov_b32 v219, 0
  v_mov_b32 v222, 0
  v_mov_b32 v223, 0
  v_mov_b32 v226, 0
  v_mov_b32 v227, 0
  v_mov_b32 v230, 0
  v_mov_b32 v231, 0
  s_add_u32 s26, s34, 25165824
  s_add_u32 s27, s34, 25169920
  s_add_u32 s28, s34, 41943040
  s_add_u32 s29, s34, 41947136
  buffer_load_dwordx4 v[56:59], v232, s[12:15], s26 offen offset:0
  buffer_load_dwordx4 v[60:63], v232, s[12:15], s26 offen offset:1024
  buffer_load_dwordx4 v[64:67], v232, s[12:15], s26 offen offset:2048
  buffer_load_dwordx4 v[68:71], v232, s[12:15], s26 offen offset:3072
  buffer_load_dwordx4 v[72:75], v232, s[12:15], s27 offen offset:0
  buffer_load_dwordx4 v[76:79], v232, s[12:15], s27 offen offset:1024
  buffer_load_dwordx4 v[80:83], v232, s[12:15], s27 offen offset:2048
  buffer_load_dwordx4 v[84:87], v232, s[12:15], s27 offen offset:3072
  buffer_load_dwordx4 v[120:123], v232, s[12:15], s28 offen offset:0
  buffer_load_dwordx4 v[124:127], v232, s[12:15], s28 offen offset:1024
  buffer_load_dwordx4 v[128:131], v232, s[12:15], s28 offen offset:2048
  buffer_load_dwordx4 v[132:135], v232, s[12:15], s28 offen offset:3072
  buffer_load_dwordx4 v[136:139], v232, s[12:15], s29 offen offset:0
  buffer_load_dwordx4 v[140:143], v232, s[12:15], s29 offen offset:1024
  buffer_load_dwordx4 v[144:147], v232, s[12:15], s29 offen offset:2048
  buffer_load_dwordx4 v[148:151], v232, s[12:15], s29 offen offset:3072
  v_cmp_gt_i32 vcc, s33, v239
  s_cbranch_vccz .qw30k
.qw30:
  buffer_load_dword v239, v238, s[12:15], 0 offen sc1
  s_sub_u32 s50, s50, 1
  s_cbranch_scc1 .g_end2
  s_waitcnt vmcnt(0)
  v_cmp_gt_i32 vcc, s33, v239
  s_cbranch_vccnz .qw30
.qw30k:
  s_add_u32 s26, s35, 94371840
  s_add_u32 s27, s35, 98566144
  buffer_load_dwordx4 v[88:91], v233, s[12:15], s26 offen offset:0
  buffer_load_dwordx4 v[92:95], v233, s[12:15], s26 offen offset:256
  buffer_load_dwordx4 v[96:99], v233, s[12:15], s26 offen offset:512
  buffer_load_dwordx4 v[100:103], v233, s[12:15], s26 offen offset:768
  buffer_load_dwordx4 v[104:107], v233, s[12:15], s26 offen offset:1024
  buffer_load_dwordx4 v[108:111], v233, s[12:15], s26 offen offset:1280
  buffer_load_dwordx4 v[112:115], v233, s[12:15], s26 offen offset:1536
  buffer_load_dwordx4 v[116:119], v233, s[12:15], s26 offen offset:1792
  buffer_load_dwordx2 v[216:217], v234, s[12:15], s27 offen offset:0
  buffer_load_dwordx2 v[220:221], v234, s[12:15], s27 offen offset:512
  buffer_load_dwordx2 v[224:225], v234, s[12:15], s27 offen offset:1024
  buffer_load_dwordx2 v[228:229], v234, s[12:15], s27 offen offset:1536
  v_accvgpr_read_b32 v152, a0
  v_accvgpr_read_b32 v153, a1
  v_accvgpr_read_b32 v154, a2
  v_accvgpr_read_b32 v155, a3
  v_accvgpr_read_b32 v156, a4
  v_accvgpr_read_b32 v157, a5
  v_accvgpr_read_b32 v158, a6
  v_accvgpr_read_b32 v159, a7
  v_cvt_pk_bf16_f32 v24, v152, v153
  v_cvt_pk_bf16_f32 v26, v156, v157
  v_cvt_pk_bf16_f32 v25, v154, v155
  v_cvt_pk_bf16_f32 v27, v158, v159
  s_nop 0
  v_permlane16_swap_b32 v24, v26
  v_permlane16_swap_b32 v25, v27
  v_accvgpr_read_b32 v160, a8
  v_accvgpr_read_b32 v161, a9
  v_accvgpr_read_b32 v162, a10
  v_accvgpr_read_b32 v163, a11
  v_accvgpr_read_b32 v164, a12
  v_accvgpr_read_b32 v165, a13
  v_accvgpr_read_b32 v166, a14
  v_accvgpr_read_b32 v167, a15
  v_cvt_pk_bf16_f32 v28, v160, v161
  v_cvt_pk_bf16_f32 v30, v164, v165
  v_cvt_pk_bf16_f32 v29, v162, v163
  v_cvt_pk_bf16_f32 v31, v166, v167
  s_nop 0
  v_permlane16_swap_b32 v28, v30
  v_permlane16_swap_b32 v29, v31
  v_accvgpr_read_b32 v152, a16
  v_accvgpr_read_b32 v153, a17
  v_accvgpr_read_b32 v154, a18
  v_accvgpr_read_b32 v155, a19
  v_accvgpr_read_b32 v156, a20
  v_accvgpr_read_b32 v157, a21
  v_accvgpr_read_b32 v158, a22
  v_accvgpr_read_b32 v159, a23
  v_cvt_pk_bf16_f32 v32, v152, v153
  v_cvt_pk_bf16_f32 v34, v156, v157
  v_cvt_pk_bf16_f32 v33, v154, v155
  v_cvt_pk_bf16_f32 v35, v158, v159
  s_nop 0
  v_permlane16_swap_b32 v32, v34
  v_permlane16_swap_b32 v33, v35
  v_accvgpr_read_b32 v160, a24
  v_accvgpr_read_b32 v161, a25
  v_accvgpr_read_b32 v162, a26
  v_accvgpr_read_b32 v163, a27
  v_accvgpr_read_b32 v164, a28
  v_accvgpr_read_b32 v165, a29
  v_accvgpr_read_b32 v166, a30
  v_accvgpr_read_b32 v167, a31
  v_cvt_pk_bf16_f32 v36, v160, v161
  v_cvt_pk_bf16_f32 v38, v164, v165
  v_cvt_pk_bf16_f32 v37, v162, v163
  v_cvt_pk_bf16_f32 v39, v166, v167
  s_nop 0
  v_permlane16_swap_b32 v36, v38
  v_permlane16_swap_b32 v37, v39
  v_accvgpr_read_b32 v152, a32
  v_accvgpr_read_b32 v153, a33
  v_accvgpr_read_b32 v154, a34
  v_accvgpr_read_b32 v155, a35
  v_accvgpr_read_b32 v156, a36
  v_accvgpr_read_b32 v157, a37
  v_accvgpr_read_b32 v158, a38
  v_accvgpr_read_b32 v159, a39
  v_cvt_pk_bf16_f32 v40, v152, v153
  v_cvt_pk_bf16_f32 v42, v156, v157
  v_cvt_pk_bf16_f32 v41, v154, v155
  v_cvt_pk_bf16_f32 v43, v158, v159
  s_nop 0
  v_permlane16_swap_b32 v40, v42
  v_permlane16_swap_b32 v41, v43
  v_accvgpr_read_b32 v160, a40
  v_accvgpr_read_b32 v161, a41
  v_accvgpr_read_b32 v162, a42
  v_accvgpr_read_b32 v163, a43
  v_accvgpr_read_b32 v164, a44
  v_accvgpr_read_b32 v165, a45
  v_accvgpr_read_b32 v166, a46
  v_accvgpr_read_b32 v167, a47
  v_cvt_pk_bf16_f32 v44, v160, v161
  v_cvt_pk_bf16_f32 v46, v164, v165
  v_cvt_pk_bf16_f32 v45, v162, v163
  v_cvt_pk_bf16_f32 v47, v166, v167
  s_nop 0
  v_permlane16_swap_b32 v44, v46
  v_permlane16_swap_b32 v45, v47
  v_accvgpr_read_b32 v152, a48
  v_accvgpr_read_b32 v153, a49
  v_accvgpr_read_b32 v154, a50
  v_accvgpr_read_b32 v155, a51
  v_accvgpr_read_b32 v156, a52
  v_accvgpr_read_b32 v157, a53
  v_accvgpr_read_b32 v158, a54
  v_accvgpr_read_b32 v159, a55
  v_cvt_pk_bf16_f32 v48, v152, v153
  v_cvt_pk_bf16_f32 v50, v156, v157
  v_cvt_pk_bf16_f32 v49, v154, v155
  v_cvt_pk_bf16_f32 v51, v158, v159
  s_nop 0
  v_permlane16_swap_b32 v48, v50
  v_permlane16_swap_b32 v49, v51
  v_accvgpr_read_b32 v160, a56
  v_accvgpr_read_b32 v161, a57
  v_accvgpr_read_b32 v162, a58
  v_accvgpr_read_b32 v163, a59
  v_accvgpr_read_b32 v164, a60
  v_accvgpr_read_b32 v165, a61
  v_accvgpr_read_b32 v166, a62
  v_accvgpr_read_b32 v167, a63
  v_cvt_pk_bf16_f32 v52, v160, v161
  v_cvt_pk_bf16_f32 v54, v164, v165
  v_cvt_pk_bf16_f32 v53, v162, v163
  v_cvt_pk_bf16_f32 v55, v166, v167
  s_nop 0
  v_permlane16_swap_b32 v52, v54
  v_permlane16_swap_b32 v53, v55
  s_waitcnt vmcnt(20)
  v_mfma_f32_32x32x16_bf16 v[152:167], v[56:59], v[24:27], 0
  v_mfma_f32_32x32x16_bf16 v[152:167], v[60:63], v[28:31], v[152:167]
  v_mfma_f32_32x32x16_bf16 v[152:167], v[64:67], v[32:35], v[152:167]
  v_mfma_f32_32x32x16_bf16 v[152:167], v[68:71], v[36:39], v[152:167]
  v_mfma_f32_32x32x16_bf16 v[152:167], v[72:75], v[40:43], v[152:167]
  v_mfma_f32_32x32x16_bf16 v[152:167], v[76:79], v[44:47], v[152:167]
  v_mfma_f32_32x32x16_bf16 v[152:167], v[80:83], v[48:51], v[152:167]
  v_mfma_f32_32x32x16_bf16 v[152:167], v[84:87], v[52:55], v[152:167]
  s_waitcnt vmcnt(11)
  v_mfma_f32_32x32x16_bf16 v[168:183], v[88:91], v[24:27], 0
  s_waitcnt vmcnt(10)
  v_mfma_f32_32x32x16_bf16 v[168:183], v[92:95], v[28:31], v[168:183]
  s_waitcnt vmcnt(9)
  v_mfma_f32_32x32x16_bf16 v[168:183], v[96:99], v[32:35], v[168:183]
  s_waitcnt vmcnt(8)
  v_mfma_f32_32x32x16_bf16 v[168:183], v[100:103], v[36:39], v[168:183]
  s_waitcnt vmcnt(7)
  v_mfma_f32_32x32x16_bf16 v[168:183], v[104:107], v[40:43], v[168:183]
  s_waitcnt vmcnt(6)
  v_mfma_f32_32x32x16_bf16 v[168:183], v[108:111], v[44:47], v[168:183]
  s_waitcnt vmcnt(5)
  v_mfma_f32_32x32x16_bf16 v[168:183], v[112:115], v[48:51], v[168:183]
  s_waitcnt vmcnt(4)
  v_mfma_f32_32x32x16_bf16 v[168:183], v[116:119], v[52:55], v[168:183]
  s_add_u32 s28, s34, 58720256
  s_add_u32 s29, s34, 58724352
  v_mov_b32 v236, 3492320863
  s_mov_b32 s27, 1040356334
  s_add_u32 s34, s34, 524288
  s_add_u32 s35, s35, 131072
  s_add_u32 s33, s33, 2
  v_cmp_le_i32 vcc, 0, v235
  s_nop 1
  v_cndmask_b32 v152, v236, v152, vcc
  v_cmp_le_i32 vcc, 1, v235
  s_nop 1
  v_cndmask_b32 v153, v236, v153, vcc
  v_cmp_le_i32 vcc, 2, v235
  s_nop 1
  v_cndmask_b32 v154, v236, v154, vcc
  v_cmp_le_i32 vcc, 3, v235
  s_nop 1
  v_cndmask_b32 v155, v236, v155, vcc
  v_cmp_le_i32 vcc, 8, v235
  s_nop 1
  v_cndmask_b32 v156, v236, v156, vcc
  v_cmp_le_i32 vcc, 9, v235
  s_nop 1
  v_cndmask_b32 v157, v236, v157, vcc
  v_cmp_le_i32 vcc, 10, v235
  s_nop 1
  v_cndmask_b32 v158, v236, v158, vcc
  v_cmp_le_i32 vcc, 11, v235
  s_nop 1
  v_cndmask_b32 v159, v236, v159, vcc
  v_cmp_le_i32 vcc, 16, v235
  s_nop 1
  v_cndmask_b32 v160, v236, v160, vcc
  v_cmp_le_i32 vcc, 17, v235
  s_nop 1
  v_cndmask_b32 v161, v236, v161, vcc
  v_cmp_le_i32 vcc, 18, v235
  s_nop 1
  v_cndmask_b32 v162, v236, v162, vcc
  v_cmp_le_i32 vcc, 19, v235
  s_nop 1
  v_cndmask_b32 v163, v236, v163, vcc
  v_cmp_le_i32 vcc, 24, v235
  s_nop 1
  v_cndmask_b32 v164, v236, v164, vcc
  v_cmp_le_i32 vcc, 25, v235
  s_nop 1
  v_cndmask_b32 v165, v236, v165, vcc
  v_cmp_le_i32 vcc, 26, v235
  s_nop 1
  v_cndmask_b32 v166, v236, v166, vcc
  v_cmp_le_i32 vcc, 27, v235
  s_nop 1
  v_cndmask_b32 v167, v236, v167, vcc
  v_max3_f32 v237, v152, v153, v171
  v_max3_f32 v237, v154, v155, v237
  v_max3_f32 v237, v156, v157, v237
  v_max3_f32 v237, v158, v159, v237
  v_max3_f32 v237, v160, v161, v237
  v_max3_f32 v237, v162, v163, v237
  v_max3_f32 v237, v164, v165, v237
  v_max3_f32 v237, v166, v167, v237
  v_max3_f32 v237, v168, v169, v237
  v_max_f32 v237, v170, v237
  v_mov_b32 v236, v237
  s_nop 1
  v_permlane32_swap_b32 v236, v237
  s_nop 1
  v_max_f32 v237, v236, v237
  v_mul_f32 v237, s27, v237
  v_fma_f32 v152, v152, s27, -v237
  v_fma_f32 v153, v153, s27, -v237
  v_fma_f32 v154, v154, s27, -v237
  v_fma_f32 v155, v155, s27, -v237
  v_fma_f32 v156, v156, s27, -v237
  v_fma_f32 v157, v157, s27, -v237
  v_fma_f32 v158, v158, s27, -v237
  v_fma_f32 v159, v159, s27, -v237
  v_fma_f32 v160, v160, s27, -v237
  v_fma_f32 v161, v161, s27, -v237
  v_fma_f32 v162, v162, s27, -v237
  v_fma_f32 v163, v163, s27, -v237
  v_fma_f32 v164, v164, s27, -v237
  v_fma_f32 v165, v165, s27, -v237
  v_fma_f32 v166, v166, s27, -v237
  v_fma_f32 v167, v167, s27, -v237
  v_fma_f32 v168, v168, s27, -v237
  v_fma_f32 v169, v169, s27, -v237
  v_fma_f32 v170, v170, s27, -v237
  v_fma_f32 v171, v171, s27, -v237
  v_exp_f32 v152, v152
  v_exp_f32 v153, v153
  v_exp_f32 v154, v154
  v_exp_f32 v155, v155
  v_exp_f32 v156, v156
  v_exp_f32 v157, v157
  v_exp_f32 v158, v158
  v_exp_f32 v159, v159
  v_exp_f32 v160, v160
  v_exp_f32 v161, v161
  v_exp_f32 v162, v162
  v_exp_f32 v163, v163
  v_exp_f32 v164, v164
  v_exp_f32 v165, v165
  v_exp_f32 v166, v166
  v_exp_f32 v167, v167
  v_exp_f32 v168, v168
  v_exp_f32 v169, v169
  v_exp_f32 v170, v170
  v_exp_f32 v171, v171
  v_add_f32 v237, v152, v153
  v_add_f32 v237, v237, v154
  v_add_f32 v237, v237, v155
  v_add_f32 v237, v237, v156
  v_add_f32 v237, v237, v157
  v_add_f32 v237, v237, v158
  v_add_f32 v237, v237, v159
  v_add_f32 v237, v237, v160
  v_add_f32 v237, v237, v161
  v_add_f32 v237, v237, v162
  v_add_f32 v237, v237, v163
  v_add_f32 v237, v237, v164
  v_add_f32 v237, v237, v165
  v_add_f32 v237, v237, v166
  v_add_f32 v237, v237, v167
  v_add_f32 v237, v237, v168
  v_add_f32 v237, v237, v169
  v_add_f32 v237, v237, v170
  v_add_f32 v237, v237, v171
  v_cvt_pk_bf16_f32 v24, v152, v153
  v_cvt_pk_bf16_f32 v25, v154, v155
  v_cvt_pk_bf16_f32 v26, v156, v157
  v_cvt_pk_bf16_f32 v27, v158, v159
  v_cvt_pk_bf16_f32 v28, v160, v161
  v_cvt_pk_bf16_f32 v29, v162, v163
  v_cvt_pk_bf16_f32 v30, v164, v165
  v_cvt_pk_bf16_f32 v31, v166, v167
  v_cvt_pk_bf16_f32 v32, v168, v169
  v_cvt_pk_bf16_f32 v33, v170, v171
  v_mov_b32 v34, 0
  v_mov_b32 v35, 0
  v_mov_b32 v236, v237
  s_nop 1
  v_permlane32_swap_b32 v236, v237
  s_waitcnt vmcnt(0)
  s_nop 0
  v_add_f32 v237, v236, v237
  v_rcp_f32 v236, v237
  v_mfma_f32_32x32x16_bf16 v[184:199], v[120:123], v[24:27], 0
  v_mfma_f32_32x32x16_bf16 v[184:199], v[124:127], v[28:31], v[184:199]
  v_mfma_f32_32x32x16_bf16 v[184:199], v[216:219], v[32:35], v[184:199]
  v_mfma_f32_32x32x16_bf16 v[200:215], v[128:131], v[24:27], 0
  v_mfma_f32_32x32x16_bf16 v[200:215], v[132:135], v[28:31], v[200:215]
  v_mfma_f32_32x32x16_bf16 v[200:215], v[220:223], v[32:35], v[200:215]
  v_mfma_f32_32x32x16_bf16 v[152:167], v[136:139], v[24:27], 0
  v_mfma_f32_32x32x16_bf16 v[152:167], v[140:143], v[28:31], v[152:167]
  v_mfma_f32_32x32x16_bf16 v[152:167], v[224:227], v[32:35], v[152:167]
  v_mfma_f32_32x32x16_bf16 v[168:183], v[144:147], v[24:27], 0
  v_mfma_f32_32x32x16_bf16 v[168:183], v[148:151], v[28:31], v[168:183]
  v_mfma_f32_32x32x16_bf16 v[168:183], v[228:231], v[32:35], v[168:183]
  v_pk_mul_f32 v[184:185], v[184:185], v[236:237] op_sel_hi:[1,0]
  v_pk_mul_f32 v[186:187], v[186:187], v[236:237] op_sel_hi:[1,0]
  v_pk_mul_f32 v[188:189], v[188:189], v[236:237] op_sel_hi:[1,0]
  v_pk_mul_f32 v[190:191], v[190:191], v[236:237] op_sel_hi:[1,0]
  v_pk_mul_f32 v[192:193], v[192:193], v[236:237] op_sel_hi:[1,0]
  v_pk_mul_f32 v[194:195], v[194:195], v[236:237] op_sel_hi:[1,0]
  v_pk_mul_f32 v[196:197], v[196:197], v[236:237] op_sel_hi:[1,0]
  v_pk_mul_f32 v[198:199], v[198:199], v[236:237] op_sel_hi:[1,0]
  v_cvt_pk_bf16_f32 v88, v184, v185
  v_cvt_pk_bf16_f32 v89, v186, v187
  v_cvt_pk_bf16_f32 v90, v188, v189
  v_cvt_pk_bf16_f32 v91, v190, v191
  v_cvt_pk_bf16_f32 v92, v192, v193
  v_cvt_pk_bf16_f32 v93, v194, v195
  v_cvt_pk_bf16_f32 v94, v196, v197
  v_cvt_pk_bf16_f32 v95, v198, v199
  buffer_store_dwordx4 v[88:91], v232, s[12:15], s28 offen offset:0 sc1
  buffer_store_dwordx4 v[92:95], v232, s[12:15], s28 offen offset:1024 sc1
  v_pk_mul_f32 v[200:201], v[200:201], v[236:237] op_sel_hi:[1,0]
  v_pk_mul_f32 v[202:203], v[202:203], v[236:237] op_sel_hi:[1,0]
  v_pk_mul_f32 v[204:205], v[204:205], v[236:237] op_sel_hi:[1,0]
  v_pk_mul_f32 v[206:207], v[206:207], v[236:237] op_sel_hi:[1,0]
  v_pk_mul_f32 v[208:209], v[208:209], v[236:237] op_sel_hi:[1,0]
  v_pk_mul_f32 v[210:211], v[210:211], v[236:237] op_sel_hi:[1,0]
  v_pk_mul_f32 v[212:213], v[212:213], v[236:237] op_sel_hi:[1,0]
  v_pk_mul_f32 v[214:215], v[214:215], v[236:237] op_sel_hi:[1,0]
  v_cvt_pk_bf16_f32 v96, v200, v201
  v_cvt_pk_bf16_f32 v97, v202, v203
  v_cvt_pk_bf16_f32 v98, v204, v205
  v_cvt_pk_bf16_f32 v99, v206, v207
  v_cvt_pk_bf16_f32 v100, v208, v209
  v_cvt_pk_bf16_f32 v101, v210, v211
  v_cvt_pk_bf16_f32 v102, v212, v213
  v_cvt_pk_bf16_f32 v103, v214, v215
  buffer_store_dwordx4 v[96:99], v232, s[12:15], s28 offen offset:2048 sc1
  buffer_store_dwordx4 v[100:103], v232, s[12:15], s28 offen offset:3072 sc1
  v_pk_mul_f32 v[152:153], v[152:153], v[236:237] op_sel_hi:[1,0]
  v_pk_mul_f32 v[154:155], v[154:155], v[236:237] op_sel_hi:[1,0]
  v_pk_mul_f32 v[156:157], v[156:157], v[236:237] op_sel_hi:[1,0]
  v_pk_mul_f32 v[158:159], v[158:159], v[236:237] op_sel_hi:[1,0]
  v_pk_mul_f32 v[160:161], v[160:161], v[236:237] op_sel_hi:[1,0]
  v_pk_mul_f32 v[162:163], v[162:163], v[236:237] op_sel_hi:[1,0]
  v_pk_mul_f32 v[164:165], v[164:165], v[236:237] op_sel_hi:[1,0]
  v_pk_mul_f32 v[166:167], v[166:167], v[236:237] op_sel_hi:[1,0]
  v_cvt_pk_bf16_f32 v104, v152, v153
  v_cvt_pk_bf16_f32 v105, v154, v155
  v_cvt_pk_bf16_f32 v106, v156, v157
  v_cvt_pk_bf16_f32 v107, v158, v159
  v_cvt_pk_bf16_f32 v108, v160, v161
  v_cvt_pk_bf16_f32 v109, v162, v163
  v_cvt_pk_bf16_f32 v110, v164, v165
  v_cvt_pk_bf16_f32 v111, v166, v167
  buffer_store_dwordx4 v[104:107], v232, s[12:15], s29 offen offset:0 sc1
  buffer_store_dwordx4 v[108:111], v232, s[12:15], s29 offen offset:1024 sc1
  s_nop 3
  v_pk_mul_f32 v[168:169], v[168:169], v[236:237] op_sel_hi:[1,0]
  v_pk_mul_f32 v[170:171], v[170:171], v[236:237] op_sel_hi:[1,0]
  v_pk_mul_f32 v[172:173], v[172:173], v[236:237] op_sel_hi:[1,0]
  v_pk_mul_f32 v[174:175], v[174:175], v[236:237] op_sel_hi:[1,0]
  v_pk_mul_f32 v[176:177], v[176:177], v[236:237] op_sel_hi:[1,0]
  v_pk_mul_f32 v[178:179], v[178:179], v[236:237] op_sel_hi:[1,0]
  v_pk_mul_f32 v[180:181], v[180:181], v[236:237] op_sel_hi:[1,0]
  v_pk_mul_f32 v[182:183], v[182:183], v[236:237] op_sel_hi:[1,0]
  v_cvt_pk_bf16_f32 v112, v168, v169
  v_cvt_pk_bf16_f32 v113, v170, v171
  v_cvt_pk_bf16_f32 v114, v172, v173
  v_cvt_pk_bf16_f32 v115, v174, v175
  v_cvt_pk_bf16_f32 v116, v176, v177
  v_cvt_pk_bf16_f32 v117, v178, v179
  v_cvt_pk_bf16_f32 v118, v180, v181
  v_cvt_pk_bf16_f32 v119, v182, v183
  buffer_store_dwordx4 v[112:115], v232, s[12:15], s29 offen offset:2048 sc1
  buffer_store_dwordx4 v[116:119], v232, s[12:15], s29 offen offset:3072 sc1
  s_add_u32 s26, s34, 25165824
  s_add_u32 s27, s34, 25169920
  s_add_u32 s28, s34, 41943040
  s_add_u32 s29, s34, 41947136
  buffer_load_dwordx4 v[56:59], v232, s[12:15], s26 offen offset:0
  buffer_load_dwordx4 v[60:63], v232, s[12:15], s26 offen offset:1024
  buffer_load_dwordx4 v[64:67], v232, s[12:15], s26 offen offset:2048
  buffer_load_dwordx4 v[68:71], v232, s[12:15], s26 offen offset:3072
  buffer_load_dwordx4 v[72:75], v232, s[12:15], s27 offen offset:0
  buffer_load_dwordx4 v[76:79], v232, s[12:15], s27 offen offset:1024
  buffer_load_dwordx4 v[80:83], v232, s[12:15], s27 offen offset:2048
  buffer_load_dwordx4 v[84:87], v232, s[12:15], s27 offen offset:3072
  buffer_load_dwordx4 v[120:123], v232, s[12:15], s28 offen offset:0
  buffer_load_dwordx4 v[124:127], v232, s[12:15], s28 offen offset:1024
  buffer_load_dwordx4 v[128:131], v232, s[12:15], s28 offen offset:2048
  buffer_load_dwordx4 v[132:135], v232, s[12:15], s28 offen offset:3072
  buffer_load_dwordx4 v[136:139], v232, s[12:15], s29 offen offset:0
  buffer_load_dwordx4 v[140:143], v232, s[12:15], s29 offen offset:1024
  buffer_load_dwordx4 v[144:147], v232, s[12:15], s29 offen offset:2048
  buffer_load_dwordx4 v[148:151], v232, s[12:15], s29 offen offset:3072
  s_mov_b64 exec, 1
  s_waitcnt vmcnt(16)
  buffer_atomic_add v240, off, s[12:15], s30 sc1
  s_mov_b64 exec, -1
  s_add_u32 s30, s30, 256
  v_cmp_gt_i32 vcc, s33, v239
  s_cbranch_vccz .qw31k
.qw31:
  buffer_load_dword v239, v238, s[12:15], 0 offen sc1
  s_sub_u32 s50, s50, 1
  s_cbranch_scc1 .g_end2
  s_waitcnt vmcnt(0)
  v_cmp_gt_i32 vcc, s33, v239
  s_cbranch_vccnz .qw31
.qw31k:
  s_add_u32 s26, s35, 94371840
  s_add_u32 s27, s35, 98566144
  buffer_load_dwordx4 v[88:91], v233, s[12:15], s26 offen offset:0
  buffer_load_dwordx4 v[92:95], v233, s[12:15], s26 offen offset:256
  buffer_load_dwordx4 v[96:99], v233, s[12:15], s26 offen offset:512
  buffer_load_dwordx4 v[100:103], v233, s[12:15], s26 offen offset:768
  buffer_load_dwordx4 v[104:107], v233, s[12:15], s26 offen offset:1024
  buffer_load_dwordx4 v[108:111], v233, s[12:15], s26 offen offset:1280
  buffer_load_dwordx4 v[112:115], v233, s[12:15], s26 offen offset:1536
  buffer_load_dwordx4 v[116:119], v233, s[12:15], s26 offen offset:1792
  buffer_load_dwordx2 v[216:217], v234, s[12:15], s27 offen offset:0
  buffer_load_dwordx2 v[220:221], v234, s[12:15], s27 offen offset:512
  buffer_load_dwordx2 v[224:225], v234, s[12:15], s27 offen offset:1024
  buffer_load_dwordx2 v[228:229], v234, s[12:15], s27 offen offset:1536
  v_accvgpr_read_b32 v152, a64
  v_accvgpr_read_b32 v153, a65
  v_accvgpr_read_b32 v154, a66
  v_accvgpr_read_b32 v155, a67
  v_accvgpr_read_b32 v156, a68
  v_accvgpr_read_b32 v157, a69
  v_accvgpr_read_b32 v158, a70
  v_accvgpr_read_b32 v159, a71
  v_cvt_pk_bf16_f32 v24, v152, v153
  v_cvt_pk_bf16_f32 v26, v156, v157
  v_cvt_pk_bf16_f32 v25, v154, v155
  v_cvt_pk_bf16_f32 v27, v158, v159
  s_nop 0
  v_permlane16_swap_b32 v24, v26
  v_permlane16_swap_b32 v25, v27
  v_accvgpr_read_b32 v160, a72
  v_accvgpr_read_b32 v161, a73
  v_accvgpr_read_b32 v162, a74
  v_accvgpr_read_b32 v163, a75
  v_accvgpr_read_b32 v164, a76
  v_accvgpr_read_b32 v165, a77
  v_accvgpr_read_b32 v166, a78
  v_accvgpr_read_b32 v167, a79
  v_cvt_pk_bf16_f32 v28, v160, v161
  v_cvt_pk_bf16_f32 v30, v164, v165
  v_cvt_pk_bf16_f32 v29, v162, v163
  v_cvt_pk_bf16_f32 v31, v166, v167
  s_nop 0
  v_permlane16_swap_b32 v28, v30
  v_permlane16_swap_b32 v29, v31
  v_accvgpr_read_b32 v152, a80
  v_accvgpr_read_b32 v153, a81
  v_accvgpr_read_b32 v154, a82
  v_accvgpr_read_b32 v155, a83
  v_accvgpr_read_b32 v156, a84
  v_accvgpr_read_b32 v157, a85
  v_accvgpr_read_b32 v158, a86
  v_accvgpr_read_b32 v159, a87
  v_cvt_pk_bf16_f32 v32, v152, v153
  v_cvt_pk_bf16_f32 v34, v156, v157
  v_cvt_pk_bf16_f32 v33, v154, v155
  v_cvt_pk_bf16_f32 v35, v158, v159
  s_nop 0
  v_permlane16_swap_b32 v32, v34
  v_permlane16_swap_b32 v33, v35
  v_accvgpr_read_b32 v160, a88
  v_accvgpr_read_b32 v161, a89
  v_accvgpr_read_b32 v162, a90
  v_accvgpr_read_b32 v163, a91
  v_accvgpr_read_b32 v164, a92
  v_accvgpr_read_b32 v165, a93
  v_accvgpr_read_b32 v166, a94
  v_accvgpr_read_b32 v167, a95
  v_cvt_pk_bf16_f32 v36, v160, v161
  v_cvt_pk_bf16_f32 v38, v164, v165
  v_cvt_pk_bf16_f32 v37, v162, v163
  v_cvt_pk_bf16_f32 v39, v166, v167
  s_nop 0
  v_permlane16_swap_b32 v36, v38
  v_permlane16_swap_b32 v37, v39
  v_accvgpr_read_b32 v152, a96
  v_accvgpr_read_b32 v153, a97
  v_accvgpr_read_b32 v154, a98
  v_accvgpr_read_b32 v155, a99
  v_accvgpr_read_b32 v156, a100
  v_accvgpr_read_b32 v157, a101
  v_accvgpr_read_b32 v158, a102
  v_accvgpr_read_b32 v159, a103
  v_cvt_pk_bf16_f32 v40, v152, v153
  v_cvt_pk_bf16_f32 v42, v156, v157
  v_cvt_pk_bf16_f32 v41, v154, v155
  v_cvt_pk_bf16_f32 v43, v158, v159
  s_nop 0
  v_permlane16_swap_b32 v40, v42
  v_permlane16_swap_b32 v41, v43
  v_accvgpr_read_b32 v160, a104
  v_accvgpr_read_b32 v161, a105
  v_accvgpr_read_b32 v162, a106
  v_accvgpr_read_b32 v163, a107
  v_accvgpr_read_b32 v164, a108
  v_accvgpr_read_b32 v165, a109
  v_accvgpr_read_b32 v166, a110
  v_accvgpr_read_b32 v167, a111
  v_cvt_pk_bf16_f32 v44, v160, v161
  v_cvt_pk_bf16_f32 v46, v164, v165
  v_cvt_pk_bf16_f32 v45, v162, v163
  v_cvt_pk_bf16_f32 v47, v166, v167
  s_nop 0
  v_permlane16_swap_b32 v44, v46
  v_permlane16_swap_b32 v45, v47
  v_accvgpr_read_b32 v152, a112
  v_accvgpr_read_b32 v153, a113
  v_accvgpr_read_b32 v154, a114
  v_accvgpr_read_b32 v155, a115
  v_accvgpr_read_b32 v156, a116
  v_accvgpr_read_b32 v157, a117
  v_accvgpr_read_b32 v158, a118
  v_accvgpr_read_b32 v159, a119
  v_cvt_pk_bf16_f32 v48, v152, v153
  v_cvt_pk_bf16_f32 v50, v156, v157
  v_cvt_pk_bf16_f32 v49, v154, v155
  v_cvt_pk_bf16_f32 v51, v158, v159
  s_nop 0
  v_permlane16_swap_b32 v48, v50
  v_permlane16_swap_b32 v49, v51
  v_accvgpr_read_b32 v160, a120
  v_accvgpr_read_b32 v161, a121
  v_accvgpr_read_b32 v162, a122
  v_accvgpr_read_b32 v163, a123
  v_accvgpr_read_b32 v164, a124
  v_accvgpr_read_b32 v165, a125
  v_accvgpr_read_b32 v166, a126
  v_accvgpr_read_b32 v167, a127
  v_cvt_pk_bf16_f32 v52, v160, v161
  v_cvt_pk_bf16_f32 v54, v164, v165
  v_cvt_pk_bf16_f32 v53, v162, v163
  v_cvt_pk_bf16_f32 v55, v166, v167
  s_nop 0
  v_permlane16_swap_b32 v52, v54
  v_permlane16_swap_b32 v53, v55
  s_waitcnt vmcnt(20)
  v_mfma_f32_32x32x16_bf16 v[152:167], v[56:59], v[24:27], 0
  v_mfma_f32_32x32x16_bf16 v[152:167], v[60:63], v[28:31], v[152:167]
  v_mfma_f32_32x32x16_bf16 v[152:167], v[64:67], v[32:35], v[152:167]
  v_mfma_f32_32x32x16_bf16 v[152:167], v[68:71], v[36:39], v[152:167]
  v_mfma_f32_32x32x16_bf16 v[152:167], v[72:75], v[40:43], v[152:167]
  v_mfma_f32_32x32x16_bf16 v[152:167], v[76:79], v[44:47], v[152:167]
  v_mfma_f32_32x32x16_bf16 v[152:167], v[80:83], v[48:51], v[152:167]
  v_mfma_f32_32x32x16_bf16 v[152:167], v[84:87], v[52:55], v[152:167]
  s_waitcnt vmcnt(11)
  v_mfma_f32_32x32x16_bf16 v[168:183], v[88:91], v[24:27], 0
  s_waitcnt vmcnt(10)
  v_mfma_f32_32x32x16_bf16 v[168:183], v[92:95], v[28:31], v[168:183]
  s_waitcnt vmcnt(9)
  v_mfma_f32_32x32x16_bf16 v[168:183], v[96:99], v[32:35], v[168:183]
  s_waitcnt vmcnt(8)
  v_mfma_f32_32x32x16_bf16 v[168:183], v[100:103], v[36:39], v[168:183]
  s_waitcnt vmcnt(7)
  v_mfma_f32_32x32x16_bf16 v[168:183], v[104:107], v[40:43], v[168:183]
  s_waitcnt vmcnt(6)
  v_mfma_f32_32x32x16_bf16 v[168:183], v[108:111], v[44:47], v[168:183]
  s_waitcnt vmcnt(5)
  v_mfma_f32_32x32x16_bf16 v[168:183], v[112:115], v[48:51], v[168:183]
  s_waitcnt vmcnt(4)
  v_mfma_f32_32x32x16_bf16 v[168:183], v[116:119], v[52:55], v[168:183]
  s_add_u32 s28, s34, 58720256
  s_add_u32 s29, s34, 58724352
  v_mov_b32 v236, 3492320863
  s_mov_b32 s27, 1040356334
  s_add_u32 s34, s34, 524288
  s_add_u32 s35, s35, 131072
  s_add_u32 s33, s33, 2
  v_cmp_le_i32 vcc, 0, v235
  s_nop 1
  v_cndmask_b32 v152, v236, v152, vcc
  v_cmp_le_i32 vcc, 1, v235
  s_nop 1
  v_cndmask_b32 v153, v236, v153, vcc
  v_cmp_le_i32 vcc, 2, v235
  s_nop 1
  v_cndmask_b32 v154, v236, v154, vcc
  v_cmp_le_i32 vcc, 3, v235
  s_nop 1
  v_cndmask_b32 v155, v236, v155, vcc
  v_cmp_le_i32 vcc, 8, v235
  s_nop 1
  v_cndmask_b32 v156, v236, v156, vcc
  v_cmp_le_i32 vcc, 9, v235
  s_nop 1
  v_cndmask_b32 v157, v236, v157, vcc
  v_cmp_le_i32 vcc, 10, v235
  s_nop 1
  v_cndmask_b32 v158, v236, v158, vcc
  v_cmp_le_i32 vcc, 11, v235
  s_nop 1
  v_cndmask_b32 v159, v236, v159, vcc
  v_cmp_le_i32 vcc, 16, v235
  s_nop 1
  v_cndmask_b32 v160, v236, v160, vcc
  v_cmp_le_i32 vcc, 17, v235
  s_nop 1
  v_cndmask_b32 v161, v236, v161, vcc
  v_cmp_le_i32 vcc, 18, v235
  s_nop 1
  v_cndmask_b32 v162, v236, v162, vcc
  v_cmp_le_i32 vcc, 19, v235
  s_nop 1
  v_cndmask_b32 v163, v236, v163, vcc
  v_cmp_le_i32 vcc, 24, v235
  s_nop 1
  v_cndmask_b32 v164, v236, v164, vcc
  v_cmp_le_i32 vcc, 25, v235
  s_nop 1
  v_cndmask_b32 v165, v236, v165, vcc
  v_cmp_le_i32 vcc, 26, v235
  s_nop 1
  v_cndmask_b32 v166, v236, v166, vcc
  v_cmp_le_i32 vcc, 27, v235
  s_nop 1
  v_cndmask_b32 v167, v236, v167, vcc
  v_max3_f32 v237, v152, v153, v171
  v_max3_f32 v237, v154, v155, v237
  v_max3_f32 v237, v156, v157, v237
  v_max3_f32 v237, v158, v159, v237
  v_max3_f32 v237, v160, v161, v237
  v_max3_f32 v237, v162, v163, v237
  v_max3_f32 v237, v164, v165, v237
  v_max3_f32 v237, v166, v167, v237
  v_max3_f32 v237, v168, v169, v237
  v_max_f32 v237, v170, v237
  v_mov_b32 v236, v237
  s_nop 1
  v_permlane32_swap_b32 v236, v237
  s_nop 1
  v_max_f32 v237, v236, v237
  v_mul_f32 v237, s27, v237
  v_fma_f32 v152, v152, s27, -v237
  v_fma_f32 v153, v153, s27, -v237
  v_fma_f32 v154, v154, s27, -v237
  v_fma_f32 v155, v155, s27, -v237
  v_fma_f32 v156, v156, s27, -v237
  v_fma_f32 v157, v157, s27, -v237
  v_fma_f32 v158, v158, s27, -v237
  v_fma_f32 v159, v159, s27, -v237
  v_fma_f32 v160, v160, s27, -v237
  v_fma_f32 v161, v161, s27, -v237
  v_fma_f32 v162, v162, s27, -v237
  v_fma_f32 v163, v163, s27, -v237
  v_fma_f32 v164, v164, s27, -v237
  v_fma_f32 v165, v165, s27, -v237
  v_fma_f32 v166, v166, s27, -v237
  v_fma_f32 v167, v167, s27, -v237
  v_fma_f32 v168, v168, s27, -v237
  v_fma_f32 v169, v169, s27, -v237
  v_fma_f32 v170, v170, s27, -v237
  v_fma_f32 v171, v171, s27, -v237
  v_exp_f32 v152, v152
  v_exp_f32 v153, v153
  v_exp_f32 v154, v154
  v_exp_f32 v155, v155
  v_exp_f32 v156, v156
  v_exp_f32 v157, v157
  v_exp_f32 v158, v158
  v_exp_f32 v159, v159
  v_exp_f32 v160, v160
  v_exp_f32 v161, v161
  v_exp_f32 v162, v162
  v_exp_f32 v163, v163
  v_exp_f32 v164, v164
  v_exp_f32 v165, v165
  v_exp_f32 v166, v166
  v_exp_f32 v167, v167
  v_exp_f32 v168, v168
  v_exp_f32 v169, v169
  v_exp_f32 v170, v170
  v_exp_f32 v171, v171
  v_add_f32 v237, v152, v153
  v_add_f32 v237, v237, v154
  v_add_f32 v237, v237, v155
  v_add_f32 v237, v237, v156
  v_add_f32 v237, v237, v157
  v_add_f32 v237, v237, v158
  v_add_f32 v237, v237, v159
  v_add_f32 v237, v237, v160
  v_add_f32 v237, v237, v161
  v_add_f32 v237, v237, v162
  v_add_f32 v237, v237, v163
  v_add_f32 v237, v237, v164
  v_add_f32 v237, v237, v165
  v_add_f32 v237, v237, v166
  v_add_f32 v237, v237, v167
  v_add_f32 v237, v237, v168
  v_add_f32 v237, v237, v169
  v_add_f32 v237, v237, v170
  v_add_f32 v237, v237, v171
  v_cvt_pk_bf16_f32 v24, v152, v153
  v_cvt_pk_bf16_f32 v25, v154, v155
  v_cvt_pk_bf16_f32 v26, v156, v157
  v_cvt_pk_bf16_f32 v27, v158, v159
  v_cvt_pk_bf16_f32 v28, v160, v161
  v_cvt_pk_bf16_f32 v29, v162, v163
  v_cvt_pk_bf16_f32 v30, v164, v165
  v_cvt_pk_bf16_f32 v31, v166, v167
  v_cvt_pk_bf16_f32 v32, v168, v169
  v_cvt_pk_bf16_f32 v33, v170, v171
  v_mov_b32 v34, 0
  v_mov_b32 v35, 0
  v_mov_b32 v236, v237
  s_nop 1
  v_permlane32_swap_b32 v236, v237
  s_waitcnt vmcnt(0)
  s_nop 0
  v_add_f32 v237, v236, v237
  v_rcp_f32 v236, v237
  v_mfma_f32_32x32x16_bf16 v[184:199], v[120:123], v[24:27], 0
  v_mfma_f32_32x32x16_bf16 v[184:199], v[124:127], v[28:31], v[184:199]
  v_mfma_f32_32x32x16_bf16 v[184:199], v[216:219], v[32:35], v[184:199]
  v_mfma_f32_32x32x16_bf16 v[200:215], v[128:131], v[24:27], 0
  v_mfma_f32_32x32x16_bf16 v[200:215], v[132:135], v[28:31], v[200:215]
  v_mfma_f32_32x32x16_bf16 v[200:215], v[220:223], v[32:35], v[200:215]
  v_mfma_f32_32x32x16_bf16 v[152:167], v[136:139], v[24:27], 0
  v_mfma_f32_32x32x16_bf16 v[152:167], v[140:143], v[28:31], v[152:167]
  v_mfma_f32_32x32x16_bf16 v[152:167], v[224:227], v[32:35], v[152:167]
  v_mfma_f32_32x32x16_bf16 v[168:183], v[144:147], v[24:27], 0
  v_mfma_f32_32x32x16_bf16 v[168:183], v[148:151], v[28:31], v[168:183]
  v_mfma_f32_32x32x16_bf16 v[168:183], v[228:231], v[32:35], v[168:183]
  v_pk_mul_f32 v[184:185], v[184:185], v[236:237] op_sel_hi:[1,0]
  v_pk_mul_f32 v[186:187], v[186:187], v[236:237] op_sel_hi:[1,0]
  v_pk_mul_f32 v[188:189], v[188:189], v[236:237] op_sel_hi:[1,0]
  v_pk_mul_f32 v[190:191], v[190:191], v[236:237] op_sel_hi:[1,0]
  v_pk_mul_f32 v[192:193], v[192:193], v[236:237] op_sel_hi:[1,0]
  v_pk_mul_f32 v[194:195], v[194:195], v[236:237] op_sel_hi:[1,0]
  v_pk_mul_f32 v[196:197], v[196:197], v[236:237] op_sel_hi:[1,0]
  v_pk_mul_f32 v[198:199], v[198:199], v[236:237] op_sel_hi:[1,0]
  v_cvt_pk_bf16_f32 v88, v184, v185
  v_cvt_pk_bf16_f32 v89, v186, v187
  v_cvt_pk_bf16_f32 v90, v188, v189
  v_cvt_pk_bf16_f32 v91, v190, v191
  v_cvt_pk_bf16_f32 v92, v192, v193
  v_cvt_pk_bf16_f32 v93, v194, v195
  v_cvt_pk_bf16_f32 v94, v196, v197
  v_cvt_pk_bf16_f32 v95, v198, v199
  buffer_store_dwordx4 v[88:91], v232, s[12:15], s28 offen offset:0 sc1
  buffer_store_dwordx4 v[92:95], v232, s[12:15], s28 offen offset:1024 sc1
  v_pk_mul_f32 v[200:201], v[200:201], v[236:237] op_sel_hi:[1,0]
  v_pk_mul_f32 v[202:203], v[202:203], v[236:237] op_sel_hi:[1,0]
  v_pk_mul_f32 v[204:205], v[204:205], v[236:237] op_sel_hi:[1,0]
  v_pk_mul_f32 v[206:207], v[206:207], v[236:237] op_sel_hi:[1,0]
  v_pk_mul_f32 v[208:209], v[208:209], v[236:237] op_sel_hi:[1,0]
  v_pk_mul_f32 v[210:211], v[210:211], v[236:237] op_sel_hi:[1,0]
  v_pk_mul_f32 v[212:213], v[212:213], v[236:237] op_sel_hi:[1,0]
  v_pk_mul_f32 v[214:215], v[214:215], v[236:237] op_sel_hi:[1,0]
  v_cvt_pk_bf16_f32 v96, v200, v201
  v_cvt_pk_bf16_f32 v97, v202, v203
  v_cvt_pk_bf16_f32 v98, v204, v205
  v_cvt_pk_bf16_f32 v99, v206, v207
  v_cvt_pk_bf16_f32 v100, v208, v209
  v_cvt_pk_bf16_f32 v101, v210, v211
  v_cvt_pk_bf16_f32 v102, v212, v213
  v_cvt_pk_bf16_f32 v103, v214, v215
  buffer_store_dwordx4 v[96:99], v232, s[12:15], s28 offen offset:2048 sc1
  buffer_store_dwordx4 v[100:103], v232, s[12:15], s28 offen offset:3072 sc1
  v_pk_mul_f32 v[152:153], v[152:153], v[236:237] op_sel_hi:[1,0]
  v_pk_mul_f32 v[154:155], v[154:155], v[236:237] op_sel_hi:[1,0]
  v_pk_mul_f32 v[156:157], v[156:157], v[236:237] op_sel_hi:[1,0]
  v_pk_mul_f32 v[158:159], v[158:159], v[236:237] op_sel_hi:[1,0]
  v_pk_mul_f32 v[160:161], v[160:161], v[236:237] op_sel_hi:[1,0]
  v_pk_mul_f32 v[162:163], v[162:163], v[236:237] op_sel_hi:[1,0]
  v_pk_mul_f32 v[164:165], v[164:165], v[236:237] op_sel_hi:[1,0]
  v_pk_mul_f32 v[166:167], v[166:167], v[236:237] op_sel_hi:[1,0]
  v_cvt_pk_bf16_f32 v104, v152, v153
  v_cvt_pk_bf16_f32 v105, v154, v155
  v_cvt_pk_bf16_f32 v106, v156, v157
  v_cvt_pk_bf16_f32 v107, v158, v159
  v_cvt_pk_bf16_f32 v108, v160, v161
  v_cvt_pk_bf16_f32 v109, v162, v163
  v_cvt_pk_bf16_f32 v110, v164, v165
  v_cvt_pk_bf16_f32 v111, v166, v167
  buffer_store_dwordx4 v[104:107], v232, s[12:15], s29 offen offset:0 sc1
  buffer_store_dwordx4 v[108:111], v232, s[12:15], s29 offen offset:1024 sc1
  s_nop 3
  v_pk_mul_f32 v[168:169], v[168:169], v[236:237] op_sel_hi:[1,0]
  v_pk_mul_f32 v[170:171], v[170:171], v[236:237] op_sel_hi:[1,0]
  v_pk_mul_f32 v[172:173], v[172:173], v[236:237] op_sel_hi:[1,0]
  v_pk_mul_f32 v[174:175], v[174:175], v[236:237] op_sel_hi:[1,0]
  v_pk_mul_f32 v[176:177], v[176:177], v[236:237] op_sel_hi:[1,0]
  v_pk_mul_f32 v[178:179], v[178:179], v[236:237] op_sel_hi:[1,0]
  v_pk_mul_f32 v[180:181], v[180:181], v[236:237] op_sel_hi:[1,0]
  v_pk_mul_f32 v[182:183], v[182:183], v[236:237] op_sel_hi:[1,0]
  v_cvt_pk_bf16_f32 v112, v168, v169
  v_cvt_pk_bf16_f32 v113, v170, v171
  v_cvt_pk_bf16_f32 v114, v172, v173
  v_cvt_pk_bf16_f32 v115, v174, v175
  v_cvt_pk_bf16_f32 v116, v176, v177
  v_cvt_pk_bf16_f32 v117, v178, v179
  v_cvt_pk_bf16_f32 v118, v180, v181
  v_cvt_pk_bf16_f32 v119, v182, v183
  buffer_store_dwordx4 v[112:115], v232, s[12:15], s29 offen offset:2048 sc1
  buffer_store_dwordx4 v[116:119], v232, s[12:15], s29 offen offset:3072 sc1
  s_add_u32 s26, s34, 25165824
  s_add_u32 s27, s34, 25169920
  s_add_u32 s28, s34, 41943040
  s_add_u32 s29, s34, 41947136
  buffer_load_dwordx4 v[56:59], v232, s[12:15], s26 offen offset:0
  buffer_load_dwordx4 v[60:63], v232, s[12:15], s26 offen offset:1024
  buffer_load_dwordx4 v[64:67], v232, s[12:15], s26 offen offset:2048
  buffer_load_dwordx4 v[68:71], v232, s[12:15], s26 offen offset:3072
  buffer_load_dwordx4 v[72:75], v232, s[12:15], s27 offen offset:0
  buffer_load_dwordx4 v[76:79], v232, s[12:15], s27 offen offset:1024
  buffer_load_dwordx4 v[80:83], v232, s[12:15], s27 offen offset:2048
  buffer_load_dwordx4 v[84:87], v232, s[12:15], s27 offen offset:3072
  buffer_load_dwordx4 v[120:123], v232, s[12:15], s28 offen offset:0
  buffer_load_dwordx4 v[124:127], v232, s[12:15], s28 offen offset:1024
  buffer_load_dwordx4 v[128:131], v232, s[12:15], s28 offen offset:2048
  buffer_load_dwordx4 v[132:135], v232, s[12:15], s28 offen offset:3072
  buffer_load_dwordx4 v[136:139], v232, s[12:15], s29 offen offset:0
  buffer_load_dwordx4 v[140:143], v232, s[12:15], s29 offen offset:1024
  buffer_load_dwordx4 v[144:147], v232, s[12:15], s29 offen offset:2048
  buffer_load_dwordx4 v[148:151], v232, s[12:15], s29 offen offset:3072
  s_mov_b64 exec, 1
  s_waitcnt vmcnt(16)
  buffer_atomic_add v240, off, s[12:15], s30 sc1
  s_mov_b64 exec, -1
  s_add_u32 s30, s30, 256
  v_cmp_gt_i32 vcc, s33, v239
  s_cbranch_vccz .qw32k
.qw32:
  buffer_load_dword v239, v238, s[12:15], 0 offen sc1
  s_sub_u32 s50, s50, 1
  s_cbranch_scc1 .g_end2
  s_waitcnt vmcnt(0)
  v_cmp_gt_i32 vcc, s33, v239
  s_cbranch_vccnz .qw32
.qw32k:
  s_add_u32 s26, s35, 94371840
  s_add_u32 s27, s35, 98566144
  buffer_load_dwordx4 v[88:91], v233, s[12:15], s26 offen offset:0
  buffer_load_dwordx4 v[92:95], v233, s[12:15], s26 offen offset:256
  buffer_load_dwordx4 v[96:99], v233, s[12:15], s26 offen offset:512
  buffer_load_dwordx4 v[100:103], v233, s[12:15], s26 offen offset:768
  buffer_load_dwordx4 v[104:107], v233, s[12:15], s26 offen offset:1024
  buffer_load_dwordx4 v[108:111], v233, s[12:15], s26 offen offset:1280
  buffer_load_dwordx4 v[112:115], v233, s[12:15], s26 offen offset:1536
  buffer_load_dwordx4 v[116:119], v233, s[12:15], s26 offen offset:1792
  buffer_load_dwordx2 v[216:217], v234, s[12:15], s27 offen offset:0
  buffer_load_dwordx2 v[220:221], v234, s[12:15], s27 offen offset:512
  buffer_load_dwordx2 v[224:225], v234, s[12:15], s27 offen offset:1024
  buffer_load_dwordx2 v[228:229], v234, s[12:15], s27 offen offset:1536
  v_accvgpr_read_b32 v152, a128
  v_accvgpr_read_b32 v153, a129
  v_accvgpr_read_b32 v154, a130
  v_accvgpr_read_b32 v155, a131
  v_accvgpr_read_b32 v156, a132
  v_accvgpr_read_b32 v157, a133
  v_accvgpr_read_b32 v158, a134
  v_accvgpr_read_b32 v159, a135
  v_cvt_pk_bf16_f32 v24, v152, v153
  v_cvt_pk_bf16_f32 v26, v156, v157
  v_cvt_pk_bf16_f32 v25, v154, v155
  v_cvt_pk_bf16_f32 v27, v158, v159
  s_nop 0
  v_permlane16_swap_b32 v24, v26
  v_permlane16_swap_b32 v25, v27
  v_accvgpr_read_b32 v160, a136
  v_accvgpr_read_b32 v161, a137
  v_accvgpr_read_b32 v162, a138
  v_accvgpr_read_b32 v163, a139
  v_accvgpr_read_b32 v164, a140
  v_accvgpr_read_b32 v165, a141
  v_accvgpr_read_b32 v166, a142
  v_accvgpr_read_b32 v167, a143
  v_cvt_pk_bf16_f32 v28, v160, v161
  v_cvt_pk_bf16_f32 v30, v164, v165
  v_cvt_pk_bf16_f32 v29, v162, v163
  v_cvt_pk_bf16_f32 v31, v166, v167
  s_nop 0
  v_permlane16_swap_b32 v28, v30
  v_permlane16_swap_b32 v29, v31
  v_accvgpr_read_b32 v152, a144
  v_accvgpr_read_b32 v153, a145
  v_accvgpr_read_b32 v154, a146
  v_accvgpr_read_b32 v155, a147
  v_accvgpr_read_b32 v156, a148
  v_accvgpr_read_b32 v157, a149
  v_accvgpr_read_b32 v158, a150
  v_accvgpr_read_b32 v159, a151
  v_cvt_pk_bf16_f32 v32, v152, v153
  v_cvt_pk_bf16_f32 v34, v156, v157
  v_cvt_pk_bf16_f32 v33, v154, v155
  v_cvt_pk_bf16_f32 v35, v158, v159
  s_nop 0
  v_permlane16_swap_b32 v32, v34
  v_permlane16_swap_b32 v33, v35
  v_accvgpr_read_b32 v160, a152
  v_accvgpr_read_b32 v161, a153
  v_accvgpr_read_b32 v162, a154
  v_accvgpr_read_b32 v163, a155
  v_accvgpr_read_b32 v164, a156
  v_accvgpr_read_b32 v165, a157
  v_accvgpr_read_b32 v166, a158
  v_accvgpr_read_b32 v167, a159
  v_cvt_pk_bf16_f32 v36, v160, v161
  v_cvt_pk_bf16_f32 v38, v164, v165
  v_cvt_pk_bf16_f32 v37, v162, v163
  v_cvt_pk_bf16_f32 v39, v166, v167
  s_nop 0
  v_permlane16_swap_b32 v36, v38
  v_permlane16_swap_b32 v37, v39
  v_accvgpr_read_b32 v152, a160
  v_accvgpr_read_b32 v153, a161
  v_accvgpr_read_b32 v154, a162
  v_accvgpr_read_b32 v155, a163
  v_accvgpr_read_b32 v156, a164
  v_accvgpr_read_b32 v157, a165
  v_accvgpr_read_b32 v158, a166
  v_accvgpr_read_b32 v159, a167
  v_cvt_pk_bf16_f32 v40, v152, v153
  v_cvt_pk_bf16_f32 v42, v156, v157
  v_cvt_pk_bf16_f32 v41, v154, v155
  v_cvt_pk_bf16_f32 v43, v158, v159
  s_nop 0
  v_permlane16_swap_b32 v40, v42
  v_permlane16_swap_b32 v41, v43
  v_accvgpr_read_b32 v160, a168
  v_accvgpr_read_b32 v161, a169
  v_accvgpr_read_b32 v162, a170
  v_accvgpr_read_b32 v163, a171
  v_accvgpr_read_b32 v164, a172
  v_accvgpr_read_b32 v165, a173
  v_accvgpr_read_b32 v166, a174
  v_accvgpr_read_b32 v167, a175
  v_cvt_pk_bf16_f32 v44, v160, v161
  v_cvt_pk_bf16_f32 v46, v164, v165
  v_cvt_pk_bf16_f32 v45, v162, v163
  v_cvt_pk_bf16_f32 v47, v166, v167
  s_nop 0
  v_permlane16_swap_b32 v44, v46
  v_permlane16_swap_b32 v45, v47
  v_accvgpr_read_b32 v152, a176
  v_accvgpr_read_b32 v153, a177
  v_accvgpr_read_b32 v154, a178
  v_accvgpr_read_b32 v155, a179
  v_accvgpr_read_b32 v156, a180
  v_accvgpr_read_b32 v157, a181
  v_accvgpr_read_b32 v158, a182
  v_accvgpr_read_b32 v159, a183
  v_cvt_pk_bf16_f32 v48, v152, v153
  v_cvt_pk_bf16_f32 v50, v156, v157
  v_cvt_pk_bf16_f32 v49, v154, v155
  v_cvt_pk_bf16_f32 v51, v158, v159
  s_nop 0
  v_permlane16_swap_b32 v48, v50
  v_permlane16_swap_b32 v49, v51
  v_accvgpr_read_b32 v160, a184
  v_accvgpr_read_b32 v161, a185
  v_accvgpr_read_b32 v162, a186
  v_accvgpr_read_b32 v163, a187
  v_accvgpr_read_b32 v164, a188
  v_accvgpr_read_b32 v165, a189
  v_accvgpr_read_b32 v166, a190
  v_accvgpr_read_b32 v167, a191
  v_cvt_pk_bf16_f32 v52, v160, v161
  v_cvt_pk_bf16_f32 v54, v164, v165
  v_cvt_pk_bf16_f32 v53, v162, v163
  v_cvt_pk_bf16_f32 v55, v166, v167
  s_nop 0
  v_permlane16_swap_b32 v52, v54
  v_permlane16_swap_b32 v53, v55
  s_waitcnt vmcnt(20)
  v_mfma_f32_32x32x16_bf16 v[152:167], v[56:59], v[24:27], 0
  v_mfma_f32_32x32x16_bf16 v[152:167], v[60:63], v[28:31], v[152:167]
  v_mfma_f32_32x32x16_bf16 v[152:167], v[64:67], v[32:35], v[152:167]
  v_mfma_f32_32x32x16_bf16 v[152:167], v[68:71], v[36:39], v[152:167]
  v_mfma_f32_32x32x16_bf16 v[152:167], v[72:75], v[40:43], v[152:167]
  v_mfma_f32_32x32x16_bf16 v[152:167], v[76:79], v[44:47], v[152:167]
  v_mfma_f32_32x32x16_bf16 v[152:167], v[80:83], v[48:51], v[152:167]
  v_mfma_f32_32x32x16_bf16 v[152:167], v[84:87], v[52:55], v[152:167]
  s_waitcnt vmcnt(11)
  v_mfma_f32_32x32x16_bf16 v[168:183], v[88:91], v[24:27], 0
  s_waitcnt vmcnt(10)
  v_mfma_f32_32x32x16_bf16 v[168:183], v[92:95], v[28:31], v[168:183]
  s_waitcnt vmcnt(9)
  v_mfma_f32_32x32x16_bf16 v[168:183], v[96:99], v[32:35], v[168:183]
  s_waitcnt vmcnt(8)
  v_mfma_f32_32x32x16_bf16 v[168:183], v[100:103], v[36:39], v[168:183]
  s_waitcnt vmcnt(7)
  v_mfma_f32_32x32x16_bf16 v[168:183], v[104:107], v[40:43], v[168:183]
  s_waitcnt vmcnt(6)
  v_mfma_f32_32x32x16_bf16 v[168:183], v[108:111], v[44:47], v[168:183]
  s_waitcnt vmcnt(5)
  v_mfma_f32_32x32x16_bf16 v[168:183], v[112:115], v[48:51], v[168:183]
  s_waitcnt vmcnt(4)
  v_mfma_f32_32x32x16_bf16 v[168:183], v[116:119], v[52:55], v[168:183]
  s_add_u32 s28, s34, 58720256
  s_add_u32 s29, s34, 58724352
  v_mov_b32 v236, 3492320863
  s_mov_b32 s27, 1040356334
  s_add_u32 s34, s34, 524288
  s_add_u32 s35, s35, 131072
  s_add_u32 s33, s33, 2
  v_cmp_le_i32 vcc, 0, v235
  s_nop 1
  v_cndmask_b32 v152, v236, v152, vcc
  v_cmp_le_i32 vcc, 1, v235
  s_nop 1
  v_cndmask_b32 v153, v236, v153, vcc
  v_cmp_le_i32 vcc, 2, v235
  s_nop 1
  v_cndmask_b32 v154, v236, v154, vcc
  v_cmp_le_i32 vcc, 3, v235
  s_nop 1
  v_cndmask_b32 v155, v236, v155, vcc
  v_cmp_le_i32 vcc, 8, v235
  s_nop 1
  v_cndmask_b32 v156, v236, v156, vcc
  v_cmp_le_i32 vcc, 9, v235
  s_nop 1
  v_cndmask_b32 v157, v236, v157, vcc
  v_cmp_le_i32 vcc, 10, v235
  s_nop 1
  v_cndmask_b32 v158, v236, v158, vcc
  v_cmp_le_i32 vcc, 11, v235
  s_nop 1
  v_cndmask_b32 v159, v236, v159, vcc
  v_cmp_le_i32 vcc, 16, v235
  s_nop 1
  v_cndmask_b32 v160, v236, v160, vcc
  v_cmp_le_i32 vcc, 17, v235
  s_nop 1
  v_cndmask_b32 v161, v236, v161, vcc
  v_cmp_le_i32 vcc, 18, v235
  s_nop 1
  v_cndmask_b32 v162, v236, v162, vcc
  v_cmp_le_i32 vcc, 19, v235
  s_nop 1
  v_cndmask_b32 v163, v236, v163, vcc
  v_cmp_le_i32 vcc, 24, v235
  s_nop 1
  v_cndmask_b32 v164, v236, v164, vcc
  v_cmp_le_i32 vcc, 25, v235
  s_nop 1
  v_cndmask_b32 v165, v236, v165, vcc
  v_cmp_le_i32 vcc, 26, v235
  s_nop 1
  v_cndmask_b32 v166, v236, v166, vcc
  v_cmp_le_i32 vcc, 27, v235
  s_nop 1
  v_cndmask_b32 v167, v236, v167, vcc
  v_max3_f32 v237, v152, v153, v171
  v_max3_f32 v237, v154, v155, v237
  v_max3_f32 v237, v156, v157, v237
  v_max3_f32 v237, v158, v159, v237
  v_max3_f32 v237, v160, v161, v237
  v_max3_f32 v237, v162, v163, v237
  v_max3_f32 v237, v164, v165, v237
  v_max3_f32 v237, v166, v167, v237
  v_max3_f32 v237, v168, v169, v237
  v_max_f32 v237, v170, v237
  v_mov_b32 v236, v237
  s_nop 1
  v_permlane32_swap_b32 v236, v237
  s_nop 1
  v_max_f32 v237, v236, v237
  v_mul_f32 v237, s27, v237
  v_fma_f32 v152, v152, s27, -v237
  v_fma_f32 v153, v153, s27, -v237
  v_fma_f32 v154, v154, s27, -v237
  v_fma_f32 v155, v155, s27, -v237
  v_fma_f32 v156, v156, s27, -v237
  v_fma_f32 v157, v157, s27, -v237
  v_fma_f32 v158, v158, s27, -v237
  v_fma_f32 v159, v159, s27, -v237
  v_fma_f32 v160, v160, s27, -v237
  v_fma_f32 v161, v161, s27, -v237
  v_fma_f32 v162, v162, s27, -v237
  v_fma_f32 v163, v163, s27, -v237
  v_fma_f32 v164, v164, s27, -v237
  v_fma_f32 v165, v165, s27, -v237
  v_fma_f32 v166, v166, s27, -v237
  v_fma_f32 v167, v167, s27, -v237
  v_fma_f32 v168, v168, s27, -v237
  v_fma_f32 v169, v169, s27, -v237
  v_fma_f32 v170, v170, s27, -v237
  v_fma_f32 v171, v171, s27, -v237
  v_exp_f32 v152, v152
  v_exp_f32 v153, v153
  v_exp_f32 v154, v154
  v_exp_f32 v155, v155
  v_exp_f32 v156, v156
  v_exp_f32 v157, v157
  v_exp_f32 v158, v158
  v_exp_f32 v159, v159
  v_exp_f32 v160, v160
  v_exp_f32 v161, v161
  v_exp_f32 v162, v162
  v_exp_f32 v163, v163
  v_exp_f32 v164, v164
  v_exp_f32 v165, v165
  v_exp_f32 v166, v166
  v_exp_f32 v167, v167
  v_exp_f32 v168, v168
  v_exp_f32 v169, v169
  v_exp_f32 v170, v170
  v_exp_f32 v171, v171
  v_add_f32 v237, v152, v153
  v_add_f32 v237, v237, v154
  v_add_f32 v237, v237, v155
  v_add_f32 v237, v237, v156
  v_add_f32 v237, v237, v157
  v_add_f32 v237, v237, v158
  v_add_f32 v237, v237, v159
  v_add_f32 v237, v237, v160
  v_add_f32 v237, v237, v161
  v_add_f32 v237, v237, v162
  v_add_f32 v237, v237, v163
  v_add_f32 v237, v237, v164
  v_add_f32 v237, v237, v165
  v_add_f32 v237, v237, v166
  v_add_f32 v237, v237, v167
  v_add_f32 v237, v237, v168
  v_add_f32 v237, v237, v169
  v_add_f32 v237, v237, v170
  v_add_f32 v237, v237, v171
  v_cvt_pk_bf16_f32 v24, v152, v153
  v_cvt_pk_bf16_f32 v25, v154, v155
  v_cvt_pk_bf16_f32 v26, v156, v157
  v_cvt_pk_bf16_f32 v27, v158, v159
  v_cvt_pk_bf16_f32 v28, v160, v161
  v_cvt_pk_bf16_f32 v29, v162, v163
  v_cvt_pk_bf16_f32 v30, v164, v165
  v_cvt_pk_bf16_f32 v31, v166, v167
  v_cvt_pk_bf16_f32 v32, v168, v169
  v_cvt_pk_bf16_f32 v33, v170, v171
  v_mov_b32 v34, 0
  v_mov_b32 v35, 0
  v_mov_b32 v236, v237
  s_nop 1
  v_permlane32_swap_b32 v236, v237
  s_waitcnt vmcnt(0)
  s_nop 0
  v_add_f32 v237, v236, v237
  v_rcp_f32 v236, v237
  v_mfma_f32_32x32x16_bf16 v[184:199], v[120:123], v[24:27], 0
  v_mfma_f32_32x32x16_bf16 v[184:199], v[124:127], v[28:31], v[184:199]
  v_mfma_f32_32x32x16_bf16 v[184:199], v[216:219], v[32:35], v[184:199]
  v_mfma_f32_32x32x16_bf16 v[200:215], v[128:131], v[24:27], 0
  v_mfma_f32_32x32x16_bf16 v[200:215], v[132:135], v[28:31], v[200:215]
  v_mfma_f32_32x32x16_bf16 v[200:215], v[220:223], v[32:35], v[200:215]
  v_mfma_f32_32x32x16_bf16 v[152:167], v[136:139], v[24:27], 0
  v_mfma_f32_32x32x16_bf16 v[152:167], v[140:143], v[28:31], v[152:167]
  v_mfma_f32_32x32x16_bf16 v[152:167], v[224:227], v[32:35], v[152:167]
  v_mfma_f32_32x32x16_bf16 v[168:183], v[144:147], v[24:27], 0
  v_mfma_f32_32x32x16_bf16 v[168:183], v[148:151], v[28:31], v[168:183]
  v_mfma_f32_32x32x16_bf16 v[168:183], v[228:231], v[32:35], v[168:183]
  v_pk_mul_f32 v[184:185], v[184:185], v[236:237] op_sel_hi:[1,0]
  v_pk_mul_f32 v[186:187], v[186:187], v[236:237] op_sel_hi:[1,0]
  v_pk_mul_f32 v[188:189], v[188:189], v[236:237] op_sel_hi:[1,0]
  v_pk_mul_f32 v[190:191], v[190:191], v[236:237] op_sel_hi:[1,0]
  v_pk_mul_f32 v[192:193], v[192:193], v[236:237] op_sel_hi:[1,0]
  v_pk_mul_f32 v[194:195], v[194:195], v[236:237] op_sel_hi:[1,0]
  v_pk_mul_f32 v[196:197], v[196:197], v[236:237] op_sel_hi:[1,0]
  v_pk_mul_f32 v[198:199], v[198:199], v[236:237] op_sel_hi:[1,0]
  v_cvt_pk_bf16_f32 v88, v184, v185
  v_cvt_pk_bf16_f32 v89, v186, v187
  v_cvt_pk_bf16_f32 v90, v188, v189
  v_cvt_pk_bf16_f32 v91, v190, v191
  v_cvt_pk_bf16_f32 v92, v192, v193
  v_cvt_pk_bf16_f32 v93, v194, v195
  v_cvt_pk_bf16_f32 v94, v196, v197
  v_cvt_pk_bf16_f32 v95, v198, v199
  buffer_store_dwordx4 v[88:91], v232, s[12:15], s28 offen offset:0 sc1
  buffer_store_dwordx4 v[92:95], v232, s[12:15], s28 offen offset:1024 sc1
  v_pk_mul_f32 v[200:201], v[200:201], v[236:237] op_sel_hi:[1,0]
  v_pk_mul_f32 v[202:203], v[202:203], v[236:237] op_sel_hi:[1,0]
  v_pk_mul_f32 v[204:205], v[204:205], v[236:237] op_sel_hi:[1,0]
  v_pk_mul_f32 v[206:207], v[206:207], v[236:237] op_sel_hi:[1,0]
  v_pk_mul_f32 v[208:209], v[208:209], v[236:237] op_sel_hi:[1,0]
  v_pk_mul_f32 v[210:211], v[210:211], v[236:237] op_sel_hi:[1,0]
  v_pk_mul_f32 v[212:213], v[212:213], v[236:237] op_sel_hi:[1,0]
  v_pk_mul_f32 v[214:215], v[214:215], v[236:237] op_sel_hi:[1,0]
  v_cvt_pk_bf16_f32 v96, v200, v201
  v_cvt_pk_bf16_f32 v97, v202, v203
  v_cvt_pk_bf16_f32 v98, v204, v205
  v_cvt_pk_bf16_f32 v99, v206, v207
  v_cvt_pk_bf16_f32 v100, v208, v209
  v_cvt_pk_bf16_f32 v101, v210, v211
  v_cvt_pk_bf16_f32 v102, v212, v213
  v_cvt_pk_bf16_f32 v103, v214, v215
  buffer_store_dwordx4 v[96:99], v232, s[12:15], s28 offen offset:2048 sc1
  buffer_store_dwordx4 v[100:103], v232, s[12:15], s28 offen offset:3072 sc1
  v_pk_mul_f32 v[152:153], v[152:153], v[236:237] op_sel_hi:[1,0]
  v_pk_mul_f32 v[154:155], v[154:155], v[236:237] op_sel_hi:[1,0]
  v_pk_mul_f32 v[156:157], v[156:157], v[236:237] op_sel_hi:[1,0]
  v_pk_mul_f32 v[158:159], v[158:159], v[236:237] op_sel_hi:[1,0]
  v_pk_mul_f32 v[160:161], v[160:161], v[236:237] op_sel_hi:[1,0]
  v_pk_mul_f32 v[162:163], v[162:163], v[236:237] op_sel_hi:[1,0]
  v_pk_mul_f32 v[164:165], v[164:165], v[236:237] op_sel_hi:[1,0]
  v_pk_mul_f32 v[166:167], v[166:167], v[236:237] op_sel_hi:[1,0]
  v_cvt_pk_bf16_f32 v104, v152, v153
  v_cvt_pk_bf16_f32 v105, v154, v155
  v_cvt_pk_bf16_f32 v106, v156, v157
  v_cvt_pk_bf16_f32 v107, v158, v159
  v_cvt_pk_bf16_f32 v108, v160, v161
  v_cvt_pk_bf16_f32 v109, v162, v163
  v_cvt_pk_bf16_f32 v110, v164, v165
  v_cvt_pk_bf16_f32 v111, v166, v167
  buffer_store_dwordx4 v[104:107], v232, s[12:15], s29 offen offset:0 sc1
  buffer_store_dwordx4 v[108:111], v232, s[12:15], s29 offen offset:1024 sc1
  s_nop 3
  v_pk_mul_f32 v[168:169], v[168:169], v[236:237] op_sel_hi:[1,0]
  v_pk_mul_f32 v[170:171], v[170:171], v[236:237] op_sel_hi:[1,0]
  v_pk_mul_f32 v[172:173], v[172:173], v[236:237] op_sel_hi:[1,0]
  v_pk_mul_f32 v[174:175], v[174:175], v[236:237] op_sel_hi:[1,0]
  v_pk_mul_f32 v[176:177], v[176:177], v[236:237] op_sel_hi:[1,0]
  v_pk_mul_f32 v[178:179], v[178:179], v[236:237] op_sel_hi:[1,0]
  v_pk_mul_f32 v[180:181], v[180:181], v[236:237] op_sel_hi:[1,0]
  v_pk_mul_f32 v[182:183], v[182:183], v[236:237] op_sel_hi:[1,0]
  v_cvt_pk_bf16_f32 v112, v168, v169
  v_cvt_pk_bf16_f32 v113, v170, v171
  v_cvt_pk_bf16_f32 v114, v172, v173
  v_cvt_pk_bf16_f32 v115, v174, v175
  v_cvt_pk_bf16_f32 v116, v176, v177
  v_cvt_pk_bf16_f32 v117, v178, v179
  v_cvt_pk_bf16_f32 v118, v180, v181
  v_cvt_pk_bf16_f32 v119, v182, v183
  buffer_store_dwordx4 v[112:115], v232, s[12:15], s29 offen offset:2048 sc1
  buffer_store_dwordx4 v[116:119], v232, s[12:15], s29 offen offset:3072 sc1
  s_add_u32 s26, s34, 25165824
  s_add_u32 s27, s34, 25169920
  s_add_u32 s28, s34, 41943040
  s_add_u32 s29, s34, 41947136
  buffer_load_dwordx4 v[56:59], v232, s[12:15], s26 offen offset:0
  buffer_load_dwordx4 v[60:63], v232, s[12:15], s26 offen offset:1024
  buffer_load_dwordx4 v[64:67], v232, s[12:15], s26 offen offset:2048
  buffer_load_dwordx4 v[68:71], v232, s[12:15], s26 offen offset:3072
  buffer_load_dwordx4 v[72:75], v232, s[12:15], s27 offen offset:0
  buffer_load_dwordx4 v[76:79], v232, s[12:15], s27 offen offset:1024
  buffer_load_dwordx4 v[80:83], v232, s[12:15], s27 offen offset:2048
  buffer_load_dwordx4 v[84:87], v232, s[12:15], s27 offen offset:3072
  buffer_load_dwordx4 v[120:123], v232, s[12:15], s28 offen offset:0
  buffer_load_dwordx4 v[124:127], v232, s[12:15], s28 offen offset:1024
  buffer_load_dwordx4 v[128:131], v232, s[12:15], s28 offen offset:2048
  buffer_load_dwordx4 v[132:135], v232, s[12:15], s28 offen offset:3072
  buffer_load_dwordx4 v[136:139], v232, s[12:15], s29 offen offset:0
  buffer_load_dwordx4 v[140:143], v232, s[12:15], s29 offen offset:1024
  buffer_load_dwordx4 v[144:147], v232, s[12:15], s29 offen offset:2048
  buffer_load_dwordx4 v[148:151], v232, s[12:15], s29 offen offset:3072
  s_mov_b64 exec, 1
  s_waitcnt vmcnt(16)
  buffer_atomic_add v240, off, s[12:15], s30 sc1
  s_mov_b64 exec, -1
  s_add_u32 s30, s30, 256
  v_cmp_gt_i32 vcc, s33, v239
  s_cbranch_vccz .qw33k
.qw33:
  buffer_load_dword v239, v238, s[12:15], 0 offen sc1
  s_sub_u32 s50, s50, 1
  s_cbranch_scc1 .g_end2
  s_waitcnt vmcnt(0)
  v_cmp_gt_i32 vcc, s33, v239
  s_cbranch_vccnz .qw33
.qw33k:
  s_add_u32 s26, s35, 94371840
  s_add_u32 s27, s35, 98566144
  buffer_load_dwordx4 v[88:91], v233, s[12:15], s26 offen offset:0
  buffer_load_dwordx4 v[92:95], v233, s[12:15], s26 offen offset:256
  buffer_load_dwordx4 v[96:99], v233, s[12:15], s26 offen offset:512
  buffer_load_dwordx4 v[100:103], v233, s[12:15], s26 offen offset:768
  buffer_load_dwordx4 v[104:107], v233, s[12:15], s26 offen offset:1024
  buffer_load_dwordx4 v[108:111], v233, s[12:15], s26 offen offset:1280
  buffer_load_dwordx4 v[112:115], v233, s[12:15], s26 offen offset:1536
  buffer_load_dwordx4 v[116:119], v233, s[12:15], s26 offen offset:1792
  buffer_load_dwordx2 v[216:217], v234, s[12:15], s27 offen offset:0
  buffer_load_dwordx2 v[220:221], v234, s[12:15], s27 offen offset:512
  buffer_load_dwordx2 v[224:225], v234, s[12:15], s27 offen offset:1024
  buffer_load_dwordx2 v[228:229], v234, s[12:15], s27 offen offset:1536
  v_accvgpr_read_b32 v152, a192
  v_accvgpr_read_b32 v153, a193
  v_accvgpr_read_b32 v154, a194
  v_accvgpr_read_b32 v155, a195
  v_accvgpr_read_b32 v156, a196
  v_accvgpr_read_b32 v157, a197
  v_accvgpr_read_b32 v158, a198
  v_accvgpr_read_b32 v159, a199
  v_cvt_pk_bf16_f32 v24, v152, v153
  v_cvt_pk_bf16_f32 v26, v156, v157
  v_cvt_pk_bf16_f32 v25, v154, v155
  v_cvt_pk_bf16_f32 v27, v158, v159
  s_nop 0
  v_permlane16_swap_b32 v24, v26
  v_permlane16_swap_b32 v25, v27
  v_accvgpr_read_b32 v160, a200
  v_accvgpr_read_b32 v161, a201
  v_accvgpr_read_b32 v162, a202
  v_accvgpr_read_b32 v163, a203
  v_accvgpr_read_b32 v164, a204
  v_accvgpr_read_b32 v165, a205
  v_accvgpr_read_b32 v166, a206
  v_accvgpr_read_b32 v167, a207
  v_cvt_pk_bf16_f32 v28, v160, v161
  v_cvt_pk_bf16_f32 v30, v164, v165
  v_cvt_pk_bf16_f32 v29, v162, v163
  v_cvt_pk_bf16_f32 v31, v166, v167
  s_nop 0
  v_permlane16_swap_b32 v28, v30
  v_permlane16_swap_b32 v29, v31
  v_accvgpr_read_b32 v152, a208
  v_accvgpr_read_b32 v153, a209
  v_accvgpr_read_b32 v154, a210
  v_accvgpr_read_b32 v155, a211
  v_accvgpr_read_b32 v156, a212
  v_accvgpr_read_b32 v157, a213
  v_accvgpr_read_b32 v158, a214
  v_accvgpr_read_b32 v159, a215
  v_cvt_pk_bf16_f32 v32, v152, v153
  v_cvt_pk_bf16_f32 v34, v156, v157
  v_cvt_pk_bf16_f32 v33, v154, v155
  v_cvt_pk_bf16_f32 v35, v158, v159
  s_nop 0
  v_permlane16_swap_b32 v32, v34
  v_permlane16_swap_b32 v33, v35
  v_accvgpr_read_b32 v160, a216
  v_accvgpr_read_b32 v161, a217
  v_accvgpr_read_b32 v162, a218
  v_accvgpr_read_b32 v163, a219
  v_accvgpr_read_b32 v164, a220
  v_accvgpr_read_b32 v165, a221
  v_accvgpr_read_b32 v166, a222
  v_accvgpr_read_b32 v167, a223
  v_cvt_pk_bf16_f32 v36, v160, v161
  v_cvt_pk_bf16_f32 v38, v164, v165
  v_cvt_pk_bf16_f32 v37, v162, v163
  v_cvt_pk_bf16_f32 v39, v166, v167
  s_nop 0
  v_permlane16_swap_b32 v36, v38
  v_permlane16_swap_b32 v37, v39
  v_accvgpr_read_b32 v152, a224
  v_accvgpr_read_b32 v153, a225
  v_accvgpr_read_b32 v154, a226
  v_accvgpr_read_b32 v155, a227
  v_accvgpr_read_b32 v156, a228
  v_accvgpr_read_b32 v157, a229
  v_accvgpr_read_b32 v158, a230
  v_accvgpr_read_b32 v159, a231
  v_cvt_pk_bf16_f32 v40, v152, v153
  v_cvt_pk_bf16_f32 v42, v156, v157
  v_cvt_pk_bf16_f32 v41, v154, v155
  v_cvt_pk_bf16_f32 v43, v158, v159
  s_nop 0
  v_permlane16_swap_b32 v40, v42
  v_permlane16_swap_b32 v41, v43
  v_accvgpr_read_b32 v160, a232
  v_accvgpr_read_b32 v161, a233
  v_accvgpr_read_b32 v162, a234
  v_accvgpr_read_b32 v163, a235
  v_accvgpr_read_b32 v164, a236
  v_accvgpr_read_b32 v165, a237
  v_accvgpr_read_b32 v166, a238
  v_accvgpr_read_b32 v167, a239
  v_cvt_pk_bf16_f32 v44, v160, v161
  v_cvt_pk_bf16_f32 v46, v164, v165
  v_cvt_pk_bf16_f32 v45, v162, v163
  v_cvt_pk_bf16_f32 v47, v166, v167
  s_nop 0
  v_permlane16_swap_b32 v44, v46
  v_permlane16_swap_b32 v45, v47
  v_accvgpr_read_b32 v152, a240
  v_accvgpr_read_b32 v153, a241
  v_accvgpr_read_b32 v154, a242
  v_accvgpr_read_b32 v155, a243
  v_accvgpr_read_b32 v156, a244
  v_accvgpr_read_b32 v157, a245
  v_accvgpr_read_b32 v158, a246
  v_accvgpr_read_b32 v159, a247
  v_cvt_pk_bf16_f32 v48, v152, v153
  v_cvt_pk_bf16_f32 v50, v156, v157
  v_cvt_pk_bf16_f32 v49, v154, v155
  v_cvt_pk_bf16_f32 v51, v158, v159
  s_nop 0
  v_permlane16_swap_b32 v48, v50
  v_permlane16_swap_b32 v49, v51
  v_accvgpr_read_b32 v160, a248
  v_accvgpr_read_b32 v161, a249
  v_accvgpr_read_b32 v162, a250
  v_accvgpr_read_b32 v163, a251
  v_accvgpr_read_b32 v164, a252
  v_accvgpr_read_b32 v165, a253
  v_accvgpr_read_b32 v166, a254
  v_accvgpr_read_b32 v167, a255
  v_cvt_pk_bf16_f32 v52, v160, v161
  v_cvt_pk_bf16_f32 v54, v164, v165
  v_cvt_pk_bf16_f32 v53, v162, v163
  v_cvt_pk_bf16_f32 v55, v166, v167
  s_nop 0
  v_permlane16_swap_b32 v52, v54
  v_permlane16_swap_b32 v53, v55
  s_waitcnt vmcnt(20)
  v_mfma_f32_32x32x16_bf16 v[152:167], v[56:59], v[24:27], 0
  v_mfma_f32_32x32x16_bf16 v[152:167], v[60:63], v[28:31], v[152:167]
  v_mfma_f32_32x32x16_bf16 v[152:167], v[64:67], v[32:35], v[152:167]
  v_mfma_f32_32x32x16_bf16 v[152:167], v[68:71], v[36:39], v[152:167]
  v_mfma_f32_32x32x16_bf16 v[152:167], v[72:75], v[40:43], v[152:167]
  v_mfma_f32_32x32x16_bf16 v[152:167], v[76:79], v[44:47], v[152:167]
  v_mfma_f32_32x32x16_bf16 v[152:167], v[80:83], v[48:51], v[152:167]
  v_mfma_f32_32x32x16_bf16 v[152:167], v[84:87], v[52:55], v[152:167]
  s_waitcnt vmcnt(11)
  v_mfma_f32_32x32x16_bf16 v[168:183], v[88:91], v[24:27], 0
  s_waitcnt vmcnt(10)
  v_mfma_f32_32x32x16_bf16 v[168:183], v[92:95], v[28:31], v[168:183]
  s_waitcnt vmcnt(9)
  v_mfma_f32_32x32x16_bf16 v[168:183], v[96:99], v[32:35], v[168:183]
  s_waitcnt vmcnt(8)
  v_mfma_f32_32x32x16_bf16 v[168:183], v[100:103], v[36:39], v[168:183]
  s_waitcnt vmcnt(7)
  v_mfma_f32_32x32x16_bf16 v[168:183], v[104:107], v[40:43], v[168:183]
  s_waitcnt vmcnt(6)
  v_mfma_f32_32x32x16_bf16 v[168:183], v[108:111], v[44:47], v[168:183]
  s_waitcnt vmcnt(5)
  v_mfma_f32_32x32x16_bf16 v[168:183], v[112:115], v[48:51], v[168:183]
  s_waitcnt vmcnt(4)
  v_mfma_f32_32x32x16_bf16 v[168:183], v[116:119], v[52:55], v[168:183]
  s_add_u32 s28, s34, 58720256
  s_add_u32 s29, s34, 58724352
  v_mov_b32 v236, 3492320863
  s_mov_b32 s27, 1040356334
  s_add_u32 s34, s34, 524288
  s_add_u32 s35, s35, 131072
  s_add_u32 s33, s33, 2
  v_cmp_le_i32 vcc, 0, v235
  s_nop 1
  v_cndmask_b32 v152, v236, v152, vcc
  v_cmp_le_i32 vcc, 1, v235
  s_nop 1
  v_cndmask_b32 v153, v236, v153, vcc
  v_cmp_le_i32 vcc, 2, v235
  s_nop 1
  v_cndmask_b32 v154, v236, v154, vcc
  v_cmp_le_i32 vcc, 3, v235
  s_nop 1
  v_cndmask_b32 v155, v236, v155, vcc
  v_cmp_le_i32 vcc, 8, v235
  s_nop 1
  v_cndmask_b32 v156, v236, v156, vcc
  v_cmp_le_i32 vcc, 9, v235
  s_nop 1
  v_cndmask_b32 v157, v236, v157, vcc
  v_cmp_le_i32 vcc, 10, v235
  s_nop 1
  v_cndmask_b32 v158, v236, v158, vcc
  v_cmp_le_i32 vcc, 11, v235
  s_nop 1
  v_cndmask_b32 v159, v236, v159, vcc
  v_cmp_le_i32 vcc, 16, v235
  s_nop 1
  v_cndmask_b32 v160, v236, v160, vcc
  v_cmp_le_i32 vcc, 17, v235
  s_nop 1
  v_cndmask_b32 v161, v236, v161, vcc
  v_cmp_le_i32 vcc, 18, v235
  s_nop 1
  v_cndmask_b32 v162, v236, v162, vcc
  v_cmp_le_i32 vcc, 19, v235
  s_nop 1
  v_cndmask_b32 v163, v236, v163, vcc
  v_cmp_le_i32 vcc, 24, v235
  s_nop 1
  v_cndmask_b32 v164, v236, v164, vcc
  v_cmp_le_i32 vcc, 25, v235
  s_nop 1
  v_cndmask_b32 v165, v236, v165, vcc
  v_cmp_le_i32 vcc, 26, v235
  s_nop 1
  v_cndmask_b32 v166, v236, v166, vcc
  v_cmp_le_i32 vcc, 27, v235
  s_nop 1
  v_cndmask_b32 v167, v236, v167, vcc
  v_max3_f32 v237, v152, v153, v171
  v_max3_f32 v237, v154, v155, v237
  v_max3_f32 v237, v156, v157, v237
  v_max3_f32 v237, v158, v159, v237
  v_max3_f32 v237, v160, v161, v237
  v_max3_f32 v237, v162, v163, v237
  v_max3_f32 v237, v164, v165, v237
  v_max3_f32 v237, v166, v167, v237
  v_max3_f32 v237, v168, v169, v237
  v_max_f32 v237, v170, v237
  v_mov_b32 v236, v237
  s_nop 1
  v_permlane32_swap_b32 v236, v237
  s_nop 1
  v_max_f32 v237, v236, v237
  v_mul_f32 v237, s27, v237
  v_fma_f32 v152, v152, s27, -v237
  v_fma_f32 v153, v153, s27, -v237
  v_fma_f32 v154, v154, s27, -v237
  v_fma_f32 v155, v155, s27, -v237
  v_fma_f32 v156, v156, s27, -v237
  v_fma_f32 v157, v157, s27, -v237
  v_fma_f32 v158, v158, s27, -v237
  v_fma_f32 v159, v159, s27, -v237
  v_fma_f32 v160, v160, s27, -v237
  v_fma_f32 v161, v161, s27, -v237
  v_fma_f32 v162, v162, s27, -v237
  v_fma_f32 v163, v163, s27, -v237
  v_fma_f32 v164, v164, s27, -v237
  v_fma_f32 v165, v165, s27, -v237
  v_fma_f32 v166, v166, s27, -v237
  v_fma_f32 v167, v167, s27, -v237
  v_fma_f32 v168, v168, s27, -v237
  v_fma_f32 v169, v169, s27, -v237
  v_fma_f32 v170, v170, s27, -v237
  v_fma_f32 v171, v171, s27, -v237
  v_exp_f32 v152, v152
  v_exp_f32 v153, v153
  v_exp_f32 v154, v154
  v_exp_f32 v155, v155
  v_exp_f32 v156, v156
  v_exp_f32 v157, v157
  v_exp_f32 v158, v158
  v_exp_f32 v159, v159
  v_exp_f32 v160, v160
  v_exp_f32 v161, v161
  v_exp_f32 v162, v162
  v_exp_f32 v163, v163
  v_exp_f32 v164, v164
  v_exp_f32 v165, v165
  v_exp_f32 v166, v166
  v_exp_f32 v167, v167
  v_exp_f32 v168, v168
  v_exp_f32 v169, v169
  v_exp_f32 v170, v170
  v_exp_f32 v171, v171
  v_add_f32 v237, v152, v153
  v_add_f32 v237, v237, v154
  v_add_f32 v237, v237, v155
  v_add_f32 v237, v237, v156
  v_add_f32 v237, v237, v157
  v_add_f32 v237, v237, v158
  v_add_f32 v237, v237, v159
  v_add_f32 v237, v237, v160
  v_add_f32 v237, v237, v161
  v_add_f32 v237, v237, v162
  v_add_f32 v237, v237, v163
  v_add_f32 v237, v237, v164
  v_add_f32 v237, v237, v165
  v_add_f32 v237, v237, v166
  v_add_f32 v237, v237, v167
  v_add_f32 v237, v237, v168
  v_add_f32 v237, v237, v169
  v_add_f32 v237, v237, v170
  v_add_f32 v237, v237, v171
  v_cvt_pk_bf16_f32 v24, v152, v153
  v_cvt_pk_bf16_f32 v25, v154, v155
  v_cvt_pk_bf16_f32 v26, v156, v157
  v_cvt_pk_bf16_f32 v27, v158, v159
  v_cvt_pk_bf16_f32 v28, v160, v161
  v_cvt_pk_bf16_f32 v29, v162, v163
  v_cvt_pk_bf16_f32 v30, v164, v165
  v_cvt_pk_bf16_f32 v31, v166, v167
  v_cvt_pk_bf16_f32 v32, v168, v169
  v_cvt_pk_bf16_f32 v33, v170, v171
  v_mov_b32 v34, 0
  v_mov_b32 v35, 0
  v_mov_b32 v236, v237
  s_nop 1
  v_permlane32_swap_b32 v236, v237
  s_waitcnt vmcnt(0)
  s_nop 0
  v_add_f32 v237, v236, v237
  v_rcp_f32 v236, v237
  v_mfma_f32_32x32x16_bf16 v[184:199], v[120:123], v[24:27], 0
  v_mfma_f32_32x32x16_bf16 v[184:199], v[124:127], v[28:31], v[184:199]
  v_mfma_f32_32x32x16_bf16 v[184:199], v[216:219], v[32:35], v[184:199]
  v_mfma_f32_32x32x16_bf16 v[200:215], v[128:131], v[24:27], 0
  v_mfma_f32_32x32x16_bf16 v[200:215], v[132:135], v[28:31], v[200:215]
  v_mfma_f32_32x32x16_bf16 v[200:215], v[220:223], v[32:35], v[200:215]
  v_mfma_f32_32x32x16_bf16 v[152:167], v[136:139], v[24:27], 0
  v_mfma_f32_32x32x16_bf16 v[152:167], v[140:143], v[28:31], v[152:167]
  v_mfma_f32_32x32x16_bf16 v[152:167], v[224:227], v[32:35], v[152:167]
  v_mfma_f32_32x32x16_bf16 v[168:183], v[144:147], v[24:27], 0
  v_mfma_f32_32x32x16_bf16 v[168:183], v[148:151], v[28:31], v[168:183]
  v_mfma_f32_32x32x16_bf16 v[168:183], v[228:231], v[32:35], v[168:183]
  v_pk_mul_f32 v[184:185], v[184:185], v[236:237] op_sel_hi:[1,0]
  v_pk_mul_f32 v[186:187], v[186:187], v[236:237] op_sel_hi:[1,0]
  v_pk_mul_f32 v[188:189], v[188:189], v[236:237] op_sel_hi:[1,0]
  v_pk_mul_f32 v[190:191], v[190:191], v[236:237] op_sel_hi:[1,0]
  v_pk_mul_f32 v[192:193], v[192:193], v[236:237] op_sel_hi:[1,0]
  v_pk_mul_f32 v[194:195], v[194:195], v[236:237] op_sel_hi:[1,0]
  v_pk_mul_f32 v[196:197], v[196:197], v[236:237] op_sel_hi:[1,0]
  v_pk_mul_f32 v[198:199], v[198:199], v[236:237] op_sel_hi:[1,0]
  v_cvt_pk_bf16_f32 v88, v184, v185
  v_cvt_pk_bf16_f32 v89, v186, v187
  v_cvt_pk_bf16_f32 v90, v188, v189
  v_cvt_pk_bf16_f32 v91, v190, v191
  v_cvt_pk_bf16_f32 v92, v192, v193
  v_cvt_pk_bf16_f32 v93, v194, v195
  v_cvt_pk_bf16_f32 v94, v196, v197
  v_cvt_pk_bf16_f32 v95, v198, v199
  buffer_store_dwordx4 v[88:91], v232, s[12:15], s28 offen offset:0 sc1
  buffer_store_dwordx4 v[92:95], v232, s[12:15], s28 offen offset:1024 sc1
  v_pk_mul_f32 v[200:201], v[200:201], v[236:237] op_sel_hi:[1,0]
  v_pk_mul_f32 v[202:203], v[202:203], v[236:237] op_sel_hi:[1,0]
  v_pk_mul_f32 v[204:205], v[204:205], v[236:237] op_sel_hi:[1,0]
  v_pk_mul_f32 v[206:207], v[206:207], v[236:237] op_sel_hi:[1,0]
  v_pk_mul_f32 v[208:209], v[208:209], v[236:237] op_sel_hi:[1,0]
  v_pk_mul_f32 v[210:211], v[210:211], v[236:237] op_sel_hi:[1,0]
  v_pk_mul_f32 v[212:213], v[212:213], v[236:237] op_sel_hi:[1,0]
  v_pk_mul_f32 v[214:215], v[214:215], v[236:237] op_sel_hi:[1,0]
  v_cvt_pk_bf16_f32 v96, v200, v201
  v_cvt_pk_bf16_f32 v97, v202, v203
  v_cvt_pk_bf16_f32 v98, v204, v205
  v_cvt_pk_bf16_f32 v99, v206, v207
  v_cvt_pk_bf16_f32 v100, v208, v209
  v_cvt_pk_bf16_f32 v101, v210, v211
  v_cvt_pk_bf16_f32 v102, v212, v213
  v_cvt_pk_bf16_f32 v103, v214, v215
  buffer_store_dwordx4 v[96:99], v232, s[12:15], s28 offen offset:2048 sc1
  buffer_store_dwordx4 v[100:103], v232, s[12:15], s28 offen offset:3072 sc1
  v_pk_mul_f32 v[152:153], v[152:153], v[236:237] op_sel_hi:[1,0]
  v_pk_mul_f32 v[154:155], v[154:155], v[236:237] op_sel_hi:[1,0]
  v_pk_mul_f32 v[156:157], v[156:157], v[236:237] op_sel_hi:[1,0]
  v_pk_mul_f32 v[158:159], v[158:159], v[236:237] op_sel_hi:[1,0]
  v_pk_mul_f32 v[160:161], v[160:161], v[236:237] op_sel_hi:[1,0]
  v_pk_mul_f32 v[162:163], v[162:163], v[236:237] op_sel_hi:[1,0]
  v_pk_mul_f32 v[164:165], v[164:165], v[236:237] op_sel_hi:[1,0]
  v_pk_mul_f32 v[166:167], v[166:167], v[236:237] op_sel_hi:[1,0]
  v_cvt_pk_bf16_f32 v104, v152, v153
  v_cvt_pk_bf16_f32 v105, v154, v155
  v_cvt_pk_bf16_f32 v106, v156, v157
  v_cvt_pk_bf16_f32 v107, v158, v159
  v_cvt_pk_bf16_f32 v108, v160, v161
  v_cvt_pk_bf16_f32 v109, v162, v163
  v_cvt_pk_bf16_f32 v110, v164, v165
  v_cvt_pk_bf16_f32 v111, v166, v167
  buffer_store_dwordx4 v[104:107], v232, s[12:15], s29 offen offset:0 sc1
  buffer_store_dwordx4 v[108:111], v232, s[12:15], s29 offen offset:1024 sc1
  s_nop 3
  v_pk_mul_f32 v[168:169], v[168:169], v[236:237] op_sel_hi:[1,0]
  v_pk_mul_f32 v[170:171], v[170:171], v[236:237] op_sel_hi:[1,0]
  v_pk_mul_f32 v[172:173], v[172:173], v[236:237] op_sel_hi:[1,0]
  v_pk_mul_f32 v[174:175], v[174:175], v[236:237] op_sel_hi:[1,0]
  v_pk_mul_f32 v[176:177], v[176:177], v[236:237] op_sel_hi:[1,0]
  v_pk_mul_f32 v[178:179], v[178:179], v[236:237] op_sel_hi:[1,0]
  v_pk_mul_f32 v[180:181], v[180:181], v[236:237] op_sel_hi:[1,0]
  v_pk_mul_f32 v[182:183], v[182:183], v[236:237] op_sel_hi:[1,0]
  v_cvt_pk_bf16_f32 v112, v168, v169
  v_cvt_pk_bf16_f32 v113, v170, v171
  v_cvt_pk_bf16_f32 v114, v172, v173
  v_cvt_pk_bf16_f32 v115, v174, v175
  v_cvt_pk_bf16_f32 v116, v176, v177
  v_cvt_pk_bf16_f32 v117, v178, v179
  v_cvt_pk_bf16_f32 v118, v180, v181
  v_cvt_pk_bf16_f32 v119, v182, v183
  buffer_store_dwordx4 v[112:115], v232, s[12:15], s29 offen offset:2048 sc1
  buffer_store_dwordx4 v[116:119], v232, s[12:15], s29 offen offset:3072 sc1
  s_mov_b64 exec, 1
  s_waitcnt vmcnt(0)
  buffer_atomic_add v240, off, s[12:15], s30 sc1
  s_mov_b64 exec, -1
  s_add_u32 s30, s30, 256
.g_ed:
  s_cmp_lg_u32 s56, 0
  s_cbranch_scc1 .g_go
  s_waitcnt vmcnt(0)
  s_barrier
  s_mov_b32 s55, 0
  s_cmp_lg_u32 s23, 0
  s_cbranch_scc1 .sg34
  v_mov_b32 v18, 4
  s_mov_b64 exec, 1
  buffer_atomic_add v18, off, s[96:99], s54 sc1
  s_mov_b64 exec, -1
.sg34:
  s_branch .g_b
.g_go:
  s_mov_b32 s3, s51
  s_mov_b32 s31, s52
  s_mov_b32 s32, s53
  s_mov_b32 s22, 262144
  s_mov_b32 s35, 25165824
  s_mov_b32 s36, s82
  s_mov_b32 s37, s83
  s_cmp_eq_u32 s3, 1
  s_cselect_b32 s35, 41943040, s35
  s_cmp_eq_u32 s3, 3
  s_cselect_b32 s35, 75497472, s35
  s_cselect_b32 s22, 229376, s22
  s_cmp_eq_u32 s3, 4
  s_cselect_b32 s35, 90177536, s35
  s_cselect_b32 s22, 65536, s22
  s_cselect_b32 s36, s86, s36
  s_cselect_b32 s37, s87, s37
  s_lshl_b32 s33, s32, 9
  s_add_u32 s36, s36, s33
  s_addc_u32 s37, s37, 0
  s_movk_i32 s38, 512
  s_mov_b32 s39, 0x20000
  s_lshl_b32 s14, s22, 3
  s_mul_i32 s34, s31, s14
  s_add_u32 s35, s35, s34
  s_lshl_b32 s34, s32, 14
  s_add_u32 s35, s35, s34
  s_add_u32 s12, s94, s35
  s_addc_u32 s13, s95, 0
  s_mov_b32 s14, s14
  s_mov_b32 s15, 0x20000
  v_accvgpr_write_b32 a0, 0
  v_accvgpr_write_b32 a1, 0
  v_accvgpr_write_b32 a2, 0
  v_accvgpr_write_b32 a3, 0
  v_accvgpr_write_b32 a4, 0
  v_accvgpr_write_b32 a5, 0
  v_accvgpr_write_b32 a6, 0
  v_accvgpr_write_b32 a7, 0
  v_accvgpr_write_b32 a8, 0
  v_accvgpr_write_b32 a9, 0
  v_accvgpr_write_b32 a10, 0
  v_accvgpr_write_b32 a11, 0
  v_accvgpr_write_b32 a12, 0
  v_accvgpr_write_b32 a13, 0
  v_accvgpr_write_b32 a14, 0
  v_accvgpr_write_b32 a15, 0
  v_accvgpr_write_b32 a16, 0
  v_accvgpr_write_b32 a17, 0
  v_accvgpr_write_b32 a18, 0
  v_accvgpr_write_b32 a19, 0
  v_accvgpr_write_b32 a20, 0
  v_accvgpr_write_b32 a21, 0
  v_accvgpr_write_b32 a22, 0
  v_accvgpr_write_b32 a23, 0
  v_accvgpr_write_b32 a24, 0
  v_accvgpr_write_b32 a25, 0
  v_accvgpr_write_b32 a26, 0
  v_accvgpr_write_b32 a27, 0
  v_accvgpr_write_b32 a28, 0
  v_accvgpr_write_b32 a29, 0
  v_accvgpr_write_b32 a30, 0
  v_accvgpr_write_b32 a31, 0
  v_accvgpr_write_b32 a32, 0
  v_accvgpr_write_b32 a33, 0
  v_accvgpr_write_b32 a34, 0
  v_accvgpr_write_b32 a35, 0
  v_accvgpr_write_b32 a36, 0
  v_accvgpr_write_b32 a37, 0
  v_accvgpr_write_b32 a38, 0
  v_accvgpr_write_b32 a39, 0
  v_accvgpr_write_b32 a40, 0
  v_accvgpr_write_b32 a41, 0
  v_accvgpr_write_b32 a42, 0
  v_accvgpr_write_b32 a43, 0
  v_accvgpr_write_b32 a44, 0
  v_accvgpr_write_b32 a45, 0
  v_accvgpr_write_b32 a46, 0
  v_accvgpr_write_b32 a47, 0
  v_accvgpr_write_b32 a48, 0
  v_accvgpr_write_b32 a49, 0
  v_accvgpr_write_b32 a50, 0
  v_accvgpr_write_b32 a51, 0
  v_accvgpr_write_b32 a52, 0
  v_accvgpr_write_b32 a53, 0
  v_accvgpr_write_b32 a54, 0
  v_accvgpr_write_b32 a55, 0
  v_accvgpr_write_b32 a56, 0
  v_accvgpr_write_b32 a57, 0
  v_accvgpr_write_b32 a58, 0
  v_accvgpr_write_b32 a59, 0
  v_accvgpr_write_b32 a60, 0
  v_accvgpr_write_b32 a61, 0
  v_accvgpr_write_b32 a62, 0
  v_accvgpr_write_b32 a63, 0
  v_accvgpr_write_b32 a64, 0
  v_accvgpr_write_b32 a65, 0
  v_accvgpr_write_b32 a66, 0
  v_accvgpr_write_b32 a67, 0
  v_accvgpr_write_b32 a68, 0
  v_accvgpr_write_b32 a69, 0
  v_accvgpr_write_b32 a70, 0
  v_accvgpr_write_b32 a71, 0
  v_accvgpr_write_b32 a72, 0
  v_accvgpr_write_b32 a73, 0
  v_accvgpr_write_b32 a74, 0
  v_accvgpr_write_b32 a75, 0
  v_accvgpr_write_b32 a76, 0
  v_accvgpr_write_b32 a77, 0
  v_accvgpr_write_b32 a78, 0
  v_accvgpr_write_b32 a79, 0
  v_accvgpr_write_b32 a80, 0
  v_accvgpr_write_b32 a81, 0
  v_accvgpr_write_b32 a82, 0
  v_accvgpr_write_b32 a83, 0
  v_accvgpr_write_b32 a84, 0
  v_accvgpr_write_b32 a85, 0
  v_accvgpr_write_b32 a86, 0
  v_accvgpr_write_b32 a87, 0
  v_accvgpr_write_b32 a88, 0
  v_accvgpr_write_b32 a89, 0
  v_accvgpr_write_b32 a90, 0
  v_accvgpr_write_b32 a91, 0
  v_accvgpr_write_b32 a92, 0
  v_accvgpr_write_b32 a93, 0
  v_accvgpr_write_b32 a94, 0
  v_accvgpr_write_b32 a95, 0
  v_accvgpr_write_b32 a96, 0
  v_accvgpr_write_b32 a97, 0
  v_accvgpr_write_b32 a98, 0
  v_accvgpr_write_b32 a99, 0
  v_accvgpr_write_b32 a100, 0
  v_accvgpr_write_b32 a101, 0
  v_accvgpr_write_b32 a102, 0
  v_accvgpr_write_b32 a103, 0
  v_accvgpr_write_b32 a104, 0
  v_accvgpr_write_b32 a105, 0
  v_accvgpr_write_b32 a106, 0
  v_accvgpr_write_b32 a107, 0
  v_accvgpr_write_b32 a108, 0
  v_accvgpr_write_b32 a109, 0
  v_accvgpr_write_b32 a110, 0
  v_accvgpr_write_b32 a111, 0
  v_accvgpr_write_b32 a112, 0
  v_accvgpr_write_b32 a113, 0
  v_accvgpr_write_b32 a114, 0
  v_accvgpr_write_b32 a115, 0
  v_accvgpr_write_b32 a116, 0
  v_accvgpr_write_b32 a117, 0
  v_accvgpr_write_b32 a118, 0
  v_accvgpr_write_b32 a119, 0
  v_accvgpr_write_b32 a120, 0
  v_accvgpr_write_b32 a121, 0
  v_accvgpr_write_b32 a122, 0
  v_accvgpr_write_b32 a123, 0
  v_accvgpr_write_b32 a124, 0
  v_accvgpr_write_b32 a125, 0
  v_accvgpr_write_b32 a126, 0
  v_accvgpr_write_b32 a127, 0
  v_accvgpr_write_b32 a128, 0
  v_accvgpr_write_b32 a129, 0
  v_accvgpr_write_b32 a130, 0
  v_accvgpr_write_b32 a131, 0
  v_accvgpr_write_b32 a132, 0
  v_accvgpr_write_b32 a133, 0
  v_accvgpr_write_b32 a134, 0
  v_accvgpr_write_b32 a135, 0
  v_accvgpr_write_b32 a136, 0
  v_accvgpr_write_b32 a137, 0
  v_accvgpr_write_b32 a138, 0
  v_accvgpr_write_b32 a139, 0
  v_accvgpr_write_b32 a140, 0
  v_accvgpr_write_b32 a141, 0
  v_accvgpr_write_b32 a142, 0
  v_accvgpr_write_b32 a143, 0
  v_accvgpr_write_b32 a144, 0
  v_accvgpr_write_b32 a145, 0
  v_accvgpr_write_b32 a146, 0
  v_accvgpr_write_b32 a147, 0
  v_accvgpr_write_b32 a148, 0
  v_accvgpr_write_b32 a149, 0
  v_accvgpr_write_b32 a150, 0
  v_accvgpr_write_b32 a151, 0
  v_accvgpr_write_b32 a152, 0
  v_accvgpr_write_b32 a153, 0
  v_accvgpr_write_b32 a154, 0
  v_accvgpr_write_b32 a155, 0
  v_accvgpr_write_b32 a156, 0
  v_accvgpr_write_b32 a157, 0
  v_accvgpr_write_b32 a158, 0
  v_accvgpr_write_b32 a159, 0
  v_accvgpr_write_b32 a160, 0
  v_accvgpr_write_b32 a161, 0
  v_accvgpr_write_b32 a162, 0
  v_accvgpr_write_b32 a163, 0
  v_accvgpr_write_b32 a164, 0
  v_accvgpr_write_b32 a165, 0
  v_accvgpr_write_b32 a166, 0
  v_accvgpr_write_b32 a167, 0
  v_accvgpr_write_b32 a168, 0
  v_accvgpr_write_b32 a169, 0
  v_accvgpr_write_b32 a170, 0
  v_accvgpr_write_b32 a171, 0
  v_accvgpr_write_b32 a172, 0
  v_accvgpr_write_b32 a173, 0
  v_accvgpr_write_b32 a174, 0
  v_accvgpr_write_b32 a175, 0
  v_accvgpr_write_b32 a176, 0
  v_accvgpr_write_b32 a177, 0
  v_accvgpr_write_b32 a178, 0
  v_accvgpr_write_b32 a179, 0
  v_accvgpr_write_b32 a180, 0
  v_accvgpr_write_b32 a181, 0
  v_accvgpr_write_b32 a182, 0
  v_accvgpr_write_b32 a183, 0
  v_accvgpr_write_b32 a184, 0
  v_accvgpr_write_b32 a185, 0
  v_accvgpr_write_b32 a186, 0
  v_accvgpr_write_b32 a187, 0
  v_accvgpr_write_b32 a188, 0
  v_accvgpr_write_b32 a189, 0
  v_accvgpr_write_b32 a190, 0
  v_accvgpr_write_b32 a191, 0
  v_accvgpr_write_b32 a192, 0
  v_accvgpr_write_b32 a193, 0
  v_accvgpr_write_b32 a194, 0
  v_accvgpr_write_b32 a195, 0
  v_accvgpr_write_b32 a196, 0
  v_accvgpr_write_b32 a197, 0
  v_accvgpr_write_b32 a198, 0
  v_accvgpr_write_b32 a199, 0
  v_accvgpr_write_b32 a200, 0
  v_accvgpr_write_b32 a201, 0
  v_accvgpr_write_b32 a202, 0
  v_accvgpr_write_b32 a203, 0
  v_accvgpr_write_b32 a204, 0
  v_accvgpr_write_b32 a205, 0
  v_accvgpr_write_b32 a206, 0
  v_accvgpr_write_b32 a207, 0
  v_accvgpr_write_b32 a208, 0
  v_accvgpr_write_b32 a209, 0
  v_accvgpr_write_b32 a210, 0
  v_accvgpr_write_b32 a211, 0
  v_accvgpr_write_b32 a212, 0
  v_accvgpr_write_b32 a213, 0
  v_accvgpr_write_b32 a214, 0
  v_accvgpr_write_b32 a215, 0
  v_accvgpr_write_b32 a216, 0
  v_accvgpr_write_b32 a217, 0
  v_accvgpr_write_b32 a218, 0
  v_accvgpr_write_b32 a219, 0
  v_accvgpr_write_b32 a220, 0
  v_accvgpr_write_b32 a221, 0
  v_accvgpr_write_b32 a222, 0
  v_accvgpr_write_b32 a223, 0
  v_accvgpr_write_b32 a224, 0
  v_accvgpr_write_b32 a225, 0
  v_accvgpr_write_b32 a226, 0
  v_accvgpr_write_b32 a227, 0
  v_accvgpr_write_b32 a228, 0
  v_accvgpr_write_b32 a229, 0
  v_accvgpr_write_b32 a230, 0
  v_accvgpr_write_b32 a231, 0
  v_accvgpr_write_b32 a232, 0
  v_accvgpr_write_b32 a233, 0
  v_accvgpr_write_b32 a234, 0
  v_accvgpr_write_b32 a235, 0
  v_accvgpr_write_b32 a236, 0
  v_accvgpr_write_b32 a237, 0
  v_accvgpr_write_b32 a238, 0
  v_accvgpr_write_b32 a239, 0
  v_accvgpr_write_b32 a240, 0
  v_accvgpr_write_b32 a241, 0
  v_accvgpr_write_b32 a242, 0
  v_accvgpr_write_b32 a243, 0
  v_accvgpr_write_b32 a244, 0
  v_accvgpr_write_b32 a245, 0
  v_accvgpr_write_b32 a246, 0
  v_accvgpr_write_b32 a247, 0
  v_accvgpr_write_b32 a248, 0
  v_accvgpr_write_b32 a249, 0
  v_accvgpr_write_b32 a250, 0
  v_accvgpr_write_b32 a251, 0
  v_accvgpr_write_b32 a252, 0
  v_accvgpr_write_b32 a253, 0
  v_accvgpr_write_b32 a254, 0
  v_accvgpr_write_b32 a255, 0
  s_cmp_eq_u32 s3, 1
  s_cselect_b32 s26, 3, 2
  s_cselect_b32 s27, 2, 3
  v_and_b32 v8, 3, v1
  v_bfe_u32 v18, v1, 2, 1
  v_lshl_add_u32 v8, v18, s26, v8
  v_bfe_u32 v18, v1, 3, 1
  v_lshl_add_u32 v8, v18, s27, v8
  v_lshrrev_b32 v19, 4, v1
  v_lshl_add_u32 v8, v19, 5, v8
  s_lshr_b32 s28, s23, 1
  s_lshl_b32 s28, s28, 11
  v_lshl_add_u32 v8, v8, 4, s28
  v_add_u32 v9, 0x10000, v8
  v_bfe_u32 v18, v1, 2, 2
  v_lshl_add_u32 v20, v19, 3, v18
  v_lshlrev_b32 v20, 8, v20
  v_and_b32 v21, 1, v1
  v_lshl_add_u32 v20, v21, s26, v20
  v_bfe_u32 v21, v1, 1, 1
  v_lshl_add_u32 v20, v21, s27, v20
  v_lshlrev_b32 v20, 1, v20
  v_add_u32 v20, 16384, v20
  v_and_b32 v19, 1, v19
  v_lshl_add_u32 v18, v18, 1, v19
  s_and_b32 s28, s23, 1
  s_lshl_b32 s28, s28, 3
  s_add_u32 s29, s28, 0
  v_xor_b32 v21, s29, v18
  v_lshl_add_u32 v192, v21, 5, v20
  v_add_u32 v200, 0x10000, v192
  s_add_u32 s29, s28, 1
  v_xor_b32 v21, s29, v18
  v_lshl_add_u32 v193, v21, 5, v20
  v_add_u32 v201, 0x10000, v193
  s_add_u32 s29, s28, 2
  v_xor_b32 v21, s29, v18
  v_lshl_add_u32 v194, v21, 5, v20
  v_add_u32 v202, 0x10000, v194
  s_add_u32 s29, s28, 3
  v_xor_b32 v21, s29, v18
  v_lshl_add_u32 v195, v21, 5, v20
  v_add_u32 v203, 0x10000, v195
  s_add_u32 s29, s28, 4
  v_xor_b32 v21, s29, v18
  v_lshl_add_u32 v196, v21, 5, v20
  v_add_u32 v204, 0x10000, v196
  s_add_u32 s29, s28, 5
  v_xor_b32 v21, s29, v18
  v_lshl_add_u32 v197, v21, 5, v20
  v_add_u32 v205, 0x10000, v197
  s_add_u32 s29, s28, 6
  v_xor_b32 v21, s29, v18
  v_lshl_add_u32 v198, v21, 5, v20
  v_add_u32 v206, 0x10000, v198
  s_add_u32 s29, s28, 7
  v_xor_b32 v21, s29, v18
  v_lshl_add_u32 v199, v21, 5, v20
  v_add_u32 v207, 0x10000, v199
  s_waitcnt vmcnt(32)
  s_cmp_lg_u32 s55, 0
  s_cbranch_scc1 .g_g2
  s_waitcnt vmcnt(24)
.g_g2:
  s_cmp_eq_u32 s3, 1
  s_barrier
  s_cbranch_scc1 .g_mv
  ds_read_b128 v[64:67], v8 offset:0
  ds_read_b64_tr_b16 v[96:97], v192 offset:0
  ds_read_b64_tr_b16 v[98:99], v192 offset:2048
  ds_read_b64_tr_b16 v[100:101], v193 offset:0
  ds_read_b64_tr_b16 v[102:103], v193 offset:2048
  ds_read_b64_tr_b16 v[104:105], v194 offset:0
  ds_read_b64_tr_b16 v[106:107], v194 offset:2048
  ds_read_b64_tr_b16 v[108:109], v195 offset:0
  ds_read_b64_tr_b16 v[110:111], v195 offset:2048
  ds_read_b64_tr_b16 v[112:113], v196 offset:0
  ds_read_b64_tr_b16 v[114:115], v196 offset:2048
  ds_read_b64_tr_b16 v[116:117], v197 offset:0
  ds_read_b64_tr_b16 v[118:119], v197 offset:2048
  ds_read_b64_tr_b16 v[120:121], v198 offset:0
  ds_read_b64_tr_b16 v[122:123], v198 offset:2048
  ds_read_b64_tr_b16 v[124:125], v199 offset:0
  ds_read_b64_tr_b16 v[126:127], v199 offset:2048
  ds_read_b128 v[68:71], v8 offset:256
  ds_read_b128 v[72:75], v8 offset:4096
  ds_read_b128 v[76:79], v8 offset:4352
  ds_read_b128 v[80:83], v8 offset:8192
  ds_read_b128 v[84:87], v8 offset:8448
  ds_read_b128 v[88:91], v8 offset:12288
  ds_read_b128 v[92:95], v8 offset:12544
.gm35:
  s_sub_u32 s19, s19, 1
  s_waitcnt lgkmcnt(0)
  v_mfma_f32_16x16x32_bf16 a[0:3], v[96:99], v[64:67], a[0:3]
  s_cmp_lg_u32 s55, 0
  s_cbranch_scc1 .gm35w0
  s_waitcnt vmcnt(16)
.gm35w0:
  v_mfma_f32_16x16x32_bf16 a[8:11], v[100:103], v[64:67], a[8:11]
  s_barrier
  v_mfma_f32_16x16x32_bf16 a[16:19], v[104:107], v[64:67], a[16:19]
  s_cmp_eq_u32 s19, 0
  s_cselect_b32 s6, 0, s6
  s_cselect_b32 s10, 0, s10
  v_mfma_f32_16x16x32_bf16 a[24:27], v[108:111], v[64:67], a[24:27]
  ds_read_b128 v[128:131], v8 offset:32768
  v_mfma_f32_16x16x32_bf16 a[32:35], v[112:115], v[64:67], a[32:35]
  s_add_u32 m0, s24, 0
  v_mfma_f32_16x16x32_bf16 a[40:43], v[116:119], v[64:67], a[40:43]
  ds_read_b64_tr_b16 v[160:161], v192 offset:32768
  v_mfma_f32_16x16x32_bf16 a[48:51], v[120:123], v[64:67], a[48:51]
  buffer_load_dwordx4 v2, s[4:7], s16 offen offset:0 lds
  v_mfma_f32_16x16x32_bf16 a[56:59], v[124:127], v[64:67], a[56:59]
  ds_read_b64_tr_b16 v[162:163], v192 offset:34816
  v_mfma_f32_16x16x32_bf16 a[4:7], v[96:99], v[68:71], a[4:7]
  v_mfma_f32_16x16x32_bf16 a[12:15], v[100:103], v[68:71], a[12:15]
  ds_read_b64_tr_b16 v[164:165], v193 offset:32768
  v_mfma_f32_16x16x32_bf16 a[20:23], v[104:107], v[68:71], a[20:23]
  v_mfma_f32_16x16x32_bf16 a[28:31], v[108:111], v[68:71], a[28:31]
  ds_read_b64_tr_b16 v[166:167], v193 offset:34816
  v_mfma_f32_16x16x32_bf16 a[36:39], v[112:115], v[68:71], a[36:39]
  buffer_load_dwordx4 v2, s[4:7], s16 offen offset:1024 lds
  v_mfma_f32_16x16x32_bf16 a[44:47], v[116:119], v[68:71], a[44:47]
  ds_read_b64_tr_b16 v[168:169], v194 offset:32768
  v_mfma_f32_16x16x32_bf16 a[52:55], v[120:123], v[68:71], a[52:55]
  v_mfma_f32_16x16x32_bf16 a[60:63], v[124:127], v[68:71], a[60:63]
  ds_read_b64_tr_b16 v[170:171], v194 offset:34816
  v_mfma_f32_16x16x32_bf16 a[64:67], v[96:99], v[72:75], a[64:67]
  v_mfma_f32_16x16x32_bf16 a[72:75], v[100:103], v[72:75], a[72:75]
  ds_read_b64_tr_b16 v[172:173], v195 offset:32768
  v_mfma_f32_16x16x32_bf16 a[80:83], v[104:107], v[72:75], a[80:83]
  buffer_load_dwordx4 v3, s[4:7], s16 offen offset:2048 lds
  v_mfma_f32_16x16x32_bf16 a[88:91], v[108:111], v[72:75], a[88:91]
  ds_read_b64_tr_b16 v[174:175], v195 offset:34816
  v_mfma_f32_16x16x32_bf16 a[96:99], v[112:115], v[72:75], a[96:99]
  v_mfma_f32_16x16x32_bf16 a[104:107], v[116:119], v[72:75], a[104:107]
  ds_read_b64_tr_b16 v[176:177], v196 offset:32768
  v_mfma_f32_16x16x32_bf16 a[112:115], v[120:123], v[72:75], a[112:115]
  v_mfma_f32_16x16x32_bf16 a[120:123], v[124:127], v[72:75], a[120:123]
  ds_read_b64_tr_b16 v[178:179], v196 offset:34816
  v_mfma_f32_16x16x32_bf16 a[68:71], v[96:99], v[76:79], a[68:71]
  buffer_load_dwordx4 v3, s[4:7], s16 offen offset:3072 lds
  v_mfma_f32_16x16x32_bf16 a[76:79], v[100:103], v[76:79], a[76:79]
  ds_read_b64_tr_b16 v[180:181], v197 offset:32768
  v_mfma_f32_16x16x32_bf16 a[84:87], v[104:107], v[76:79], a[84:87]
  s_add_u32 s16, s16, 2048
  v_mfma_f32_16x16x32_bf16 a[92:95], v[108:111], v[76:79], a[92:95]
  ds_read_b64_tr_b16 v[182:183], v197 offset:34816
  v_mfma_f32_16x16x32_bf16 a[100:103], v[112:115], v[76:79], a[100:103]
  s_add_u32 m0, s25, 0
  v_mfma_f32_16x16x32_bf16 a[108:111], v[116:119], v[76:79], a[108:111]
  ds_read_b64_tr_b16 v[184:185], v198 offset:32768
  v_mfma_f32_16x16x32_bf16 a[116:119], v[120:123], v[76:79], a[116:119]
  buffer_load_dwordx4 v4, s[8:11], s17 offen offset:0 lds
  v_mfma_f32_16x16x32_bf16 a[124:127], v[124:127], v[76:79], a[124:127]
  ds_read_b64_tr_b16 v[186:187], v198 offset:34816
  v_mfma_f32_16x16x32_bf16 a[128:131], v[96:99], v[80:83], a[128:131]
  v_mfma_f32_16x16x32_bf16 a[136:139], v[100:103], v[80:83], a[136:139]
  ds_read_b64_tr_b16 v[188:189], v199 offset:32768
  v_mfma_f32_16x16x32_bf16 a[144:147], v[104:107], v[80:83], a[144:147]
  v_mfma_f32_16x16x32_bf16 a[152:155], v[108:111], v[80:83], a[152:155]
  ds_read_b64_tr_b16 v[190:191], v199 offset:34816
  v_mfma_f32_16x16x32_bf16 a[160:163], v[112:115], v[80:83], a[160:163]
  buffer_load_dwordx4 v5, s[8:11], s17 offen offset:1024 lds
  v_mfma_f32_16x16x32_bf16 a[168:171], v[116:119], v[80:83], a[168:171]
  ds_read_b128 v[132:135], v8 offset:33024
  v_mfma_f32_16x16x32_bf16 a[176:179], v[120:123], v[80:83], a[176:179]
  v_mfma_f32_16x16x32_bf16 a[184:187], v[124:127], v[80:83], a[184:187]
  ds_read_b128 v[136:139], v8 offset:36864
  v_mfma_f32_16x16x32_bf16 a[132:135], v[96:99], v[84:87], a[132:135]
  v_mfma_f32_16x16x32_bf16 a[140:143], v[100:103], v[84:87], a[140:143]
  ds_read_b128 v[140:143], v8 offset:37120
  v_mfma_f32_16x16x32_bf16 a[148:151], v[104:107], v[84:87], a[148:151]
  buffer_load_dwordx4 v6, s[8:11], s17 offen offset:2048 lds
  v_mfma_f32_16x16x32_bf16 a[156:159], v[108:111], v[84:87], a[156:159]
  ds_read_b128 v[144:147], v8 offset:40960
  v_mfma_f32_16x16x32_bf16 a[164:167], v[112:115], v[84:87], a[164:167]
  v_mfma_f32_16x16x32_bf16 a[172:175], v[116:119], v[84:87], a[172:175]
  ds_read_b128 v[148:151], v8 offset:41216
  v_mfma_f32_16x16x32_bf16 a[180:183], v[120:123], v[84:87], a[180:183]
  v_mfma_f32_16x16x32_bf16 a[188:191], v[124:127], v[84:87], a[188:191]
  ds_read_b128 v[152:155], v8 offset:45056
  v_mfma_f32_16x16x32_bf16 a[192:195], v[96:99], v[88:91], a[192:195]
  buffer_load_dwordx4 v7, s[8:11], s17 offen offset:3072 lds
  v_mfma_f32_16x16x32_bf16 a[200:203], v[100:103], v[88:91], a[200:203]
  ds_read_b128 v[156:159], v8 offset:45312
  v_mfma_f32_16x16x32_bf16 a[208:211], v[104:107], v[88:91], a[208:211]
  s_add_u32 s17, s17, s18
  v_mfma_f32_16x16x32_bf16 a[216:219], v[108:111], v[88:91], a[216:219]
  v_mfma_f32_16x16x32_bf16 a[224:227], v[112:115], v[88:91], a[224:227]
  v_mfma_f32_16x16x32_bf16 a[232:235], v[116:119], v[88:91], a[232:235]
  v_mfma_f32_16x16x32_bf16 a[240:243], v[120:123], v[88:91], a[240:243]
  v_mfma_f32_16x16x32_bf16 a[248:251], v[124:127], v[88:91], a[248:251]
  v_mfma_f32_16x16x32_bf16 a[196:199], v[96:99], v[92:95], a[196:199]
  v_mfma_f32_16x16x32_bf16 a[204:207], v[100:103], v[92:95], a[204:207]
  v_mfma_f32_16x16x32_bf16 a[212:215], v[104:107], v[92:95], a[212:215]
  v_mfma_f32_16x16x32_bf16 a[220:223], v[108:111], v[92:95], a[220:223]
  v_mfma_f32_16x16x32_bf16 a[228:231], v[112:115], v[92:95], a[228:231]
  v_mfma_f32_16x16x32_bf16 a[236:239], v[116:119], v[92:95], a[236:239]
  v_mfma_f32_16x16x32_bf16 a[244:247], v[120:123], v[92:95], a[244:247]
  v_mfma_f32_16x16x32_bf16 a[252:255], v[124:127], v[92:95], a[252:255]
  s_waitcnt lgkmcnt(0)
  v_mfma_f32_16x16x32_bf16 a[0:3], v[160:163], v[128:131], a[0:3]
  s_cmp_lg_u32 s55, 0
  s_cbranch_scc1 .gm35w1
  s_waitcnt vmcnt(16)
.gm35w1:
  v_mfma_f32_16x16x32_bf16 a[8:11], v[164:167], v[128:131], a[8:11]
  s_barrier
  v_mfma_f32_16x16x32_bf16 a[16:19], v[168:171], v[128:131], a[16:19]
  v_mfma_f32_16x16x32_bf16 a[24:27], v[172:175], v[128:131], a[24:27]
  ds_read_b128 v[64:67], v9 offset:0
  v_mfma_f32_16x16x32_bf16 a[32:35], v[176:179], v[128:131], a[32:35]
  s_add_u32 m0, s24, 32768
  v_mfma_f32_16x16x32_bf16 a[40:43], v[180:183], v[128:131], a[40:43]
  ds_read_b64_tr_b16 v[96:97], v200 offset:0
  v_mfma_f32_16x16x32_bf16 a[48:51], v[184:187], v[128:131], a[48:51]
  buffer_load_dwordx4 v2, s[4:7], s16 offen offset:0 lds
  v_mfma_f32_16x16x32_bf16 a[56:59], v[188:191], v[128:131], a[56:59]
  ds_read_b64_tr_b16 v[98:99], v200 offset:2048
  v_mfma_f32_16x16x32_bf16 a[4:7], v[160:163], v[132:135], a[4:7]
  v_mfma_f32_16x16x32_bf16 a[12:15], v[164:167], v[132:135], a[12:15]
  ds_read_b64_tr_b16 v[100:101], v201 offset:0
  v_mfma_f32_16x16x32_bf16 a[20:23], v[168:171], v[132:135], a[20:23]
  v_mfma_f32_16x16x32_bf16 a[28:31], v[172:175], v[132:135], a[28:31]
  ds_read_b64_tr_b16 v[102:103], v201 offset:2048
  v_mfma_f32_16x16x32_bf16 a[36:39], v[176:179], v[132:135], a[36:39]
  buffer_load_dwordx4 v2, s[4:7], s16 offen offset:1024 lds
  v_mfma_f32_16x16x32_bf16 a[44:47], v[180:183], v[132:135], a[44:47]
  ds_read_b64_tr_b16 v[104:105], v202 offset:0
  v_mfma_f32_16x16x32_bf16 a[52:55], v[184:187], v[132:135], a[52:55]
  v_mfma_f32_16x16x32_bf16 a[60:63], v[188:191], v[132:135], a[60:63]
  ds_read_b64_tr_b16 v[106:107], v202 offset:2048
  v_mfma_f32_16x16x32_bf16 a[64:67], v[160:163], v[136:139], a[64:67]
  v_mfma_f32_16x16x32_bf16 a[72:75], v[164:167], v[136:139], a[72:75]
  ds_read_b64_tr_b16 v[108:109], v203 offset:0
  v_mfma_f32_16x16x32_bf16 a[80:83], v[168:171], v[136:139], a[80:83]
  buffer_load_dwordx4 v3, s[4:7], s16 offen offset:2048 lds
  v_mfma_f32_16x16x32_bf16 a[88:91], v[172:175], v[136:139], a[88:91]
  ds_read_b64_tr_b16 v[110:111], v203 offset:2048
  v_mfma_f32_16x16x32_bf16 a[96:99], v[176:179], v[136:139], a[96:99]
  v_mfma_f32_16x16x32_bf16 a[104:107], v[180:183], v[136:139], a[104:107]
  ds_read_b64_tr_b16 v[112:113], v204 offset:0
  v_mfma_f32_16x16x32_bf16 a[112:115], v[184:187], v[136:139], a[112:115]
  v_mfma_f32_16x16x32_bf16 a[120:123], v[188:191], v[136:139], a[120:123]
  ds_read_b64_tr_b16 v[114:115], v204 offset:2048
  v_mfma_f32_16x16x32_bf16 a[68:71], v[160:163], v[140:143], a[68:71]
  buffer_load_dwordx4 v3, s[4:7], s16 offen offset:3072 lds
  v_mfma_f32_16x16x32_bf16 a[76:79], v[164:167], v[140:143], a[76:79]
  ds_read_b64_tr_b16 v[116:117], v205 offset:0
  v_mfma_f32_16x16x32_bf16 a[84:87], v[168:171], v[140:143], a[84:87]
  s_add_u32 s16, s16, 2048
  v_mfma_f32_16x16x32_bf16 a[92:95], v[172:175], v[140:143], a[92:95]
  ds_read_b64_tr_b16 v[118:119], v205 offset:2048
  v_mfma_f32_16x16x32_bf16 a[100:103], v[176:179], v[140:143], a[100:103]
  s_add_u32 m0, s25, 32768
  v_mfma_f32_16x16x32_bf16 a[108:111], v[180:183], v[140:143], a[108:111]
  ds_read_b64_tr_b16 v[120:121], v206 offset:0
  v_mfma_f32_16x16x32_bf16 a[116:119], v[184:187], v[140:143], a[116:119]
  buffer_load_dwordx4 v4, s[8:11], s17 offen offset:0 lds
  v_mfma_f32_16x16x32_bf16 a[124:127], v[188:191], v[140:143], a[124:127]
  ds_read_b64_tr_b16 v[122:123], v206 offset:2048
  v_mfma_f32_16x16x32_bf16 a[128:131], v[160:163], v[144:147], a[128:131]
  v_mfma_f32_16x16x32_bf16 a[136:139], v[164:167], v[144:147], a[136:139]
  ds_read_b64_tr_b16 v[124:125], v207 offset:0
  v_mfma_f32_16x16x32_bf16 a[144:147], v[168:171], v[144:147], a[144:147]
  v_mfma_f32_16x16x32_bf16 a[152:155], v[172:175], v[144:147], a[152:155]
  ds_read_b64_tr_b16 v[126:127], v207 offset:2048
  v_mfma_f32_16x16x32_bf16 a[160:163], v[176:179], v[144:147], a[160:163]
  buffer_load_dwordx4 v5, s[8:11], s17 offen offset:1024 lds
  v_mfma_f32_16x16x32_bf16 a[168:171], v[180:183], v[144:147], a[168:171]
  ds_read_b128 v[68:71], v9 offset:256
  v_mfma_f32_16x16x32_bf16 a[176:179], v[184:187], v[144:147], a[176:179]
  v_mfma_f32_16x16x32_bf16 a[184:187], v[188:191], v[144:147], a[184:187]
  ds_read_b128 v[72:75], v9 offset:4096
  v_mfma_f32_16x16x32_bf16 a[132:135], v[160:163], v[148:151], a[132:135]
  v_mfma_f32_16x16x32_bf16 a[140:143], v[164:167], v[148:151], a[140:143]
  ds_read_b128 v[76:79], v9 offset:4352
  v_mfma_f32_16x16x32_bf16 a[148:151], v[168:171], v[148:151], a[148:151]
  buffer_load_dwordx4 v6, s[8:11], s17 offen offset:2048 lds
  v_mfma_f32_16x16x32_bf16 a[156:159], v[172:175], v[148:151], a[156:159]
  ds_read_b128 v[80:83], v9 offset:8192
  v_mfma_f32_16x16x32_bf16 a[164:167], v[176:179], v[148:151], a[164:167]
  v_mfma_f32_16x16x32_bf16 a[172:175], v[180:183], v[148:151], a[172:175]
  ds_read_b128 v[84:87], v9 offset:8448
  v_mfma_f32_16x16x32_bf16 a[180:183], v[184:187], v[148:151], a[180:183]
  v_mfma_f32_16x16x32_bf16 a[188:191], v[188:191], v[148:151], a[188:191]
  ds_read_b128 v[88:91], v9 offset:12288
  v_mfma_f32_16x16x32_bf16 a[192:195], v[160:163], v[152:155], a[192:195]
  buffer_load_dwordx4 v7, s[8:11], s17 offen offset:3072 lds
  v_mfma_f32_16x16x32_bf16 a[200:203], v[164:167], v[152:155], a[200:203]
  ds_read_b128 v[92:95], v9 offset:12544
  v_mfma_f32_16x16x32_bf16 a[208:211], v[168:171], v[152:155], a[208:211]
  s_add_u32 s17, s17, s18
  v_mfma_f32_16x16x32_bf16 a[216:219], v[172:175], v[152:155], a[216:219]
  v_mfma_f32_16x16x32_bf16 a[224:227], v[176:179], v[152:155], a[224:227]
  v_mfma_f32_16x16x32_bf16 a[232:235], v[180:183], v[152:155], a[232:235]
  v_mfma_f32_16x16x32_bf16 a[240:243], v[184:187], v[152:155], a[240:243]
  v_mfma_f32_16x16x32_bf16 a[248:251], v[188:191], v[152:155], a[248:251]
  v_mfma_f32_16x16x32_bf16 a[196:199], v[160:163], v[156:159], a[196:199]
  v_mfma_f32_16x16x32_bf16 a[204:207], v[164:167], v[156:159], a[204:207]
  v_mfma_f32_16x16x32_bf16 a[212:215], v[168:171], v[156:159], a[212:215]
  v_mfma_f32_16x16x32_bf16 a[220:223], v[172:175], v[156:159], a[220:223]
  v_mfma_f32_16x16x32_bf16 a[228:231], v[176:179], v[156:159], a[228:231]
  v_mfma_f32_16x16x32_bf16 a[236:239], v[180:183], v[156:159], a[236:239]
  v_mfma_f32_16x16x32_bf16 a[244:247], v[184:187], v[156:159], a[244:247]
  v_mfma_f32_16x16x32_bf16 a[252:255], v[188:191], v[156:159], a[252:255]
  s_waitcnt lgkmcnt(0)
  v_mfma_f32_16x16x32_bf16 a[0:3], v[96:99], v[64:67], a[0:3]
  s_cmp_lg_u32 s55, 0
  s_cbranch_scc1 .gm35w2
  s_waitcnt vmcnt(16)
.gm35w2:
  v_mfma_f32_16x16x32_bf16 a[8:11], v[100:103], v[64:67], a[8:11]
  s_barrier
  v_mfma_f32_16x16x32_bf16 a[16:19], v[104:107], v[64:67], a[16:19]
  v_mfma_f32_16x16x32_bf16 a[24:27], v[108:111], v[64:67], a[24:27]
  ds_read_b128 v[128:131], v9 offset:32768
  v_mfma_f32_16x16x32_bf16 a[32:35], v[112:115], v[64:67], a[32:35]
  s_add_u32 m0, s24, 65536
  v_mfma_f32_16x16x32_bf16 a[40:43], v[116:119], v[64:67], a[40:43]
  ds_read_b64_tr_b16 v[160:161], v200 offset:32768
  v_mfma_f32_16x16x32_bf16 a[48:51], v[120:123], v[64:67], a[48:51]
  buffer_load_dwordx4 v2, s[4:7], s16 offen offset:0 lds
  v_mfma_f32_16x16x32_bf16 a[56:59], v[124:127], v[64:67], a[56:59]
  ds_read_b64_tr_b16 v[162:163], v200 offset:34816
  v_mfma_f32_16x16x32_bf16 a[4:7], v[96:99], v[68:71], a[4:7]
  v_mfma_f32_16x16x32_bf16 a[12:15], v[100:103], v[68:71], a[12:15]
  ds_read_b64_tr_b16 v[164:165], v201 offset:32768
  v_mfma_f32_16x16x32_bf16 a[20:23], v[104:107], v[68:71], a[20:23]
  v_mfma_f32_16x16x32_bf16 a[28:31], v[108:111], v[68:71], a[28:31]
  ds_read_b64_tr_b16 v[166:167], v201 offset:34816
  v_mfma_f32_16x16x32_bf16 a[36:39], v[112:115], v[68:71], a[36:39]
  buffer_load_dwordx4 v2, s[4:7], s16 offen offset:1024 lds
  v_mfma_f32_16x16x32_bf16 a[44:47], v[116:119], v[68:71], a[44:47]
  ds_read_b64_tr_b16 v[168:169], v202 offset:32768
  v_mfma_f32_16x16x32_bf16 a[52:55], v[120:123], v[68:71], a[52:55]
  v_mfma_f32_16x16x32_bf16 a[60:63], v[124:127], v[68:71], a[60:63]
  ds_read_b64_tr_b16 v[170:171], v202 offset:34816
  v_mfma_f32_16x16x32_bf16 a[64:67], v[96:99], v[72:75], a[64:67]
  v_mfma_f32_16x16x32_bf16 a[72:75], v[100:103], v[72:75], a[72:75]
  ds_read_b64_tr_b16 v[172:173], v203 offset:32768
  v_mfma_f32_16x16x32_bf16 a[80:83], v[104:107], v[72:75], a[80:83]
  buffer_load_dwordx4 v3, s[4:7], s16 offen offset:2048 lds
  v_mfma_f32_16x16x32_bf16 a[88:91], v[108:111], v[72:75], a[88:91]
  ds_read_b64_tr_b16 v[174:175], v203 offset:34816
  v_mfma_f32_16x16x32_bf16 a[96:99], v[112:115], v[72:75], a[96:99]
  v_mfma_f32_16x16x32_bf16 a[104:107], v[116:119], v[72:75], a[104:107]
  ds_read_b64_tr_b16 v[176:177], v204 offset:32768
  v_mfma_f32_16x16x32_bf16 a[112:115], v[120:123], v[72:75], a[112:115]
  v_mfma_f32_16x16x32_bf16 a[120:123], v[124:127], v[72:75], a[120:123]
  ds_read_b64_tr_b16 v[178:179], v204 offset:34816
  v_mfma_f32_16x16x32_bf16 a[68:71], v[96:99], v[76:79], a[68:71]
  buffer_load_dwordx4 v3, s[4:7], s16 offen offset:3072 lds
  v_mfma_f32_16x16x32_bf16 a[76:79], v[100:103], v[76:79], a[76:79]
  ds_read_b64_tr_b16 v[180:181], v205 offset:32768
  v_mfma_f32_16x16x32_bf16 a[84:87], v[104:107], v[76:79], a[84:87]
  s_add_u32 s16, s16, 2048
  v_mfma_f32_16x16x32_bf16 a[92:95], v[108:111], v[76:79], a[92:95]
  ds_read_b64_tr_b16 v[182:183], v205 offset:34816
  v_mfma_f32_16x16x32_bf16 a[100:103], v[112:115], v[76:79], a[100:103]
  s_add_u32 m0, s25, 65536
  v_mfma_f32_16x16x32_bf16 a[108:111], v[116:119], v[76:79], a[108:111]
  ds_read_b64_tr_b16 v[184:185], v206 offset:32768
  v_mfma_f32_16x16x32_bf16 a[116:119], v[120:123], v[76:79], a[116:119]
  buffer_load_dwordx4 v4, s[8:11], s17 offen offset:0 lds
  v_mfma_f32_16x16x32_bf16 a[124:127], v[124:127], v[76:79], a[124:127]
  ds_read_b64_tr_b16 v[186:187], v206 offset:34816
  v_mfma_f32_16x16x32_bf16 a[128:131], v[96:99], v[80:83], a[128:131]
  v_mfma_f32_16x16x32_bf16 a[136:139], v[100:103], v[80:83], a[136:139]
  ds_read_b64_tr_b16 v[188:189], v207 offset:32768
  v_mfma_f32_16x16x32_bf16 a[144:147], v[104:107], v[80:83], a[144:147]
  v_mfma_f32_16x16x32_bf16 a[152:155], v[108:111], v[80:83], a[152:155]
  ds_read_b64_tr_b16 v[190:191], v207 offset:34816
  v_mfma_f32_16x16x32_bf16 a[160:163], v[112:115], v[80:83], a[160:163]
  buffer_load_dwordx4 v5, s[8:11], s17 offen offset:1024 lds
  v_mfma_f32_16x16x32_bf16 a[168:171], v[116:119], v[80:83], a[168:171]
  ds_read_b128 v[132:135], v9 offset:33024
  v_mfma_f32_16x16x32_bf16 a[176:179], v[120:123], v[80:83], a[176:179]
  v_mfma_f32_16x16x32_bf16 a[184:187], v[124:127], v[80:83], a[184:187]
  ds_read_b128 v[136:139], v9 offset:36864
  v_mfma_f32_16x16x32_bf16 a[132:135], v[96:99], v[84:87], a[132:135]
  v_mfma_f32_16x16x32_bf16 a[140:143], v[100:103], v[84:87], a[140:143]
  ds_read_b128 v[140:143], v9 offset:37120
  v_mfma_f32_16x16x32_bf16 a[148:151], v[104:107], v[84:87], a[148:151]
  buffer_load_dwordx4 v6, s[8:11], s17 offen offset:2048 lds
  v_mfma_f32_16x16x32_bf16 a[156:159], v[108:111], v[84:87], a[156:159]
  ds_read_b128 v[144:147], v9 offset:40960
  v_mfma_f32_16x16x32_bf16 a[164:167], v[112:115], v[84:87], a[164:167]
  v_mfma_f32_16x16x32_bf16 a[172:175], v[116:119], v[84:87], a[172:175]
  ds_read_b128 v[148:151], v9 offset:41216
  v_mfma_f32_16x16x32_bf16 a[180:183], v[120:123], v[84:87], a[180:183]
  v_mfma_f32_16x16x32_bf16 a[188:191], v[124:127], v[84:87], a[188:191]
  ds_read_b128 v[152:155], v9 offset:45056
  v_mfma_f32_16x16x32_bf16 a[192:195], v[96:99], v[88:91], a[192:195]
  buffer_load_dwordx4 v7, s[8:11], s17 offen offset:3072 lds
  v_mfma_f32_16x16x32_bf16 a[200:203], v[100:103], v[88:91], a[200:203]
  ds_read_b128 v[156:159], v9 offset:45312
  v_mfma_f32_16x16x32_bf16 a[208:211], v[104:107], v[88:91], a[208:211]
  s_add_u32 s17, s17, s18
  v_mfma_f32_16x16x32_bf16 a[216:219], v[108:111], v[88:91], a[216:219]
  v_mfma_f32_16x16x32_bf16 a[224:227], v[112:115], v[88:91], a[224:227]
  v_mfma_f32_16x16x32_bf16 a[232:235], v[116:119], v[88:91], a[232:235]
  v_mfma_f32_16x16x32_bf16 a[240:243], v[120:123], v[88:91], a[240:243]
  v_mfma_f32_16x16x32_bf16 a[248:251], v[124:127], v[88:91], a[248:251]
  v_mfma_f32_16x16x32_bf16 a[196:199], v[96:99], v[92:95], a[196:199]
  v_mfma_f32_16x16x32_bf16 a[204:207], v[100:103], v[92:95], a[204:207]
  v_mfma_f32_16x16x32_bf16 a[212:215], v[104:107], v[92:95], a[212:215]
  v_mfma_f32_16x16x32_bf16 a[220:223], v[108:111], v[92:95], a[220:223]
  v_mfma_f32_16x16x32_bf16 a[228:231], v[112:115], v[92:95], a[228:231]
  v_mfma_f32_16x16x32_bf16 a[236:239], v[116:119], v[92:95], a[236:239]
  v_mfma_f32_16x16x32_bf16 a[244:247], v[120:123], v[92:95], a[244:247]
  v_mfma_f32_16x16x32_bf16 a[252:255], v[124:127], v[92:95], a[252:255]
  s_waitcnt lgkmcnt(0)
  v_mfma_f32_16x16x32_bf16 a[0:3], v[160:163], v[128:131], a[0:3]
  s_waitcnt vmcnt(16)
  s_cmp_lg_u32 s55, 0
  v_mfma_f32_16x16x32_bf16 a[8:11], v[164:167], v[128:131], a[8:11]
  s_barrier
  s_cbranch_scc1 .gm35s
.gm35r:
  v_mfma_f32_16x16x32_bf16 a[16:19], v[168:171], v[128:131], a[16:19]
  v_mfma_f32_16x16x32_bf16 a[24:27], v[172:175], v[128:131], a[24:27]
  ds_read_b128 v[64:67], v8 offset:0
  v_mfma_f32_16x16x32_bf16 a[32:35], v[176:179], v[128:131], a[32:35]
  s_add_u32 m0, s24, 98304
  v_mfma_f32_16x16x32_bf16 a[40:43], v[180:183], v[128:131], a[40:43]
  ds_read_b64_tr_b16 v[96:97], v192 offset:0
  v_mfma_f32_16x16x32_bf16 a[48:51], v[184:187], v[128:131], a[48:51]
  buffer_load_dwordx4 v2, s[4:7], s16 offen offset:0 lds
  v_mfma_f32_16x16x32_bf16 a[56:59], v[188:191], v[128:131], a[56:59]
  ds_read_b64_tr_b16 v[98:99], v192 offset:2048
  v_mfma_f32_16x16x32_bf16 a[4:7], v[160:163], v[132:135], a[4:7]
  v_mfma_f32_16x16x32_bf16 a[12:15], v[164:167], v[132:135], a[12:15]
  ds_read_b64_tr_b16 v[100:101], v193 offset:0
  v_mfma_f32_16x16x32_bf16 a[20:23], v[168:171], v[132:135], a[20:23]
  v_mfma_f32_16x16x32_bf16 a[28:31], v[172:175], v[132:135], a[28:31]
  ds_read_b64_tr_b16 v[102:103], v193 offset:2048
  v_mfma_f32_16x16x32_bf16 a[36:39], v[176:179], v[132:135], a[36:39]
  buffer_load_dwordx4 v2, s[4:7], s16 offen offset:1024 lds
  v_mfma_f32_16x16x32_bf16 a[44:47], v[180:183], v[132:135], a[44:47]
  ds_read_b64_tr_b16 v[104:105], v194 offset:0
  v_mfma_f32_16x16x32_bf16 a[52:55], v[184:187], v[132:135], a[52:55]
  v_mfma_f32_16x16x32_bf16 a[60:63], v[188:191], v[132:135], a[60:63]
  ds_read_b64_tr_b16 v[106:107], v194 offset:2048
  v_mfma_f32_16x16x32_bf16 a[64:67], v[160:163], v[136:139], a[64:67]
  v_mfma_f32_16x16x32_bf16 a[72:75], v[164:167], v[136:139], a[72:75]
  ds_read_b64_tr_b16 v[108:109], v195 offset:0
  v_mfma_f32_16x16x32_bf16 a[80:83], v[168:171], v[136:139], a[80:83]
  buffer_load_dwordx4 v3, s[4:7], s16 offen offset:2048 lds
  v_mfma_f32_16x16x32_bf16 a[88:91], v[172:175], v[136:139], a[88:91]
  ds_read_b64_tr_b16 v[110:111], v195 offset:2048
  v_mfma_f32_16x16x32_bf16 a[96:99], v[176:179], v[136:139], a[96:99]
  v_mfma_f32_16x16x32_bf16 a[104:107], v[180:183], v[136:139], a[104:107]
  ds_read_b64_tr_b16 v[112:113], v196 offset:0
  v_mfma_f32_16x16x32_bf16 a[112:115], v[184:187], v[136:139], a[112:115]
  v_mfma_f32_16x16x32_bf16 a[120:123], v[188:191], v[136:139], a[120:123]
  ds_read_b64_tr_b16 v[114:115], v196 offset:2048
  v_mfma_f32_16x16x32_bf16 a[68:71], v[160:163], v[140:143], a[68:71]
  buffer_load_dwordx4 v3, s[4:7], s16 offen offset:3072 lds
  v_mfma_f32_16x16x32_bf16 a[76:79], v[164:167], v[140:143], a[76:79]
  ds_read_b64_tr_b16 v[116:117], v197 offset:0
  v_mfma_f32_16x16x32_bf16 a[84:87], v[168:171], v[140:143], a[84:87]
  s_add_u32 s16, s16, 2048
  v_mfma_f32_16x16x32_bf16 a[92:95], v[172:175], v[140:143], a[92:95]
  ds_read_b64_tr_b16 v[118:119], v197 offset:2048
  v_mfma_f32_16x16x32_bf16 a[100:103], v[176:179], v[140:143], a[100:103]
  s_add_u32 m0, s25, 98304
  v_mfma_f32_16x16x32_bf16 a[108:111], v[180:183], v[140:143], a[108:111]
  ds_read_b64_tr_b16 v[120:121], v198 offset:0
  v_mfma_f32_16x16x32_bf16 a[116:119], v[184:187], v[140:143], a[116:119]
  buffer_load_dwordx4 v4, s[8:11], s17 offen offset:0 lds
  v_mfma_f32_16x16x32_bf16 a[124:127], v[188:191], v[140:143], a[124:127]
  ds_read_b64_tr_b16 v[122:123], v198 offset:2048
  v_mfma_f32_16x16x32_bf16 a[128:131], v[160:163], v[144:147], a[128:131]
  v_mfma_f32_16x16x32_bf16 a[136:139], v[164:167], v[144:147], a[136:139]
  ds_read_b64_tr_b16 v[124:125], v199 offset:0
  v_mfma_f32_16x16x32_bf16 a[144:147], v[168:171], v[144:147], a[144:147]
  v_mfma_f32_16x16x32_bf16 a[152:155], v[172:175], v[144:147], a[152:155]
  ds_read_b64_tr_b16 v[126:127], v199 offset:2048
  v_mfma_f32_16x16x32_bf16 a[160:163], v[176:179], v[144:147], a[160:163]
  buffer_load_dwordx4 v5, s[8:11], s17 offen offset:1024 lds
  v_mfma_f32_16x16x32_bf16 a[168:171], v[180:183], v[144:147], a[168:171]
  ds_read_b128 v[68:71], v8 offset:256
  v_mfma_f32_16x16x32_bf16 a[176:179], v[184:187], v[144:147], a[176:179]
  v_mfma_f32_16x16x32_bf16 a[184:187], v[188:191], v[144:147], a[184:187]
  ds_read_b128 v[72:75], v8 offset:4096
  v_mfma_f32_16x16x32_bf16 a[132:135], v[160:163], v[148:151], a[132:135]
  v_mfma_f32_16x16x32_bf16 a[140:143], v[164:167], v[148:151], a[140:143]
  ds_read_b128 v[76:79], v8 offset:4352
  v_mfma_f32_16x16x32_bf16 a[148:151], v[168:171], v[148:151], a[148:151]
  buffer_load_dwordx4 v6, s[8:11], s17 offen offset:2048 lds
  v_mfma_f32_16x16x32_bf16 a[156:159], v[172:175], v[148:151], a[156:159]
  ds_read_b128 v[80:83], v8 offset:8192
  v_mfma_f32_16x16x32_bf16 a[164:167], v[176:179], v[148:151], a[164:167]
  v_mfma_f32_16x16x32_bf16 a[172:175], v[180:183], v[148:151], a[172:175]
  ds_read_b128 v[84:87], v8 offset:8448
  v_mfma_f32_16x16x32_bf16 a[180:183], v[184:187], v[148:151], a[180:183]
  v_mfma_f32_16x16x32_bf16 a[188:191], v[188:191], v[148:151], a[188:191]
  ds_read_b128 v[88:91], v8 offset:12288
  v_mfma_f32_16x16x32_bf16 a[192:195], v[160:163], v[152:155], a[192:195]
  buffer_load_dwordx4 v7, s[8:11], s17 offen offset:3072 lds
  v_mfma_f32_16x16x32_bf16 a[200:203], v[164:167], v[152:155], a[200:203]
  ds_read_b128 v[92:95], v8 offset:12544
  v_mfma_f32_16x16x32_bf16 a[208:211], v[168:171], v[152:155], a[208:211]
  s_add_u32 s17, s17, s18
  v_mfma_f32_16x16x32_bf16 a[216:219], v[172:175], v[152:155], a[216:219]
  v_mfma_f32_16x16x32_bf16 a[224:227], v[176:179], v[152:155], a[224:227]
  v_mfma_f32_16x16x32_bf16 a[232:235], v[180:183], v[152:155], a[232:235]
  v_mfma_f32_16x16x32_bf16 a[240:243], v[184:187], v[152:155], a[240:243]
  v_mfma_f32_16x16x32_bf16 a[248:251], v[188:191], v[152:155], a[248:251]
  v_mfma_f32_16x16x32_bf16 a[196:199], v[160:163], v[156:159], a[196:199]
  v_mfma_f32_16x16x32_bf16 a[204:207], v[164:167], v[156:159], a[204:207]
  v_mfma_f32_16x16x32_bf16 a[212:215], v[168:171], v[156:159], a[212:215]
  v_mfma_f32_16x16x32_bf16 a[220:223], v[172:175], v[156:159], a[220:223]
  v_mfma_f32_16x16x32_bf16 a[228:231], v[176:179], v[156:159], a[228:231]
  v_mfma_f32_16x16x32_bf16 a[236:239], v[180:183], v[156:159], a[236:239]
  v_mfma_f32_16x16x32_bf16 a[244:247], v[184:187], v[156:159], a[244:247]
  v_mfma_f32_16x16x32_bf16 a[252:255], v[188:191], v[156:159], a[252:255]
  s_cmp_lg_u32 s19, 0
  s_cbranch_scc1 .gm35
  s_branch .gm35e
.gm35s:
  s_mov_b32 s55, 0
  s_cmp_lg_u32 s23, 0
  s_cbranch_scc1 .sg36
  v_mov_b32 v18, 4
  s_mov_b64 exec, 1
  buffer_atomic_add v18, off, s[96:99], s54 sc1
  s_mov_b64 exec, -1
.sg36:
  s_branch .gm35r
.gm35e:
  s_waitcnt vmcnt(0) lgkmcnt(0)
  s_nop 7
  s_branch .g_me
.g_mv:
  ds_read_b128 v[64:67], v8 offset:0
  ds_read_b64_tr_b16 v[96:97], v192 offset:0
  ds_read_b64_tr_b16 v[98:99], v192 offset:2048
  ds_read_b64_tr_b16 v[100:101], v193 offset:0
  ds_read_b64_tr_b16 v[102:103], v193 offset:2048
  ds_read_b64_tr_b16 v[104:105], v194 offset:0
  ds_read_b64_tr_b16 v[106:107], v194 offset:2048
  ds_read_b64_tr_b16 v[108:109], v195 offset:0
  ds_read_b64_tr_b16 v[110:111], v195 offset:2048
  ds_read_b64_tr_b16 v[112:113], v196 offset:0
  ds_read_b64_tr_b16 v[114:115], v196 offset:2048
  ds_read_b64_tr_b16 v[116:117], v197 offset:0
  ds_read_b64_tr_b16 v[118:119], v197 offset:2048
  ds_read_b64_tr_b16 v[120:121], v198 offset:0
  ds_read_b64_tr_b16 v[122:123], v198 offset:2048
  ds_read_b64_tr_b16 v[124:125], v199 offset:0
  ds_read_b64_tr_b16 v[126:127], v199 offset:2048
  ds_read_b128 v[68:71], v8 offset:256
  ds_read_b128 v[72:75], v8 offset:4096
  ds_read_b128 v[76:79], v8 offset:4352
  ds_read_b128 v[80:83], v8 offset:8192
  ds_read_b128 v[84:87], v8 offset:8448
  ds_read_b128 v[88:91], v8 offset:12288
  ds_read_b128 v[92:95], v8 offset:12544
.gm37:
  s_sub_u32 s19, s19, 1
  s_waitcnt lgkmcnt(0)
  v_mfma_f32_16x16x32_bf16 a[0:3], v[64:67], v[96:99], a[0:3]
  s_cmp_lg_u32 s55, 0
  s_cbranch_scc1 .gm37w0
  s_waitcnt vmcnt(16)
.gm37w0:
  v_mfma_f32_16x16x32_bf16 a[4:7], v[64:67], v[100:103], a[4:7]
  s_barrier
  v_mfma_f32_16x16x32_bf16 a[16:19], v[64:67], v[104:107], a[16:19]
  s_cmp_eq_u32 s19, 0
  s_cselect_b32 s6, 0, s6
  s_cselect_b32 s10, 0, s10
  v_mfma_f32_16x16x32_bf16 a[20:23], v[64:67], v[108:111], a[20:23]
  ds_read_b128 v[128:131], v8 offset:32768
  v_mfma_f32_16x16x32_bf16 a[32:35], v[64:67], v[112:115], a[32:35]
  s_add_u32 m0, s24, 0
  v_mfma_f32_16x16x32_bf16 a[36:39], v[64:67], v[116:119], a[36:39]
  ds_read_b64_tr_b16 v[160:161], v192 offset:32768
  v_mfma_f32_16x16x32_bf16 a[48:51], v[64:67], v[120:123], a[48:51]
  buffer_load_dwordx4 v2, s[4:7], s16 offen offset:0 lds
  v_mfma_f32_16x16x32_bf16 a[52:55], v[64:67], v[124:127], a[52:55]
  ds_read_b64_tr_b16 v[162:163], v192 offset:34816
  v_mfma_f32_16x16x32_bf16 a[8:11], v[68:71], v[96:99], a[8:11]
  v_mfma_f32_16x16x32_bf16 a[12:15], v[68:71], v[100:103], a[12:15]
  ds_read_b64_tr_b16 v[164:165], v193 offset:32768
  v_mfma_f32_16x16x32_bf16 a[24:27], v[68:71], v[104:107], a[24:27]
  v_mfma_f32_16x16x32_bf16 a[28:31], v[68:71], v[108:111], a[28:31]
  ds_read_b64_tr_b16 v[166:167], v193 offset:34816
  v_mfma_f32_16x16x32_bf16 a[40:43], v[68:71], v[112:115], a[40:43]
  buffer_load_dwordx4 v2, s[4:7], s16 offen offset:1024 lds
  v_mfma_f32_16x16x32_bf16 a[44:47], v[68:71], v[116:119], a[44:47]
  ds_read_b64_tr_b16 v[168:169], v194 offset:32768
  v_mfma_f32_16x16x32_bf16 a[56:59], v[68:71], v[120:123], a[56:59]
  v_mfma_f32_16x16x32_bf16 a[60:63], v[68:71], v[124:127], a[60:63]
  ds_read_b64_tr_b16 v[170:171], v194 offset:34816
  v_mfma_f32_16x16x32_bf16 a[64:67], v[72:75], v[96:99], a[64:67]
  v_mfma_f32_16x16x32_bf16 a[68:71], v[72:75], v[100:103], a[68:71]
  ds_read_b64_tr_b16 v[172:173], v195 offset:32768
  v_mfma_f32_16x16x32_bf16 a[80:83], v[72:75], v[104:107], a[80:83]
  buffer_load_dwordx4 v3, s[4:7], s16 offen offset:2048 lds
  v_mfma_f32_16x16x32_bf16 a[84:87], v[72:75], v[108:111], a[84:87]
  ds_read_b64_tr_b16 v[174:175], v195 offset:34816
  v_mfma_f32_16x16x32_bf16 a[96:99], v[72:75], v[112:115], a[96:99]
  v_mfma_f32_16x16x32_bf16 a[100:103], v[72:75], v[116:119], a[100:103]
  ds_read_b64_tr_b16 v[176:177], v196 offset:32768
  v_mfma_f32_16x16x32_bf16 a[112:115], v[72:75], v[120:123], a[112:115]
  v_mfma_f32_16x16x32_bf16 a[116:119], v[72:75], v[124:127], a[116:119]
  ds_read_b64_tr_b16 v[178:179], v196 offset:34816
  v_mfma_f32_16x16x32_bf16 a[72:75], v[76:79], v[96:99], a[72:75]
  buffer_load_dwordx4 v3, s[4:7], s16 offen offset:3072 lds
  v_mfma_f32_16x16x32_bf16 a[76:79], v[76:79], v[100:103], a[76:79]
  ds_read_b64_tr_b16 v[180:181], v197 offset:32768
  v_mfma_f32_16x16x32_bf16 a[88:91], v[76:79], v[104:107], a[88:91]
  s_add_u32 s16, s16, 2048
  v_mfma_f32_16x16x32_bf16 a[92:95], v[76:79], v[108:111], a[92:95]
  ds_read_b64_tr_b16 v[182:183], v197 offset:34816
  v_mfma_f32_16x16x32_bf16 a[104:107], v[76:79], v[112:115], a[104:107]
  s_add_u32 m0, s25, 0
  v_mfma_f32_16x16x32_bf16 a[108:111], v[76:79], v[116:119], a[108:111]
  ds_read_b64_tr_b16 v[184:185], v198 offset:32768
  v_mfma_f32_16x16x32_bf16 a[120:123], v[76:79], v[120:123], a[120:123]
  buffer_load_dwordx4 v4, s[8:11], s17 offen offset:0 lds
  v_mfma_f32_16x16x32_bf16 a[124:127], v[76:79], v[124:127], a[124:127]
  ds_read_b64_tr_b16 v[186:187], v198 offset:34816
  v_mfma_f32_16x16x32_bf16 a[128:131], v[80:83], v[96:99], a[128:131]
  v_mfma_f32_16x16x32_bf16 a[132:135], v[80:83], v[100:103], a[132:135]
  ds_read_b64_tr_b16 v[188:189], v199 offset:32768
  v_mfma_f32_16x16x32_bf16 a[144:147], v[80:83], v[104:107], a[144:147]
  v_mfma_f32_16x16x32_bf16 a[148:151], v[80:83], v[108:111], a[148:151]
  ds_read_b64_tr_b16 v[190:191], v199 offset:34816
  v_mfma_f32_16x16x32_bf16 a[160:163], v[80:83], v[112:115], a[160:163]
  buffer_load_dwordx4 v5, s[8:11], s17 offen offset:1024 lds
  v_mfma_f32_16x16x32_bf16 a[164:167], v[80:83], v[116:119], a[164:167]
  ds_read_b128 v[132:135], v8 offset:33024
  v_mfma_f32_16x16x32_bf16 a[176:179], v[80:83], v[120:123], a[176:179]
  v_mfma_f32_16x16x32_bf16 a[180:183], v[80:83], v[124:127], a[180:183]
  ds_read_b128 v[136:139], v8 offset:36864
  v_mfma_f32_16x16x32_bf16 a[136:139], v[84:87], v[96:99], a[136:139]
  v_mfma_f32_16x16x32_bf16 a[140:143], v[84:87], v[100:103], a[140:143]
  ds_read_b128 v[140:143], v8 offset:37120
  v_mfma_f32_16x16x32_bf16 a[152:155], v[84:87], v[104:107], a[152:155]
  buffer_load_dwordx4 v6, s[8:11], s17 offen offset:2048 lds
  v_mfma_f32_16x16x32_bf16 a[156:159], v[84:87], v[108:111], a[156:159]
  ds_read_b128 v[144:147], v8 offset:40960
  v_mfma_f32_16x16x32_bf16 a[168:171], v[84:87], v[112:115], a[168:171]
  v_mfma_f32_16x16x32_bf16 a[172:175], v[84:87], v[116:119], a[172:175]
  ds_read_b128 v[148:151], v8 offset:41216
  v_mfma_f32_16x16x32_bf16 a[184:187], v[84:87], v[120:123], a[184:187]
  v_mfma_f32_16x16x32_bf16 a[188:191], v[84:87], v[124:127], a[188:191]
  ds_read_b128 v[152:155], v8 offset:45056
  v_mfma_f32_16x16x32_bf16 a[192:195], v[88:91], v[96:99], a[192:195]
  buffer_load_dwordx4 v7, s[8:11], s17 offen offset:3072 lds
  v_mfma_f32_16x16x32_bf16 a[196:199], v[88:91], v[100:103], a[196:199]
  ds_read_b128 v[156:159], v8 offset:45312
  v_mfma_f32_16x16x32_bf16 a[208:211], v[88:91], v[104:107], a[208:211]
  s_add_u32 s17, s17, s18
  v_mfma_f32_16x16x32_bf16 a[212:215], v[88:91], v[108:111], a[212:215]
  v_mfma_f32_16x16x32_bf16 a[224:227], v[88:91], v[112:115], a[224:227]
  v_mfma_f32_16x16x32_bf16 a[228:231], v[88:91], v[116:119], a[228:231]
  v_mfma_f32_16x16x32_bf16 a[240:243], v[88:91], v[120:123], a[240:243]
  v_mfma_f32_16x16x32_bf16 a[244:247], v[88:91], v[124:127], a[244:247]
  v_mfma_f32_16x16x32_bf16 a[200:203], v[92:95], v[96:99], a[200:203]
  v_mfma_f32_16x16x32_bf16 a[204:207], v[92:95], v[100:103], a[204:207]
  v_mfma_f32_16x16x32_bf16 a[216:219], v[92:95], v[104:107], a[216:219]
  v_mfma_f32_16x16x32_bf16 a[220:223], v[92:95], v[108:111], a[220:223]
  v_mfma_f32_16x16x32_bf16 a[232:235], v[92:95], v[112:115], a[232:235]
  v_mfma_f32_16x16x32_bf16 a[236:239], v[92:95], v[116:119], a[236:239]
  v_mfma_f32_16x16x32_bf16 a[248:251], v[92:95], v[120:123], a[248:251]
  v_mfma_f32_16x16x32_bf16 a[252:255], v[92:95], v[124:127], a[252:255]
  s_waitcnt lgkmcnt(0)
  v_mfma_f32_16x16x32_bf16 a[0:3], v[128:131], v[160:163], a[0:3]
  s_cmp_lg_u32 s55, 0
  s_cbranch_scc1 .gm37w1
  s_waitcnt vmcnt(16)
.gm37w1:
  v_mfma_f32_16x16x32_bf16 a[4:7], v[128:131], v[164:167], a[4:7]
  s_barrier
  v_mfma_f32_16x16x32_bf16 a[16:19], v[128:131], v[168:171], a[16:19]
  v_mfma_f32_16x16x32_bf16 a[20:23], v[128:131], v[172:175], a[20:23]
  ds_read_b128 v[64:67], v9 offset:0
  v_mfma_f32_16x16x32_bf16 a[32:35], v[128:131], v[176:179], a[32:35]
  s_add_u32 m0, s24, 32768
  v_mfma_f32_16x16x32_bf16 a[36:39], v[128:131], v[180:183], a[36:39]
  ds_read_b64_tr_b16 v[96:97], v200 offset:0
  v_mfma_f32_16x16x32_bf16 a[48:51], v[128:131], v[184:187], a[48:51]
  buffer_load_dwordx4 v2, s[4:7], s16 offen offset:0 lds
  v_mfma_f32_16x16x32_bf16 a[52:55], v[128:131], v[188:191], a[52:55]
  ds_read_b64_tr_b16 v[98:99], v200 offset:2048
  v_mfma_f32_16x16x32_bf16 a[8:11], v[132:135], v[160:163], a[8:11]
  v_mfma_f32_16x16x32_bf16 a[12:15], v[132:135], v[164:167], a[12:15]
  ds_read_b64_tr_b16 v[100:101], v201 offset:0
  v_mfma_f32_16x16x32_bf16 a[24:27], v[132:135], v[168:171], a[24:27]
  v_mfma_f32_16x16x32_bf16 a[28:31], v[132:135], v[172:175], a[28:31]
  ds_read_b64_tr_b16 v[102:103], v201 offset:2048
  v_mfma_f32_16x16x32_bf16 a[40:43], v[132:135], v[176:179], a[40:43]
  buffer_load_dwordx4 v2, s[4:7], s16 offen offset:1024 lds
  v_mfma_f32_16x16x32_bf16 a[44:47], v[132:135], v[180:183], a[44:47]
  ds_read_b64_tr_b16 v[104:105], v202 offset:0
  v_mfma_f32_16x16x32_bf16 a[56:59], v[132:135], v[184:187], a[56:59]
  v_mfma_f32_16x16x32_bf16 a[60:63], v[132:135], v[188:191], a[60:63]
  ds_read_b64_tr_b16 v[106:107], v202 offset:2048
  v_mfma_f32_16x16x32_bf16 a[64:67], v[136:139], v[160:163], a[64:67]
  v_mfma_f32_16x16x32_bf16 a[68:71], v[136:139], v[164:167], a[68:71]
  ds_read_b64_tr_b16 v[108:109], v203 offset:0
  v_mfma_f32_16x16x32_bf16 a[80:83], v[136:139], v[168:171], a[80:83]
  buffer_load_dwordx4 v3, s[4:7], s16 offen offset:2048 lds
  v_mfma_f32_16x16x32_bf16 a[84:87], v[136:139], v[172:175], a[84:87]
  ds_read_b64_tr_b16 v[110:111], v203 offset:2048
  v_mfma_f32_16x16x32_bf16 a[96:99], v[136:139], v[176:179], a[96:99]
  v_mfma_f32_16x16x32_bf16 a[100:103], v[136:139], v[180:183], a[100:103]
  ds_read_b64_tr_b16 v[112:113], v204 offset:0
  v_mfma_f32_16x16x32_bf16 a[112:115], v[136:139], v[184:187], a[112:115]
  v_mfma_f32_16x16x32_bf16 a[116:119], v[136:139], v[188:191], a[116:119]
  ds_read_b64_tr_b16 v[114:115], v204 offset:2048
  v_mfma_f32_16x16x32_bf16 a[72:75], v[140:143], v[160:163], a[72:75]
  buffer_load_dwordx4 v3, s[4:7], s16 offen offset:3072 lds
  v_mfma_f32_16x16x32_bf16 a[76:79], v[140:143], v[164:167], a[76:79]
  ds_read_b64_tr_b16 v[116:117], v205 offset:0
  v_mfma_f32_16x16x32_bf16 a[88:91], v[140:143], v[168:171], a[88:91]
  s_add_u32 s16, s16, 2048
  v_mfma_f32_16x16x32_bf16 a[92:95], v[140:143], v[172:175], a[92:95]
  ds_read_b64_tr_b16 v[118:119], v205 offset:2048
  v_mfma_f32_16x16x32_bf16 a[104:107], v[140:143], v[176:179], a[104:107]
  s_add_u32 m0, s25, 32768
  v_mfma_f32_16x16x32_bf16 a[108:111], v[140:143], v[180:183], a[108:111]
  ds_read_b64_tr_b16 v[120:121], v206 offset:0
  v_mfma_f32_16x16x32_bf16 a[120:123], v[140:143], v[184:187], a[120:123]
  buffer_load_dwordx4 v4, s[8:11], s17 offen offset:0 lds
  v_mfma_f32_16x16x32_bf16 a[124:127], v[140:143], v[188:191], a[124:127]
  ds_read_b64_tr_b16 v[122:123], v206 offset:2048
  v_mfma_f32_16x16x32_bf16 a[128:131], v[144:147], v[160:163], a[128:131]
  v_mfma_f32_16x16x32_bf16 a[132:135], v[144:147], v[164:167], a[132:135]
  ds_read_b64_tr_b16 v[124:125], v207 offset:0
  v_mfma_f32_16x16x32_bf16 a[144:147], v[144:147], v[168:171], a[144:147]
  v_mfma_f32_16x16x32_bf16 a[148:151], v[144:147], v[172:175], a[148:151]
  ds_read_b64_tr_b16 v[126:127], v207 offset:2048
  v_mfma_f32_16x16x32_bf16 a[160:163], v[144:147], v[176:179], a[160:163]
  buffer_load_dwordx4 v5, s[8:11], s17 offen offset:1024 lds
  v_mfma_f32_16x16x32_bf16 a[164:167], v[144:147], v[180:183], a[164:167]
  ds_read_b128 v[68:71], v9 offset:256
  v_mfma_f32_16x16x32_bf16 a[176:179], v[144:147], v[184:187], a[176:179]
  v_mfma_f32_16x16x32_bf16 a[180:183], v[144:147], v[188:191], a[180:183]
  ds_read_b128 v[72:75], v9 offset:4096
  v_mfma_f32_16x16x32_bf16 a[136:139], v[148:151], v[160:163], a[136:139]
  v_mfma_f32_16x16x32_bf16 a[140:143], v[148:151], v[164:167], a[140:143]
  ds_read_b128 v[76:79], v9 offset:4352
  v_mfma_f32_16x16x32_bf16 a[152:155], v[148:151], v[168:171], a[152:155]
  buffer_load_dwordx4 v6, s[8:11], s17 offen offset:2048 lds
  v_mfma_f32_16x16x32_bf16 a[156:159], v[148:151], v[172:175], a[156:159]
  ds_read_b128 v[80:83], v9 offset:8192
  v_mfma_f32_16x16x32_bf16 a[168:171], v[148:151], v[176:179], a[168:171]
  v_mfma_f32_16x16x32_bf16 a[172:175], v[148:151], v[180:183], a[172:175]
  ds_read_b128 v[84:87], v9 offset:8448
  v_mfma_f32_16x16x32_bf16 a[184:187], v[148:151], v[184:187], a[184:187]
  v_mfma_f32_16x16x32_bf16 a[188:191], v[148:151], v[188:191], a[188:191]
  ds_read_b128 v[88:91], v9 offset:12288
  v_mfma_f32_16x16x32_bf16 a[192:195], v[152:155], v[160:163], a[192:195]
  buffer_load_dwordx4 v7, s[8:11], s17 offen offset:3072 lds
  v_mfma_f32_16x16x32_bf16 a[196:199], v[152:155], v[164:167], a[196:199]
  ds_read_b128 v[92:95], v9 offset:12544
  v_mfma_f32_16x16x32_bf16 a[208:211], v[152:155], v[168:171], a[208:211]
  s_add_u32 s17, s17, s18
  v_mfma_f32_16x16x32_bf16 a[212:215], v[152:155], v[172:175], a[212:215]
  v_mfma_f32_16x16x32_bf16 a[224:227], v[152:155], v[176:179], a[224:227]
  v_mfma_f32_16x16x32_bf16 a[228:231], v[152:155], v[180:183], a[228:231]
  v_mfma_f32_16x16x32_bf16 a[240:243], v[152:155], v[184:187], a[240:243]
  v_mfma_f32_16x16x32_bf16 a[244:247], v[152:155], v[188:191], a[244:247]
  v_mfma_f32_16x16x32_bf16 a[200:203], v[156:159], v[160:163], a[200:203]
  v_mfma_f32_16x16x32_bf16 a[204:207], v[156:159], v[164:167], a[204:207]
  v_mfma_f32_16x16x32_bf16 a[216:219], v[156:159], v[168:171], a[216:219]
  v_mfma_f32_16x16x32_bf16 a[220:223], v[156:159], v[172:175], a[220:223]
  v_mfma_f32_16x16x32_bf16 a[232:235], v[156:159], v[176:179], a[232:235]
  v_mfma_f32_16x16x32_bf16 a[236:239], v[156:159], v[180:183], a[236:239]
  v_mfma_f32_16x16x32_bf16 a[248:251], v[156:159], v[184:187], a[248:251]
  v_mfma_f32_16x16x32_bf16 a[252:255], v[156:159], v[188:191], a[252:255]
  s_waitcnt lgkmcnt(0)
  v_mfma_f32_16x16x32_bf16 a[0:3], v[64:67], v[96:99], a[0:3]
  s_cmp_lg_u32 s55, 0
  s_cbranch_scc1 .gm37w2
  s_waitcnt vmcnt(16)
.gm37w2:
  v_mfma_f32_16x16x32_bf16 a[4:7], v[64:67], v[100:103], a[4:7]
  s_barrier
  v_mfma_f32_16x16x32_bf16 a[16:19], v[64:67], v[104:107], a[16:19]
  v_mfma_f32_16x16x32_bf16 a[20:23], v[64:67], v[108:111], a[20:23]
  ds_read_b128 v[128:131], v9 offset:32768
  v_mfma_f32_16x16x32_bf16 a[32:35], v[64:67], v[112:115], a[32:35]
  s_add_u32 m0, s24, 65536
  v_mfma_f32_16x16x32_bf16 a[36:39], v[64:67], v[116:119], a[36:39]
  ds_read_b64_tr_b16 v[160:161], v200 offset:32768
  v_mfma_f32_16x16x32_bf16 a[48:51], v[64:67], v[120:123], a[48:51]
  buffer_load_dwordx4 v2, s[4:7], s16 offen offset:0 lds
  v_mfma_f32_16x16x32_bf16 a[52:55], v[64:67], v[124:127], a[52:55]
  ds_read_b64_tr_b16 v[162:163], v200 offset:34816
  v_mfma_f32_16x16x32_bf16 a[8:11], v[68:71], v[96:99], a[8:11]
  v_mfma_f32_16x16x32_bf16 a[12:15], v[68:71], v[100:103], a[12:15]
  ds_read_b64_tr_b16 v[164:165], v201 offset:32768
  v_mfma_f32_16x16x32_bf16 a[24:27], v[68:71], v[104:107], a[24:27]
  v_mfma_f32_16x16x32_bf16 a[28:31], v[68:71], v[108:111], a[28:31]
  ds_read_b64_tr_b16 v[166:167], v201 offset:34816
  v_mfma_f32_16x16x32_bf16 a[40:43], v[68:71], v[112:115], a[40:43]
  buffer_load_dwordx4 v2, s[4:7], s16 offen offset:1024 lds
  v_mfma_f32_16x16x32_bf16 a[44:47], v[68:71], v[116:119], a[44:47]
  ds_read_b64_tr_b16 v[168:169], v202 offset:32768
  v_mfma_f32_16x16x32_bf16 a[56:59], v[68:71], v[120:123], a[56:59]
  v_mfma_f32_16x16x32_bf16 a[60:63], v[68:71], v[124:127], a[60:63]
  ds_read_b64_tr_b16 v[170:171], v202 offset:34816
  v_mfma_f32_16x16x32_bf16 a[64:67], v[72:75], v[96:99], a[64:67]
  v_mfma_f32_16x16x32_bf16 a[68:71], v[72:75], v[100:103], a[68:71]
  ds_read_b64_tr_b16 v[172:173], v203 offset:32768
  v_mfma_f32_16x16x32_bf16 a[80:83], v[72:75], v[104:107], a[80:83]
  buffer_load_dwordx4 v3, s[4:7], s16 offen offset:2048 lds
  v_mfma_f32_16x16x32_bf16 a[84:87], v[72:75], v[108:111], a[84:87]
  ds_read_b64_tr_b16 v[174:175], v203 offset:34816
  v_mfma_f32_16x16x32_bf16 a[96:99], v[72:75], v[112:115], a[96:99]
  v_mfma_f32_16x16x32_bf16 a[100:103], v[72:75], v[116:119], a[100:103]
  ds_read_b64_tr_b16 v[176:177], v204 offset:32768
  v_mfma_f32_16x16x32_bf16 a[112:115], v[72:75], v[120:123], a[112:115]
  v_mfma_f32_16x16x32_bf16 a[116:119], v[72:75], v[124:127], a[116:119]
  ds_read_b64_tr_b16 v[178:179], v204 offset:34816
  v_mfma_f32_16x16x32_bf16 a[72:75], v[76:79], v[96:99], a[72:75]
  buffer_load_dwordx4 v3, s[4:7], s16 offen offset:3072 lds
  v_mfma_f32_16x16x32_bf16 a[76:79], v[76:79], v[100:103], a[76:79]
  ds_read_b64_tr_b16 v[180:181], v205 offset:32768
  v_mfma_f32_16x16x32_bf16 a[88:91], v[76:79], v[104:107], a[88:91]
  s_add_u32 s16, s16, 2048
  v_mfma_f32_16x16x32_bf16 a[92:95], v[76:79], v[108:111], a[92:95]
  ds_read_b64_tr_b16 v[182:183], v205 offset:34816
  v_mfma_f32_16x16x32_bf16 a[104:107], v[76:79], v[112:115], a[104:107]
  s_add_u32 m0, s25, 65536
  v_mfma_f32_16x16x32_bf16 a[108:111], v[76:79], v[116:119], a[108:111]
  ds_read_b64_tr_b16 v[184:185], v206 offset:32768
  v_mfma_f32_16x16x32_bf16 a[120:123], v[76:79], v[120:123], a[120:123]
  buffer_load_dwordx4 v4, s[8:11], s17 offen offset:0 lds
  v_mfma_f32_16x16x32_bf16 a[124:127], v[76:79], v[124:127], a[124:127]
  ds_read_b64_tr_b16 v[186:187], v206 offset:34816
  v_mfma_f32_16x16x32_bf16 a[128:131], v[80:83], v[96:99], a[128:131]
  v_mfma_f32_16x16x32_bf16 a[132:135], v[80:83], v[100:103], a[132:135]
  ds_read_b64_tr_b16 v[188:189], v207 offset:32768
  v_mfma_f32_16x16x32_bf16 a[144:147], v[80:83], v[104:107], a[144:147]
  v_mfma_f32_16x16x32_bf16 a[148:151], v[80:83], v[108:111], a[148:151]
  ds_read_b64_tr_b16 v[190:191], v207 offset:34816
  v_mfma_f32_16x16x32_bf16 a[160:163], v[80:83], v[112:115], a[160:163]
  buffer_load_dwordx4 v5, s[8:11], s17 offen offset:1024 lds
  v_mfma_f32_16x16x32_bf16 a[164:167], v[80:83], v[116:119], a[164:167]
  ds_read_b128 v[132:135], v9 offset:33024
  v_mfma_f32_16x16x32_bf16 a[176:179], v[80:83], v[120:123], a[176:179]
  v_mfma_f32_16x16x32_bf16 a[180:183], v[80:83], v[124:127], a[180:183]
  ds_read_b128 v[136:139], v9 offset:36864
  v_mfma_f32_16x16x32_bf16 a[136:139], v[84:87], v[96:99], a[136:139]
  v_mfma_f32_16x16x32_bf16 a[140:143], v[84:87], v[100:103], a[140:143]
  ds_read_b128 v[140:143], v9 offset:37120
  v_mfma_f32_16x16x32_bf16 a[152:155], v[84:87], v[104:107], a[152:155]
  buffer_load_dwordx4 v6, s[8:11], s17 offen offset:2048 lds
  v_mfma_f32_16x16x32_bf16 a[156:159], v[84:87], v[108:111], a[156:159]
  ds_read_b128 v[144:147], v9 offset:40960
  v_mfma_f32_16x16x32_bf16 a[168:171], v[84:87], v[112:115], a[168:171]
  v_mfma_f32_16x16x32_bf16 a[172:175], v[84:87], v[116:119], a[172:175]
  ds_read_b128 v[148:151], v9 offset:41216
  v_mfma_f32_16x16x32_bf16 a[184:187], v[84:87], v[120:123], a[184:187]
  v_mfma_f32_16x16x32_bf16 a[188:191], v[84:87], v[124:127], a[188:191]
  ds_read_b128 v[152:155], v9 offset:45056
  v_mfma_f32_16x16x32_bf16 a[192:195], v[88:91], v[96:99], a[192:195]
  buffer_load_dwordx4 v7, s[8:11], s17 offen offset:3072 lds
  v_mfma_f32_16x16x32_bf16 a[196:199], v[88:91], v[100:103], a[196:199]
  ds_read_b128 v[156:159], v9 offset:45312
  v_mfma_f32_16x16x32_bf16 a[208:211], v[88:91], v[104:107], a[208:211]
  s_add_u32 s17, s17, s18
  v_mfma_f32_16x16x32_bf16 a[212:215], v[88:91], v[108:111], a[212:215]
  v_mfma_f32_16x16x32_bf16 a[224:227], v[88:91], v[112:115], a[224:227]
  v_mfma_f32_16x16x32_bf16 a[228:231], v[88:91], v[116:119], a[228:231]
  v_mfma_f32_16x16x32_bf16 a[240:243], v[88:91], v[120:123], a[240:243]
  v_mfma_f32_16x16x32_bf16 a[244:247], v[88:91], v[124:127], a[244:247]
  v_mfma_f32_16x16x32_bf16 a[200:203], v[92:95], v[96:99], a[200:203]
  v_mfma_f32_16x16x32_bf16 a[204:207], v[92:95], v[100:103], a[204:207]
  v_mfma_f32_16x16x32_bf16 a[216:219], v[92:95], v[104:107], a[216:219]
  v_mfma_f32_16x16x32_bf16 a[220:223], v[92:95], v[108:111], a[220:223]
  v_mfma_f32_16x16x32_bf16 a[232:235], v[92:95], v[112:115], a[232:235]
  v_mfma_f32_16x16x32_bf16 a[236:239], v[92:95], v[116:119], a[236:239]
  v_mfma_f32_16x16x32_bf16 a[248:251], v[92:95], v[120:123], a[248:251]
  v_mfma_f32_16x16x32_bf16 a[252:255], v[92:95], v[124:127], a[252:255]
  s_waitcnt lgkmcnt(0)
  v_mfma_f32_16x16x32_bf16 a[0:3], v[128:131], v[160:163], a[0:3]
  s_waitcnt vmcnt(16)
  s_cmp_lg_u32 s55, 0
  v_mfma_f32_16x16x32_bf16 a[4:7], v[128:131], v[164:167], a[4:7]
  s_barrier
  s_cbranch_scc1 .gm37s
.gm37r:
  v_mfma_f32_16x16x32_bf16 a[16:19], v[128:131], v[168:171], a[16:19]
  v_mfma_f32_16x16x32_bf16 a[20:23], v[128:131], v[172:175], a[20:23]
  ds_read_b128 v[64:67], v8 offset:0
  v_mfma_f32_16x16x32_bf16 a[32:35], v[128:131], v[176:179], a[32:35]
  s_add_u32 m0, s24, 98304
  v_mfma_f32_16x16x32_bf16 a[36:39], v[128:131], v[180:183], a[36:39]
  ds_read_b64_tr_b16 v[96:97], v192 offset:0
  v_mfma_f32_16x16x32_bf16 a[48:51], v[128:131], v[184:187], a[48:51]
  buffer_load_dwordx4 v2, s[4:7], s16 offen offset:0 lds
  v_mfma_f32_16x16x32_bf16 a[52:55], v[128:131], v[188:191], a[52:55]
  ds_read_b64_tr_b16 v[98:99], v192 offset:2048
  v_mfma_f32_16x16x32_bf16 a[8:11], v[132:135], v[160:163], a[8:11]
  v_mfma_f32_16x16x32_bf16 a[12:15], v[132:135], v[164:167], a[12:15]
  ds_read_b64_tr_b16 v[100:101], v193 offset:0
  v_mfma_f32_16x16x32_bf16 a[24:27], v[132:135], v[168:171], a[24:27]
  v_mfma_f32_16x16x32_bf16 a[28:31], v[132:135], v[172:175], a[28:31]
  ds_read_b64_tr_b16 v[102:103], v193 offset:2048
  v_mfma_f32_16x16x32_bf16 a[40:43], v[132:135], v[176:179], a[40:43]
  buffer_load_dwordx4 v2, s[4:7], s16 offen offset:1024 lds
  v_mfma_f32_16x16x32_bf16 a[44:47], v[132:135], v[180:183], a[44:47]
  ds_read_b64_tr_b16 v[104:105], v194 offset:0
  v_mfma_f32_16x16x32_bf16 a[56:59], v[132:135], v[184:187], a[56:59]
  v_mfma_f32_16x16x32_bf16 a[60:63], v[132:135], v[188:191], a[60:63]
  ds_read_b64_tr_b16 v[106:107], v194 offset:2048
  v_mfma_f32_16x16x32_bf16 a[64:67], v[136:139], v[160:163], a[64:67]
  v_mfma_f32_16x16x32_bf16 a[68:71], v[136:139], v[164:167], a[68:71]
  ds_read_b64_tr_b16 v[108:109], v195 offset:0
  v_mfma_f32_16x16x32_bf16 a[80:83], v[136:139], v[168:171], a[80:83]
  buffer_load_dwordx4 v3, s[4:7], s16 offen offset:2048 lds
  v_mfma_f32_16x16x32_bf16 a[84:87], v[136:139], v[172:175], a[84:87]
  ds_read_b64_tr_b16 v[110:111], v195 offset:2048
  v_mfma_f32_16x16x32_bf16 a[96:99], v[136:139], v[176:179], a[96:99]
  v_mfma_f32_16x16x32_bf16 a[100:103], v[136:139], v[180:183], a[100:103]
  ds_read_b64_tr_b16 v[112:113], v196 offset:0
  v_mfma_f32_16x16x32_bf16 a[112:115], v[136:139], v[184:187], a[112:115]
  v_mfma_f32_16x16x32_bf16 a[116:119], v[136:139], v[188:191], a[116:119]
  ds_read_b64_tr_b16 v[114:115], v196 offset:2048
  v_mfma_f32_16x16x32_bf16 a[72:75], v[140:143], v[160:163], a[72:75]
  buffer_load_dwordx4 v3, s[4:7], s16 offen offset:3072 lds
  v_mfma_f32_16x16x32_bf16 a[76:79], v[140:143], v[164:167], a[76:79]
  ds_read_b64_tr_b16 v[116:117], v197 offset:0
  v_mfma_f32_16x16x32_bf16 a[88:91], v[140:143], v[168:171], a[88:91]
  s_add_u32 s16, s16, 2048
  v_mfma_f32_16x16x32_bf16 a[92:95], v[140:143], v[172:175], a[92:95]
  ds_read_b64_tr_b16 v[118:119], v197 offset:2048
  v_mfma_f32_16x16x32_bf16 a[104:107], v[140:143], v[176:179], a[104:107]
  s_add_u32 m0, s25, 98304
  v_mfma_f32_16x16x32_bf16 a[108:111], v[140:143], v[180:183], a[108:111]
  ds_read_b64_tr_b16 v[120:121], v198 offset:0
  v_mfma_f32_16x16x32_bf16 a[120:123], v[140:143], v[184:187], a[120:123]
  buffer_load_dwordx4 v4, s[8:11], s17 offen offset:0 lds
  v_mfma_f32_16x16x32_bf16 a[124:127], v[140:143], v[188:191], a[124:127]
  ds_read_b64_tr_b16 v[122:123], v198 offset:2048
  v_mfma_f32_16x16x32_bf16 a[128:131], v[144:147], v[160:163], a[128:131]
  v_mfma_f32_16x16x32_bf16 a[132:135], v[144:147], v[164:167], a[132:135]
  ds_read_b64_tr_b16 v[124:125], v199 offset:0
  v_mfma_f32_16x16x32_bf16 a[144:147], v[144:147], v[168:171], a[144:147]
  v_mfma_f32_16x16x32_bf16 a[148:151], v[144:147], v[172:175], a[148:151]
  ds_read_b64_tr_b16 v[126:127], v199 offset:2048
  v_mfma_f32_16x16x32_bf16 a[160:163], v[144:147], v[176:179], a[160:163]
  buffer_load_dwordx4 v5, s[8:11], s17 offen offset:1024 lds
  v_mfma_f32_16x16x32_bf16 a[164:167], v[144:147], v[180:183], a[164:167]
  ds_read_b128 v[68:71], v8 offset:256
  v_mfma_f32_16x16x32_bf16 a[176:179], v[144:147], v[184:187], a[176:179]
  v_mfma_f32_16x16x32_bf16 a[180:183], v[144:147], v[188:191], a[180:183]
  ds_read_b128 v[72:75], v8 offset:4096
  v_mfma_f32_16x16x32_bf16 a[136:139], v[148:151], v[160:163], a[136:139]
  v_mfma_f32_16x16x32_bf16 a[140:143], v[148:151], v[164:167], a[140:143]
  ds_read_b128 v[76:79], v8 offset:4352
  v_mfma_f32_16x16x32_bf16 a[152:155], v[148:151], v[168:171], a[152:155]
  buffer_load_dwordx4 v6, s[8:11], s17 offen offset:2048 lds
  v_mfma_f32_16x16x32_bf16 a[156:159], v[148:151], v[172:175], a[156:159]
  ds_read_b128 v[80:83], v8 offset:8192
  v_mfma_f32_16x16x32_bf16 a[168:171], v[148:151], v[176:179], a[168:171]
  v_mfma_f32_16x16x32_bf16 a[172:175], v[148:151], v[180:183], a[172:175]
  ds_read_b128 v[84:87], v8 offset:8448
  v_mfma_f32_16x16x32_bf16 a[184:187], v[148:151], v[184:187], a[184:187]
  v_mfma_f32_16x16x32_bf16 a[188:191], v[148:151], v[188:191], a[188:191]
  ds_read_b128 v[88:91], v8 offset:12288
  v_mfma_f32_16x16x32_bf16 a[192:195], v[152:155], v[160:163], a[192:195]
  buffer_load_dwordx4 v7, s[8:11], s17 offen offset:3072 lds
  v_mfma_f32_16x16x32_bf16 a[196:199], v[152:155], v[164:167], a[196:199]
  ds_read_b128 v[92:95], v8 offset:12544
  v_mfma_f32_16x16x32_bf16 a[208:211], v[152:155], v[168:171], a[208:211]
  s_add_u32 s17, s17, s18
  v_mfma_f32_16x16x32_bf16 a[212:215], v[152:155], v[172:175], a[212:215]
  v_mfma_f32_16x16x32_bf16 a[224:227], v[152:155], v[176:179], a[224:227]
  v_mfma_f32_16x16x32_bf16 a[228:231], v[152:155], v[180:183], a[228:231]
  v_mfma_f32_16x16x32_bf16 a[240:243], v[152:155], v[184:187], a[240:243]
  v_mfma_f32_16x16x32_bf16 a[244:247], v[152:155], v[188:191], a[244:247]
  v_mfma_f32_16x16x32_bf16 a[200:203], v[156:159], v[160:163], a[200:203]
  v_mfma_f32_16x16x32_bf16 a[204:207], v[156:159], v[164:167], a[204:207]
  v_mfma_f32_16x16x32_bf16 a[216:219], v[156:159], v[168:171], a[216:219]
  v_mfma_f32_16x16x32_bf16 a[220:223], v[156:159], v[172:175], a[220:223]
  v_mfma_f32_16x16x32_bf16 a[232:235], v[156:159], v[176:179], a[232:235]
  v_mfma_f32_16x16x32_bf16 a[236:239], v[156:159], v[180:183], a[236:239]
  v_mfma_f32_16x16x32_bf16 a[248:251], v[156:159], v[184:187], a[248:251]
  v_mfma_f32_16x16x32_bf16 a[252:255], v[156:159], v[188:191], a[252:255]
  s_cmp_lg_u32 s19, 0
  s_cbranch_scc1 .gm37
  s_branch .gm37e
.gm37s:
  s_mov_b32 s55, 0
  s_cmp_lg_u32 s23, 0
  s_cbranch_scc1 .sg38
  v_mov_b32 v18, 4
  s_mov_b64 exec, 1
  buffer_atomic_add v18, off, s[96:99], s54 sc1
  s_mov_b64 exec, -1
.sg38:
  s_branch .gm37r
.gm37e:
  s_waitcnt vmcnt(0) lgkmcnt(0)
  s_nop 7
.g_me:
  s_mov_b32 s55, 1
  s_add_u32 s48, s48, 1
  s_branch .g_b
  s_endpgm
.section .rodata,"a"
.p2align 6
.amdhsa_kernel gated_mix__memory_aug_recurrent_mem_tr__mixer_channel_mlp__prompt_kernel
  .amdhsa_next_free_vgpr 512
  .amdhsa_next_free_sgpr 102
  .amdhsa_accum_offset 256
  .amdhsa_group_segment_fixed_size 0
  .amdhsa_kernarg_size 128
  .amdhsa_user_sgpr_count 2
  .amdhsa_user_sgpr_kernarg_segment_ptr 1
  .amdhsa_system_sgpr_workgroup_id_x 1
.end_amdhsa_kernel
```
